```python
import torch

def _softmax(x, axis=-1):
    return torch.softmax(x, dim=axis)
def _gelu(x):
    return torch.nn.functional.gelu(x, approximate="tanh")
def _silu(x):
    return torch.nn.functional.silu(x)
def _sigmoid(x):
    return torch.sigmoid(x)
def _layernorm(x, axis=-1, eps=1e-5):
    m = x.mean(dim=axis, keepdim=True)
    v = x.var(dim=axis, keepdim=True, unbiased=False)
    return (x - m) / torch.sqrt(v + eps)
def _scatter_add(tgt, idx, src, axis=0):
    return tgt.clone().index_add_(axis, idx, src)
def _segment_sum(src, seg, n):
    out = torch.zeros((n,) + src.shape[1:], dtype=src.dtype)
    return out.index_add_(0, seg, src)
def _pad(x, pw):
    flat = tuple(v for pair in reversed(pw) for v in pair)
    return torch.nn.functional.pad(x, flat)

kernel_name = 'concat_heads__mha_block_cached__gqa_block_cached__near_ridge'

def setup_inputs():

    _w = (lambda a: (lambda t: t.to(torch.bfloat16) if t.is_floating_point() else t)(torch.as_tensor(a)))
    def _A_setup():
        B, Sq, D = 16, 160, 512
        H, Sk, Dh = 32, 512, 128
        return {
            "x": _w((lambda *s: torch.randn(*s, dtype=torch.bfloat16) * 0.8)(B, Sq, D)),
            "k_cache": _w((lambda *s: torch.randn(*s, dtype=torch.bfloat16) * 0.8)(B, H, Sk, Dh)),
            "v_cache": _w((lambda *s: torch.randn(*s, dtype=torch.bfloat16) * 0.05)(B, H, Sk, Dh)),
            "wq": _w((lambda *s: torch.randn(*s, dtype=torch.bfloat16) * 0.8)(D, H * Dh) * (D ** -0.5)),
            "wo": _w((lambda *s: torch.randn(*s, dtype=torch.bfloat16) * 0.05)(H * Dh, D) * ((H * Dh) ** -0.5)),
        }
    _A_in = _A_setup()

    def _B_setup():
        B, Sq, D = 16, 160, 512
        Hq, Hkv, Sk, Dh = 32, 32, 512, 128
        assert Hq % Hkv == 0, (Hq, Hkv)
        return {
            "x": _w((lambda *s: torch.randn(*s, dtype=torch.bfloat16) * 0.8)(B, Sq, D)),
            "k_cache": _w((lambda *s: torch.randn(*s, dtype=torch.bfloat16) * 0.8)(B, Hkv, Sk, Dh)),
            "v_cache": _w((lambda *s: torch.randn(*s, dtype=torch.bfloat16) * 0.05)(B, Hkv, Sk, Dh)),
            "wq": _w((lambda *s: torch.randn(*s, dtype=torch.bfloat16) * 0.8)(D, Hq * Dh) * (D ** -0.5)),
            "wo": _w((lambda *s: torch.randn(*s, dtype=torch.bfloat16) * 0.05)(Hq * Dh, D) * ((Hq * Dh) ** -0.5)),
        }
    _B_in = _B_setup()

    return {
        "A_x": _A_in["x"],
        "A_k_cache": _A_in["k_cache"],
        "A_v_cache": _A_in["v_cache"],
        "A_wq": _A_in["wq"],
        "A_wo": _A_in["wo"],
        "B_x": _B_in["x"],
        "B_k_cache": _B_in["k_cache"],
        "B_v_cache": _B_in["v_cache"],
        "B_wq": _B_in["wq"],
        "B_wo": _B_in["wo"],
    }

def reference(A_x, A_k_cache, A_v_cache, A_wq, A_wo, B_x, B_k_cache, B_v_cache, B_wq, B_wo):
    def _A_ref(x, k_cache, v_cache, wq, wo):
        B, Sq, D = x.shape
        H, Dh = 32, 128
        q = (lambda x, *d: x.permute(*d))((x @ wq).reshape(B, Sq, H, Dh), 0, 2, 1, 3)
        scores = torch.einsum("bhqd,bhkd->bhqk", q, k_cache) * (Dh ** -0.5)
        p = _softmax(scores, axis=-1)
        o = torch.einsum("bhqk,bhkd->bhqd", p, v_cache)
        return (lambda x, *d: x.permute(*d))(o, 0, 2, 1, 3).reshape(B, Sq, H * Dh) @ wo

    def _B_ref(x, k_cache, v_cache, wq, wo):
        B, Sq, D = x.shape
        Hq, Dh = 32, 128
        Hkv = k_cache.shape[1]
        rep = Hq // Hkv
        q = (lambda x, *d: x.permute(*d))((x @ wq).reshape(B, Sq, Hq, Dh), 0, 2, 1, 3)
        k = (lambda x, n, axis: torch.repeat_interleave(x, n, dim=axis))(k_cache, rep, axis=1)
        v = (lambda x, n, axis: torch.repeat_interleave(x, n, dim=axis))(v_cache, rep, axis=1)
        scores = torch.einsum("bhqd,bhkd->bhqk", q, k) * (Dh ** -0.5)
        p = _softmax(scores, axis=-1)
        o = torch.einsum("bhqk,bhkd->bhqd", p, v)
        return (lambda x, *d: x.permute(*d))(o, 0, 2, 1, 3).reshape(B, Sq, Hq * Dh) @ wo

    a = _A_ref(A_x, A_k_cache, A_v_cache, A_wq, A_wo)
    b = _B_ref(B_x, B_k_cache, B_v_cache, B_wq, B_wo)
    return torch.concatenate([a, b], axis=-1)
```

```asm
; @launch grid=(256,1,1) block=(256,1,1) lds=163840
.amdgcn_target "amdgcn-amd-amdhsa--gfx950"
.macro M d, a, b, c
v_mfma_f32_16x16x32_bf16 \d, \a, \b, \c
.endm
.text
.globl concat_heads__mha_block_cached__gqa_block_cached__near_ridge_kernel
.p2align 8
.type concat_heads__mha_block_cached__gqa_block_cached__near_ridge_kernel,@function
concat_heads__mha_block_cached__gqa_block_cached__near_ridge_kernel:
s_cmp_ge_u32 s2, 256
s_cbranch_scc1 L_end
s_load_dwordx8 s[4:11], s[0:1], 0
s_getpc_b64 s[28:29]
L_pc:
s_mov_b32 s30, L_codeend-L_pc
s_mov_b32 s31, 0x20000
s_bfe_u32 s62, s2, 0x20003
s_lshl_b32 s62, s62, 15
v_lshlrev_b32 v56, 7, v0
buffer_load_dword a204, v56, s[28:31], s62 offen
s_load_dwordx4 s[12:15], s[0:1], 32
s_load_dwordx8 s[16:23], s[0:1], 48
s_load_dwordx2 s[24:25], s[0:1], 96
s_load_dwordx4 s[96:99], s[0:1], 80
L_main:
v_mov_b32 v85, v0
v_lshrrev_b32 v1, 6, v0
v_and_b32 v2, 63, v0
v_readfirstlane_b32 s3, v1
v_and_b32 v3, 15, v2
v_lshrrev_b32 v4, 4, v2
v_and_b32 v5, 3, v2
v_bfe_u32 v6, v2, 2, 2
v_and_b32 v7, 7, v2
v_lshrrev_b32 v8, 3, v2
s_bfe_u32 s62, s2, 65536
s_lshr_b32 s63, s2, 3
s_bfe_u32 s56, s2, 65537
s_lshl_b32 s56, s56, 2
s_and_b32 s57, s63, 3
s_add_u32 s56, s56, s57
s_bfe_u32 s58, s2, 65538
s_lshl_b32 s58, s58, 3
s_lshr_b32 s59, s63, 2
s_add_u32 s101, s58, s59
s_lshr_b32 s60, s3, 1
s_and_b32 s61, s3, 1
s_lshl_b32 s45, s56, 2
s_add_u32 s45, s45, s60
s_lshl_b32 s46, s61, 12
s_mov_b32 s35, s45
s_lshl_b32 s44, s45, 8
s_lshl_b32 s47, s61, 18
s_add_u32 s33, s44, s47
s_mul_i32 s44, s101, 163840
s_mul_i32 s47, s3, 40960
s_add_u32 s34, s44, s47
s_lshl_b32 s44, s60, 13
s_add_u32 s36, s44, s46
s_mul_i32 s44, s3, 5120
s_add_u32 s37, s44, 32768
s_mul_i32 s47, s60, 18432
s_add_u32 s38, s44, s47
s_add_u32 s38, s38, 53248
s_lshl_b32 s44, s57, 1
s_add_u32 s52, s44, s59
s_add_u32 s44, s3, 0
s_and_b32 s44, s44, 1
s_lshl_b32 s44, s44, 2
v_add_u32 v9, s44, v4
v_xor_b32 v9, v9, v7
v_lshlrev_b32 v9, 4, v9
v_lshl_add_u32 v71, v8, 10, v9
s_add_u32 s44, s3, 1
s_and_b32 s44, s44, 1
s_lshl_b32 s44, s44, 2
v_add_u32 v9, s44, v4
v_xor_b32 v9, v9, v7
v_lshlrev_b32 v9, 4, v9
v_lshl_add_u32 v72, v8, 10, v9
v_and_b32 v9, 1, v4
v_lshlrev_b32 v9, 2, v9
v_xor_b32 v9, v9, v7
v_lshlrev_b32 v9, 4, v9
v_lshl_add_u32 v73, v8, 13, v9
s_waitcnt lgkmcnt(0)
s_cmp_eq_u32 s62, 0
s_cselect_b32 s4, s4, s14
s_cselect_b32 s5, s5, s15
s_cselect_b32 s14, s6, s16
s_cselect_b32 s15, s7, s17
s_cselect_b32 s16, s8, s18
s_cselect_b32 s17, s9, s19
s_cselect_b32 s8, s10, s20
s_cselect_b32 s9, s11, s21
s_cselect_b32 s20, s12, s22
s_cselect_b32 s21, s13, s23
s_mov_b32 s6, 2621440
s_mov_b32 s7, 0x20000
s_mov_b32 s10, 4194304
s_mov_b32 s11, 0x20000
s_lshl_b32 s62, s57, 15
s_add_u32 m0, s37, 0
s_add_u32 s58, s52, 0
s_and_b32 s58, s58, 7
s_mul_i32 s72, s58, 128
s_add_u32 s72, s72, s34
s_add_u32 s44, s72, 0
buffer_load_dwordx4 v71, s[4:7], s44 offen lds
s_add_u32 m0, s37, 1024
s_add_u32 s45, s72, 8192
buffer_load_dwordx4 v72, s[4:7], s45 offen lds
s_add_u32 m0, s37, 2048
s_add_u32 s46, s72, 16384
buffer_load_dwordx4 v71, s[4:7], s46 offen lds
s_add_u32 m0, s37, 3072
s_add_u32 s47, s72, 24576
buffer_load_dwordx4 v72, s[4:7], s47 offen lds
s_add_u32 m0, s37, 4096
s_add_u32 s48, s72, 32768
buffer_load_dwordx4 v71, s[4:7], s48 offen lds
s_add_u32 m0, s36, 131072
s_mul_i32 s64, s58, 524288
s_add_u32 s64, s64, s33
s_add_u32 s49, s64, 0
buffer_load_dwordx4 v73, s[8:11], s49 offen lds
s_add_u32 m0, s36, 132096
s_add_u32 s50, s64, 65536
buffer_load_dwordx4 v73, s[8:11], s50 offen lds
s_add_u32 s58, s52, 1
s_and_b32 s58, s58, 7
s_mul_i32 s65, s58, 524288
s_mul_i32 s73, s58, 128
s_add_u32 s65, s65, s33
s_add_u32 s73, s73, s34
s_add_u32 m0, s36, 133120
s_add_u32 s51, s64, 131072
buffer_load_dwordx4 v73, s[8:11], s51 offen lds
s_add_u32 m0, s36, 134144
s_add_u32 s44, s64, 196608
buffer_load_dwordx4 v73, s[8:11], s44 offen lds
s_add_u32 m0, s36, 147456
s_add_u32 s45, s64, 128
buffer_load_dwordx4 v73, s[8:11], s45 offen lds
s_add_u32 m0, s36, 148480
s_add_u32 s46, s64, 65664
buffer_load_dwordx4 v73, s[8:11], s46 offen lds
s_add_u32 m0, s36, 149504
s_add_u32 s47, s64, 131200
buffer_load_dwordx4 v73, s[8:11], s47 offen lds
s_add_u32 m0, s36, 150528
s_lshl_b32 s41, s101, 5
s_add_u32 s41, s41, s35
s_lshl_b32 s41, s41, 17
s_lshl_b32 s42, s61, 12
s_add_u32 s32, s41, s42
s_lshl_b32 s41, s35, 17
s_lshl_b32 s42, s61, 16
s_add_u32 s35, s41, s42
s_lshl_b32 s39, s36, 1
s_bfe_u32 s41, s2, 65536
s_lshl_b32 s41, s41, 4
s_add_u32 s41, s41, s101
s_lshl_b32 s54, s41, 2
s_lshl_b32 s41, s41, 3
s_add_u32 s41, s41, s56
s_mul_i32 s40, s41, 163840
s_lshl_b32 s41, s3, 2
s_add_u32 s55, s41, 63488
s_add_u32 s53, s56, s59
s_add_u32 s53, s53, 1
s_add_u32 s100, s32, 262144
s_mul_i32 s41, s60, 8
s_mul_i32 s42, s57, 4
s_add_u32 s41, s41, s42
s_mul_i32 s42, s59, 1
s_add_u32 s41, s41, s42
s_mul_i32 s42, s2, 0
s_add_u32 s41, s41, s42
s_and_b32 s41, s41, 15
s_lshl_b32 s43, s41, 13
s_mov_b32 s41, 0x3e0293ee
s_mov_b32 s42, 0x21800000
v_add_u32 v9, 0, v4
v_lshlrev_b32 v9, 1, v9
v_xor_b32 v9, v9, v3
v_lshlrev_b32 v9, 4, v9
v_lshl_add_u32 v69, v4, 8, v9
v_add_u32 v9, 4, v4
v_lshlrev_b32 v9, 1, v9
v_xor_b32 v9, v9, v3
v_lshlrev_b32 v9, 4, v9
v_lshl_add_u32 v70, v4, 8, v9
v_lshlrev_b32 v9, 1, v4
v_xor_b32 v9, v9, v7
v_lshlrev_b32 v9, 4, v9
v_lshl_add_u32 v84, v8, 10, v9
s_mov_b32 s12, s14
s_mov_b32 s13, s15
s_mov_b32 s14, 67108864
s_mov_b32 s15, 0x20000
s_mov_b32 s18, 67108864
s_mov_b32 s19, 0x20000
s_mov_b32 s22, 4194304
s_mov_b32 s23, 0x20000
s_mov_b32 s26, 290455552
s_mov_b32 s27, 0x20000
s_mov_b32 s3, s56
s_add_u32 s48, s64, 196736
buffer_load_dwordx4 v73, s[8:11], s48 offen lds
s_add_u32 m0, s38, 0
s_add_u32 s49, s73, 0
buffer_load_dwordx4 v71, s[4:7], s49 offen lds
s_add_u32 m0, s38, 1024
s_add_u32 s50, s73, 8192
buffer_load_dwordx4 v72, s[4:7], s50 offen lds
s_add_u32 m0, s38, 2048
s_add_u32 s51, s73, 16384
buffer_load_dwordx4 v71, s[4:7], s51 offen lds
s_add_u32 m0, s38, 3072
s_add_u32 s44, s73, 24576
buffer_load_dwordx4 v72, s[4:7], s44 offen lds
s_add_u32 m0, s38, 4096
s_add_u32 s45, s73, 32768
buffer_load_dwordx4 v71, s[4:7], s45 offen lds
v_lshrrev_b32 v10, 1, v3
v_add_u32 v9, 0, v4
v_xor_b32 v9, v9, v10
v_lshlrev_b32 v9, 4, v9
s_mul_i32 s63, s61, 10240
s_mul_i32 s59, s61, 28672
s_add_u32 s63, s63, 32768
s_add_u32 s59, s59, 53248
v_lshl_add_u32 v9, v3, 7, v9
v_add_u32 v80, s63, v9
v_add_u32 v82, s59, v9
v_add_u32 v9, 4, v4
v_xor_b32 v9, v9, v10
v_lshlrev_b32 v9, 4, v9
v_lshl_add_u32 v9, v3, 7, v9
v_lshl_add_u32 v10, v4, 3, v6
s_lshl_b32 s62, s60, 13
v_add_u32 v81, s63, v9
v_add_u32 v83, s59, v9
v_lshlrev_b32 v10, 7, v10
v_lshrrev_b32 v11, 1, v6
v_add_u32 v10, s62, v10
v_lshlrev_b32 v11, 2, v11
v_add_u32 v9, 0, v5
v_add_u32 v10, 98304, v10
v_xor_b32 v9, v9, v11
v_lshl_add_u32 v74, v9, 4, v10
v_add_u32 v9, 4, v5
v_xor_b32 v9, v9, v11
v_lshl_add_u32 v75, v9, 4, v10
s_mov_b64 exec, 0
s_branch L_hop_a0
L_ret_a0:
s_mov_b64 exec, -1
s_mov_b64 exec, 0
s_branch L_hop_a1
L_ret_a1:
s_mov_b64 exec, -1
s_mov_b64 exec, 0
s_branch L_hop_a2
L_ret_a2:
s_mov_b64 exec, -1
s_waitcnt vmcnt(9)
s_barrier
ds_read_b128 a[40:43], v80 offset:0
s_add_u32 s58, s52, 2
ds_read_b64_tr_b16 a[160:161], v74 offset:32768
s_and_b32 s58, s58, 7
s_mul_i32 s66, s58, 524288
s_mul_i32 s74, s58, 128
ds_read_b64_tr_b16 a[162:163], v74 offset:33280
s_add_u32 s66, s66, s33
s_add_u32 s74, s74, s34
s_add_u32 s58, s52, 3
ds_read_b128 a[44:47], v81 offset:0
s_and_b32 s58, s58, 7
s_mul_i32 s67, s58, 524288
s_mul_i32 s75, s58, 128
ds_read_b64_tr_b16 a[164:165], v74 offset:36864
s_add_u32 s67, s67, s33
s_add_u32 s75, s75, s34
s_add_u32 s58, s52, 4
ds_read_b64_tr_b16 a[166:167], v74 offset:37376
s_and_b32 s58, s58, 7
s_mul_i32 s68, s58, 524288
s_mul_i32 s76, s58, 128
ds_read_b128 a[48:51], v80 offset:2048
s_add_u32 s68, s68, s33
s_add_u32 s76, s76, s34
s_add_u32 s58, s52, 5
ds_read_b128 a[52:55], v81 offset:2048
s_and_b32 s58, s58, 7
s_mul_i32 s69, s58, 524288
s_mul_i32 s77, s58, 128
ds_read_b128 a[56:59], v80 offset:4096
s_add_u32 s69, s69, s33
s_add_u32 s77, s77, s34
s_add_u32 s58, s52, 6
ds_read_b128 a[60:63], v81 offset:4096
s_and_b32 s58, s58, 7
s_mul_i32 s70, s58, 524288
s_waitcnt lgkmcnt(7)
M v[96:99], a[160:163], a[40:43], 0
s_waitcnt lgkmcnt(4)
ds_read_b128 a[64:67], v80 offset:6144
ds_read_b128 a[68:71], v81 offset:6144
s_mul_i32 s78, s58, 128
s_add_u32 s70, s70, s33
s_add_u32 s78, s78, s34
ds_read_b128 a[72:75], v80 offset:8192
s_add_u32 m0, s36, 98304
s_add_u32 s46, s65, 0
M v[96:99], a[164:167], a[44:47], v[96:99]
s_waitcnt lgkmcnt(6)
s_add_u32 s58, s52, 7
ds_read_b128 a[76:79], v81 offset:8192
s_and_b32 s58, s58, 7
ds_read_b64_tr_b16 a[168:169], v74 offset:32776
s_mul_i32 s71, s58, 524288
s_mul_i32 s79, s58, 128
s_add_u32 s71, s71, s33
ds_read_b64_tr_b16 a[170:171], v74 offset:33288
M v[100:103], a[160:163], a[48:51], 0
s_waitcnt lgkmcnt(8)
s_add_u32 s79, s79, s34
s_add_u32 s47, s65, 65536
ds_read_b64_tr_b16 a[172:173], v74 offset:36872
buffer_load_dwordx4 v73, s[8:11], s46 offen lds
M v[100:103], a[164:167], a[52:55], v[100:103]
s_waitcnt lgkmcnt(8)
s_add_u32 m0, s36, 99328
ds_read_b64_tr_b16 a[174:175], v74 offset:37384
M v[104:107], a[160:163], a[56:59], 0
s_waitcnt lgkmcnt(8)
ds_read_b64_tr_b16 a[176:177], v75 offset:32768
v_lshlrev_b32 v10, 8, v3
M v[104:107], a[164:167], a[60:63], v[104:107]
s_waitcnt lgkmcnt(8)
buffer_load_dwordx4 v73, s[8:11], s47 offen lds
M v[108:111], a[160:163], a[64:67], 0
s_waitcnt lgkmcnt(7)
s_add_u32 s48, s65, 131072
s_add_u32 m0, s36, 100352
M v[108:111], a[164:167], a[68:71], v[108:111]
s_waitcnt lgkmcnt(6)
ds_read_b64_tr_b16 a[178:179], v75 offset:33280
v_lshlrev_b32 v11, 1, v7
M v[112:115], a[160:163], a[72:75], 0
s_waitcnt lgkmcnt(6)
buffer_load_dwordx4 v73, s[8:11], s48 offen lds
M v[112:115], a[164:167], a[76:79], v[112:115]
s_waitcnt lgkmcnt(4)
s_add_u32 s49, s65, 196608
s_add_u32 m0, s36, 101376
M v[116:119], a[168:171], a[40:43], 0
s_waitcnt lgkmcnt(2)
ds_read_b64_tr_b16 a[180:181], v75 offset:36864
v_add_u32 v9, 0, v4
M v[116:119], a[172:175], a[44:47], v[116:119]
s_add_u32 s50, s65, 128
buffer_load_dwordx4 v73, s[8:11], s49 offen lds
M v[120:123], a[168:171], a[48:51], 0
s_add_u32 m0, s36, 114688
ds_read_b64_tr_b16 a[182:183], v75 offset:37376
v_add_u32 v10, s62, v10
M v[120:123], a[172:175], a[52:55], v[120:123]
s_add_u32 s51, s65, 65664
ds_read_b64_tr_b16 a[184:185], v75 offset:32776
v_xor_b32 v9, v9, v11
M v[124:127], a[168:171], a[56:59], 0
s_add_u32 s44, s65, 131200
buffer_load_dwordx4 v73, s[8:11], s50 offen lds
M v[124:127], a[172:175], a[60:63], v[124:127]
s_add_u32 m0, s36, 115712
ds_read_b64_tr_b16 a[186:187], v75 offset:33288
v_lshl_add_u32 v57, v9, 4, v10
M v[128:131], a[168:171], a[64:67], 0
s_add_u32 s45, s65, 196736
ds_read_b64_tr_b16 a[188:189], v75 offset:36872
v_add_u32 v9, 4, v4
M v[128:131], a[172:175], a[68:71], v[128:131]
s_add_u32 s46, s66, 0
buffer_load_dwordx4 v73, s[8:11], s51 offen lds
M v[132:135], a[168:171], a[72:75], 0
s_add_u32 m0, s36, 116736
ds_read_b64_tr_b16 a[190:191], v75 offset:37384
v_xor_b32 v9, v9, v11
M v[132:135], a[172:175], a[76:79], v[132:135]
s_waitcnt lgkmcnt(6)
v_lshl_add_u32 v58, v9, 4, v10
v_lshl_add_u32 v12, v4, 2, v6
M v[136:139], a[176:179], a[40:43], 0
s_waitcnt lgkmcnt(4)
buffer_load_dwordx4 v73, s[8:11], s44 offen lds
M v[136:139], a[180:183], a[44:47], v[136:139]
s_add_u32 m0, s36, 117760
v_add_u32 v9, 8, v4
v_and_b32 v13, 1, v5
M v[140:143], a[176:179], a[48:51], 0
s_add_u32 s47, s66, 65536
v_xor_b32 v9, v9, v11
v_lshrrev_b32 v14, 1, v5
M v[140:143], a[180:183], a[52:55], v[140:143]
s_add_u32 s48, s66, 131072
buffer_load_dwordx4 v73, s[8:11], s45 offen lds
M v[144:147], a[176:179], a[56:59], 0
s_add_u32 m0, s36, 131072
v_lshl_add_u32 v59, v9, 4, v10
v_add_u32 v9, 12, v4
M v[144:147], a[180:183], a[60:63], v[144:147]
s_add_u32 s49, s66, 196608
v_xor_b32 v9, v9, v11
v_lshl_add_u32 v60, v9, 4, v10
M v[148:151], a[176:179], a[64:67], 0
s_waitcnt vmcnt(8) lgkmcnt(0)
v_lshlrev_b32 v10, 8, v12
v_and_b32 v11, 7, v12
M v[148:151], a[180:183], a[68:71], v[148:151]
s_barrier
buffer_load_dwordx4 v73, s[8:11], s46 offen lds
M v[152:155], a[176:179], a[72:75], 0
s_add_u32 m0, s36, 132096
ds_read_b64_tr_b16 a[160:161], v74 offset:49152
v_lshl_add_u32 v10, v13, 3, v10
M v[152:155], a[180:183], a[76:79], v[152:155]
s_add_u32 s50, s74, 0
ds_read_b64_tr_b16 a[162:163], v74 offset:49664
v_add_u32 v10, s62, v10
M v[156:159], a[184:187], a[40:43], 0
s_add_u32 s51, s74, 8192
buffer_load_dwordx4 v73, s[8:11], s47 offen lds
M v[156:159], a[188:191], a[44:47], v[156:159]
s_add_u32 m0, s36, 133120
ds_read_b64_tr_b16 a[164:165], v74 offset:53248
v_lshlrev_b32 v11, 1, v11
M v[160:163], a[184:187], a[48:51], 0
s_add_u32 s44, s74, 16384
ds_read_b64_tr_b16 a[166:167], v74 offset:53760
v_add_u32 v9, 0, v14
M v[160:163], a[188:191], a[52:55], v[160:163]
s_add_u32 s45, s74, 24576
buffer_load_dwordx4 v73, s[8:11], s48 offen lds
M v[164:167], a[184:187], a[56:59], 0
s_add_u32 m0, s36, 134144
ds_read_b64_tr_b16 a[168:169], v74 offset:49160
v_add_u32 v10, 65536, v10
M v[164:167], a[188:191], a[60:63], v[164:167]
s_add_u32 s46, s74, 32768
ds_read_b64_tr_b16 a[170:171], v74 offset:49672
v_xor_b32 v9, v9, v11
M v[168:171], a[184:187], a[64:67], 0
s_add_u32 s47, s43, 0
buffer_load_dwordx4 v73, s[8:11], s49 offen lds
M v[168:171], a[188:191], a[68:71], v[168:171]
s_add_u32 m0, s37, 0
ds_read_b64_tr_b16 a[172:173], v74 offset:53256
v_lshl_add_u32 v61, v9, 4, v10
M v[172:175], a[184:187], a[72:75], 0
s_and_b32 s47, s47, 131071
ds_read_b64_tr_b16 a[174:175], v74 offset:53768
v_add_u32 v9, 2, v14
M v[172:175], a[188:191], a[76:79], v[172:175]
s_waitcnt lgkmcnt(6)
buffer_load_dwordx4 v71, s[4:7], s50 offen lds
M v[176:179], a[160:163], a[40:43], 0
s_waitcnt lgkmcnt(4)
s_add_u32 m0, s37, 1024
ds_read_b64_tr_b16 a[176:177], v75 offset:49152
M v[176:179], a[164:167], a[44:47], v[176:179]
s_add_u32 s47, s47, s32
ds_read_b64_tr_b16 a[178:179], v75 offset:49664
v_xor_b32 v9, v9, v11
M v[180:183], a[160:163], a[48:51], 0
s_add_u32 s48, s66, 128
buffer_load_dwordx4 v72, s[4:7], s51 offen lds
M v[180:183], a[164:167], a[52:55], v[180:183]
s_add_u32 m0, s37, 2048
ds_read_b64_tr_b16 a[180:181], v75 offset:53248
v_lshl_add_u32 v62, v9, 4, v10
M v[184:187], a[160:163], a[56:59], 0
s_add_u32 s49, s66, 65664
ds_read_b64_tr_b16 a[182:183], v75 offset:53760
v_add_u32 v9, 4, v14
M v[184:187], a[164:167], a[60:63], v[184:187]
s_add_u32 s50, s66, 131200
buffer_load_dwordx4 v71, s[4:7], s44 offen lds
M v[188:191], a[160:163], a[64:67], 0
s_add_u32 m0, s37, 3072
ds_read_b128 v[16:19], v82 offset:0
v_xor_b32 v9, v9, v11
M v[188:191], a[164:167], a[68:71], v[188:191]
s_add_u32 s51, s66, 196736
ds_read_b128 v[20:23], v83 offset:0
v_lshl_add_u32 v63, v9, 4, v10
M v[192:195], a[160:163], a[72:75], 0
s_add_u32 s44, s75, 0
buffer_load_dwordx4 v72, s[4:7], s45 offen lds
M v[192:195], a[164:167], a[76:79], v[192:195]
s_waitcnt lgkmcnt(8)
s_add_u32 m0, s37, 4096
ds_read_b128 v[24:27], v82 offset:2048
M v[196:199], a[168:171], a[40:43], 0
s_waitcnt lgkmcnt(7)
ds_read_b128 v[28:31], v83 offset:2048
v_add_u32 v9, 6, v14
M v[196:199], a[172:175], a[44:47], v[196:199]
s_add_u32 s45, s75, 8192
ds_read_b128 v[32:35], v82 offset:4096
v_xor_b32 v9, v9, v11
M v[200:203], a[168:171], a[48:51], 0
buffer_load_dwordx4 v71, s[4:7], s46 offen lds
ds_read_b128 v[36:39], v83 offset:4096
M v[200:203], a[172:175], a[52:55], v[200:203]
s_add_u32 m0, s36, 0
ds_read_b128 v[40:43], v82 offset:6144
v_lshl_add_u32 v64, v9, 4, v10
M v[204:207], a[168:171], a[56:59], 0
s_add_u32 s46, s75, 16384
ds_read_b128 v[44:47], v83 offset:6144
v_add_u32 v9, 8, v14
M v[204:207], a[172:175], a[60:63], v[204:207]
buffer_load_dwordx4 v69, s[12:15], s47 offen nt lds
ds_read_b128 v[48:51], v82 offset:8192
M v[208:211], a[168:171], a[64:67], 0
ds_read_b128 v[52:55], v83 offset:8192
v_xor_b32 v9, v9, v11
M v[208:211], a[172:175], a[68:71], v[208:211]
buffer_load_dwordx4 v70, s[12:15], s47 offen offset:1024 nt lds
ds_read_b64_tr_b16 a[184:185], v75 offset:49160
M v[212:215], a[168:171], a[72:75], 0
ds_read_b64_tr_b16 a[186:187], v75 offset:49672
v_lshl_add_u32 v65, v9, 4, v10
M v[212:215], a[172:175], a[76:79], v[212:215]
s_waitcnt lgkmcnt(14)
ds_read_b64_tr_b16 a[188:189], v75 offset:53256
v_add_u32 v9, 10, v14
M v[216:219], a[176:179], a[40:43], 0
s_waitcnt lgkmcnt(13)
buffer_load_dwordx4 v69, s[12:15], s47 offen offset:2048 nt lds
M v[216:219], a[180:183], a[44:47], v[216:219]
L_hop_a0:
s_cbranch_execz L_ret_a0
ds_read_b64_tr_b16 a[190:191], v75 offset:53768
v_xor_b32 v9, v9, v11
M v[220:223], a[176:179], a[48:51], 0
buffer_load_dwordx4 v70, s[12:15], s47 offen offset:3072 nt lds
M v[220:223], a[180:183], a[52:55], v[220:223]
s_add_u32 m0, s36, 147456
v_lshl_add_u32 v66, v9, 4, v10
v_add_u32 v9, 12, v14
M v[224:227], a[176:179], a[56:59], 0
s_add_u32 s47, s75, 24576
v_xor_b32 v9, v9, v11
v_lshl_add_u32 v67, v9, 4, v10
M v[224:227], a[180:183], a[60:63], v[224:227]
v_add_u32 v9, 14, v14
v_xor_b32 v9, v9, v11
M v[228:231], a[176:179], a[64:67], 0
v_lshl_add_u32 v68, v9, 4, v10
M v[228:231], a[180:183], a[68:71], v[228:231]
M v[232:235], a[176:179], a[72:75], 0
M v[232:235], a[180:183], a[76:79], v[232:235]
s_waitcnt lgkmcnt(2)
M v[236:239], a[184:187], a[40:43], 0
s_waitcnt lgkmcnt(0)
M v[236:239], a[188:191], a[44:47], v[236:239]
s_waitcnt vmcnt(17)
M v[240:243], a[184:187], a[48:51], 0
s_barrier
ds_read_b64_tr_b16 a[160:161], v74 offset:0
buffer_load_dwordx4 v73, s[8:11], s48 offen lds
ds_read_b64_tr_b16 a[162:163], v74 offset:512
s_add_u32 m0, s36, 148480
s_add_u32 s48, s75, 32768
ds_read_b64_tr_b16 a[164:165], v74 offset:4096
M v[240:243], a[188:191], a[52:55], v[240:243]
buffer_load_dwordx4 v73, s[8:11], s49 offen lds
ds_read_b64_tr_b16 a[166:167], v74 offset:4608
M v[244:247], a[184:187], a[56:59], 0
s_add_u32 m0, s36, 149504
ds_read_b64_tr_b16 a[168:169], v74 offset:8
M v[244:247], a[188:191], a[60:63], v[244:247]
s_add_u32 s49, s67, 0
ds_read_b64_tr_b16 a[170:171], v74 offset:520
M v[248:251], a[184:187], a[64:67], 0
ds_read_b64_tr_b16 a[172:173], v74 offset:4104
M v[248:251], a[188:191], a[68:71], v[248:251]
buffer_load_dwordx4 v73, s[8:11], s50 offen lds
M v[252:255], a[184:187], a[72:75], 0
s_add_u32 m0, s36, 150528
ds_read_b64_tr_b16 a[174:175], v74 offset:4616
M v[252:255], a[188:191], a[76:79], v[252:255]
s_waitcnt lgkmcnt(6)
ds_read_b64_tr_b16 a[176:177], v75 offset:0
M v[96:99], a[160:163], v[16:19], v[96:99]
s_waitcnt lgkmcnt(5)
ds_read_b64_tr_b16 a[178:179], v75 offset:512
M v[96:99], a[164:167], v[20:23], v[96:99]
s_add_u32 s50, s67, 65536
buffer_load_dwordx4 v73, s[8:11], s51 offen lds
M v[100:103], a[160:163], v[24:27], v[100:103]
s_add_u32 m0, s38, 0
ds_read_b64_tr_b16 a[180:181], v75 offset:4096
M v[100:103], a[164:167], v[28:31], v[100:103]
s_add_u32 s51, s67, 131072
ds_read_b64_tr_b16 a[182:183], v75 offset:4608
M v[104:107], a[160:163], v[32:35], v[104:107]
ds_read_b64_tr_b16 a[184:185], v75 offset:8
M v[104:107], a[164:167], v[36:39], v[104:107]
ds_read_b64_tr_b16 a[186:187], v75 offset:520
M v[108:111], a[160:163], v[40:43], v[108:111]
buffer_load_dwordx4 v71, s[4:7], s44 offen lds
M v[108:111], a[164:167], v[44:47], v[108:111]
s_add_u32 m0, s38, 1024
ds_read_b64_tr_b16 a[188:189], v75 offset:4104
M v[112:115], a[160:163], v[48:51], v[112:115]
s_add_u32 s44, s67, 196608
ds_read_b64_tr_b16 a[190:191], v75 offset:4616
M v[112:115], a[164:167], v[52:55], v[112:115]
s_waitcnt lgkmcnt(10)
M v[116:119], a[168:171], v[16:19], v[116:119]
s_waitcnt lgkmcnt(8)
buffer_load_dwordx4 v72, s[4:7], s45 offen lds
M v[116:119], a[172:175], v[20:23], v[116:119]
s_add_u32 m0, s38, 2048
M v[120:123], a[168:171], v[24:27], v[120:123]
s_add_u32 s45, s43, 0
M v[120:123], a[172:175], v[28:31], v[120:123]
s_and_b32 s45, s45, 131071
M v[124:127], a[168:171], v[32:35], v[124:127]
s_add_u32 s45, s45, s32
buffer_load_dwordx4 v71, s[4:7], s46 offen lds
M v[124:127], a[172:175], v[36:39], v[124:127]
s_add_u32 m0, s38, 3072
M v[128:131], a[168:171], v[40:43], v[128:131]
M v[128:131], a[172:175], v[44:47], v[128:131]
M v[132:135], a[168:171], v[48:51], v[132:135]
buffer_load_dwordx4 v72, s[4:7], s47 offen lds
M v[132:135], a[172:175], v[52:55], v[132:135]
s_waitcnt lgkmcnt(6)
s_add_u32 m0, s38, 4096
M v[136:139], a[176:179], v[16:19], v[136:139]
s_waitcnt lgkmcnt(4)
M v[136:139], a[180:183], v[20:23], v[136:139]
M v[140:143], a[176:179], v[24:27], v[140:143]
buffer_load_dwordx4 v71, s[4:7], s48 offen lds
M v[140:143], a[180:183], v[28:31], v[140:143]
s_add_u32 m0, s36, 98304
M v[144:147], a[176:179], v[32:35], v[144:147]
s_waitcnt vmcnt(13) lgkmcnt(0)
M v[144:147], a[180:183], v[36:39], v[144:147]
s_barrier
ds_read_b64_tr_b16 a[160:161], v74 offset:16384
M v[148:151], a[176:179], v[40:43], v[148:151]
ds_read_b64_tr_b16 a[162:163], v74 offset:16896
M v[148:151], a[180:183], v[44:47], v[148:151]
ds_read_b64_tr_b16 a[164:165], v74 offset:20480
M v[152:155], a[176:179], v[48:51], v[152:155]
s_add_u32 s46, s67, 128
ds_read_b64_tr_b16 a[166:167], v74 offset:20992
M v[152:155], a[180:183], v[52:55], v[152:155]
buffer_load_dwordx4 v73, s[8:11], s49 offen lds
M v[156:159], a[184:187], v[16:19], v[156:159]
s_add_u32 m0, s36, 99328
ds_read_b64_tr_b16 a[168:169], v74 offset:16392
M v[156:159], a[188:191], v[20:23], v[156:159]
ds_read_b64_tr_b16 a[170:171], v74 offset:16904
M v[160:163], a[184:187], v[24:27], v[160:163]
s_add_u32 s47, s67, 65664
ds_read_b64_tr_b16 a[172:173], v74 offset:20488
M v[160:163], a[188:191], v[28:31], v[160:163]
ds_read_b64_tr_b16 a[174:175], v74 offset:21000
M v[164:167], a[184:187], v[32:35], v[164:167]
buffer_load_dwordx4 v73, s[8:11], s50 offen lds
M v[164:167], a[188:191], v[36:39], v[164:167]
s_add_u32 m0, s36, 100352
ds_read_b64_tr_b16 a[176:177], v75 offset:16384
M v[168:171], a[184:187], v[40:43], v[168:171]
ds_read_b64_tr_b16 a[178:179], v75 offset:16896
M v[168:171], a[188:191], v[44:47], v[168:171]
s_add_u32 s48, s67, 131200
ds_read_b64_tr_b16 a[180:181], v75 offset:20480
M v[172:175], a[184:187], v[48:51], v[172:175]
ds_read_b64_tr_b16 a[182:183], v75 offset:20992
M v[172:175], a[188:191], v[52:55], v[172:175]
s_waitcnt lgkmcnt(10)
buffer_load_dwordx4 v73, s[8:11], s51 offen lds
M v[176:179], a[160:163], v[16:19], v[176:179]
s_waitcnt lgkmcnt(8)
s_add_u32 m0, s36, 101376
ds_read_b128 a[40:43], v80 offset:0
M v[176:179], a[164:167], v[20:23], v[176:179]
s_add_u32 s49, s67, 196736
ds_read_b128 a[44:47], v81 offset:0
M v[180:183], a[160:163], v[24:27], v[180:183]
ds_read_b128 a[48:51], v80 offset:2048
M v[180:183], a[164:167], v[28:31], v[180:183]
buffer_load_dwordx4 v73, s[8:11], s44 offen lds
M v[184:187], a[160:163], v[32:35], v[184:187]
s_add_u32 m0, s36, 65536
ds_read_b128 a[52:55], v81 offset:2048
M v[184:187], a[164:167], v[36:39], v[184:187]
s_add_u32 s50, s76, 0
ds_read_b128 a[56:59], v80 offset:4096
M v[188:191], a[160:163], v[40:43], v[188:191]
ds_read_b128 a[60:63], v81 offset:4096
M v[188:191], a[164:167], v[44:47], v[188:191]
ds_read_b128 a[64:67], v80 offset:6144
M v[192:195], a[160:163], v[48:51], v[192:195]
buffer_load_dwordx4 v69, s[16:19], s45 offen nt lds
M v[192:195], a[164:167], v[52:55], v[192:195]
s_waitcnt lgkmcnt(13)
ds_read_b128 a[68:71], v81 offset:6144
M v[196:199], a[168:171], v[16:19], v[196:199]
s_waitcnt lgkmcnt(12)
ds_read_b128 a[72:75], v80 offset:8192
M v[196:199], a[172:175], v[20:23], v[196:199]
s_add_u32 s51, s76, 8192
ds_read_b128 a[76:79], v81 offset:8192
M v[200:203], a[168:171], v[24:27], v[200:203]
ds_read_b64_tr_b16 a[184:185], v75 offset:16392
M v[200:203], a[172:175], v[28:31], v[200:203]
buffer_load_dwordx4 v70, s[16:19], s45 offen offset:1024 nt lds
M v[204:207], a[168:171], v[32:35], v[204:207]
s_add_u32 s44, s76, 16384
ds_read_b64_tr_b16 a[186:187], v75 offset:16904
M v[204:207], a[172:175], v[36:39], v[204:207]
ds_read_b64_tr_b16 a[188:189], v75 offset:20488
M v[208:211], a[168:171], v[40:43], v[208:211]
ds_read_b64_tr_b16 a[190:191], v75 offset:21000
M v[208:211], a[172:175], v[44:47], v[208:211]
M v[212:215], a[168:171], v[48:51], v[212:215]
buffer_load_dwordx4 v69, s[16:19], s45 offen offset:2048 nt lds
M v[212:215], a[172:175], v[52:55], v[212:215]
s_waitcnt lgkmcnt(15)
M v[216:219], a[176:179], v[16:19], v[216:219]
s_waitcnt lgkmcnt(14)
M v[216:219], a[180:183], v[20:23], v[216:219]
M v[220:223], a[176:179], v[24:27], v[220:223]
buffer_load_dwordx4 v70, s[16:19], s45 offen offset:3072 nt lds
M v[220:223], a[180:183], v[28:31], v[220:223]
s_add_u32 m0, s36, 114688
M v[224:227], a[176:179], v[32:35], v[224:227]
s_waitcnt lgkmcnt(0)
M v[224:227], a[180:183], v[36:39], v[224:227]
s_barrier
ds_read_b64_tr_b16 a[160:161], v74 offset:32768
M v[228:231], a[176:179], v[40:43], v[228:231]
s_add_u32 s45, s76, 24576
ds_read_b64_tr_b16 a[162:163], v74 offset:33280
M v[228:231], a[180:183], v[44:47], v[228:231]
ds_read_b64_tr_b16 a[164:165], v74 offset:36864
M v[232:235], a[176:179], v[48:51], v[232:235]
ds_read_b64_tr_b16 a[166:167], v74 offset:37376
M v[232:235], a[180:183], v[52:55], v[232:235]
buffer_load_dwordx4 v73, s[8:11], s46 offen lds
M v[236:239], a[184:187], v[16:19], v[236:239]
s_add_u32 m0, s36, 115712
ds_read_b64_tr_b16 a[168:169], v74 offset:32776
M v[236:239], a[188:191], v[20:23], v[236:239]
s_add_u32 s46, s76, 32768
ds_read_b64_tr_b16 a[170:171], v74 offset:33288
M v[240:243], a[184:187], v[24:27], v[240:243]
ds_read_b64_tr_b16 a[172:173], v74 offset:36872
M v[240:243], a[188:191], v[28:31], v[240:243]
buffer_load_dwordx4 v73, s[8:11], s47 offen lds
M v[244:247], a[184:187], v[32:35], v[244:247]
s_add_u32 m0, s36, 116736
ds_read_b64_tr_b16 a[174:175], v74 offset:37384
M v[244:247], a[188:191], v[36:39], v[244:247]
s_add_u32 s47, s68, 0
ds_read_b64_tr_b16 a[176:177], v75 offset:32768
M v[248:251], a[184:187], v[40:43], v[248:251]
ds_read_b64_tr_b16 a[178:179], v75 offset:33280
M v[248:251], a[188:191], v[44:47], v[248:251]
buffer_load_dwordx4 v73, s[8:11], s48 offen lds
M v[252:255], a[184:187], v[48:51], v[252:255]
s_add_u32 m0, s36, 117760
ds_read_b64_tr_b16 a[180:181], v75 offset:36864
M v[252:255], a[188:191], v[52:55], v[252:255]
s_waitcnt lgkmcnt(9)
ds_read_b64_tr_b16 a[182:183], v75 offset:37376
M v[96:99], a[160:163], a[40:43], v[96:99]
s_waitcnt lgkmcnt(8)
ds_read_b64_tr_b16 a[184:185], v75 offset:32776
M v[96:99], a[164:167], a[44:47], v[96:99]
s_add_u32 s48, s68, 65536
buffer_load_dwordx4 v73, s[8:11], s49 offen lds
M v[100:103], a[160:163], a[48:51], v[100:103]
s_add_u32 m0, s37, 0
ds_read_b64_tr_b16 a[186:187], v75 offset:33288
M v[100:103], a[164:167], a[52:55], v[100:103]
s_add_u32 s49, s68, 131072
ds_read_b64_tr_b16 a[188:189], v75 offset:36872
M v[104:107], a[160:163], a[56:59], v[104:107]
ds_read_b64_tr_b16 a[190:191], v75 offset:37384
M v[104:107], a[164:167], a[60:63], v[104:107]
M v[108:111], a[160:163], a[64:67], v[108:111]
buffer_load_dwordx4 v71, s[4:7], s50 offen lds
M v[108:111], a[164:167], a[68:71], v[108:111]
s_add_u32 m0, s37, 1024
M v[112:115], a[160:163], a[72:75], v[112:115]
s_add_u32 s50, s68, 196608
M v[112:115], a[164:167], a[76:79], v[112:115]
s_waitcnt lgkmcnt(10)
M v[116:119], a[168:171], a[40:43], v[116:119]
s_waitcnt lgkmcnt(8)
buffer_load_dwordx4 v72, s[4:7], s51 offen lds
M v[116:119], a[172:175], a[44:47], v[116:119]
s_add_u32 m0, s37, 2048
M v[120:123], a[168:171], a[48:51], v[120:123]
M v[120:123], a[172:175], a[52:55], v[120:123]
M v[124:127], a[168:171], a[56:59], v[124:127]
buffer_load_dwordx4 v71, s[4:7], s44 offen lds
M v[124:127], a[172:175], a[60:63], v[124:127]
s_add_u32 m0, s37, 3072
M v[128:131], a[168:171], a[64:67], v[128:131]
M v[128:131], a[172:175], a[68:71], v[128:131]
M v[132:135], a[168:171], a[72:75], v[132:135]
buffer_load_dwordx4 v72, s[4:7], s45 offen lds
M v[132:135], a[172:175], a[76:79], v[132:135]
s_waitcnt lgkmcnt(6)
s_add_u32 m0, s37, 4096
M v[136:139], a[176:179], a[40:43], v[136:139]
s_waitcnt lgkmcnt(4)
M v[136:139], a[180:183], a[44:47], v[136:139]
M v[140:143], a[176:179], a[48:51], v[140:143]
buffer_load_dwordx4 v71, s[4:7], s46 offen lds
M v[140:143], a[180:183], a[52:55], v[140:143]
s_add_u32 m0, s36, 131072
M v[144:147], a[176:179], a[56:59], v[144:147]
s_waitcnt vmcnt(17) lgkmcnt(0)
M v[144:147], a[180:183], a[60:63], v[144:147]
s_barrier
ds_read_b64_tr_b16 a[160:161], v74 offset:49152
M v[148:151], a[176:179], a[64:67], v[148:151]
s_add_u32 s51, s43, 8192
ds_read_b64_tr_b16 a[162:163], v74 offset:49664
M v[148:151], a[180:183], a[68:71], v[148:151]
s_and_b32 s51, s51, 131071
ds_read_b64_tr_b16 a[164:165], v74 offset:53248
M v[152:155], a[176:179], a[72:75], v[152:155]
s_add_u32 s51, s51, s32
ds_read_b64_tr_b16 a[166:167], v74 offset:53760
M v[152:155], a[180:183], a[76:79], v[152:155]
s_add_u32 s44, s68, 128
buffer_load_dwordx4 v73, s[8:11], s47 offen lds
M v[156:159], a[184:187], a[40:43], v[156:159]
s_add_u32 m0, s36, 132096
ds_read_b64_tr_b16 a[168:169], v74 offset:49160
M v[156:159], a[188:191], a[44:47], v[156:159]
ds_read_b64_tr_b16 a[170:171], v74 offset:49672
M v[160:163], a[184:187], a[48:51], v[160:163]
s_add_u32 s45, s68, 65664
ds_read_b64_tr_b16 a[172:173], v74 offset:53256
M v[160:163], a[188:191], a[52:55], v[160:163]
ds_read_b64_tr_b16 a[174:175], v74 offset:53768
M v[164:167], a[184:187], a[56:59], v[164:167]
buffer_load_dwordx4 v73, s[8:11], s48 offen lds
M v[164:167], a[188:191], a[60:63], v[164:167]
s_add_u32 m0, s36, 133120
ds_read_b64_tr_b16 a[176:177], v75 offset:49152
M v[168:171], a[184:187], a[64:67], v[168:171]
ds_read_b64_tr_b16 a[178:179], v75 offset:49664
M v[168:171], a[188:191], a[68:71], v[168:171]
s_add_u32 s46, s68, 131200
ds_read_b64_tr_b16 a[180:181], v75 offset:53248
M v[172:175], a[184:187], a[72:75], v[172:175]
ds_read_b64_tr_b16 a[182:183], v75 offset:53760
M v[172:175], a[188:191], a[76:79], v[172:175]
s_waitcnt lgkmcnt(10)
buffer_load_dwordx4 v73, s[8:11], s49 offen lds
M v[176:179], a[160:163], a[40:43], v[176:179]
s_waitcnt lgkmcnt(8)
s_add_u32 m0, s36, 134144
ds_read_b128 v[16:19], v82 offset:0
M v[176:179], a[164:167], a[44:47], v[176:179]
s_add_u32 s47, s68, 196736
ds_read_b128 v[20:23], v83 offset:0
M v[180:183], a[160:163], a[48:51], v[180:183]
ds_read_b128 v[24:27], v82 offset:2048
M v[180:183], a[164:167], a[52:55], v[180:183]
buffer_load_dwordx4 v73, s[8:11], s50 offen lds
M v[184:187], a[160:163], a[56:59], v[184:187]
s_add_u32 m0, s36, 16384
ds_read_b128 v[28:31], v83 offset:2048
M v[184:187], a[164:167], a[60:63], v[184:187]
s_add_u32 s48, s77, 0
ds_read_b128 v[32:35], v82 offset:4096
M v[188:191], a[160:163], a[64:67], v[188:191]
ds_read_b128 v[36:39], v83 offset:4096
M v[188:191], a[164:167], a[68:71], v[188:191]
ds_read_b128 v[40:43], v82 offset:6144
M v[192:195], a[160:163], a[72:75], v[192:195]
buffer_load_dwordx4 v69, s[12:15], s51 offen nt lds
M v[192:195], a[164:167], a[76:79], v[192:195]
s_waitcnt lgkmcnt(13)
ds_read_b128 v[44:47], v83 offset:6144
M v[196:199], a[168:171], a[40:43], v[196:199]
s_waitcnt lgkmcnt(12)
ds_read_b128 v[48:51], v82 offset:8192
M v[196:199], a[172:175], a[44:47], v[196:199]
s_add_u32 s49, s77, 8192
ds_read_b128 v[52:55], v83 offset:8192
M v[200:203], a[168:171], a[48:51], v[200:203]
ds_read_b64_tr_b16 a[184:185], v75 offset:49160
M v[200:203], a[172:175], a[52:55], v[200:203]
buffer_load_dwordx4 v70, s[12:15], s51 offen offset:1024 nt lds
M v[204:207], a[168:171], a[56:59], v[204:207]
s_add_u32 s50, s77, 16384
ds_read_b64_tr_b16 a[186:187], v75 offset:49672
M v[204:207], a[172:175], a[60:63], v[204:207]
ds_read_b64_tr_b16 a[188:189], v75 offset:53256
M v[208:211], a[168:171], a[64:67], v[208:211]
ds_read_b64_tr_b16 a[190:191], v75 offset:53768
M v[208:211], a[172:175], a[68:71], v[208:211]
M v[212:215], a[168:171], a[72:75], v[212:215]
buffer_load_dwordx4 v69, s[12:15], s51 offen offset:2048 nt lds
M v[212:215], a[172:175], a[76:79], v[212:215]
s_waitcnt lgkmcnt(15)
M v[216:219], a[176:179], a[40:43], v[216:219]
s_waitcnt lgkmcnt(14)
M v[216:219], a[180:183], a[44:47], v[216:219]
M v[220:223], a[176:179], a[48:51], v[220:223]
buffer_load_dwordx4 v70, s[12:15], s51 offen offset:3072 nt lds
M v[220:223], a[180:183], a[52:55], v[220:223]
s_add_u32 m0, s36, 147456
M v[224:227], a[176:179], a[56:59], v[224:227]
s_waitcnt vmcnt(21) lgkmcnt(0)
M v[224:227], a[180:183], a[60:63], v[224:227]
s_barrier
ds_read_b64_tr_b16 a[160:161], v74 offset:0
M v[228:231], a[176:179], a[64:67], v[228:231]
s_add_u32 s51, s77, 24576
ds_read_b64_tr_b16 a[162:163], v74 offset:512
M v[228:231], a[180:183], a[68:71], v[228:231]
ds_read_b64_tr_b16 a[164:165], v74 offset:4096
M v[232:235], a[176:179], a[72:75], v[232:235]
ds_read_b64_tr_b16 a[166:167], v74 offset:4608
M v[232:235], a[180:183], a[76:79], v[232:235]
buffer_load_dwordx4 v73, s[8:11], s44 offen lds
M v[236:239], a[184:187], a[40:43], v[236:239]
s_add_u32 m0, s36, 148480
ds_read_b64_tr_b16 a[168:169], v74 offset:8
M v[236:239], a[188:191], a[44:47], v[236:239]
s_add_u32 s44, s77, 32768
ds_read_b64_tr_b16 a[170:171], v74 offset:520
M v[240:243], a[184:187], a[48:51], v[240:243]
ds_read_b64_tr_b16 a[172:173], v74 offset:4104
M v[240:243], a[188:191], a[52:55], v[240:243]
buffer_load_dwordx4 v73, s[8:11], s45 offen lds
M v[244:247], a[184:187], a[56:59], v[244:247]
s_add_u32 m0, s36, 149504
ds_read_b64_tr_b16 a[174:175], v74 offset:4616
M v[244:247], a[188:191], a[60:63], v[244:247]
s_add_u32 s45, s69, 0
ds_read_b64_tr_b16 a[176:177], v75 offset:0
M v[248:251], a[184:187], a[64:67], v[248:251]
ds_read_b64_tr_b16 a[178:179], v75 offset:512
M v[248:251], a[188:191], a[68:71], v[248:251]
buffer_load_dwordx4 v73, s[8:11], s46 offen lds
M v[252:255], a[184:187], a[72:75], v[252:255]
s_add_u32 m0, s36, 150528
ds_read_b64_tr_b16 a[180:181], v75 offset:4096
M v[252:255], a[188:191], a[76:79], v[252:255]
s_waitcnt lgkmcnt(9)
ds_read_b64_tr_b16 a[182:183], v75 offset:4608
M v[96:99], a[160:163], v[16:19], v[96:99]
s_waitcnt lgkmcnt(8)
ds_read_b64_tr_b16 a[184:185], v75 offset:8
M v[96:99], a[164:167], v[20:23], v[96:99]
s_add_u32 s46, s69, 65536
buffer_load_dwordx4 v73, s[8:11], s47 offen lds
M v[100:103], a[160:163], v[24:27], v[100:103]
s_add_u32 m0, s38, 0
ds_read_b64_tr_b16 a[186:187], v75 offset:520
M v[100:103], a[164:167], v[28:31], v[100:103]
s_add_u32 s47, s69, 131072
ds_read_b64_tr_b16 a[188:189], v75 offset:4104
M v[104:107], a[160:163], v[32:35], v[104:107]
s_add_u32 s63, s43, 40960
ds_read_b64_tr_b16 a[190:191], v75 offset:4616
M v[104:107], a[164:167], v[36:39], v[104:107]
s_and_b32 s63, s63, 131071
M v[108:111], a[160:163], v[40:43], v[108:111]
s_add_u32 s63, s63, s32
buffer_load_dwordx4 v71, s[4:7], s48 offen lds
M v[108:111], a[164:167], v[44:47], v[108:111]
s_add_u32 m0, s38, 1024
M v[112:115], a[160:163], v[48:51], v[112:115]
s_add_u32 s48, s69, 196608
M v[112:115], a[164:167], v[52:55], v[112:115]
s_waitcnt lgkmcnt(10)
M v[116:119], a[168:171], v[16:19], v[116:119]
s_waitcnt lgkmcnt(8)
buffer_load_dwordx4 v72, s[4:7], s49 offen lds
M v[116:119], a[172:175], v[20:23], v[116:119]
s_add_u32 m0, s38, 2048
M v[120:123], a[168:171], v[24:27], v[120:123]
M v[120:123], a[172:175], v[28:31], v[120:123]
M v[124:127], a[168:171], v[32:35], v[124:127]
buffer_load_dwordx4 v71, s[4:7], s50 offen lds
M v[124:127], a[172:175], v[36:39], v[124:127]
s_add_u32 m0, s38, 3072
M v[128:131], a[168:171], v[40:43], v[128:131]
M v[128:131], a[172:175], v[44:47], v[128:131]
M v[132:135], a[168:171], v[48:51], v[132:135]
buffer_load_dwordx4 v72, s[4:7], s51 offen lds
M v[132:135], a[172:175], v[52:55], v[132:135]
s_waitcnt lgkmcnt(6)
s_add_u32 m0, s38, 4096
M v[136:139], a[176:179], v[16:19], v[136:139]
s_waitcnt lgkmcnt(4)
M v[136:139], a[180:183], v[20:23], v[136:139]
M v[140:143], a[176:179], v[24:27], v[140:143]
buffer_load_dwordx4 v71, s[4:7], s44 offen lds
M v[140:143], a[180:183], v[28:31], v[140:143]
s_add_u32 m0, s36, 98304
M v[144:147], a[176:179], v[32:35], v[144:147]
s_waitcnt vmcnt(17) lgkmcnt(0)
M v[144:147], a[180:183], v[36:39], v[144:147]
s_barrier
ds_read_b64_tr_b16 a[160:161], v74 offset:16384
M v[148:151], a[176:179], v[40:43], v[148:151]
ds_read_b64_tr_b16 a[162:163], v74 offset:16896
M v[148:151], a[180:183], v[44:47], v[148:151]
ds_read_b64_tr_b16 a[164:165], v74 offset:20480
M v[152:155], a[176:179], v[48:51], v[152:155]
s_add_u32 s49, s69, 128
ds_read_b64_tr_b16 a[166:167], v74 offset:20992
M v[152:155], a[180:183], v[52:55], v[152:155]
buffer_load_dwordx4 v73, s[8:11], s45 offen lds
M v[156:159], a[184:187], v[16:19], v[156:159]
s_add_u32 m0, s36, 99328
ds_read_b64_tr_b16 a[168:169], v74 offset:16392
M v[156:159], a[188:191], v[20:23], v[156:159]
ds_read_b64_tr_b16 a[170:171], v74 offset:16904
M v[160:163], a[184:187], v[24:27], v[160:163]
s_add_u32 s50, s69, 65664
ds_read_b64_tr_b16 a[172:173], v74 offset:20488
M v[160:163], a[188:191], v[28:31], v[160:163]
ds_read_b64_tr_b16 a[174:175], v74 offset:21000
M v[164:167], a[184:187], v[32:35], v[164:167]
buffer_load_dwordx4 v73, s[8:11], s46 offen lds
M v[164:167], a[188:191], v[36:39], v[164:167]
s_add_u32 m0, s36, 100352
ds_read_b64_tr_b16 a[176:177], v75 offset:16384
M v[168:171], a[184:187], v[40:43], v[168:171]
ds_read_b64_tr_b16 a[178:179], v75 offset:16896
M v[168:171], a[188:191], v[44:47], v[168:171]
s_add_u32 s51, s69, 131200
ds_read_b64_tr_b16 a[180:181], v75 offset:20480
M v[172:175], a[184:187], v[48:51], v[172:175]
ds_read_b64_tr_b16 a[182:183], v75 offset:20992
M v[172:175], a[188:191], v[52:55], v[172:175]
s_waitcnt lgkmcnt(10)
buffer_load_dwordx4 v73, s[8:11], s47 offen lds
M v[176:179], a[160:163], v[16:19], v[176:179]
s_waitcnt lgkmcnt(8)
ds_read_b128 a[40:43], v80 offset:0
M v[176:179], a[164:167], v[20:23], v[176:179]
s_add_u32 m0, s36, 101376
ds_read_b128 a[44:47], v81 offset:0
M v[180:183], a[160:163], v[24:27], v[180:183]
s_add_u32 s44, s69, 196736
ds_read_b128 a[48:51], v80 offset:2048
M v[180:183], a[164:167], v[28:31], v[180:183]
ds_read_b128 a[52:55], v81 offset:2048
M v[184:187], a[160:163], v[32:35], v[184:187]
buffer_load_dwordx4 v73, s[8:11], s48 offen lds
M v[184:187], a[164:167], v[36:39], v[184:187]
s_add_u32 m0, s36, 114688
ds_read_b128 a[56:59], v80 offset:4096
M v[188:191], a[160:163], v[40:43], v[188:191]
s_add_u32 s45, s78, 0
ds_read_b128 a[60:63], v81 offset:4096
M v[188:191], a[164:167], v[44:47], v[188:191]
ds_read_b128 a[64:67], v80 offset:6144
M v[192:195], a[160:163], v[48:51], v[192:195]
buffer_load_dwordx4 a[208:211], v69, s[12:15], s63 offen offset:0 nt
M v[192:195], a[164:167], v[52:55], v[192:195]
s_waitcnt lgkmcnt(13)
ds_read_b128 a[68:71], v81 offset:6144
M v[196:199], a[168:171], v[16:19], v[196:199]
s_waitcnt lgkmcnt(12)
ds_read_b128 a[72:75], v80 offset:8192
M v[196:199], a[172:175], v[20:23], v[196:199]
L_hop_a1:
s_cbranch_execz L_ret_a1
s_add_u32 s46, s78, 8192
ds_read_b128 a[76:79], v81 offset:8192
M v[200:203], a[168:171], v[24:27], v[200:203]
s_add_u32 s56, s53, 7
buffer_load_dwordx4 a[212:215], v70, s[12:15], s63 offen offset:1024 nt
M v[200:203], a[172:175], v[28:31], v[200:203]
s_and_b32 s56, s56, 7
s_lshl_b32 s56, s56, 7
s_lshl_b32 s57, s54, 8
M v[204:207], a[168:171], v[32:35], v[204:207]
s_add_u32 s56, s56, s57
s_add_u32 s56, s56, 50331648
ds_read_b64_tr_b16 a[184:185], v75 offset:16392
M v[204:207], a[172:175], v[36:39], v[204:207]
s_add_u32 s47, s78, 16384
ds_read_b64_tr_b16 a[186:187], v75 offset:16904
M v[208:211], a[168:171], v[40:43], v[208:211]
buffer_load_dwordx4 a[216:219], v69, s[12:15], s63 offen offset:2048 nt
ds_read_b64_tr_b16 a[188:189], v75 offset:20488
M v[208:211], a[172:175], v[44:47], v[208:211]
v_lshl_add_u32 v56, v85, 2, s56
v_cmp_gt_u32 vcc, 8, v85
M v[212:215], a[168:171], v[48:51], v[212:215]
s_add_u32 s48, s78, 24576
v_cndmask_b32 v56, -16, v56, vcc
v_mov_b32 v15, 0
M v[212:215], a[172:175], v[52:55], v[212:215]
s_waitcnt lgkmcnt(15)
ds_read_b64_tr_b16 a[190:191], v75 offset:21000
M v[216:219], a[176:179], v[16:19], v[216:219]
s_waitcnt lgkmcnt(14)
buffer_load_dwordx4 a[220:223], v70, s[12:15], s63 offen offset:3072 nt
buffer_store_dword v15, v56, s[24:27], 0 offen sc1
M v[216:219], a[180:183], v[20:23], v[216:219]
M v[220:223], a[176:179], v[24:27], v[220:223]
M v[220:223], a[180:183], v[28:31], v[220:223]
M v[224:227], a[176:179], v[32:35], v[224:227]
M v[224:227], a[180:183], v[36:39], v[224:227]
M v[228:231], a[176:179], v[40:43], v[228:231]
s_waitcnt vmcnt(22) lgkmcnt(0)
M v[228:231], a[180:183], v[44:47], v[228:231]
s_barrier
ds_read_b64_tr_b16 a[160:161], v74 offset:32768
M v[232:235], a[176:179], v[48:51], v[232:235]
ds_read_b64_tr_b16 a[162:163], v74 offset:33280
M v[232:235], a[180:183], v[52:55], v[232:235]
buffer_load_dwordx4 v73, s[8:11], s49 offen lds
M v[236:239], a[184:187], v[16:19], v[236:239]
s_add_u32 m0, s36, 115712
ds_read_b64_tr_b16 a[164:165], v74 offset:36864
M v[236:239], a[188:191], v[20:23], v[236:239]
s_add_u32 s49, s78, 32768
ds_read_b64_tr_b16 a[166:167], v74 offset:37376
M v[240:243], a[184:187], v[24:27], v[240:243]
ds_read_b64_tr_b16 a[168:169], v74 offset:32776
M v[240:243], a[188:191], v[28:31], v[240:243]
buffer_load_dwordx4 v73, s[8:11], s50 offen lds
M v[244:247], a[184:187], v[32:35], v[244:247]
s_add_u32 m0, s36, 116736
ds_read_b64_tr_b16 a[170:171], v74 offset:33288
M v[244:247], a[188:191], v[36:39], v[244:247]
s_add_u32 s50, s70, 0
ds_read_b64_tr_b16 a[172:173], v74 offset:36872
M v[248:251], a[184:187], v[40:43], v[248:251]
ds_read_b64_tr_b16 a[174:175], v74 offset:37384
M v[248:251], a[188:191], v[44:47], v[248:251]
buffer_load_dwordx4 v73, s[8:11], s51 offen lds
M v[252:255], a[184:187], v[48:51], v[252:255]
s_add_u32 m0, s36, 117760
ds_read_b64_tr_b16 a[176:177], v75 offset:32768
M v[252:255], a[188:191], v[52:55], v[252:255]
s_waitcnt lgkmcnt(7)
ds_read_b64_tr_b16 a[178:179], v75 offset:33280
M v[96:99], a[160:163], a[40:43], v[96:99]
s_waitcnt lgkmcnt(6)
ds_read_b64_tr_b16 a[180:181], v75 offset:36864
M v[96:99], a[164:167], a[44:47], v[96:99]
s_add_u32 s51, s70, 65536
buffer_load_dwordx4 v73, s[8:11], s44 offen lds
M v[100:103], a[160:163], a[48:51], v[100:103]
s_add_u32 m0, s37, 0
ds_read_b64_tr_b16 a[182:183], v75 offset:37376
M v[100:103], a[164:167], a[52:55], v[100:103]
s_add_u32 s44, s70, 131072
ds_read_b64_tr_b16 a[184:185], v75 offset:32776
M v[104:107], a[160:163], a[56:59], v[104:107]
s_add_u32 s63, s43, 40960
ds_read_b64_tr_b16 a[186:187], v75 offset:33288
M v[104:107], a[164:167], a[60:63], v[104:107]
s_and_b32 s63, s63, 131071
ds_read_b64_tr_b16 a[188:189], v75 offset:36872
M v[108:111], a[160:163], a[64:67], v[108:111]
s_add_u32 s63, s63, s32
buffer_load_dwordx4 v71, s[4:7], s45 offen lds
M v[108:111], a[164:167], a[68:71], v[108:111]
s_add_u32 m0, s37, 1024
ds_read_b64_tr_b16 a[190:191], v75 offset:37384
M v[112:115], a[160:163], a[72:75], v[112:115]
s_add_u32 s45, s70, 196608
M v[112:115], a[164:167], a[76:79], v[112:115]
s_waitcnt lgkmcnt(10)
M v[116:119], a[168:171], a[40:43], v[116:119]
s_waitcnt lgkmcnt(8)
buffer_load_dwordx4 v72, s[4:7], s46 offen lds
M v[116:119], a[172:175], a[44:47], v[116:119]
s_add_u32 m0, s37, 2048
M v[120:123], a[168:171], a[48:51], v[120:123]
M v[120:123], a[172:175], a[52:55], v[120:123]
M v[124:127], a[168:171], a[56:59], v[124:127]
buffer_load_dwordx4 v71, s[4:7], s47 offen lds
M v[124:127], a[172:175], a[60:63], v[124:127]
s_add_u32 m0, s37, 3072
M v[128:131], a[168:171], a[64:67], v[128:131]
M v[128:131], a[172:175], a[68:71], v[128:131]
M v[132:135], a[168:171], a[72:75], v[132:135]
buffer_load_dwordx4 v72, s[4:7], s48 offen lds
M v[132:135], a[172:175], a[76:79], v[132:135]
s_waitcnt lgkmcnt(6)
s_add_u32 m0, s37, 4096
M v[136:139], a[176:179], a[40:43], v[136:139]
s_waitcnt lgkmcnt(4)
M v[136:139], a[180:183], a[44:47], v[136:139]
M v[140:143], a[176:179], a[48:51], v[140:143]
M v[140:143], a[180:183], a[52:55], v[140:143]
s_waitcnt vmcnt(17) lgkmcnt(0)
buffer_load_dwordx4 v71, s[4:7], s49 offen lds
M v[144:147], a[176:179], a[56:59], v[144:147]
s_add_u32 m0, s36, 131072
M v[144:147], a[180:183], a[60:63], v[144:147]
s_barrier
ds_read_b64_tr_b16 a[160:161], v74 offset:49152
M v[148:151], a[176:179], a[64:67], v[148:151]
ds_read_b64_tr_b16 a[162:163], v74 offset:49664
M v[148:151], a[180:183], a[68:71], v[148:151]
ds_read_b64_tr_b16 a[164:165], v74 offset:53248
M v[152:155], a[176:179], a[72:75], v[152:155]
s_add_u32 s46, s71, 0
ds_read_b64_tr_b16 a[166:167], v74 offset:53760
M v[152:155], a[180:183], a[76:79], v[152:155]
buffer_load_dwordx4 v73, s[8:11], s50 offen lds
M v[156:159], a[184:187], a[40:43], v[156:159]
s_add_u32 m0, s36, 132096
ds_read_b64_tr_b16 a[168:169], v74 offset:49160
M v[156:159], a[188:191], a[44:47], v[156:159]
ds_read_b64_tr_b16 a[170:171], v74 offset:49672
M v[160:163], a[184:187], a[48:51], v[160:163]
s_add_u32 s47, s71, 65536
ds_read_b64_tr_b16 a[172:173], v74 offset:53256
M v[160:163], a[188:191], a[52:55], v[160:163]
ds_read_b64_tr_b16 a[174:175], v74 offset:53768
M v[164:167], a[184:187], a[56:59], v[164:167]
buffer_load_dwordx4 v73, s[8:11], s51 offen lds
M v[164:167], a[188:191], a[60:63], v[164:167]
s_add_u32 m0, s36, 133120
ds_read_b64_tr_b16 a[176:177], v75 offset:49152
M v[168:171], a[184:187], a[64:67], v[168:171]
ds_read_b64_tr_b16 a[178:179], v75 offset:49664
M v[168:171], a[188:191], a[68:71], v[168:171]
s_add_u32 s48, s71, 131072
ds_read_b64_tr_b16 a[180:181], v75 offset:53248
M v[172:175], a[184:187], a[72:75], v[172:175]
buffer_load_dwordx4 v73, s[8:11], s44 offen lds
M v[172:175], a[188:191], a[76:79], v[172:175]
s_waitcnt lgkmcnt(9)
ds_read_b64_tr_b16 a[182:183], v75 offset:53760
M v[176:179], a[160:163], a[40:43], v[176:179]
s_waitcnt lgkmcnt(8)
ds_read_b128 v[16:19], v82 offset:0
M v[176:179], a[164:167], a[44:47], v[176:179]
s_add_u32 m0, s36, 134144
ds_read_b128 v[20:23], v83 offset:0
M v[180:183], a[160:163], a[48:51], v[180:183]
s_add_u32 s49, s71, 196608
buffer_load_dwordx4 v73, s[8:11], s45 offen lds
M v[180:183], a[164:167], a[52:55], v[180:183]
s_add_u32 m0, s36, 147456
ds_read_b128 v[24:27], v82 offset:2048
M v[184:187], a[160:163], a[56:59], v[184:187]
ds_read_b128 v[28:31], v83 offset:2048
M v[184:187], a[164:167], a[60:63], v[184:187]
s_add_u32 s50, s79, 0
ds_read_b128 v[32:35], v82 offset:4096
M v[188:191], a[160:163], a[64:67], v[188:191]
buffer_load_dwordx4 a[224:227], v69, s[16:19], s63 offen offset:0 nt
M v[188:191], a[164:167], a[68:71], v[188:191]
ds_read_b128 v[36:39], v83 offset:4096
M v[192:195], a[160:163], a[72:75], v[192:195]
ds_read_b128 v[40:43], v82 offset:6144
M v[192:195], a[164:167], a[76:79], v[192:195]
s_waitcnt lgkmcnt(13)
ds_read_b128 v[44:47], v83 offset:6144
M v[196:199], a[168:171], a[40:43], v[196:199]
s_waitcnt lgkmcnt(12)
buffer_load_dwordx4 a[228:231], v70, s[16:19], s63 offen offset:1024 nt
M v[196:199], a[172:175], a[44:47], v[196:199]
s_add_u32 s51, s79, 8192
ds_read_b128 v[48:51], v82 offset:8192
M v[200:203], a[168:171], a[48:51], v[200:203]
ds_read_b128 v[52:55], v83 offset:8192
M v[200:203], a[172:175], a[52:55], v[200:203]
ds_read_b64_tr_b16 a[184:185], v75 offset:49160
M v[204:207], a[168:171], a[56:59], v[204:207]
s_add_u32 s44, s79, 16384
buffer_load_dwordx4 a[232:235], v69, s[16:19], s63 offen offset:2048 nt
M v[204:207], a[172:175], a[60:63], v[204:207]
ds_read_b64_tr_b16 a[186:187], v75 offset:49672
M v[208:211], a[168:171], a[64:67], v[208:211]
ds_read_b64_tr_b16 a[188:189], v75 offset:53256
M v[208:211], a[172:175], a[68:71], v[208:211]
ds_read_b64_tr_b16 a[190:191], v75 offset:53768
M v[212:215], a[168:171], a[72:75], v[212:215]
s_add_u32 s45, s79, 24576
buffer_load_dwordx4 a[236:239], v70, s[16:19], s63 offen offset:3072 nt
M v[212:215], a[172:175], a[76:79], v[212:215]
s_waitcnt lgkmcnt(15)
M v[216:219], a[176:179], a[40:43], v[216:219]
s_waitcnt lgkmcnt(14)
M v[216:219], a[180:183], a[44:47], v[216:219]
M v[220:223], a[176:179], a[48:51], v[220:223]
M v[220:223], a[180:183], a[52:55], v[220:223]
M v[224:227], a[176:179], a[56:59], v[224:227]
M v[224:227], a[180:183], a[60:63], v[224:227]
s_waitcnt vmcnt(22) lgkmcnt(0)
M v[228:231], a[176:179], a[64:67], v[228:231]
s_barrier
ds_read_b64_tr_b16 a[160:161], v74 offset:0
M v[228:231], a[180:183], a[68:71], v[228:231]
buffer_load_dwordx4 v73, s[8:11], s46 offen lds
M v[232:235], a[176:179], a[72:75], v[232:235]
s_add_u32 m0, s36, 148480
ds_read_b64_tr_b16 a[162:163], v74 offset:512
M v[232:235], a[180:183], a[76:79], v[232:235]
s_add_u32 s46, s79, 32768
ds_read_b64_tr_b16 a[164:165], v74 offset:4096
M v[236:239], a[184:187], a[40:43], v[236:239]
ds_read_b64_tr_b16 a[166:167], v74 offset:4608
M v[236:239], a[188:191], a[44:47], v[236:239]
buffer_load_dwordx4 v73, s[8:11], s47 offen lds
M v[240:243], a[184:187], a[48:51], v[240:243]
s_add_u32 m0, s36, 149504
ds_read_b64_tr_b16 a[168:169], v74 offset:8
M v[240:243], a[188:191], a[52:55], v[240:243]
s_add_u32 s47, s70, 128
ds_read_b64_tr_b16 a[170:171], v74 offset:520
M v[244:247], a[184:187], a[56:59], v[244:247]
ds_read_b64_tr_b16 a[172:173], v74 offset:4104
M v[244:247], a[188:191], a[60:63], v[244:247]
buffer_load_dwordx4 v73, s[8:11], s48 offen lds
M v[248:251], a[184:187], a[64:67], v[248:251]
s_add_u32 m0, s36, 150528
ds_read_b64_tr_b16 a[174:175], v74 offset:4616
M v[248:251], a[188:191], a[68:71], v[248:251]
s_add_u32 s48, s70, 65664
ds_read_b64_tr_b16 a[176:177], v75 offset:0
M v[252:255], a[184:187], a[72:75], v[252:255]
ds_read_b64_tr_b16 a[178:179], v75 offset:512
M v[252:255], a[188:191], a[76:79], v[252:255]
s_waitcnt lgkmcnt(8)
buffer_load_dwordx4 v73, s[8:11], s49 offen lds
M v[96:99], a[160:163], v[16:19], v[96:99]
s_waitcnt lgkmcnt(6)
ds_read_b64_tr_b16 a[180:181], v75 offset:4096
M v[96:99], a[164:167], v[20:23], v[96:99]
s_add_u32 m0, s38, 0
ds_read_b64_tr_b16 a[182:183], v75 offset:4608
M v[100:103], a[160:163], v[24:27], v[100:103]
s_add_u32 s49, s70, 131200
buffer_load_dwordx4 v71, s[4:7], s50 offen lds
M v[100:103], a[164:167], v[28:31], v[100:103]
s_add_u32 m0, s38, 1024
ds_read_b64_tr_b16 a[184:185], v75 offset:8
M v[104:107], a[160:163], v[32:35], v[104:107]
s_add_u32 s50, s70, 196736
ds_read_b64_tr_b16 a[186:187], v75 offset:520
M v[104:107], a[164:167], v[36:39], v[104:107]
s_add_u32 s63, s43, 49152
ds_read_b64_tr_b16 a[188:189], v75 offset:4104
M v[108:111], a[160:163], v[40:43], v[108:111]
s_and_b32 s63, s63, 131071
ds_read_b64_tr_b16 a[190:191], v75 offset:4616
M v[108:111], a[164:167], v[44:47], v[108:111]
s_add_u32 s63, s63, s32
buffer_load_dwordx4 v72, s[4:7], s51 offen lds
M v[112:115], a[160:163], v[48:51], v[112:115]
s_add_u32 m0, s38, 2048
M v[112:115], a[164:167], v[52:55], v[112:115]
s_waitcnt lgkmcnt(10)
M v[116:119], a[168:171], v[16:19], v[116:119]
s_waitcnt lgkmcnt(8)
M v[116:119], a[172:175], v[20:23], v[116:119]
buffer_load_dwordx4 v71, s[4:7], s44 offen lds
M v[120:123], a[168:171], v[24:27], v[120:123]
s_add_u32 m0, s38, 3072
M v[120:123], a[172:175], v[28:31], v[120:123]
M v[124:127], a[168:171], v[32:35], v[124:127]
M v[124:127], a[172:175], v[36:39], v[124:127]
buffer_load_dwordx4 v72, s[4:7], s45 offen lds
M v[128:131], a[168:171], v[40:43], v[128:131]
s_add_u32 m0, s38, 4096
M v[128:131], a[172:175], v[44:47], v[128:131]
M v[132:135], a[168:171], v[48:51], v[132:135]
M v[132:135], a[172:175], v[52:55], v[132:135]
s_waitcnt lgkmcnt(6)
buffer_load_dwordx4 v71, s[4:7], s46 offen lds
M v[136:139], a[176:179], v[16:19], v[136:139]
s_waitcnt lgkmcnt(4)
M v[136:139], a[180:183], v[20:23], v[136:139]
s_add_u32 m0, s36, 98304
M v[140:143], a[176:179], v[24:27], v[140:143]
M v[140:143], a[180:183], v[28:31], v[140:143]
s_waitcnt vmcnt(17) lgkmcnt(0)
M v[144:147], a[176:179], v[32:35], v[144:147]
s_barrier
ds_read_b64_tr_b16 a[160:161], v74 offset:16384
M v[144:147], a[180:183], v[36:39], v[144:147]
buffer_load_dwordx4 v73, s[8:11], s47 offen lds
M v[148:151], a[176:179], v[40:43], v[148:151]
s_add_u32 m0, s36, 99328
ds_read_b64_tr_b16 a[162:163], v74 offset:16896
M v[148:151], a[180:183], v[44:47], v[148:151]
ds_read_b64_tr_b16 a[164:165], v74 offset:20480
M v[152:155], a[176:179], v[48:51], v[152:155]
ds_read_b64_tr_b16 a[166:167], v74 offset:20992
M v[152:155], a[180:183], v[52:55], v[152:155]
s_add_u32 s51, s71, 128
ds_read_b64_tr_b16 a[168:169], v74 offset:16392
M v[156:159], a[184:187], v[16:19], v[156:159]
buffer_load_dwordx4 v73, s[8:11], s48 offen lds
M v[156:159], a[188:191], v[20:23], v[156:159]
s_add_u32 m0, s36, 100352
ds_read_b64_tr_b16 a[170:171], v74 offset:16904
M v[160:163], a[184:187], v[24:27], v[160:163]
ds_read_b64_tr_b16 a[172:173], v74 offset:20488
M v[160:163], a[188:191], v[28:31], v[160:163]
ds_read_b64_tr_b16 a[174:175], v74 offset:21000
M v[164:167], a[184:187], v[32:35], v[164:167]
s_add_u32 s44, s71, 65664
ds_read_b64_tr_b16 a[176:177], v75 offset:16384
M v[164:167], a[188:191], v[36:39], v[164:167]
buffer_load_dwordx4 v73, s[8:11], s49 offen lds
M v[168:171], a[184:187], v[40:43], v[168:171]
s_add_u32 m0, s36, 101376
ds_read_b64_tr_b16 a[178:179], v75 offset:16896
M v[168:171], a[188:191], v[44:47], v[168:171]
ds_read_b64_tr_b16 a[180:181], v75 offset:20480
M v[172:175], a[184:187], v[48:51], v[172:175]
s_add_u32 s45, s71, 131200
ds_read_b64_tr_b16 a[182:183], v75 offset:20992
M v[172:175], a[188:191], v[52:55], v[172:175]
s_waitcnt lgkmcnt(10)
ds_read_b128 a[40:43], v80 offset:0
M v[176:179], a[160:163], v[16:19], v[176:179]
s_waitcnt lgkmcnt(9)
buffer_load_dwordx4 v73, s[8:11], s50 offen lds
M v[176:179], a[164:167], v[20:23], v[176:179]
s_add_u32 m0, s36, 114688
ds_read_b128 a[44:47], v81 offset:0
M v[180:183], a[160:163], v[24:27], v[180:183]
ds_read_b128 a[48:51], v80 offset:2048
M v[180:183], a[164:167], v[28:31], v[180:183]
s_add_u32 s46, s71, 196736
ds_read_b128 a[52:55], v81 offset:2048
M v[184:187], a[160:163], v[32:35], v[184:187]
ds_read_b128 a[56:59], v80 offset:4096
M v[184:187], a[164:167], v[36:39], v[184:187]
buffer_load_dwordx4 a[240:243], v69, s[12:15], s63 offen offset:0 nt
M v[188:191], a[160:163], v[40:43], v[188:191]
ds_read_b128 a[60:63], v81 offset:4096
M v[188:191], a[164:167], v[44:47], v[188:191]
ds_read_b128 a[64:67], v80 offset:6144
M v[192:195], a[160:163], v[48:51], v[192:195]
s_add_u32 s47, s43, 16384
ds_read_b128 a[68:71], v81 offset:6144
M v[192:195], a[164:167], v[52:55], v[192:195]
s_waitcnt lgkmcnt(14)
buffer_load_dwordx4 a[244:247], v70, s[12:15], s63 offen offset:1024 nt
M v[196:199], a[168:171], v[16:19], v[196:199]
s_waitcnt lgkmcnt(12)
ds_read_b128 a[72:75], v80 offset:8192
M v[196:199], a[172:175], v[20:23], v[196:199]
s_and_b32 s47, s47, 131071
ds_read_b128 a[76:79], v81 offset:8192
M v[200:203], a[168:171], v[24:27], v[200:203]
s_add_u32 s47, s47, s32
ds_read_b64_tr_b16 a[184:185], v75 offset:16392
M v[200:203], a[172:175], v[28:31], v[200:203]
buffer_load_dwordx4 a[248:251], v69, s[12:15], s63 offen offset:2048 nt
M v[204:207], a[168:171], v[32:35], v[204:207]
ds_read_b64_tr_b16 a[186:187], v75 offset:16904
M v[204:207], a[172:175], v[36:39], v[204:207]
ds_read_b64_tr_b16 a[188:189], v75 offset:20488
M v[208:211], a[168:171], v[40:43], v[208:211]
ds_read_b64_tr_b16 a[190:191], v75 offset:21000
M v[208:211], a[172:175], v[44:47], v[208:211]
buffer_load_dwordx4 a[252:255], v70, s[12:15], s63 offen offset:3072 nt
M v[212:215], a[168:171], v[48:51], v[212:215]
M v[212:215], a[172:175], v[52:55], v[212:215]
s_waitcnt lgkmcnt(15)
M v[216:219], a[176:179], v[16:19], v[216:219]
s_waitcnt lgkmcnt(14)
M v[216:219], a[180:183], v[20:23], v[216:219]
M v[220:223], a[176:179], v[24:27], v[220:223]
M v[220:223], a[180:183], v[28:31], v[220:223]
M v[224:227], a[176:179], v[32:35], v[224:227]
s_waitcnt vmcnt(8) lgkmcnt(0)
M v[224:227], a[180:183], v[36:39], v[224:227]
s_barrier
ds_read_b64_tr_b16 a[160:161], v74 offset:32768
M v[228:231], a[176:179], v[40:43], v[228:231]
buffer_load_dwordx4 v73, s[8:11], s51 offen lds
M v[228:231], a[180:183], v[44:47], v[228:231]
s_add_u32 m0, s36, 115712
ds_read_b64_tr_b16 a[162:163], v74 offset:33280
M v[232:235], a[176:179], v[48:51], v[232:235]
ds_read_b64_tr_b16 a[164:165], v74 offset:36864
M v[232:235], a[180:183], v[52:55], v[232:235]
ds_read_b64_tr_b16 a[166:167], v74 offset:37376
M v[236:239], a[184:187], v[16:19], v[236:239]
buffer_load_dwordx4 v73, s[8:11], s44 offen lds
M v[236:239], a[188:191], v[20:23], v[236:239]
s_add_u32 m0, s36, 116736
ds_read_b64_tr_b16 a[168:169], v74 offset:32776
M v[240:243], a[184:187], v[24:27], v[240:243]
ds_read_b64_tr_b16 a[170:171], v74 offset:33288
M v[240:243], a[188:191], v[28:31], v[240:243]
s_add_u32 s48, s43, 24576
ds_read_b64_tr_b16 a[172:173], v74 offset:36872
M v[244:247], a[184:187], v[32:35], v[244:247]
s_and_b32 s48, s48, 131071
ds_read_b64_tr_b16 a[174:175], v74 offset:37384
M v[244:247], a[188:191], v[36:39], v[244:247]
s_add_u32 s48, s48, s32
buffer_load_dwordx4 v73, s[8:11], s45 offen lds
M v[248:251], a[184:187], v[40:43], v[248:251]
s_add_u32 m0, s36, 117760
ds_read_b64_tr_b16 a[176:177], v75 offset:32768
M v[248:251], a[188:191], v[44:47], v[248:251]
ds_read_b64_tr_b16 a[178:179], v75 offset:33280
M v[252:255], a[184:187], v[48:51], v[252:255]
ds_read_b64_tr_b16 a[180:181], v75 offset:36864
M v[252:255], a[188:191], v[52:55], v[252:255]
s_waitcnt lgkmcnt(9)
ds_read_b64_tr_b16 a[182:183], v75 offset:37376
M v[96:99], a[160:163], a[40:43], v[96:99]
s_waitcnt lgkmcnt(8)
buffer_load_dwordx4 v73, s[8:11], s46 offen lds
M v[96:99], a[164:167], a[44:47], v[96:99]
s_add_u32 m0, s36, 32768
ds_read_b64_tr_b16 a[184:185], v75 offset:32776
M v[100:103], a[160:163], a[48:51], v[100:103]
ds_read_b64_tr_b16 a[186:187], v75 offset:33288
M v[100:103], a[164:167], a[52:55], v[100:103]
ds_read_b64_tr_b16 a[188:189], v75 offset:36872
M v[104:107], a[160:163], a[56:59], v[104:107]
buffer_load_dwordx4 v69, s[12:15], s47 offen nt lds
M v[104:107], a[164:167], a[60:63], v[104:107]
ds_read_b64_tr_b16 a[190:191], v75 offset:37384
M v[108:111], a[160:163], a[64:67], v[108:111]
ds_read_b128 v[16:19], v82 offset:0
M v[108:111], a[164:167], a[68:71], v[108:111]
ds_read_b128 v[20:23], v83 offset:0
M v[112:115], a[160:163], a[72:75], v[112:115]
ds_read_b128 v[24:27], v82 offset:2048
M v[112:115], a[164:167], a[76:79], v[112:115]
s_waitcnt lgkmcnt(13)
buffer_load_dwordx4 v70, s[12:15], s47 offen offset:1024 nt lds
M v[116:119], a[168:171], a[40:43], v[116:119]
s_waitcnt lgkmcnt(11)
ds_read_b128 v[28:31], v83 offset:2048
M v[116:119], a[172:175], a[44:47], v[116:119]
ds_read_b128 v[32:35], v82 offset:4096
M v[120:123], a[168:171], a[48:51], v[120:123]
ds_read_b128 v[36:39], v83 offset:4096
M v[120:123], a[172:175], a[52:55], v[120:123]
ds_read_b128 v[40:43], v82 offset:6144
M v[124:127], a[168:171], a[56:59], v[124:127]
buffer_load_dwordx4 v69, s[12:15], s47 offen offset:2048 nt lds
M v[124:127], a[172:175], a[60:63], v[124:127]
ds_read_b128 v[44:47], v83 offset:6144
M v[128:131], a[168:171], a[64:67], v[128:131]
ds_read_b128 v[48:51], v82 offset:8192
M v[128:131], a[172:175], a[68:71], v[128:131]
ds_read_b128 v[52:55], v83 offset:8192
M v[132:135], a[168:171], a[72:75], v[132:135]
M v[132:135], a[172:175], a[76:79], v[132:135]
s_waitcnt lgkmcnt(15)
buffer_load_dwordx4 v70, s[12:15], s47 offen offset:3072 nt lds
M v[136:139], a[176:179], a[40:43], v[136:139]
s_waitcnt lgkmcnt(14)
M v[136:139], a[180:183], a[44:47], v[136:139]
s_add_u32 m0, s36, 49152
M v[140:143], a[176:179], a[48:51], v[140:143]
M v[140:143], a[180:183], a[52:55], v[140:143]
M v[144:147], a[176:179], a[56:59], v[144:147]
M v[144:147], a[180:183], a[60:63], v[144:147]
s_waitcnt lgkmcnt(0)
M v[148:151], a[176:179], a[64:67], v[148:151]
s_barrier
ds_read_b64_tr_b16 a[160:161], v74 offset:49152
M v[148:151], a[180:183], a[68:71], v[148:151]
ds_read_b64_tr_b16 a[162:163], v74 offset:49664
M v[152:155], a[176:179], a[72:75], v[152:155]
ds_read_b64_tr_b16 a[164:165], v74 offset:53248
M v[152:155], a[180:183], a[76:79], v[152:155]
ds_read_b64_tr_b16 a[166:167], v74 offset:53760
M v[156:159], a[184:187], a[40:43], v[156:159]
buffer_load_dwordx4 v69, s[12:15], s48 offen nt lds
M v[156:159], a[188:191], a[44:47], v[156:159]
ds_read_b64_tr_b16 a[168:169], v74 offset:49160
M v[160:163], a[184:187], a[48:51], v[160:163]
ds_read_b64_tr_b16 a[170:171], v74 offset:49672
M v[160:163], a[188:191], a[52:55], v[160:163]
s_add_u32 s49, s43, 8192
ds_read_b64_tr_b16 a[172:173], v74 offset:53256
M v[164:167], a[184:187], a[56:59], v[164:167]
s_and_b32 s49, s49, 131071
ds_read_b64_tr_b16 a[174:175], v74 offset:53768
M v[164:167], a[188:191], a[60:63], v[164:167]
s_add_u32 s49, s49, s32
buffer_load_dwordx4 v70, s[12:15], s48 offen offset:1024 nt lds
M v[168:171], a[184:187], a[64:67], v[168:171]
ds_read_b64_tr_b16 a[176:177], v75 offset:49152
M v[168:171], a[188:191], a[68:71], v[168:171]
ds_read_b64_tr_b16 a[178:179], v75 offset:49664
M v[172:175], a[184:187], a[72:75], v[172:175]
ds_read_b64_tr_b16 a[180:181], v75 offset:53248
M v[172:175], a[188:191], a[76:79], v[172:175]
s_waitcnt lgkmcnt(9)
ds_read_b64_tr_b16 a[182:183], v75 offset:53760
M v[96:99], a[160:163], v[16:19], v[96:99]
s_waitcnt lgkmcnt(8)
ds_read_b64_tr_b16 a[184:185], v75 offset:49160
M v[96:99], a[164:167], v[20:23], v[96:99]
ds_read_b64_tr_b16 a[186:187], v75 offset:49672
M v[100:103], a[160:163], v[24:27], v[100:103]
ds_read_b64_tr_b16 a[188:189], v75 offset:53256
M v[100:103], a[164:167], v[28:31], v[100:103]
ds_read_b64_tr_b16 a[190:191], v75 offset:53768
M v[104:107], a[160:163], v[32:35], v[104:107]
buffer_load_dwordx4 v69, s[12:15], s48 offen offset:2048 nt lds
M v[104:107], a[164:167], v[36:39], v[104:107]
v_mul_f32 v96, s41, v96
v_mul_f32 v97, s41, v97
M v[108:111], a[160:163], v[40:43], v[108:111]
L_hop_a2:
s_cbranch_execz L_ret_a2
v_mul_f32 v98, s41, v98
v_mul_f32 v99, s41, v99
M v[108:111], a[164:167], v[44:47], v[108:111]
v_cvt_pk_bf16_f32 v96, v96, v97
v_mul_f32 v100, s41, v100
M v[112:115], a[160:163], v[48:51], v[112:115]
v_accvgpr_write_b32 a0, v96
v_cvt_pk_bf16_f32 v97, v98, v99
M v[112:115], a[164:167], v[52:55], v[112:115]
s_waitcnt lgkmcnt(10)
v_accvgpr_write_b32 a1, v97
v_mul_f32 v101, s41, v101
M v[116:119], a[168:171], v[16:19], v[116:119]
s_waitcnt lgkmcnt(8)
v_mul_f32 v102, s41, v102
v_mul_f32 v103, s41, v103
M v[116:119], a[172:175], v[20:23], v[116:119]
v_cvt_pk_bf16_f32 v100, v100, v101
v_mul_f32 v104, s41, v104
M v[120:123], a[168:171], v[24:27], v[120:123]
v_accvgpr_write_b32 a4, v100
v_cvt_pk_bf16_f32 v101, v102, v103
M v[120:123], a[172:175], v[28:31], v[120:123]
v_accvgpr_write_b32 a5, v101
v_mul_f32 v105, s41, v105
M v[124:127], a[168:171], v[32:35], v[124:127]
buffer_load_dwordx4 v70, s[12:15], s48 offen offset:3072 nt lds
M v[124:127], a[172:175], v[36:39], v[124:127]
v_mul_f32 v116, s41, v116
v_mul_f32 v117, s41, v117
M v[128:131], a[168:171], v[40:43], v[128:131]
v_mul_f32 v118, s41, v118
v_mul_f32 v119, s41, v119
M v[128:131], a[172:175], v[44:47], v[128:131]
v_cvt_pk_bf16_f32 v116, v116, v117
v_mul_f32 v120, s41, v120
M v[132:135], a[168:171], v[48:51], v[132:135]
v_accvgpr_write_b32 a2, v116
v_cvt_pk_bf16_f32 v117, v118, v119
M v[132:135], a[172:175], v[52:55], v[132:135]
s_waitcnt lgkmcnt(6)
v_accvgpr_write_b32 a3, v117
v_mul_f32 v121, s41, v121
M v[136:139], a[176:179], v[16:19], v[136:139]
s_waitcnt lgkmcnt(4)
v_mul_f32 v122, s41, v122
v_mul_f32 v123, s41, v123
M v[136:139], a[180:183], v[20:23], v[136:139]
v_cvt_pk_bf16_f32 v120, v120, v121
v_mul_f32 v124, s41, v124
M v[140:143], a[176:179], v[24:27], v[140:143]
v_accvgpr_write_b32 a6, v120
v_cvt_pk_bf16_f32 v121, v122, v123
M v[140:143], a[180:183], v[28:31], v[140:143]
s_waitcnt vmcnt(16) lgkmcnt(0)
v_accvgpr_write_b32 a7, v121
v_mul_f32 v125, s41, v125
M v[144:147], a[176:179], v[32:35], v[144:147]
s_barrier
ds_read_b64_tr_b16 a[160:161], v74 offset:0
v_mul_f32 v136, s41, v136
M v[144:147], a[180:183], v[36:39], v[144:147]
s_add_u32 m0, s36, 81920
ds_read_b64_tr_b16 a[162:163], v74 offset:512
v_mul_f32 v137, s41, v137
M v[148:151], a[176:179], v[40:43], v[148:151]
ds_read_b64_tr_b16 a[164:165], v74 offset:4096
v_mul_f32 v138, s41, v138
M v[148:151], a[180:183], v[44:47], v[148:151]
ds_read_b64_tr_b16 a[166:167], v74 offset:4608
v_mul_f32 v139, s41, v139
M v[152:155], a[176:179], v[48:51], v[152:155]
buffer_load_dwordx4 v69, s[16:19], s49 offen nt lds
M v[152:155], a[180:183], v[52:55], v[152:155]
ds_read_b64_tr_b16 a[168:169], v74 offset:8
v_cvt_pk_bf16_f32 v136, v136, v137
M v[156:159], a[184:187], v[16:19], v[156:159]
ds_read_b64_tr_b16 a[170:171], v74 offset:520
v_cvt_pk_bf16_f32 v137, v138, v139
M v[156:159], a[188:191], v[20:23], v[156:159]
ds_read_b64_tr_b16 a[172:173], v74 offset:4104
v_accvgpr_write_b32 a20, v136
M v[160:163], a[184:187], v[24:27], v[160:163]
ds_read_b64_tr_b16 a[174:175], v74 offset:4616
v_accvgpr_write_b32 a21, v137
M v[160:163], a[188:191], v[28:31], v[160:163]
s_add_u32 s50, s43, 16384
ds_read_b64_tr_b16 a[176:177], v75 offset:0
v_mul_f32 v140, s41, v140
M v[164:167], a[184:187], v[32:35], v[164:167]
s_and_b32 s50, s50, 131071
ds_read_b64_tr_b16 a[178:179], v75 offset:512
v_mul_f32 v156, s41, v156
M v[164:167], a[188:191], v[36:39], v[164:167]
s_add_u32 s50, s50, s32
buffer_load_dwordx4 v70, s[16:19], s49 offen offset:1024 nt lds
M v[168:171], a[184:187], v[40:43], v[168:171]
ds_read_b64_tr_b16 a[180:181], v75 offset:4096
v_mul_f32 v157, s41, v157
M v[168:171], a[188:191], v[44:47], v[168:171]
ds_read_b64_tr_b16 a[182:183], v75 offset:4608
v_mul_f32 v158, s41, v158
M v[172:175], a[184:187], v[48:51], v[172:175]
ds_read_b64_tr_b16 a[184:185], v75 offset:8
v_mul_f32 v159, s41, v159
M v[172:175], a[188:191], v[52:55], v[172:175]
s_waitcnt lgkmcnt(11)
ds_read_b64_tr_b16 a[186:187], v75 offset:520
v_cvt_pk_bf16_f32 v156, v156, v157
M v[176:179], a[160:163], a[40:43], v[176:179]
s_waitcnt lgkmcnt(10)
ds_read_b64_tr_b16 a[188:189], v75 offset:4104
v_cvt_pk_bf16_f32 v157, v158, v159
M v[176:179], a[164:167], a[44:47], v[176:179]
ds_read_b64_tr_b16 a[190:191], v75 offset:4616
v_accvgpr_write_b32 a22, v156
M v[180:183], a[160:163], a[48:51], v[180:183]
v_accvgpr_write_b32 a23, v157
v_mul_f32 v141, s41, v141
M v[180:183], a[164:167], a[52:55], v[180:183]
v_mul_f32 v160, s41, v160
v_mul_f32 v161, s41, v161
M v[184:187], a[160:163], a[56:59], v[184:187]
buffer_load_dwordx4 v69, s[16:19], s49 offen offset:2048 nt lds
M v[184:187], a[164:167], a[60:63], v[184:187]
v_mul_f32 v142, s41, v142
v_mul_f32 v143, s41, v143
M v[188:191], a[160:163], a[64:67], v[188:191]
v_cvt_pk_bf16_f32 v140, v140, v141
v_mul_f32 v162, s41, v162
M v[188:191], a[164:167], a[68:71], v[188:191]
v_mul_f32 v163, s41, v163
v_cvt_pk_bf16_f32 v160, v160, v161
M v[192:195], a[160:163], a[72:75], v[192:195]
v_cvt_pk_bf16_f32 v141, v142, v143
v_cvt_pk_bf16_f32 v161, v162, v163
M v[192:195], a[164:167], a[76:79], v[192:195]
s_waitcnt lgkmcnt(10)
v_accvgpr_write_b32 a24, v140
v_accvgpr_write_b32 a25, v141
M v[196:199], a[168:171], a[40:43], v[196:199]
s_waitcnt lgkmcnt(8)
v_accvgpr_write_b32 a26, v160
v_accvgpr_write_b32 a27, v161
M v[196:199], a[172:175], a[44:47], v[196:199]
v_mul_f32 v106, s41, v106
v_mul_f32 v107, s41, v107
M v[200:203], a[168:171], a[48:51], v[200:203]
v_cvt_pk_bf16_f32 v104, v104, v105
v_mul_f32 v126, s41, v126
M v[200:203], a[172:175], a[52:55], v[200:203]
v_mul_f32 v127, s41, v127
v_cvt_pk_bf16_f32 v124, v124, v125
M v[204:207], a[168:171], a[56:59], v[204:207]
buffer_load_dwordx4 v70, s[16:19], s49 offen offset:3072 nt lds
M v[204:207], a[172:175], a[60:63], v[204:207]
v_mul_f32 v144, s41, v144
v_mul_f32 v145, s41, v145
M v[208:211], a[168:171], a[64:67], v[208:211]
v_mul_f32 v164, s41, v164
v_mul_f32 v165, s41, v165
M v[208:211], a[172:175], a[68:71], v[208:211]
v_cvt_pk_bf16_f32 v105, v106, v107
v_cvt_pk_bf16_f32 v125, v126, v127
M v[212:215], a[168:171], a[72:75], v[212:215]
v_mul_f32 v146, s41, v146
v_mul_f32 v147, s41, v147
M v[212:215], a[172:175], a[76:79], v[212:215]
s_waitcnt lgkmcnt(6)
v_cvt_pk_bf16_f32 v144, v144, v145
v_mul_f32 v166, s41, v166
M v[216:219], a[176:179], a[40:43], v[216:219]
s_waitcnt lgkmcnt(4)
v_mul_f32 v167, s41, v167
v_cvt_pk_bf16_f32 v164, v164, v165
M v[216:219], a[180:183], a[44:47], v[216:219]
v_accvgpr_write_b32 a8, v104
v_accvgpr_write_b32 a9, v105
M v[220:223], a[176:179], a[48:51], v[220:223]
v_accvgpr_write_b32 a10, v124
v_accvgpr_write_b32 a11, v125
M v[220:223], a[180:183], a[52:55], v[220:223]
s_waitcnt vmcnt(12) lgkmcnt(0)
v_cvt_pk_bf16_f32 v145, v146, v147
v_cvt_pk_bf16_f32 v165, v166, v167
M v[224:227], a[176:179], a[56:59], v[224:227]
s_barrier
ds_read_b64_tr_b16 a[160:161], v74 offset:16384
v_accvgpr_write_b32 a28, v144
M v[224:227], a[180:183], a[60:63], v[224:227]
s_add_u32 m0, s36, 98304
ds_read_b64_tr_b16 a[162:163], v74 offset:16896
v_accvgpr_write_b32 a29, v145
M v[228:231], a[176:179], a[64:67], v[228:231]
ds_read_b64_tr_b16 a[164:165], v74 offset:20480
v_accvgpr_write_b32 a30, v164
M v[228:231], a[180:183], a[68:71], v[228:231]
ds_read_b64_tr_b16 a[166:167], v74 offset:20992
v_accvgpr_write_b32 a31, v165
M v[232:235], a[176:179], a[72:75], v[232:235]
buffer_load_dwordx4 v69, s[16:19], s50 offen nt lds
M v[232:235], a[180:183], a[76:79], v[232:235]
ds_read_b64_tr_b16 a[168:169], v74 offset:16392
v_mul_f32 v108, s41, v108
M v[236:239], a[184:187], a[40:43], v[236:239]
ds_read_b64_tr_b16 a[170:171], v74 offset:16904
v_mul_f32 v109, s41, v109
M v[236:239], a[188:191], a[44:47], v[236:239]
ds_read_b64_tr_b16 a[172:173], v74 offset:20488
v_mul_f32 v128, s41, v128
M v[240:243], a[184:187], a[48:51], v[240:243]
ds_read_b64_tr_b16 a[174:175], v74 offset:21000
v_mul_f32 v129, s41, v129
M v[240:243], a[188:191], a[52:55], v[240:243]
ds_read_b64_tr_b16 a[176:177], v75 offset:16384
v_mul_f32 v110, s41, v110
M v[244:247], a[184:187], a[56:59], v[244:247]
ds_read_b64_tr_b16 a[178:179], v75 offset:16896
v_mul_f32 v111, s41, v111
M v[244:247], a[188:191], a[60:63], v[244:247]
buffer_load_dwordx4 v70, s[16:19], s50 offen offset:1024 nt lds
M v[248:251], a[184:187], a[64:67], v[248:251]
ds_read_b64_tr_b16 a[180:181], v75 offset:20480
v_cvt_pk_bf16_f32 v108, v108, v109
M v[248:251], a[188:191], a[68:71], v[248:251]
ds_read_b64_tr_b16 a[182:183], v75 offset:20992
v_mul_f32 v130, s41, v130
M v[252:255], a[184:187], a[72:75], v[252:255]
ds_read_b64_tr_b16 a[184:185], v75 offset:16392
v_mul_f32 v131, s41, v131
M v[252:255], a[188:191], a[76:79], v[252:255]
s_waitcnt lgkmcnt(11)
ds_read_b64_tr_b16 a[186:187], v75 offset:16904
v_cvt_pk_bf16_f32 v128, v128, v129
M v[176:179], a[160:163], v[16:19], v[176:179]
s_waitcnt lgkmcnt(10)
ds_read_b64_tr_b16 a[188:189], v75 offset:20488
v_mul_f32 v148, s41, v148
M v[176:179], a[164:167], v[20:23], v[176:179]
ds_read_b64_tr_b16 a[190:191], v75 offset:21000
v_mul_f32 v149, s41, v149
M v[180:183], a[160:163], v[24:27], v[180:183]
v_mul_f32 v168, s41, v168
v_mul_f32 v169, s41, v169
M v[180:183], a[164:167], v[28:31], v[180:183]
v_cvt_pk_bf16_f32 v109, v110, v111
v_cvt_pk_bf16_f32 v129, v130, v131
M v[184:187], a[160:163], v[32:35], v[184:187]
buffer_load_dwordx4 v69, s[16:19], s50 offen offset:2048 nt lds
M v[184:187], a[164:167], v[36:39], v[184:187]
v_mul_f32 v176, s41, v176
v_mul_f32 v177, s41, v177
M v[188:191], a[160:163], v[40:43], v[188:191]
s_add_u32 s51, s43, 24576
v_mul_f32 v178, s41, v178
v_mul_f32 v179, s41, v179
M v[188:191], a[164:167], v[44:47], v[188:191]
s_and_b32 s51, s51, 131071
v_cvt_pk_bf16_f32 v176, v176, v177
v_mul_f32 v180, s41, v180
M v[192:195], a[160:163], v[48:51], v[192:195]
s_add_u32 s51, s51, s32
v_accvgpr_write_b32 a40, v176
v_cvt_pk_bf16_f32 v177, v178, v179
M v[192:195], a[164:167], v[52:55], v[192:195]
s_waitcnt lgkmcnt(10)
v_accvgpr_write_b32 a41, v177
v_mul_f32 v181, s41, v181
M v[196:199], a[168:171], v[16:19], v[196:199]
s_waitcnt lgkmcnt(8)
v_mul_f32 v182, s41, v182
v_mul_f32 v183, s41, v183
M v[196:199], a[172:175], v[20:23], v[196:199]
v_cvt_pk_bf16_f32 v180, v180, v181
v_mul_f32 v184, s41, v184
M v[200:203], a[168:171], v[24:27], v[200:203]
v_accvgpr_write_b32 a44, v180
v_cvt_pk_bf16_f32 v181, v182, v183
M v[200:203], a[172:175], v[28:31], v[200:203]
v_accvgpr_write_b32 a45, v181
v_mul_f32 v185, s41, v185
M v[204:207], a[168:171], v[32:35], v[204:207]
buffer_load_dwordx4 v70, s[16:19], s50 offen offset:3072 nt lds
M v[204:207], a[172:175], v[36:39], v[204:207]
v_mul_f32 v196, s41, v196
v_mul_f32 v197, s41, v197
M v[208:211], a[168:171], v[40:43], v[208:211]
v_mul_f32 v198, s41, v198
v_mul_f32 v199, s41, v199
M v[208:211], a[172:175], v[44:47], v[208:211]
v_cvt_pk_bf16_f32 v196, v196, v197
v_mul_f32 v200, s41, v200
M v[212:215], a[168:171], v[48:51], v[212:215]
v_accvgpr_write_b32 a42, v196
v_cvt_pk_bf16_f32 v197, v198, v199
v_accvgpr_write_b32 a43, v197
v_mul_f32 v201, s41, v201
v_mul_f32 v202, s41, v202
v_mul_f32 v203, s41, v203
v_cvt_pk_bf16_f32 v200, v200, v201
v_cvt_pk_bf16_f32 v201, v202, v203
M v[212:215], a[172:175], v[52:55], v[212:215]
s_waitcnt lgkmcnt(6)
v_accvgpr_write_b32 a46, v200
v_accvgpr_write_b32 a47, v201
s_add_u32 m0, s36, 114688
v_mul_f32 v204, s41, v204
v_mul_f32 v205, s41, v205
v_mul_f32 v186, s41, v186
v_mul_f32 v187, s41, v187
v_cvt_pk_bf16_f32 v184, v184, v185
M v[216:219], a[176:179], v[16:19], v[216:219]
s_waitcnt lgkmcnt(4)
v_mul_f32 v206, s41, v206
v_mul_f32 v207, s41, v207
v_cvt_pk_bf16_f32 v204, v204, v205
v_cvt_pk_bf16_f32 v185, v186, v187
v_cvt_pk_bf16_f32 v205, v206, v207
v_accvgpr_write_b32 a48, v184
v_accvgpr_write_b32 a49, v185
v_accvgpr_write_b32 a50, v204
M v[216:219], a[180:183], v[20:23], v[216:219]
v_accvgpr_write_b32 a51, v205
v_mul_f32 v150, s41, v150
v_mul_f32 v151, s41, v151
v_cvt_pk_bf16_f32 v148, v148, v149
v_mul_f32 v170, s41, v170
v_mul_f32 v171, s41, v171
v_cvt_pk_bf16_f32 v168, v168, v169
v_accvgpr_write_b32 a12, v108
M v[220:223], a[176:179], v[24:27], v[220:223]
v_mul_f32 v216, s41, v216
v_mul_f32 v217, s41, v217
v_mul_f32 v218, s41, v218
v_mul_f32 v219, s41, v219
v_cvt_pk_bf16_f32 v216, v216, v217
v_cvt_pk_bf16_f32 v217, v218, v219
v_accvgpr_write_b32 a60, v216
v_accvgpr_write_b32 a61, v217
M v[220:223], a[180:183], v[28:31], v[220:223]
v_accvgpr_write_b32 a13, v109
v_accvgpr_write_b32 a14, v128
v_accvgpr_write_b32 a15, v129
v_mul_f32 v188, s41, v188
v_mul_f32 v189, s41, v189
v_mul_f32 v208, s41, v208
v_mul_f32 v209, s41, v209
v_cvt_pk_bf16_f32 v149, v150, v151
M v[224:227], a[176:179], v[32:35], v[224:227]
v_mul_f32 v220, s41, v220
v_mul_f32 v221, s41, v221
v_mul_f32 v222, s41, v222
v_mul_f32 v223, s41, v223
v_cvt_pk_bf16_f32 v220, v220, v221
v_cvt_pk_bf16_f32 v221, v222, v223
v_accvgpr_write_b32 a64, v220
v_accvgpr_write_b32 a65, v221
M v[224:227], a[180:183], v[36:39], v[224:227]
s_waitcnt lgkmcnt(0)
v_cvt_pk_bf16_f32 v169, v170, v171
v_mul_f32 v190, s41, v190
v_mul_f32 v191, s41, v191
v_cvt_pk_bf16_f32 v188, v188, v189
v_mul_f32 v210, s41, v210
v_mul_f32 v211, s41, v211
v_cvt_pk_bf16_f32 v208, v208, v209
v_accvgpr_write_b32 a32, v148
M v[228:231], a[176:179], v[40:43], v[228:231]
s_barrier
ds_read_b128 a[160:163], v57 offset:0
v_mul_f32 v224, s41, v224
v_mul_f32 v225, s41, v225
v_mul_f32 v226, s41, v226
v_mul_f32 v227, s41, v227
v_cvt_pk_bf16_f32 v224, v224, v225
v_cvt_pk_bf16_f32 v225, v226, v227
v_accvgpr_write_b32 a68, v224
M v[228:231], a[180:183], v[44:47], v[228:231]
ds_read_b128 a[164:167], v58 offset:0
v_accvgpr_write_b32 a69, v225
v_accvgpr_write_b32 a33, v149
v_accvgpr_write_b32 a34, v168
v_accvgpr_write_b32 a35, v169
v_cvt_pk_bf16_f32 v189, v190, v191
v_cvt_pk_bf16_f32 v209, v210, v211
v_accvgpr_write_b32 a52, v188
M v[232:235], a[176:179], v[48:51], v[232:235]
ds_read_b128 a[168:171], v59 offset:0
v_mul_f32 v228, s41, v228
v_mul_f32 v229, s41, v229
v_mul_f32 v230, s41, v230
v_mul_f32 v231, s41, v231
v_cvt_pk_bf16_f32 v228, v228, v229
v_accvgpr_write_b32 a53, v189
v_accvgpr_write_b32 a54, v208
M v[232:235], a[180:183], v[52:55], v[232:235]
ds_read_b128 a[172:175], v60 offset:0
v_accvgpr_write_b32 a55, v209
v_mul_f32 v112, s41, v112
v_mul_f32 v113, s41, v113
v_mul_f32 v132, s41, v132
v_mul_f32 v133, s41, v133
v_cvt_pk_bf16_f32 v229, v230, v231
v_mul_f32 v114, s41, v114
M v[236:239], a[184:187], v[16:19], v[236:239]
ds_read_b128 a[176:179], v57 offset:4096
v_mul_f32 v115, s41, v115
v_cvt_pk_bf16_f32 v112, v112, v113
v_mul_f32 v134, s41, v134
v_mul_f32 v135, s41, v135
v_cvt_pk_bf16_f32 v132, v132, v133
v_accvgpr_write_b32 a72, v228
v_accvgpr_write_b32 a73, v229
M v[236:239], a[188:191], v[20:23], v[236:239]
ds_read_b128 a[180:183], v58 offset:4096
v_mul_f32 v152, s41, v152
v_mul_f32 v153, s41, v153
v_mul_f32 v172, s41, v172
v_mul_f32 v173, s41, v173
v_cvt_pk_bf16_f32 v113, v114, v115
v_cvt_pk_bf16_f32 v133, v134, v135
v_mul_f32 v154, s41, v154
M v[240:243], a[184:187], v[24:27], v[240:243]
v_mul_f32 v236, s41, v236
v_mul_f32 v237, s41, v237
v_mul_f32 v238, s41, v238
v_mul_f32 v239, s41, v239
v_cvt_pk_bf16_f32 v236, v236, v237
v_cvt_pk_bf16_f32 v237, v238, v239
v_accvgpr_write_b32 a62, v236
v_accvgpr_write_b32 a63, v237
M v[240:243], a[188:191], v[28:31], v[240:243]
v_mul_f32 v155, s41, v155
v_cvt_pk_bf16_f32 v152, v152, v153
v_mul_f32 v174, s41, v174
v_mul_f32 v175, s41, v175
v_cvt_pk_bf16_f32 v172, v172, v173
v_accvgpr_write_b32 a16, v112
v_accvgpr_write_b32 a17, v113
v_accvgpr_write_b32 a18, v132
M v[244:247], a[184:187], v[32:35], v[244:247]
v_mul_f32 v240, s41, v240
v_mul_f32 v241, s41, v241
v_mul_f32 v242, s41, v242
v_mul_f32 v243, s41, v243
v_cvt_pk_bf16_f32 v240, v240, v241
v_cvt_pk_bf16_f32 v241, v242, v243
v_accvgpr_write_b32 a66, v240
v_accvgpr_write_b32 a67, v241
M v[244:247], a[188:191], v[36:39], v[244:247]
v_accvgpr_write_b32 a19, v133
v_mul_f32 v192, s41, v192
v_mul_f32 v193, s41, v193
v_mul_f32 v212, s41, v212
v_mul_f32 v213, s41, v213
v_cvt_pk_bf16_f32 v153, v154, v155
v_cvt_pk_bf16_f32 v173, v174, v175
v_mul_f32 v194, s41, v194
M v[248:251], a[184:187], v[40:43], v[248:251]
v_mul_f32 v244, s41, v244
v_mul_f32 v245, s41, v245
v_mul_f32 v246, s41, v246
v_mul_f32 v247, s41, v247
v_cvt_pk_bf16_f32 v244, v244, v245
v_cvt_pk_bf16_f32 v245, v246, v247
v_accvgpr_write_b32 a70, v244
v_accvgpr_write_b32 a71, v245
M v[248:251], a[188:191], v[44:47], v[248:251]
v_mul_f32 v195, s41, v195
v_cvt_pk_bf16_f32 v192, v192, v193
v_mul_f32 v214, s41, v214
v_mul_f32 v215, s41, v215
v_cvt_pk_bf16_f32 v212, v212, v213
v_accvgpr_write_b32 a36, v152
v_accvgpr_write_b32 a37, v153
v_accvgpr_write_b32 a38, v172
M v[252:255], a[184:187], v[48:51], v[252:255]
v_mul_f32 v248, s41, v248
v_mul_f32 v249, s41, v249
v_mul_f32 v250, s41, v250
v_mul_f32 v251, s41, v251
v_cvt_pk_bf16_f32 v248, v248, v249
v_cvt_pk_bf16_f32 v249, v250, v251
v_accvgpr_write_b32 a74, v248
v_accvgpr_write_b32 a75, v249
M v[252:255], a[188:191], v[52:55], v[252:255]
s_waitcnt lgkmcnt(5)
ds_read_b128 a[184:187], v59 offset:4096
v_accvgpr_write_b32 a39, v173
v_mul_f32 v232, s41, v232
v_mul_f32 v233, s41, v233
v_cvt_pk_bf16_f32 v193, v194, v195
v_cvt_pk_bf16_f32 v213, v214, v215
v_mul_f32 v234, s41, v234
v_mul_f32 v235, s41, v235
M v[0:3], a[160:163], a[0:3], 0
s_waitcnt lgkmcnt(5)
buffer_load_dwordx4 v69, s[16:19], s51 offen nt lds
ds_read_b128 a[188:191], v60 offset:4096
v_mul_f32 v252, s41, v252
v_mul_f32 v253, s41, v253
v_cvt_pk_bf16_f32 v232, v232, v233
v_mul_f32 v254, s41, v254
v_mul_f32 v255, s41, v255
M v[0:3], a[164:167], a[20:23], v[0:3]
s_waitcnt lgkmcnt(5)
v_accvgpr_write_b32 a56, v192
v_cvt_pk_bf16_f32 v252, v252, v253
v_accvgpr_write_b32 a57, v193
v_accvgpr_write_b32 a58, v212
v_accvgpr_write_b32 a59, v213
v_cvt_pk_bf16_f32 v233, v234, v235
v_cvt_pk_bf16_f32 v253, v254, v255
v_accvgpr_write_b32 a76, v232
M v[0:3], a[168:171], a[40:43], v[0:3]
s_waitcnt lgkmcnt(4)
v_accvgpr_write_b32 a77, v233
v_accvgpr_write_b32 a78, v252
v_accvgpr_write_b32 a79, v253
M v[0:3], a[172:175], a[60:63], v[0:3]
M v[4:7], a[160:163], a[4:7], 0
M v[4:7], a[164:167], a[24:27], v[4:7]
M v[4:7], a[168:171], a[44:47], v[4:7]
M v[4:7], a[172:175], a[64:67], v[4:7]
M v[8:11], a[160:163], a[8:11], 0
buffer_load_dwordx4 v70, s[16:19], s51 offen offset:1024 nt lds
M v[8:11], a[164:167], a[28:31], v[8:11]
M v[8:11], a[168:171], a[48:51], v[8:11]
v_exp_f32 v0, v0
v_exp_f32 v1, v1
v_exp_f32 v2, v2
v_add_f32 v90, v0, v1
v_exp_f32 v3, v3
v_add_f32 v90, v90, v2
v_cvt_pk_bf16_f32 v16, v0, v1
M v[8:11], a[172:175], a[68:71], v[8:11]
v_cvt_pk_bf16_f32 v17, v2, v3
v_add_f32 v90, v90, v3
v_exp_f32 v4, v4
v_exp_f32 v5, v5
v_exp_f32 v6, v6
v_add_f32 v91, v4, v5
v_exp_f32 v7, v7
v_add_f32 v91, v91, v6
M v[12:15], a[160:163], a[12:15], 0
v_cvt_pk_bf16_f32 v20, v4, v5
v_cvt_pk_bf16_f32 v21, v6, v7
v_add_f32 v91, v91, v7
v_exp_f32 v8, v8
v_exp_f32 v9, v9
v_exp_f32 v10, v10
v_add_f32 v92, v8, v9
v_exp_f32 v11, v11
M v[12:15], a[164:167], a[32:35], v[12:15]
v_cvt_pk_bf16_f32 v24, v8, v9
v_add_f32 v92, v92, v10
v_cvt_pk_bf16_f32 v25, v10, v11
v_add_f32 v92, v92, v11
M v[12:15], a[168:171], a[52:55], v[12:15]
M v[12:15], a[172:175], a[72:75], v[12:15]
buffer_load_dwordx4 v69, s[16:19], s51 offen offset:2048 nt lds
s_add_u32 s44, s43, 32768
s_and_b32 s44, s44, 131071
s_add_u32 s44, s44, s32
M v[0:3], a[160:163], a[16:19], 0
M v[0:3], a[164:167], a[36:39], v[0:3]
M v[0:3], a[168:171], a[56:59], v[0:3]
M v[0:3], a[172:175], a[76:79], v[0:3]
s_waitcnt lgkmcnt(3)
v_exp_f32 v12, v12
v_exp_f32 v13, v13
v_exp_f32 v14, v14
v_add_f32 v93, v12, v13
v_exp_f32 v15, v15
v_add_f32 v93, v93, v14
v_cvt_pk_bf16_f32 v28, v12, v13
M v[4:7], a[176:179], a[0:3], 0
s_waitcnt lgkmcnt(2)
v_cvt_pk_bf16_f32 v29, v14, v15
v_add_f32 v93, v93, v15
v_exp_f32 v0, v0
v_exp_f32 v1, v1
v_exp_f32 v2, v2
v_add_f32 v94, v0, v1
v_exp_f32 v3, v3
v_add_f32 v94, v94, v2
M v[4:7], a[180:183], a[20:23], v[4:7]
s_waitcnt lgkmcnt(1)
v_cvt_pk_bf16_f32 v32, v0, v1
v_cvt_pk_bf16_f32 v33, v2, v3
v_add_f32 v94, v94, v3
M v[4:7], a[184:187], a[40:43], v[4:7]
s_waitcnt lgkmcnt(0)
M v[4:7], a[188:191], a[60:63], v[4:7]
s_barrier
ds_read_b128 a[160:163], v57 offset:16384
buffer_load_dwordx4 v70, s[16:19], s51 offen offset:3072 nt lds
ds_read_b128 a[164:167], v58 offset:16384
s_add_u32 m0, s36, 0
M v[8:11], a[176:179], a[4:7], 0
ds_read_b128 a[168:171], v59 offset:16384
M v[8:11], a[180:183], a[24:27], v[8:11]
v_exp_f32 v4, v4
v_exp_f32 v5, v5
v_add_f32 v90, v90, v4
v_exp_f32 v6, v6
v_add_f32 v90, v90, v5
v_exp_f32 v7, v7
v_add_f32 v90, v90, v6
M v[8:11], a[184:187], a[44:47], v[8:11]
ds_read_b128 a[172:175], v60 offset:16384
v_cvt_pk_bf16_f32 v18, v4, v5
v_cvt_pk_bf16_f32 v19, v6, v7
v_add_f32 v90, v90, v7
M v[8:11], a[188:191], a[64:67], v[8:11]
ds_read_b64_tr_b16 a[192:193], v61 offset:0
ds_read_b64_tr_b16 a[194:195], v61 offset:4096
ds_read_b64_tr_b16 a[196:197], v62 offset:0
ds_read_b64_tr_b16 a[198:199], v62 offset:4096
ds_read_b64_tr_b16 a[200:201], v63 offset:0
ds_read_b64_tr_b16 a[202:203], v63 offset:4096
M v[12:15], a[176:179], a[8:11], 0
buffer_load_dwordx4 v69, s[12:15], s44 offen nt lds
v_exp_f32 v8, v8
v_exp_f32 v9, v9
v_add_f32 v91, v91, v8
v_exp_f32 v10, v10
v_add_f32 v91, v91, v9
v_exp_f32 v11, v11
M v[12:15], a[180:183], a[28:31], v[12:15]
v_cvt_pk_bf16_f32 v22, v8, v9
v_add_f32 v91, v91, v10
v_cvt_pk_bf16_f32 v23, v10, v11
M v[12:15], a[184:187], a[48:51], v[12:15]
ds_read_b64_tr_b16 a[204:205], v64 offset:0
v_add_f32 v91, v91, v11
M v[12:15], a[188:191], a[68:71], v[12:15]
ds_read_b64_tr_b16 a[206:207], v64 offset:4096
M v[0:3], a[176:179], a[12:15], 0
M v[0:3], a[180:183], a[32:35], v[0:3]
M v[0:3], a[184:187], a[52:55], v[0:3]
M v[0:3], a[188:191], a[72:75], v[0:3]
M v[4:7], a[176:179], a[16:19], 0
s_and_b32 s62, s3, 3
s_lshl_b32 s62, s62, 13
v_lshrrev_b32 v56, 2, v85
v_lshlrev_b32 v56, 7, v56
s_add_u32 s62, s62, L_back0-4096-L_pc
buffer_load_dword v76, v56, s[28:31], s62 offen
s_and_b32 s62, s3, 3
s_lshl_b32 s62, s62, 13
s_add_u32 s62, s62, L_back0+28672-L_pc
M v[4:7], a[180:183], a[36:39], v[4:7]
v_exp_f32 v12, v12
v_exp_f32 v13, v13
v_exp_f32 v14, v14
v_exp_f32 v15, v15
v_exp_f32 v0, v0
v_exp_f32 v1, v1
M v[4:7], a[184:187], a[56:59], v[4:7]
v_exp_f32 v2, v2
M v[4:7], a[188:191], a[76:79], v[4:7]
s_waitcnt lgkmcnt(11)
v_exp_f32 v3, v3
M v[8:11], a[160:163], a[0:3], 0
s_waitcnt lgkmcnt(10)
v_cvt_pk_bf16_f32 v26, v12, v13
v_cvt_pk_bf16_f32 v27, v14, v15
M v[8:11], a[164:167], a[20:23], v[8:11]
s_waitcnt lgkmcnt(9)
v_cvt_pk_bf16_f32 v30, v0, v1
v_cvt_pk_bf16_f32 v31, v2, v3
M v[8:11], a[168:171], a[40:43], v[8:11]
s_waitcnt lgkmcnt(8)
v_add_f32 v92, v92, v12
v_add_f32 v93, v93, v0
M v[8:11], a[172:175], a[60:63], v[8:11]
s_waitcnt lgkmcnt(6)
v_add_f32 v92, v92, v13
v_add_f32 v93, v93, v1
v_add_f32 v92, v92, v14
M v[96:99], a[192:195], v[16:19], 0
v_add_f32 v92, v92, v15
v_add_f32 v93, v93, v2
v_exp_f32 v4, v4
M v[100:103], a[192:195], v[20:23], 0
buffer_load_dword v76, v56, s[28:31], s62 offen
M v[104:107], a[192:195], v[24:27], 0
v_exp_f32 v5, v5
M v[108:111], a[192:195], v[28:31], 0
v_exp_f32 v6, v6
M v[12:15], a[160:163], a[4:7], 0
v_exp_f32 v7, v7
M v[12:15], a[164:167], a[24:27], v[12:15]
v_cvt_pk_bf16_f32 v34, v4, v5
v_cvt_pk_bf16_f32 v35, v6, v7
M v[12:15], a[168:171], a[44:47], v[12:15]
v_add_f32 v93, v93, v3
v_add_f32 v94, v94, v4
M v[12:15], a[172:175], a[64:67], v[12:15]
ds_read_b128 a[176:179], v57 offset:20480
v_add_f32 v94, v94, v5
M v[112:115], a[192:195], v[32:35], 0
s_waitcnt lgkmcnt(5)
ds_read_b128 a[180:183], v58 offset:20480
v_add_f32 v94, v94, v6
M v[116:119], a[196:199], v[16:19], 0
ds_read_b128 a[184:187], v59 offset:20480
v_add_f32 v94, v94, v7
M v[120:123], a[196:199], v[20:23], 0
buffer_load_dwordx4 v70, s[12:15], s44 offen offset:1024 nt lds
M v[124:127], a[196:199], v[24:27], 0
v_exp_f32 v8, v8
M v[0:3], a[160:163], a[8:11], 0
v_exp_f32 v9, v9
M v[0:3], a[164:167], a[28:31], v[0:3]
v_cvt_pk_bf16_f32 v36, v8, v9
v_add_f32 v90, v90, v8
M v[0:3], a[168:171], a[48:51], v[0:3]
v_exp_f32 v10, v10
M v[0:3], a[172:175], a[68:71], v[0:3]
ds_read_b128 a[188:191], v60 offset:20480
v_add_f32 v90, v90, v9
M v[128:131], a[196:199], v[28:31], 0
v_exp_f32 v11, v11
M v[132:135], a[196:199], v[32:35], 0
s_waitcnt lgkmcnt(6)
v_cvt_pk_bf16_f32 v37, v10, v11
v_add_f32 v90, v90, v10
M v[136:139], a[200:203], v[16:19], 0
ds_read_b64_tr_b16 a[192:193], v65 offset:0
v_add_f32 v90, v90, v11
M v[140:143], a[200:203], v[20:23], 0
v_exp_f32 v12, v12
M v[4:7], a[160:163], a[12:15], 0
ds_read_b64_tr_b16 a[194:195], v65 offset:4096
v_add_f32 v91, v91, v12
M v[4:7], a[164:167], a[32:35], v[4:7]
v_exp_f32 v13, v13
M v[4:7], a[168:171], a[52:55], v[4:7]
v_exp_f32 v14, v14
M v[4:7], a[172:175], a[72:75], v[4:7]
v_cvt_pk_bf16_f32 v40, v12, v13
v_add_f32 v91, v91, v13
M v[144:147], a[200:203], v[24:27], 0
v_exp_f32 v15, v15
M v[148:151], a[200:203], v[28:31], 0
v_cvt_pk_bf16_f32 v41, v14, v15
v_add_f32 v91, v91, v14
M v[152:155], a[200:203], v[32:35], 0
s_waitcnt lgkmcnt(6)
ds_read_b64_tr_b16 a[196:197], v66 offset:0
v_add_f32 v91, v91, v15
M v[156:159], a[204:207], v[16:19], 0
buffer_load_dwordx4 v69, s[12:15], s44 offen offset:2048 nt lds
M v[8:11], a[160:163], a[16:19], 0
v_exp_f32 v0, v0
M v[8:11], a[164:167], a[36:39], v[8:11]
v_exp_f32 v1, v1
M v[8:11], a[168:171], a[56:59], v[8:11]
ds_read_b64_tr_b16 a[198:199], v66 offset:4096
v_add_f32 v92, v92, v0
M v[8:11], a[172:175], a[76:79], v[8:11]
v_exp_f32 v2, v2
M v[160:163], a[204:207], v[20:23], 0
v_cvt_pk_bf16_f32 v44, v0, v1
v_add_f32 v92, v92, v1
M v[164:167], a[204:207], v[24:27], 0
v_exp_f32 v3, v3
M v[168:171], a[204:207], v[28:31], 0
v_cvt_pk_bf16_f32 v45, v2, v3
v_add_f32 v92, v92, v2
M v[172:175], a[204:207], v[32:35], 0
s_waitcnt lgkmcnt(7)
ds_read_b64_tr_b16 a[200:201], v67 offset:0
v_add_f32 v92, v92, v3
M v[12:15], a[176:179], a[0:3], 0
s_waitcnt lgkmcnt(7)
v_exp_f32 v4, v4
M v[12:15], a[180:183], a[20:23], v[12:15]
s_waitcnt lgkmcnt(6)
v_exp_f32 v5, v5
M v[12:15], a[184:187], a[40:43], v[12:15]
s_waitcnt lgkmcnt(5)
ds_read_b64_tr_b16 a[202:203], v67 offset:4096
v_add_f32 v93, v93, v4
M v[12:15], a[188:191], a[60:63], v[12:15]
s_waitcnt lgkmcnt(4)
v_exp_f32 v6, v6
M v[176:179], a[192:195], v[16:19], 0
v_cvt_pk_bf16_f32 v48, v4, v5
v_add_f32 v93, v93, v5
M v[180:183], a[192:195], v[20:23], 0
v_exp_f32 v7, v7
M v[184:187], a[192:195], v[24:27], 0
v_cvt_pk_bf16_f32 v49, v6, v7
v_add_f32 v93, v93, v6
M v[188:191], a[192:195], v[28:31], 0
v_and_b32 v86, 63, v85
v_add_f32 v93, v93, v7
M v[0:3], a[176:179], a[4:7], 0
v_exp_f32 v8, v8
M v[0:3], a[180:183], a[24:27], v[0:3]
v_lshl_add_u32 v86, v86, 4, s36
v_add_f32 v94, v94, v8
M v[0:3], a[184:187], a[44:47], v[0:3]
v_exp_f32 v9, v9
M v[0:3], a[188:191], a[64:67], v[0:3]
ds_read_b64_tr_b16 a[204:205], v68 offset:0
v_add_u32 v87, 65536, v86
M v[192:195], a[192:195], v[32:35], 0
s_waitcnt lgkmcnt(3)
buffer_load_dwordx4 v70, s[12:15], s44 offen offset:3072 nt lds
M v[196:199], a[196:199], v[16:19], 0
v_exp_f32 v10, v10
M v[200:203], a[196:199], v[20:23], 0
ds_read_b64_tr_b16 a[206:207], v68 offset:4096
v_add_f32 v94, v94, v9
v_exp_f32 v11, v11
v_add_f32 v94, v94, v10
v_add_f32 v94, v94, v11
M v[204:207], a[196:199], v[24:27], 0
v_cvt_pk_bf16_f32 v52, v8, v9
v_cvt_pk_bf16_f32 v53, v10, v11
v_exp_f32 v12, v12
v_exp_f32 v13, v13
M v[4:7], a[176:179], a[8:11], 0
v_cvt_pk_bf16_f32 v38, v12, v13
v_add_f32 v90, v90, v12
v_exp_f32 v14, v14
v_add_f32 v90, v90, v13
v_exp_f32 v15, v15
M v[4:7], a[180:183], a[28:31], v[4:7]
v_cvt_pk_bf16_f32 v39, v14, v15
v_add_f32 v90, v90, v14
M v[4:7], a[184:187], a[48:51], v[4:7]
v_add_f32 v90, v90, v15
M v[4:7], a[188:191], a[68:71], v[4:7]
v_exp_f32 v0, v0
v_exp_f32 v1, v1
v_add_f32 v91, v91, v0
M v[208:211], a[196:199], v[28:31], 0
v_exp_f32 v2, v2
M v[212:215], a[196:199], v[32:35], 0
s_waitcnt lgkmcnt(2)
v_cvt_pk_bf16_f32 v42, v0, v1
v_add_f32 v91, v91, v1
M v[216:219], a[200:203], v[16:19], 0
v_exp_f32 v3, v3
M v[220:223], a[200:203], v[20:23], 0
v_cvt_pk_bf16_f32 v43, v2, v3
v_add_f32 v91, v91, v2
M v[8:11], a[176:179], a[12:15], 0
s_waitcnt vmcnt(14) lgkmcnt(0)
v_add_f32 v91, v91, v3
v_exp_f32 v4, v4
M v[8:11], a[180:183], a[32:35], v[8:11]
s_barrier
ds_read_b128 a[160:163], v57 offset:32768
v_add_f32 v92, v92, v4
M v[8:11], a[184:187], a[52:55], v[8:11]
ds_read_b128 a[164:167], v58 offset:32768
M v[8:11], a[188:191], a[72:75], v[8:11]
ds_read_b128 a[168:171], v59 offset:32768
v_exp_f32 v5, v5
M v[224:227], a[200:203], v[24:27], 0
ds_read_b128 a[172:175], v60 offset:32768
v_cvt_pk_bf16_f32 v46, v4, v5
M v[228:231], a[200:203], v[28:31], 0
ds_read_b64_tr_b16 a[192:193], v61 offset:16384
v_add_f32 v92, v92, v5
M v[232:235], a[200:203], v[32:35], 0
ds_read_b64_tr_b16 a[194:195], v61 offset:20480
M v[236:239], a[204:207], v[16:19], 0
ds_write_b128 v86, a[208:211] offset:16384
M v[12:15], a[176:179], a[16:19], 0
s_add_u32 s45, s43, 32768
v_exp_f32 v6, v6
M v[12:15], a[180:183], a[36:39], v[12:15]
s_and_b32 s45, s45, 131071
v_exp_f32 v7, v7
M v[12:15], a[184:187], a[56:59], v[12:15]
s_add_u32 m0, s36, 65536
ds_read_b64_tr_b16 a[196:197], v62 offset:16384
v_cvt_pk_bf16_f32 v47, v6, v7
M v[12:15], a[188:191], a[76:79], v[12:15]
s_add_u32 s45, s45, s32
v_exp_f32 v8, v8
M v[240:243], a[204:207], v[20:23], 0
v_exp_f32 v9, v9
M v[244:247], a[204:207], v[24:27], 0
v_exp_f32 v10, v10
M v[248:251], a[204:207], v[28:31], 0
v_exp_f32 v11, v11
M v[252:255], a[204:207], v[32:35], 0
s_waitcnt lgkmcnt(7)
ds_read_b64_tr_b16 a[198:199], v62 offset:20480
v_cvt_pk_bf16_f32 v50, v8, v9
M v[0:3], a[160:163], a[0:3], 0
s_waitcnt lgkmcnt(7)
v_add_f32 v92, v92, v6
v_cvt_pk_bf16_f32 v51, v10, v11
M v[0:3], a[164:167], a[20:23], v[0:3]
s_waitcnt lgkmcnt(6)
ds_read_b64_tr_b16 a[200:201], v63 offset:16384
v_add_f32 v92, v92, v7
M v[0:3], a[168:171], a[40:43], v[0:3]
s_waitcnt lgkmcnt(6)
ds_write_b128 v86, a[212:215] offset:17408
M v[0:3], a[172:175], a[60:63], v[0:3]
s_waitcnt lgkmcnt(5)
v_exp_f32 v12, v12
M v[96:99], a[192:195], v[36:39], v[96:99]
v_exp_f32 v13, v13
M v[100:103], a[192:195], v[40:43], v[100:103]
v_exp_f32 v14, v14
M v[104:107], a[192:195], v[44:47], v[104:107]
v_exp_f32 v15, v15
M v[108:111], a[192:195], v[48:51], v[108:111]
v_cvt_pk_bf16_f32 v54, v12, v13
v_cvt_pk_bf16_f32 v55, v14, v15
M v[4:7], a[160:163], a[4:7], 0
ds_read_b64_tr_b16 a[202:203], v63 offset:20480
v_add_f32 v93, v93, v8
M v[4:7], a[164:167], a[24:27], v[4:7]
v_add_f32 v93, v93, v9
v_add_f32 v94, v94, v12
M v[4:7], a[168:171], a[44:47], v[4:7]
v_add_f32 v93, v93, v10
v_add_f32 v94, v94, v13
M v[4:7], a[172:175], a[64:67], v[4:7]
ds_read_b64_tr_b16 a[204:205], v64 offset:16384
v_add_f32 v93, v93, v11
M v[112:115], a[192:195], v[52:55], v[112:115]
s_waitcnt lgkmcnt(4)
ds_write_b128 v86, a[216:219] offset:18432
M v[116:119], a[196:199], v[36:39], v[116:119]
v_add_f32 v94, v94, v14
v_add_f32 v94, v94, v15
M v[120:123], a[196:199], v[40:43], v[120:123]
ds_read_b64_tr_b16 a[206:207], v64 offset:20480
M v[124:127], a[196:199], v[44:47], v[124:127]
ds_write_b128 v86, a[220:223] offset:19456
M v[8:11], a[160:163], a[8:11], 0
v_exp_f32 v0, v0
M v[8:11], a[164:167], a[28:31], v[8:11]
v_exp_f32 v1, v1
M v[8:11], a[168:171], a[48:51], v[8:11]
ds_read_b128 a[176:179], v57 offset:36864
v_add_f32 v90, v90, v0
M v[8:11], a[172:175], a[68:71], v[8:11]
v_exp_f32 v2, v2
M v[128:131], a[196:199], v[48:51], v[128:131]
v_cvt_pk_bf16_f32 v16, v0, v1
v_add_f32 v90, v90, v1
M v[132:135], a[196:199], v[52:55], v[132:135]
s_waitcnt lgkmcnt(5)
v_exp_f32 v3, v3
M v[136:139], a[200:203], v[36:39], v[136:139]
v_cvt_pk_bf16_f32 v17, v2, v3
v_add_f32 v90, v90, v2
M v[140:143], a[200:203], v[40:43], v[140:143]
ds_read_b128 a[180:183], v58 offset:36864
v_add_f32 v90, v90, v3
M v[12:15], a[160:163], a[12:15], 0
ds_read_b128 a[184:187], v59 offset:36864
M v[12:15], a[164:167], a[32:35], v[12:15]
buffer_load_dwordx4 v69, s[16:19], s45 offen nt lds
M v[12:15], a[168:171], a[52:55], v[12:15]
ds_read_b128 a[188:191], v60 offset:36864
M v[12:15], a[172:175], a[72:75], v[12:15]
ds_read_b64_tr_b16 a[192:193], v65 offset:16384
M v[144:147], a[200:203], v[44:47], v[144:147]
v_exp_f32 v4, v4
M v[148:151], a[200:203], v[48:51], v[148:151]
ds_read_b64_tr_b16 a[194:195], v65 offset:20480
v_add_f32 v91, v91, v4
M v[152:155], a[200:203], v[52:55], v[152:155]
s_waitcnt lgkmcnt(7)
v_exp_f32 v5, v5
M v[156:159], a[204:207], v[36:39], v[156:159]
v_exp_f32 v6, v6
M v[0:3], a[160:163], a[16:19], 0
v_cvt_pk_bf16_f32 v20, v4, v5
v_add_f32 v91, v91, v5
M v[0:3], a[164:167], a[36:39], v[0:3]
v_exp_f32 v7, v7
M v[0:3], a[168:171], a[56:59], v[0:3]
v_cvt_pk_bf16_f32 v21, v6, v7
v_add_f32 v91, v91, v6
M v[0:3], a[172:175], a[76:79], v[0:3]
ds_read_b64_tr_b16 a[196:197], v66 offset:16384
v_add_f32 v91, v91, v7
M v[160:163], a[204:207], v[40:43], v[160:163]
buffer_load_dwordx4 v70, s[16:19], s45 offen offset:1024 nt lds
M v[164:167], a[204:207], v[44:47], v[164:167]
v_exp_f32 v8, v8
M v[168:171], a[204:207], v[48:51], v[168:171]
v_exp_f32 v9, v9
M v[172:175], a[204:207], v[52:55], v[172:175]
s_waitcnt lgkmcnt(6)
ds_read_b64_tr_b16 a[198:199], v66 offset:20480
v_add_f32 v92, v92, v8
M v[4:7], a[176:179], a[0:3], 0
s_waitcnt lgkmcnt(6)
v_exp_f32 v10, v10
M v[4:7], a[180:183], a[20:23], v[4:7]
s_waitcnt lgkmcnt(5)
v_cvt_pk_bf16_f32 v24, v8, v9
v_add_f32 v92, v92, v9
M v[4:7], a[184:187], a[40:43], v[4:7]
s_waitcnt lgkmcnt(4)
v_exp_f32 v11, v11
M v[4:7], a[188:191], a[60:63], v[4:7]
s_waitcnt lgkmcnt(2)
v_cvt_pk_bf16_f32 v25, v10, v11
v_add_f32 v92, v92, v10
M v[176:179], a[192:195], v[36:39], v[176:179]
ds_read_b64_tr_b16 a[200:201], v67 offset:16384
v_add_f32 v92, v92, v11
M v[180:183], a[192:195], v[40:43], v[180:183]
buffer_load_dwordx4 v69, s[16:19], s45 offen offset:2048 nt lds
M v[184:187], a[192:195], v[44:47], v[184:187]
v_exp_f32 v12, v12
M v[188:191], a[192:195], v[48:51], v[188:191]
v_exp_f32 v13, v13
v_add_f32 v93, v93, v12
v_exp_f32 v14, v14
v_add_f32 v93, v93, v13
M v[8:11], a[176:179], a[4:7], 0
v_exp_f32 v15, v15
v_add_f32 v93, v93, v14
M v[8:11], a[180:183], a[24:27], v[8:11]
ds_read_b64_tr_b16 a[202:203], v67 offset:20480
v_add_f32 v93, v93, v15
M v[8:11], a[184:187], a[44:47], v[8:11]
v_cvt_pk_bf16_f32 v28, v12, v13
v_cvt_pk_bf16_f32 v29, v14, v15
v_exp_f32 v0, v0
M v[8:11], a[188:191], a[64:67], v[8:11]
v_exp_f32 v1, v1
M v[192:195], a[192:195], v[52:55], v[192:195]
s_waitcnt lgkmcnt(2)
buffer_load_dwordx4 v70, s[16:19], s45 offen offset:3072 nt lds
M v[196:199], a[196:199], v[36:39], v[196:199]
ds_read_b64_tr_b16 a[204:205], v68 offset:16384
v_add_f32 v94, v94, v0
v_exp_f32 v2, v2
v_add_f32 v94, v94, v1
v_exp_f32 v3, v3
M v[200:203], a[196:199], v[40:43], v[200:203]
ds_read_b64_tr_b16 a[206:207], v68 offset:20480
v_add_f32 v94, v94, v2
v_add_f32 v94, v94, v3
v_cvt_pk_bf16_f32 v32, v0, v1
v_cvt_pk_bf16_f32 v33, v2, v3
v_exp_f32 v4, v4
v_exp_f32 v5, v5
M v[204:207], a[196:199], v[44:47], v[204:207]
v_cvt_pk_bf16_f32 v18, v4, v5
v_add_f32 v90, v90, v4
v_exp_f32 v6, v6
v_add_f32 v90, v90, v5
M v[12:15], a[176:179], a[8:11], 0
v_exp_f32 v7, v7
v_add_f32 v90, v90, v6
v_add_f32 v90, v90, v7
v_cvt_pk_bf16_f32 v19, v6, v7
v_exp_f32 v8, v8
M v[12:15], a[180:183], a[28:31], v[12:15]
v_exp_f32 v9, v9
M v[12:15], a[184:187], a[48:51], v[12:15]
v_cvt_pk_bf16_f32 v22, v8, v9
v_add_f32 v91, v91, v8
M v[12:15], a[188:191], a[68:71], v[12:15]
v_exp_f32 v10, v10
v_add_f32 v91, v91, v9
v_exp_f32 v11, v11
M v[208:211], a[196:199], v[48:51], v[208:211]
v_cvt_pk_bf16_f32 v23, v10, v11
v_add_f32 v91, v91, v10
M v[212:215], a[196:199], v[52:55], v[212:215]
s_waitcnt lgkmcnt(2)
v_add_f32 v91, v91, v11
v_exp_f32 v12, v12
M v[216:219], a[200:203], v[36:39], v[216:219]
v_exp_f32 v13, v13
M v[220:223], a[200:203], v[40:43], v[220:223]
v_exp_f32 v14, v14
M v[0:3], a[176:179], a[12:15], 0
s_waitcnt vmcnt(14) lgkmcnt(0)
v_exp_f32 v15, v15
M v[0:3], a[180:183], a[32:35], v[0:3]
s_barrier
ds_read_b128 a[160:163], v57 offset:49152
v_cvt_pk_bf16_f32 v26, v12, v13
M v[0:3], a[184:187], a[52:55], v[0:3]
ds_read_b128 a[164:167], v58 offset:49152
v_cvt_pk_bf16_f32 v27, v14, v15
M v[0:3], a[188:191], a[72:75], v[0:3]
ds_read_b128 a[168:171], v59 offset:49152
v_add_f32 v92, v92, v12
M v[224:227], a[200:203], v[44:47], v[224:227]
ds_read_b128 a[172:175], v60 offset:49152
v_add_f32 v92, v92, v13
M v[228:231], a[200:203], v[48:51], v[228:231]
ds_read_b64_tr_b16 a[192:193], v61 offset:32768
v_add_f32 v92, v92, v14
M v[232:235], a[200:203], v[52:55], v[232:235]
ds_read_b64_tr_b16 a[194:195], v61 offset:36864
v_add_f32 v92, v92, v15
M v[236:239], a[204:207], v[36:39], v[236:239]
ds_write_b128 v86, a[240:243] offset:32768
M v[4:7], a[176:179], a[16:19], 0
s_mov_b32 s28, s98
v_exp_f32 v0, v0
M v[4:7], a[180:183], a[36:39], v[4:7]
s_mov_b32 s29, s99
ds_read_b64_tr_b16 a[196:197], v62 offset:32768
v_add_f32 v93, v93, v0
M v[4:7], a[184:187], a[56:59], v[4:7]
s_mov_b32 s30, 256
v_exp_f32 v1, v1
M v[4:7], a[188:191], a[76:79], v[4:7]
s_mov_b32 s31, 0x20000
v_exp_f32 v2, v2
M v[240:243], a[204:207], v[40:43], v[240:243]
v_exp_f32 v3, v3
M v[244:247], a[204:207], v[44:47], v[244:247]
v_lshl_add_u32 v56, v85, 2, s54
v_cmp_gt_u32 vcc, 1, v85
M v[248:251], a[204:207], v[48:51], v[248:251]
ds_read_b64_tr_b16 a[198:199], v62 offset:36864
v_cvt_pk_bf16_f32 v30, v0, v1
M v[252:255], a[204:207], v[52:55], v[252:255]
s_waitcnt lgkmcnt(8)
v_cvt_pk_bf16_f32 v31, v2, v3
v_cndmask_b32 v56, -16, v56, vcc
M v[8:11], a[160:163], a[0:3], 0
s_waitcnt lgkmcnt(7)
buffer_atomic_add v70, v56, s[28:31], 0 offen
M v[8:11], a[164:167], a[20:23], v[8:11]
s_waitcnt lgkmcnt(6)
ds_write_b128 v86, a[244:247] offset:33792
M v[8:11], a[168:171], a[40:43], v[8:11]
s_waitcnt lgkmcnt(6)
v_exp_f32 v4, v4
M v[8:11], a[172:175], a[60:63], v[8:11]
s_waitcnt lgkmcnt(4)
v_exp_f32 v5, v5
M v[96:99], a[192:195], v[16:19], v[96:99]
v_exp_f32 v6, v6
M v[100:103], a[192:195], v[20:23], v[100:103]
v_exp_f32 v7, v7
M v[104:107], a[192:195], v[24:27], v[104:107]
v_cvt_pk_bf16_f32 v34, v4, v5
v_cvt_pk_bf16_f32 v35, v6, v7
M v[108:111], a[192:195], v[28:31], v[108:111]
ds_read_b64_tr_b16 a[200:201], v63 offset:32768
v_add_f32 v93, v93, v1
M v[12:15], a[160:163], a[4:7], 0
ds_read_b64_tr_b16 a[202:203], v63 offset:36864
v_add_f32 v93, v93, v2
M v[12:15], a[164:167], a[24:27], v[12:15]
v_add_f32 v93, v93, v3
v_add_f32 v94, v94, v4
M v[12:15], a[168:171], a[44:47], v[12:15]
ds_write_b128 v86, a[248:251] offset:34816
M v[12:15], a[172:175], a[64:67], v[12:15]
v_add_f32 v94, v94, v5
v_add_f32 v94, v94, v6
M v[112:115], a[192:195], v[32:35], v[112:115]
s_waitcnt lgkmcnt(4)
ds_read_b64_tr_b16 a[204:205], v64 offset:32768
v_add_f32 v94, v94, v7
M v[116:119], a[196:199], v[16:19], v[116:119]
ds_read_b64_tr_b16 a[206:207], v64 offset:36864
M v[120:123], a[196:199], v[20:23], v[120:123]
ds_read_b128 a[176:179], v57 offset:53248
M v[124:127], a[196:199], v[24:27], v[124:127]
ds_write_b128 v86, a[252:255] offset:35840
M v[0:3], a[160:163], a[8:11], 0
v_exp_f32 v8, v8
M v[0:3], a[164:167], a[28:31], v[0:3]
ds_read_b128 a[180:183], v58 offset:53248
v_add_f32 v90, v90, v8
M v[0:3], a[168:171], a[48:51], v[0:3]
v_exp_f32 v9, v9
M v[0:3], a[172:175], a[68:71], v[0:3]
v_exp_f32 v10, v10
M v[128:131], a[196:199], v[28:31], v[128:131]
v_cvt_pk_bf16_f32 v36, v8, v9
v_add_f32 v90, v90, v9
M v[132:135], a[196:199], v[32:35], v[132:135]
s_waitcnt lgkmcnt(6)
v_exp_f32 v11, v11
M v[136:139], a[200:203], v[16:19], v[136:139]
v_cvt_pk_bf16_f32 v37, v10, v11
v_add_f32 v90, v90, v10
M v[140:143], a[200:203], v[20:23], v[140:143]
ds_read_b128 a[184:187], v59 offset:53248
v_add_f32 v90, v90, v11
M v[4:7], a[160:163], a[12:15], 0
ds_write_b128 v87, a[224:227] offset:16384
M v[4:7], a[164:167], a[32:35], v[4:7]
v_exp_f32 v12, v12
M v[4:7], a[168:171], a[52:55], v[4:7]
ds_read_b128 a[188:191], v60 offset:53248
v_add_f32 v91, v91, v12
M v[4:7], a[172:175], a[72:75], v[4:7]
ds_read_b64_tr_b16 a[192:193], v65 offset:32768
M v[144:147], a[200:203], v[24:27], v[144:147]
ds_read_b64_tr_b16 a[194:195], v65 offset:36864
M v[148:151], a[200:203], v[28:31], v[148:151]
v_exp_f32 v13, v13
M v[152:155], a[200:203], v[32:35], v[152:155]
s_waitcnt lgkmcnt(8)
v_exp_f32 v14, v14
M v[156:159], a[204:207], v[16:19], v[156:159]
v_cvt_pk_bf16_f32 v40, v12, v13
v_add_f32 v91, v91, v13
v_exp_f32 v15, v15
v_add_f32 v91, v91, v14
v_add_f32 v91, v91, v15
M v[8:11], a[160:163], a[16:19], 0
ds_read_b64_tr_b16 a[196:197], v66 offset:32768
v_cvt_pk_bf16_f32 v41, v14, v15
M v[8:11], a[164:167], a[36:39], v[8:11]
ds_write_b128 v87, a[228:231] offset:17408
M v[8:11], a[168:171], a[56:59], v[8:11]
v_exp_f32 v0, v0
M v[8:11], a[172:175], a[76:79], v[8:11]
v_exp_f32 v1, v1
M v[160:163], a[204:207], v[20:23], v[160:163]
s_add_u32 s46, s43, 57344
ds_read_b64_tr_b16 a[198:199], v66 offset:36864
v_add_f32 v92, v92, v0
M v[164:167], a[204:207], v[24:27], v[164:167]
s_and_b32 s46, s46, 131071
v_exp_f32 v2, v2
M v[168:171], a[204:207], v[28:31], v[168:171]
s_add_u32 m0, s36, 49152
v_cvt_pk_bf16_f32 v44, v0, v1
v_add_f32 v92, v92, v1
M v[172:175], a[204:207], v[32:35], v[172:175]
s_waitcnt lgkmcnt(10)
v_exp_f32 v3, v3
M v[12:15], a[176:179], a[0:3], 0
s_waitcnt lgkmcnt(8)
v_cvt_pk_bf16_f32 v45, v2, v3
v_add_f32 v92, v92, v2
M v[12:15], a[180:183], a[20:23], v[12:15]
s_waitcnt lgkmcnt(7)
ds_read_b64_tr_b16 a[200:201], v67 offset:32768
v_add_f32 v92, v92, v3
M v[12:15], a[184:187], a[40:43], v[12:15]
s_waitcnt lgkmcnt(6)
ds_write_b128 v87, a[232:235] offset:18432
M v[12:15], a[188:191], a[60:63], v[12:15]
s_waitcnt lgkmcnt(5)
v_exp_f32 v4, v4
M v[176:179], a[192:195], v[16:19], v[176:179]
s_add_u32 s46, s46, s32
v_exp_f32 v5, v5
M v[180:183], a[192:195], v[20:23], v[180:183]
ds_read_b64_tr_b16 a[202:203], v67 offset:36864
v_add_f32 v93, v93, v4
M v[184:187], a[192:195], v[24:27], v[184:187]
v_exp_f32 v6, v6
M v[188:191], a[192:195], v[28:31], v[188:191]
v_cvt_pk_bf16_f32 v48, v4, v5
v_add_f32 v93, v93, v5
M v[0:3], a[176:179], a[4:7], 0
v_exp_f32 v7, v7
M v[0:3], a[180:183], a[24:27], v[0:3]
v_cvt_pk_bf16_f32 v49, v6, v7
v_add_f32 v93, v93, v6
M v[0:3], a[184:187], a[44:47], v[0:3]
ds_read_b64_tr_b16 a[204:205], v68 offset:32768
v_add_f32 v93, v93, v7
M v[0:3], a[188:191], a[64:67], v[0:3]
ds_write_b128 v87, a[236:239] offset:19456
M v[192:195], a[192:195], v[32:35], v[192:195]
s_waitcnt lgkmcnt(5)
v_exp_f32 v8, v8
M v[196:199], a[196:199], v[16:19], v[196:199]
v_exp_f32 v9, v9
M v[200:203], a[196:199], v[20:23], v[200:203]
ds_read_b64_tr_b16 a[206:207], v68 offset:36864
v_add_f32 v94, v94, v8
v_exp_f32 v10, v10
v_add_f32 v94, v94, v9
v_exp_f32 v11, v11
M v[204:207], a[196:199], v[24:27], v[204:207]
v_cvt_pk_bf16_f32 v52, v8, v9
v_add_f32 v94, v94, v10
v_add_f32 v94, v94, v11
v_cvt_pk_bf16_f32 v53, v10, v11
M v[4:7], a[176:179], a[8:11], 0
v_exp_f32 v12, v12
v_exp_f32 v13, v13
M v[4:7], a[180:183], a[28:31], v[4:7]
v_cvt_pk_bf16_f32 v38, v12, v13
v_add_f32 v90, v90, v12
M v[4:7], a[184:187], a[48:51], v[4:7]
v_exp_f32 v14, v14
M v[4:7], a[188:191], a[68:71], v[4:7]
v_add_f32 v90, v90, v13
v_add_f32 v90, v90, v14
v_exp_f32 v15, v15
v_exp_f32 v0, v0
M v[208:211], a[196:199], v[28:31], v[208:211]
v_cvt_pk_bf16_f32 v39, v14, v15
v_add_f32 v90, v90, v15
M v[212:215], a[196:199], v[32:35], v[212:215]
s_waitcnt lgkmcnt(3)
v_exp_f32 v1, v1
M v[216:219], a[200:203], v[16:19], v[216:219]
v_cvt_pk_bf16_f32 v42, v0, v1
v_add_f32 v91, v91, v0
M v[220:223], a[200:203], v[20:23], v[220:223]
v_exp_f32 v2, v2
M v[8:11], a[176:179], a[12:15], 0
s_waitcnt vmcnt(5) lgkmcnt(0)
v_add_f32 v91, v91, v1
v_add_f32 v91, v91, v2
M v[8:11], a[180:183], a[32:35], v[8:11]
s_barrier
ds_read_b128 a[160:163], v57 offset:0
M v[8:11], a[184:187], a[52:55], v[8:11]
ds_read_b128 a[164:167], v58 offset:0
v_exp_f32 v3, v3
M v[8:11], a[188:191], a[72:75], v[8:11]
ds_read_b128 a[168:171], v59 offset:0
v_add_f32 v91, v91, v3
M v[224:227], a[200:203], v[24:27], v[224:227]
ds_read_b128 a[172:175], v60 offset:0
v_cvt_pk_bf16_f32 v43, v2, v3
M v[228:231], a[200:203], v[28:31], v[228:231]
ds_read_b64_tr_b16 a[192:193], v61 offset:49152
M v[232:235], a[200:203], v[32:35], v[232:235]
ds_read_b64_tr_b16 a[194:195], v61 offset:53248
buffer_load_dwordx4 v69, s[12:15], s46 offen nt lds
M v[236:239], a[204:207], v[16:19], v[236:239]
v_exp_f32 v4, v4
M v[12:15], a[176:179], a[16:19], 0
s_add_u32 s47, s43, 49152
v_exp_f32 v5, v5
M v[12:15], a[180:183], a[36:39], v[12:15]
s_and_b32 s47, s47, 131071
v_exp_f32 v6, v6
M v[12:15], a[184:187], a[56:59], v[12:15]
s_add_u32 s47, s47, s32
v_exp_f32 v7, v7
M v[12:15], a[188:191], a[76:79], v[12:15]
ds_read_b64_tr_b16 a[196:197], v62 offset:49152
v_cvt_pk_bf16_f32 v46, v4, v5
M v[240:243], a[204:207], v[20:23], v[240:243]
v_exp_f32 v8, v8
M v[244:247], a[204:207], v[24:27], v[244:247]
v_exp_f32 v9, v9
M v[248:251], a[204:207], v[28:31], v[248:251]
v_exp_f32 v10, v10
M v[252:255], a[204:207], v[32:35], v[252:255]
s_waitcnt lgkmcnt(6)
v_exp_f32 v11, v11
M v[0:3], a[160:163], a[0:3], 0
s_waitcnt lgkmcnt(5)
v_cvt_pk_bf16_f32 v47, v6, v7
v_add_f32 v92, v92, v4
M v[0:3], a[164:167], a[20:23], v[0:3]
s_waitcnt lgkmcnt(4)
ds_read_b64_tr_b16 a[198:199], v62 offset:53248
v_add_f32 v92, v92, v5
M v[0:3], a[168:171], a[40:43], v[0:3]
s_waitcnt lgkmcnt(4)
v_cvt_pk_bf16_f32 v50, v8, v9
v_cvt_pk_bf16_f32 v51, v10, v11
M v[0:3], a[172:175], a[60:63], v[0:3]
s_waitcnt lgkmcnt(2)
ds_read_b64_tr_b16 a[200:201], v63 offset:49152
v_add_f32 v92, v92, v6
M v[96:99], a[192:195], v[36:39], v[96:99]
v_add_f32 v92, v92, v7
v_add_f32 v93, v93, v8
v_exp_f32 v12, v12
M v[100:103], a[192:195], v[40:43], v[100:103]
buffer_load_dwordx4 v70, s[12:15], s46 offen offset:1024 nt lds
M v[104:107], a[192:195], v[44:47], v[104:107]
v_exp_f32 v13, v13
M v[108:111], a[192:195], v[48:51], v[108:111]
v_exp_f32 v14, v14
M v[4:7], a[160:163], a[4:7], 0
v_exp_f32 v15, v15
M v[4:7], a[164:167], a[24:27], v[4:7]
v_cvt_pk_bf16_f32 v54, v12, v13
v_cvt_pk_bf16_f32 v55, v14, v15
M v[4:7], a[168:171], a[44:47], v[4:7]
ds_read_b64_tr_b16 a[202:203], v63 offset:53248
v_add_f32 v93, v93, v9
M v[4:7], a[172:175], a[64:67], v[4:7]
v_add_f32 v93, v93, v10
v_add_f32 v94, v94, v12
M v[112:115], a[192:195], v[52:55], v[112:115]
s_waitcnt lgkmcnt(2)
v_add_f32 v93, v93, v11
v_add_f32 v94, v94, v13
M v[116:119], a[196:199], v[36:39], v[116:119]
buffer_load_dwordx4 v69, s[12:15], s46 offen offset:2048 nt lds
M v[120:123], a[196:199], v[40:43], v[120:123]
ds_read_b64_tr_b16 a[204:205], v64 offset:49152
v_add_f32 v94, v94, v14
M v[124:127], a[196:199], v[44:47], v[124:127]
ds_read_b64_tr_b16 a[206:207], v64 offset:53248
v_add_f32 v94, v94, v15
M v[8:11], a[160:163], a[8:11], 0
v_exp_f32 v0, v0
M v[8:11], a[164:167], a[28:31], v[8:11]
buffer_load_dwordx4 v70, s[12:15], s46 offen offset:3072 nt lds
M v[8:11], a[168:171], a[48:51], v[8:11]
s_add_u32 m0, s36, 98304
v_exp_f32 v1, v1
M v[8:11], a[172:175], a[68:71], v[8:11]
ds_read_b128 a[176:179], v57 offset:4096
v_add_f32 v90, v90, v0
M v[128:131], a[196:199], v[48:51], v[128:131]
v_exp_f32 v2, v2
M v[132:135], a[196:199], v[52:55], v[132:135]
s_waitcnt lgkmcnt(3)
v_cvt_pk_bf16_f32 v16, v0, v1
v_add_f32 v90, v90, v1
M v[136:139], a[200:203], v[36:39], v[136:139]
v_exp_f32 v3, v3
M v[140:143], a[200:203], v[40:43], v[140:143]
v_cvt_pk_bf16_f32 v17, v2, v3
v_add_f32 v90, v90, v2
M v[12:15], a[160:163], a[12:15], 0
ds_read_b128 a[180:183], v58 offset:4096
v_add_f32 v90, v90, v3
M v[12:15], a[164:167], a[32:35], v[12:15]
ds_read_b128 a[184:187], v59 offset:4096
M v[12:15], a[168:171], a[52:55], v[12:15]
buffer_load_dwordx4 v69, s[16:19], s47 offen nt lds
M v[12:15], a[172:175], a[72:75], v[12:15]
ds_read_b128 a[188:191], v60 offset:4096
M v[144:147], a[200:203], v[44:47], v[144:147]
ds_read_b64_tr_b16 a[192:193], v65 offset:49152
M v[148:151], a[200:203], v[48:51], v[148:151]
v_exp_f32 v4, v4
M v[152:155], a[200:203], v[52:55], v[152:155]
s_waitcnt lgkmcnt(5)
ds_read_b64_tr_b16 a[194:195], v65 offset:53248
v_add_f32 v91, v91, v4
M v[156:159], a[204:207], v[36:39], v[156:159]
v_exp_f32 v5, v5
M v[0:3], a[160:163], a[16:19], 0
v_exp_f32 v6, v6
M v[0:3], a[164:167], a[36:39], v[0:3]
v_cvt_pk_bf16_f32 v20, v4, v5
v_add_f32 v91, v91, v5
M v[0:3], a[168:171], a[56:59], v[0:3]
v_exp_f32 v7, v7
M v[0:3], a[172:175], a[76:79], v[0:3]
v_cvt_pk_bf16_f32 v21, v6, v7
v_add_f32 v91, v91, v6
M v[160:163], a[204:207], v[40:43], v[160:163]
s_add_u32 s48, s43, 65536
ds_read_b64_tr_b16 a[196:197], v66 offset:49152
v_add_f32 v91, v91, v7
M v[164:167], a[204:207], v[44:47], v[164:167]
s_and_b32 s48, s48, 131071
buffer_load_dwordx4 v70, s[16:19], s47 offen offset:1024 nt lds
M v[168:171], a[204:207], v[48:51], v[168:171]
s_add_u32 s48, s48, s32
v_exp_f32 v8, v8
M v[172:175], a[204:207], v[52:55], v[172:175]
s_waitcnt lgkmcnt(6)
v_exp_f32 v9, v9
M v[4:7], a[176:179], a[0:3], 0
s_waitcnt lgkmcnt(5)
ds_read_b64_tr_b16 a[198:199], v66 offset:53248
v_add_f32 v92, v92, v8
M v[4:7], a[180:183], a[20:23], v[4:7]
s_waitcnt lgkmcnt(5)
v_exp_f32 v10, v10
M v[4:7], a[184:187], a[40:43], v[4:7]
s_waitcnt lgkmcnt(4)
v_cvt_pk_bf16_f32 v24, v8, v9
v_add_f32 v92, v92, v9
M v[4:7], a[188:191], a[60:63], v[4:7]
s_waitcnt lgkmcnt(2)
v_exp_f32 v11, v11
M v[176:179], a[192:195], v[36:39], v[176:179]
v_cvt_pk_bf16_f32 v25, v10, v11
v_add_f32 v92, v92, v10
M v[180:183], a[192:195], v[40:43], v[180:183]
ds_read_b64_tr_b16 a[200:201], v67 offset:49152
v_add_f32 v92, v92, v11
M v[184:187], a[192:195], v[44:47], v[184:187]
buffer_load_dwordx4 v69, s[16:19], s47 offen offset:2048 nt lds
M v[188:191], a[192:195], v[48:51], v[188:191]
v_exp_f32 v12, v12
v_exp_f32 v13, v13
v_add_f32 v93, v93, v12
M v[8:11], a[176:179], a[4:7], 0
v_exp_f32 v14, v14
v_add_f32 v93, v93, v13
M v[8:11], a[180:183], a[24:27], v[8:11]
v_exp_f32 v15, v15
M v[8:11], a[184:187], a[44:47], v[8:11]
ds_read_b64_tr_b16 a[202:203], v67 offset:53248
v_add_f32 v93, v93, v14
M v[8:11], a[188:191], a[64:67], v[8:11]
v_cvt_pk_bf16_f32 v28, v12, v13
v_add_f32 v93, v93, v15
M v[192:195], a[192:195], v[52:55], v[192:195]
s_waitcnt lgkmcnt(2)
ds_read_b64_tr_b16 a[204:205], v68 offset:49152
v_cvt_pk_bf16_f32 v29, v14, v15
M v[196:199], a[196:199], v[36:39], v[196:199]
v_exp_f32 v0, v0
M v[200:203], a[196:199], v[40:43], v[200:203]
v_exp_f32 v1, v1
v_add_f32 v94, v94, v0
v_exp_f32 v2, v2
v_add_f32 v94, v94, v1
v_exp_f32 v3, v3
v_add_f32 v94, v94, v2
v_add_f32 v94, v94, v3
M v[204:207], a[196:199], v[44:47], v[204:207]
buffer_load_dwordx4 v70, s[16:19], s47 offen offset:3072 nt lds
ds_read_b64_tr_b16 a[206:207], v68 offset:53248
v_cvt_pk_bf16_f32 v32, v0, v1
v_cvt_pk_bf16_f32 v33, v2, v3
M v[12:15], a[176:179], a[8:11], 0
s_add_u32 m0, s36, 0
v_exp_f32 v4, v4
v_exp_f32 v5, v5
M v[12:15], a[180:183], a[28:31], v[12:15]
v_cvt_pk_bf16_f32 v18, v4, v5
v_add_f32 v90, v90, v4
M v[12:15], a[184:187], a[48:51], v[12:15]
v_exp_f32 v6, v6
M v[12:15], a[188:191], a[68:71], v[12:15]
v_add_f32 v90, v90, v5
v_add_f32 v90, v90, v6
v_exp_f32 v7, v7
v_exp_f32 v8, v8
M v[208:211], a[196:199], v[48:51], v[208:211]
v_cvt_pk_bf16_f32 v19, v6, v7
v_add_f32 v90, v90, v7
M v[212:215], a[196:199], v[52:55], v[212:215]
s_waitcnt lgkmcnt(2)
v_exp_f32 v9, v9
M v[216:219], a[200:203], v[36:39], v[216:219]
v_cvt_pk_bf16_f32 v22, v8, v9
v_add_f32 v91, v91, v8
M v[220:223], a[200:203], v[40:43], v[220:223]
v_exp_f32 v10, v10
M v[0:3], a[176:179], a[12:15], 0
s_mov_b64 exec, 0
s_branch L_hop_b0
L_ret_b0:
s_mov_b64 exec, -1
s_mov_b64 exec, 0
s_branch L_hop_b1
L_ret_b1:
s_mov_b64 exec, -1
s_waitcnt vmcnt(9) lgkmcnt(0)
v_add_f32 v91, v91, v9
v_add_f32 v91, v91, v10
M v[0:3], a[180:183], a[32:35], v[0:3]
s_barrier
ds_read_b128 a[160:163], v57 offset:16384
M v[0:3], a[184:187], a[52:55], v[0:3]
ds_read_b128 a[164:167], v58 offset:16384
v_exp_f32 v11, v11
M v[0:3], a[188:191], a[72:75], v[0:3]
ds_read_b128 a[168:171], v59 offset:16384
v_add_f32 v91, v91, v11
M v[224:227], a[200:203], v[44:47], v[224:227]
ds_read_b128 a[172:175], v60 offset:16384
v_cvt_pk_bf16_f32 v23, v10, v11
M v[228:231], a[200:203], v[48:51], v[228:231]
ds_read_b64_tr_b16 a[192:193], v61 offset:0
M v[232:235], a[200:203], v[52:55], v[232:235]
ds_read_b64_tr_b16 a[194:195], v61 offset:4096
buffer_load_dwordx4 v69, s[12:15], s48 offen nt lds
M v[236:239], a[204:207], v[36:39], v[236:239]
v_exp_f32 v12, v12
M v[4:7], a[176:179], a[16:19], 0
s_add_u32 s49, s43, 57344
v_exp_f32 v13, v13
M v[4:7], a[180:183], a[36:39], v[4:7]
s_and_b32 s49, s49, 131071
v_exp_f32 v14, v14
M v[4:7], a[184:187], a[56:59], v[4:7]
s_add_u32 s49, s49, s32
v_exp_f32 v15, v15
M v[4:7], a[188:191], a[76:79], v[4:7]
ds_read_b64_tr_b16 a[196:197], v62 offset:0
v_cvt_pk_bf16_f32 v26, v12, v13
M v[240:243], a[204:207], v[40:43], v[240:243]
v_exp_f32 v0, v0
M v[244:247], a[204:207], v[44:47], v[244:247]
v_exp_f32 v1, v1
M v[248:251], a[204:207], v[48:51], v[248:251]
v_exp_f32 v2, v2
M v[252:255], a[204:207], v[52:55], v[252:255]
s_waitcnt lgkmcnt(6)
v_exp_f32 v3, v3
M v[8:11], a[160:163], a[0:3], 0
s_waitcnt lgkmcnt(5)
v_cvt_pk_bf16_f32 v27, v14, v15
v_add_f32 v92, v92, v12
M v[8:11], a[164:167], a[20:23], v[8:11]
s_waitcnt lgkmcnt(4)
ds_read_b64_tr_b16 a[198:199], v62 offset:4096
v_add_f32 v92, v92, v13
M v[8:11], a[168:171], a[40:43], v[8:11]
s_waitcnt lgkmcnt(4)
v_cvt_pk_bf16_f32 v30, v0, v1
v_cvt_pk_bf16_f32 v31, v2, v3
M v[8:11], a[172:175], a[60:63], v[8:11]
s_waitcnt lgkmcnt(2)
ds_read_b64_tr_b16 a[200:201], v63 offset:0
v_add_f32 v92, v92, v14
M v[96:99], a[192:195], v[16:19], v[96:99]
v_add_f32 v92, v92, v15
v_add_f32 v93, v93, v0
v_exp_f32 v4, v4
M v[100:103], a[192:195], v[20:23], v[100:103]
buffer_load_dwordx4 v70, s[12:15], s48 offen offset:1024 nt lds
M v[104:107], a[192:195], v[24:27], v[104:107]
v_exp_f32 v5, v5
M v[108:111], a[192:195], v[28:31], v[108:111]
v_exp_f32 v6, v6
M v[12:15], a[160:163], a[4:7], 0
v_exp_f32 v7, v7
M v[12:15], a[164:167], a[24:27], v[12:15]
v_cvt_pk_bf16_f32 v34, v4, v5
v_cvt_pk_bf16_f32 v35, v6, v7
M v[12:15], a[168:171], a[44:47], v[12:15]
ds_read_b64_tr_b16 a[202:203], v63 offset:4096
v_add_f32 v93, v93, v1
M v[12:15], a[172:175], a[64:67], v[12:15]
v_add_f32 v93, v93, v2
v_add_f32 v94, v94, v4
M v[112:115], a[192:195], v[32:35], v[112:115]
s_waitcnt lgkmcnt(2)
v_add_f32 v93, v93, v3
v_add_f32 v94, v94, v5
M v[116:119], a[196:199], v[16:19], v[116:119]
buffer_load_dwordx4 v69, s[12:15], s48 offen offset:2048 nt lds
M v[120:123], a[196:199], v[20:23], v[120:123]
ds_read_b64_tr_b16 a[204:205], v64 offset:0
v_add_f32 v94, v94, v6
M v[124:127], a[196:199], v[24:27], v[124:127]
ds_read_b64_tr_b16 a[206:207], v64 offset:4096
v_add_f32 v94, v94, v7
M v[0:3], a[160:163], a[8:11], 0
v_exp_f32 v8, v8
M v[0:3], a[164:167], a[28:31], v[0:3]
buffer_load_dwordx4 v70, s[12:15], s48 offen offset:3072 nt lds
M v[0:3], a[168:171], a[48:51], v[0:3]
s_add_u32 m0, s36, 114688
v_exp_f32 v9, v9
M v[0:3], a[172:175], a[68:71], v[0:3]
ds_read_b128 a[176:179], v57 offset:20480
v_add_f32 v90, v90, v8
M v[128:131], a[196:199], v[28:31], v[128:131]
v_exp_f32 v10, v10
M v[132:135], a[196:199], v[32:35], v[132:135]
s_waitcnt lgkmcnt(3)
v_cvt_pk_bf16_f32 v36, v8, v9
v_add_f32 v90, v90, v9
M v[136:139], a[200:203], v[16:19], v[136:139]
v_exp_f32 v11, v11
M v[140:143], a[200:203], v[20:23], v[140:143]
v_cvt_pk_bf16_f32 v37, v10, v11
v_add_f32 v90, v90, v10
M v[4:7], a[160:163], a[12:15], 0
ds_read_b128 a[180:183], v58 offset:20480
v_add_f32 v90, v90, v11
M v[4:7], a[164:167], a[32:35], v[4:7]
ds_read_b128 a[184:187], v59 offset:20480
M v[4:7], a[168:171], a[52:55], v[4:7]
buffer_load_dwordx4 v69, s[16:19], s49 offen nt lds
M v[4:7], a[172:175], a[72:75], v[4:7]
ds_read_b128 a[188:191], v60 offset:20480
M v[144:147], a[200:203], v[24:27], v[144:147]
ds_read_b64_tr_b16 a[192:193], v65 offset:0
M v[148:151], a[200:203], v[28:31], v[148:151]
v_exp_f32 v12, v12
M v[152:155], a[200:203], v[32:35], v[152:155]
s_waitcnt lgkmcnt(5)
ds_read_b64_tr_b16 a[194:195], v65 offset:4096
v_add_f32 v91, v91, v12
M v[156:159], a[204:207], v[16:19], v[156:159]
v_exp_f32 v13, v13
M v[8:11], a[160:163], a[16:19], 0
v_exp_f32 v14, v14
M v[8:11], a[164:167], a[36:39], v[8:11]
v_cvt_pk_bf16_f32 v40, v12, v13
v_add_f32 v91, v91, v13
M v[8:11], a[168:171], a[56:59], v[8:11]
v_exp_f32 v15, v15
M v[8:11], a[172:175], a[76:79], v[8:11]
v_cvt_pk_bf16_f32 v41, v14, v15
v_add_f32 v91, v91, v14
M v[160:163], a[204:207], v[20:23], v[160:163]
s_add_u32 s50, s43, 73728
ds_read_b64_tr_b16 a[196:197], v66 offset:0
v_add_f32 v91, v91, v15
M v[164:167], a[204:207], v[24:27], v[164:167]
s_and_b32 s50, s50, 131071
buffer_load_dwordx4 v70, s[16:19], s49 offen offset:1024 nt lds
M v[168:171], a[204:207], v[28:31], v[168:171]
s_add_u32 s50, s50, s32
v_exp_f32 v0, v0
M v[172:175], a[204:207], v[32:35], v[172:175]
s_waitcnt lgkmcnt(6)
v_exp_f32 v1, v1
M v[12:15], a[176:179], a[0:3], 0
s_waitcnt lgkmcnt(5)
ds_read_b64_tr_b16 a[198:199], v66 offset:4096
v_add_f32 v92, v92, v0
M v[12:15], a[180:183], a[20:23], v[12:15]
s_waitcnt lgkmcnt(5)
v_exp_f32 v2, v2
M v[12:15], a[184:187], a[40:43], v[12:15]
s_waitcnt lgkmcnt(4)
v_cvt_pk_bf16_f32 v44, v0, v1
v_add_f32 v92, v92, v1
M v[12:15], a[188:191], a[60:63], v[12:15]
s_waitcnt lgkmcnt(2)
v_exp_f32 v3, v3
M v[176:179], a[192:195], v[16:19], v[176:179]
v_cvt_pk_bf16_f32 v45, v2, v3
v_add_f32 v92, v92, v2
M v[180:183], a[192:195], v[20:23], v[180:183]
ds_read_b64_tr_b16 a[200:201], v67 offset:0
v_add_f32 v92, v92, v3
M v[184:187], a[192:195], v[24:27], v[184:187]
buffer_load_dwordx4 v69, s[16:19], s49 offen offset:2048 nt lds
M v[188:191], a[192:195], v[28:31], v[188:191]
v_exp_f32 v4, v4
v_exp_f32 v5, v5
v_add_f32 v93, v93, v4
M v[0:3], a[176:179], a[4:7], 0
v_exp_f32 v6, v6
v_add_f32 v93, v93, v5
M v[0:3], a[180:183], a[24:27], v[0:3]
v_exp_f32 v7, v7
M v[0:3], a[184:187], a[44:47], v[0:3]
ds_read_b64_tr_b16 a[202:203], v67 offset:4096
v_add_f32 v93, v93, v6
M v[0:3], a[188:191], a[64:67], v[0:3]
v_cvt_pk_bf16_f32 v48, v4, v5
v_add_f32 v93, v93, v7
M v[192:195], a[192:195], v[32:35], v[192:195]
s_waitcnt lgkmcnt(2)
ds_read_b64_tr_b16 a[204:205], v68 offset:0
v_cvt_pk_bf16_f32 v49, v6, v7
M v[196:199], a[196:199], v[16:19], v[196:199]
v_exp_f32 v8, v8
M v[200:203], a[196:199], v[20:23], v[200:203]
v_exp_f32 v9, v9
v_add_f32 v94, v94, v8
v_exp_f32 v10, v10
v_add_f32 v94, v94, v9
v_exp_f32 v11, v11
v_add_f32 v94, v94, v10
v_add_f32 v94, v94, v11
M v[204:207], a[196:199], v[24:27], v[204:207]
buffer_load_dwordx4 v70, s[16:19], s49 offen offset:3072 nt lds
ds_read_b64_tr_b16 a[206:207], v68 offset:4096
v_cvt_pk_bf16_f32 v52, v8, v9
v_cvt_pk_bf16_f32 v53, v10, v11
M v[4:7], a[176:179], a[8:11], 0
s_add_u32 m0, s36, 16384
v_exp_f32 v12, v12
v_exp_f32 v13, v13
M v[4:7], a[180:183], a[28:31], v[4:7]
v_cvt_pk_bf16_f32 v38, v12, v13
v_add_f32 v90, v90, v12
M v[4:7], a[184:187], a[48:51], v[4:7]
v_exp_f32 v14, v14
M v[4:7], a[188:191], a[68:71], v[4:7]
v_add_f32 v90, v90, v13
v_add_f32 v90, v90, v14
v_exp_f32 v15, v15
v_exp_f32 v0, v0
M v[208:211], a[196:199], v[28:31], v[208:211]
v_cvt_pk_bf16_f32 v39, v14, v15
v_add_f32 v90, v90, v15
M v[212:215], a[196:199], v[32:35], v[212:215]
s_waitcnt lgkmcnt(2)
v_exp_f32 v1, v1
M v[216:219], a[200:203], v[16:19], v[216:219]
v_cvt_pk_bf16_f32 v42, v0, v1
v_add_f32 v91, v91, v0
M v[220:223], a[200:203], v[20:23], v[220:223]
v_exp_f32 v2, v2
M v[8:11], a[176:179], a[12:15], 0
s_waitcnt lgkmcnt(0)
v_add_f32 v91, v91, v1
v_add_f32 v91, v91, v2
M v[8:11], a[180:183], a[32:35], v[8:11]
s_barrier
ds_read_b128 a[160:163], v57 offset:32768
M v[8:11], a[184:187], a[52:55], v[8:11]
ds_read_b128 a[164:167], v58 offset:32768
v_exp_f32 v3, v3
M v[8:11], a[188:191], a[72:75], v[8:11]
ds_read_b128 a[168:171], v59 offset:32768
v_add_f32 v91, v91, v3
M v[224:227], a[200:203], v[24:27], v[224:227]
ds_read_b128 a[172:175], v60 offset:32768
v_cvt_pk_bf16_f32 v43, v2, v3
M v[228:231], a[200:203], v[28:31], v[228:231]
ds_read_b64_tr_b16 a[192:193], v61 offset:16384
M v[232:235], a[200:203], v[32:35], v[232:235]
ds_read_b64_tr_b16 a[194:195], v61 offset:20480
buffer_load_dwordx4 v69, s[12:15], s50 offen nt lds
M v[236:239], a[204:207], v[16:19], v[236:239]
v_exp_f32 v4, v4
M v[12:15], a[176:179], a[16:19], 0
s_add_u32 s51, s43, 65536
v_exp_f32 v5, v5
M v[12:15], a[180:183], a[36:39], v[12:15]
s_and_b32 s51, s51, 131071
v_exp_f32 v6, v6
M v[12:15], a[184:187], a[56:59], v[12:15]
s_add_u32 s51, s51, s32
v_exp_f32 v7, v7
M v[12:15], a[188:191], a[76:79], v[12:15]
ds_read_b64_tr_b16 a[196:197], v62 offset:16384
v_cvt_pk_bf16_f32 v46, v4, v5
M v[240:243], a[204:207], v[20:23], v[240:243]
v_exp_f32 v8, v8
M v[244:247], a[204:207], v[24:27], v[244:247]
v_exp_f32 v9, v9
M v[248:251], a[204:207], v[28:31], v[248:251]
v_exp_f32 v10, v10
M v[252:255], a[204:207], v[32:35], v[252:255]
s_waitcnt lgkmcnt(6)
v_exp_f32 v11, v11
M v[0:3], a[160:163], a[0:3], 0
s_waitcnt lgkmcnt(5)
v_cvt_pk_bf16_f32 v47, v6, v7
v_add_f32 v92, v92, v4
M v[0:3], a[164:167], a[20:23], v[0:3]
s_waitcnt lgkmcnt(4)
ds_read_b64_tr_b16 a[198:199], v62 offset:20480
v_add_f32 v92, v92, v5
M v[0:3], a[168:171], a[40:43], v[0:3]
s_waitcnt lgkmcnt(4)
v_cvt_pk_bf16_f32 v50, v8, v9
v_cvt_pk_bf16_f32 v51, v10, v11
M v[0:3], a[172:175], a[60:63], v[0:3]
s_waitcnt lgkmcnt(2)
ds_read_b64_tr_b16 a[200:201], v63 offset:16384
v_add_f32 v92, v92, v6
M v[96:99], a[192:195], v[36:39], v[96:99]
v_add_f32 v92, v92, v7
v_add_f32 v93, v93, v8
v_exp_f32 v12, v12
M v[100:103], a[192:195], v[40:43], v[100:103]
buffer_load_dwordx4 v70, s[12:15], s50 offen offset:1024 nt lds
M v[104:107], a[192:195], v[44:47], v[104:107]
v_exp_f32 v13, v13
M v[108:111], a[192:195], v[48:51], v[108:111]
v_exp_f32 v14, v14
M v[4:7], a[160:163], a[4:7], 0
v_exp_f32 v15, v15
M v[4:7], a[164:167], a[24:27], v[4:7]
v_cvt_pk_bf16_f32 v54, v12, v13
v_cvt_pk_bf16_f32 v55, v14, v15
M v[4:7], a[168:171], a[44:47], v[4:7]
ds_read_b64_tr_b16 a[202:203], v63 offset:20480
v_add_f32 v93, v93, v9
M v[4:7], a[172:175], a[64:67], v[4:7]
v_add_f32 v93, v93, v10
v_add_f32 v94, v94, v12
M v[112:115], a[192:195], v[52:55], v[112:115]
s_waitcnt lgkmcnt(2)
v_add_f32 v93, v93, v11
v_add_f32 v94, v94, v13
M v[116:119], a[196:199], v[36:39], v[116:119]
buffer_load_dwordx4 v69, s[12:15], s50 offen offset:2048 nt lds
M v[120:123], a[196:199], v[40:43], v[120:123]
ds_read_b64_tr_b16 a[204:205], v64 offset:16384
v_add_f32 v94, v94, v14
M v[124:127], a[196:199], v[44:47], v[124:127]
ds_read_b64_tr_b16 a[206:207], v64 offset:20480
v_add_f32 v94, v94, v15
M v[8:11], a[160:163], a[8:11], 0
v_exp_f32 v0, v0
M v[8:11], a[164:167], a[28:31], v[8:11]
buffer_load_dwordx4 v70, s[12:15], s50 offen offset:3072 nt lds
M v[8:11], a[168:171], a[48:51], v[8:11]
s_add_u32 m0, s36, 65536
v_exp_f32 v1, v1
M v[8:11], a[172:175], a[68:71], v[8:11]
ds_read_b128 a[176:179], v57 offset:36864
v_add_f32 v90, v90, v0
M v[128:131], a[196:199], v[48:51], v[128:131]
v_exp_f32 v2, v2
M v[132:135], a[196:199], v[52:55], v[132:135]
s_waitcnt lgkmcnt(3)
v_cvt_pk_bf16_f32 v16, v0, v1
v_add_f32 v90, v90, v1
M v[136:139], a[200:203], v[36:39], v[136:139]
v_exp_f32 v3, v3
M v[140:143], a[200:203], v[40:43], v[140:143]
v_cvt_pk_bf16_f32 v17, v2, v3
v_add_f32 v90, v90, v2
M v[12:15], a[160:163], a[12:15], 0
ds_read_b128 a[180:183], v58 offset:36864
v_add_f32 v90, v90, v3
M v[12:15], a[164:167], a[32:35], v[12:15]
ds_read_b128 a[184:187], v59 offset:36864
M v[12:15], a[168:171], a[52:55], v[12:15]
buffer_load_dwordx4 v69, s[16:19], s51 offen nt lds
M v[12:15], a[172:175], a[72:75], v[12:15]
ds_read_b128 a[188:191], v60 offset:36864
M v[144:147], a[200:203], v[44:47], v[144:147]
ds_read_b64_tr_b16 a[192:193], v65 offset:16384
M v[148:151], a[200:203], v[48:51], v[148:151]
v_exp_f32 v4, v4
M v[152:155], a[200:203], v[52:55], v[152:155]
s_waitcnt lgkmcnt(5)
ds_read_b64_tr_b16 a[194:195], v65 offset:20480
v_add_f32 v91, v91, v4
M v[156:159], a[204:207], v[36:39], v[156:159]
v_exp_f32 v5, v5
M v[0:3], a[160:163], a[16:19], 0
v_exp_f32 v6, v6
M v[0:3], a[164:167], a[36:39], v[0:3]
v_cvt_pk_bf16_f32 v20, v4, v5
v_add_f32 v91, v91, v5
M v[0:3], a[168:171], a[56:59], v[0:3]
v_exp_f32 v7, v7
M v[0:3], a[172:175], a[76:79], v[0:3]
v_cvt_pk_bf16_f32 v21, v6, v7
v_add_f32 v91, v91, v6
M v[160:163], a[204:207], v[40:43], v[160:163]
s_add_u32 s44, s43, 81920
ds_read_b64_tr_b16 a[196:197], v66 offset:16384
v_add_f32 v91, v91, v7
M v[164:167], a[204:207], v[44:47], v[164:167]
s_and_b32 s44, s44, 131071
buffer_load_dwordx4 v70, s[16:19], s51 offen offset:1024 nt lds
M v[168:171], a[204:207], v[48:51], v[168:171]
s_add_u32 s44, s44, s32
v_exp_f32 v8, v8
M v[172:175], a[204:207], v[52:55], v[172:175]
s_waitcnt lgkmcnt(6)
v_exp_f32 v9, v9
M v[4:7], a[176:179], a[0:3], 0
s_waitcnt lgkmcnt(5)
ds_read_b64_tr_b16 a[198:199], v66 offset:20480
v_add_f32 v92, v92, v8
M v[4:7], a[180:183], a[20:23], v[4:7]
s_waitcnt lgkmcnt(5)
v_exp_f32 v10, v10
M v[4:7], a[184:187], a[40:43], v[4:7]
s_waitcnt lgkmcnt(4)
v_cvt_pk_bf16_f32 v24, v8, v9
v_add_f32 v92, v92, v9
M v[4:7], a[188:191], a[60:63], v[4:7]
s_waitcnt lgkmcnt(2)
v_exp_f32 v11, v11
M v[176:179], a[192:195], v[36:39], v[176:179]
v_cvt_pk_bf16_f32 v25, v10, v11
v_add_f32 v92, v92, v10
M v[180:183], a[192:195], v[40:43], v[180:183]
ds_read_b64_tr_b16 a[200:201], v67 offset:16384
v_add_f32 v92, v92, v11
M v[184:187], a[192:195], v[44:47], v[184:187]
buffer_load_dwordx4 v69, s[16:19], s51 offen offset:2048 nt lds
M v[188:191], a[192:195], v[48:51], v[188:191]
v_exp_f32 v12, v12
v_exp_f32 v13, v13
v_add_f32 v93, v93, v12
M v[8:11], a[176:179], a[4:7], 0
v_exp_f32 v14, v14
v_add_f32 v93, v93, v13
M v[8:11], a[180:183], a[24:27], v[8:11]
v_exp_f32 v15, v15
M v[8:11], a[184:187], a[44:47], v[8:11]
ds_read_b64_tr_b16 a[202:203], v67 offset:20480
v_add_f32 v93, v93, v14
M v[8:11], a[188:191], a[64:67], v[8:11]
v_cvt_pk_bf16_f32 v28, v12, v13
v_add_f32 v93, v93, v15
M v[192:195], a[192:195], v[52:55], v[192:195]
s_waitcnt lgkmcnt(2)
ds_read_b64_tr_b16 a[204:205], v68 offset:16384
v_cvt_pk_bf16_f32 v29, v14, v15
M v[196:199], a[196:199], v[36:39], v[196:199]
v_exp_f32 v0, v0
M v[200:203], a[196:199], v[40:43], v[200:203]
v_exp_f32 v1, v1
v_add_f32 v94, v94, v0
v_exp_f32 v2, v2
v_add_f32 v94, v94, v1
v_exp_f32 v3, v3
v_add_f32 v94, v94, v2
v_add_f32 v94, v94, v3
M v[204:207], a[196:199], v[44:47], v[204:207]
buffer_load_dwordx4 v70, s[16:19], s51 offen offset:3072 nt lds
ds_read_b64_tr_b16 a[206:207], v68 offset:20480
v_cvt_pk_bf16_f32 v32, v0, v1
v_cvt_pk_bf16_f32 v33, v2, v3
M v[12:15], a[176:179], a[8:11], 0
s_add_u32 m0, s36, 32768
v_exp_f32 v4, v4
v_exp_f32 v5, v5
M v[12:15], a[180:183], a[28:31], v[12:15]
v_cvt_pk_bf16_f32 v18, v4, v5
v_add_f32 v90, v90, v4
M v[12:15], a[184:187], a[48:51], v[12:15]
v_exp_f32 v6, v6
M v[12:15], a[188:191], a[68:71], v[12:15]
v_add_f32 v90, v90, v5
v_add_f32 v90, v90, v6
v_exp_f32 v7, v7
v_exp_f32 v8, v8
M v[208:211], a[196:199], v[48:51], v[208:211]
v_cvt_pk_bf16_f32 v19, v6, v7
v_add_f32 v90, v90, v7
M v[212:215], a[196:199], v[52:55], v[212:215]
s_waitcnt lgkmcnt(2)
v_exp_f32 v9, v9
M v[216:219], a[200:203], v[36:39], v[216:219]
v_cvt_pk_bf16_f32 v22, v8, v9
v_add_f32 v91, v91, v8
M v[220:223], a[200:203], v[40:43], v[220:223]
v_exp_f32 v10, v10
M v[0:3], a[176:179], a[12:15], 0
s_mov_b64 exec, 0
s_branch L_hop_b2
L_ret_b2:
s_mov_b64 exec, -1
s_mov_b64 exec, 0
s_branch L_hop_b3
L_ret_b3:
s_mov_b64 exec, -1
s_waitcnt vmcnt(16) lgkmcnt(0)
v_add_f32 v91, v91, v9
v_add_f32 v91, v91, v10
M v[0:3], a[180:183], a[32:35], v[0:3]
s_barrier
ds_read_b128 a[160:163], v57 offset:49152
M v[0:3], a[184:187], a[52:55], v[0:3]
ds_read_b128 a[164:167], v58 offset:49152
v_exp_f32 v11, v11
M v[0:3], a[188:191], a[72:75], v[0:3]
ds_read_b128 a[168:171], v59 offset:49152
v_add_f32 v91, v91, v11
M v[224:227], a[200:203], v[44:47], v[224:227]
ds_read_b128 a[172:175], v60 offset:49152
v_cvt_pk_bf16_f32 v23, v10, v11
M v[228:231], a[200:203], v[48:51], v[228:231]
ds_read_b64_tr_b16 a[192:193], v61 offset:32768
M v[232:235], a[200:203], v[52:55], v[232:235]
ds_read_b64_tr_b16 a[194:195], v61 offset:36864
buffer_load_dwordx4 v69, s[12:15], s44 offen nt lds
M v[236:239], a[204:207], v[36:39], v[236:239]
v_exp_f32 v12, v12
M v[4:7], a[176:179], a[16:19], 0
s_add_u32 s45, s43, 73728
v_exp_f32 v13, v13
M v[4:7], a[180:183], a[36:39], v[4:7]
s_and_b32 s45, s45, 131071
v_exp_f32 v14, v14
M v[4:7], a[184:187], a[56:59], v[4:7]
s_add_u32 s45, s45, s32
v_exp_f32 v15, v15
M v[4:7], a[188:191], a[76:79], v[4:7]
ds_read_b64_tr_b16 a[196:197], v62 offset:32768
v_cvt_pk_bf16_f32 v26, v12, v13
M v[240:243], a[204:207], v[40:43], v[240:243]
v_exp_f32 v0, v0
M v[244:247], a[204:207], v[44:47], v[244:247]
v_exp_f32 v1, v1
M v[248:251], a[204:207], v[48:51], v[248:251]
v_exp_f32 v2, v2
M v[252:255], a[204:207], v[52:55], v[252:255]
s_waitcnt lgkmcnt(6)
v_exp_f32 v3, v3
M v[8:11], a[160:163], a[0:3], 0
s_waitcnt lgkmcnt(5)
v_cvt_pk_bf16_f32 v27, v14, v15
v_add_f32 v92, v92, v12
M v[8:11], a[164:167], a[20:23], v[8:11]
s_waitcnt lgkmcnt(4)
ds_read_b64_tr_b16 a[198:199], v62 offset:36864
v_add_f32 v92, v92, v13
M v[8:11], a[168:171], a[40:43], v[8:11]
s_waitcnt lgkmcnt(4)
v_cvt_pk_bf16_f32 v30, v0, v1
v_cvt_pk_bf16_f32 v31, v2, v3
M v[8:11], a[172:175], a[60:63], v[8:11]
s_waitcnt lgkmcnt(2)
ds_read_b64_tr_b16 a[200:201], v63 offset:32768
v_add_f32 v92, v92, v14
M v[96:99], a[192:195], v[16:19], v[96:99]
v_add_f32 v92, v92, v15
v_add_f32 v93, v93, v0
v_exp_f32 v4, v4
M v[100:103], a[192:195], v[20:23], v[100:103]
buffer_load_dwordx4 v70, s[12:15], s44 offen offset:1024 nt lds
M v[104:107], a[192:195], v[24:27], v[104:107]
v_exp_f32 v5, v5
M v[108:111], a[192:195], v[28:31], v[108:111]
v_exp_f32 v6, v6
M v[12:15], a[160:163], a[4:7], 0
v_exp_f32 v7, v7
M v[12:15], a[164:167], a[24:27], v[12:15]
v_cvt_pk_bf16_f32 v34, v4, v5
v_cvt_pk_bf16_f32 v35, v6, v7
M v[12:15], a[168:171], a[44:47], v[12:15]
ds_read_b64_tr_b16 a[202:203], v63 offset:36864
v_add_f32 v93, v93, v1
M v[12:15], a[172:175], a[64:67], v[12:15]
v_add_f32 v93, v93, v2
v_add_f32 v94, v94, v4
M v[112:115], a[192:195], v[32:35], v[112:115]
s_waitcnt lgkmcnt(2)
v_add_f32 v93, v93, v3
v_add_f32 v94, v94, v5
M v[116:119], a[196:199], v[16:19], v[116:119]
buffer_load_dwordx4 v69, s[12:15], s44 offen offset:2048 nt lds
M v[120:123], a[196:199], v[20:23], v[120:123]
ds_read_b64_tr_b16 a[204:205], v64 offset:32768
v_add_f32 v94, v94, v6
M v[124:127], a[196:199], v[24:27], v[124:127]
ds_read_b64_tr_b16 a[206:207], v64 offset:36864
v_add_f32 v94, v94, v7
M v[0:3], a[160:163], a[8:11], 0
v_exp_f32 v8, v8
M v[0:3], a[164:167], a[28:31], v[0:3]
buffer_load_dwordx4 v70, s[12:15], s44 offen offset:3072 nt lds
M v[0:3], a[168:171], a[48:51], v[0:3]
s_add_u32 m0, s36, 81920
v_exp_f32 v9, v9
M v[0:3], a[172:175], a[68:71], v[0:3]
ds_read_b128 a[176:179], v57 offset:53248
v_add_f32 v90, v90, v8
M v[128:131], a[196:199], v[28:31], v[128:131]
v_exp_f32 v10, v10
M v[132:135], a[196:199], v[32:35], v[132:135]
s_waitcnt lgkmcnt(3)
v_cvt_pk_bf16_f32 v36, v8, v9
v_add_f32 v90, v90, v9
M v[136:139], a[200:203], v[16:19], v[136:139]
v_exp_f32 v11, v11
M v[140:143], a[200:203], v[20:23], v[140:143]
v_cvt_pk_bf16_f32 v37, v10, v11
v_add_f32 v90, v90, v10
M v[4:7], a[160:163], a[12:15], 0
ds_read_b128 a[180:183], v58 offset:53248
v_add_f32 v90, v90, v11
M v[4:7], a[164:167], a[32:35], v[4:7]
ds_read_b128 a[184:187], v59 offset:53248
M v[4:7], a[168:171], a[52:55], v[4:7]
buffer_load_dwordx4 v69, s[16:19], s45 offen nt lds
M v[4:7], a[172:175], a[72:75], v[4:7]
ds_read_b128 a[188:191], v60 offset:53248
M v[144:147], a[200:203], v[24:27], v[144:147]
ds_read_b64_tr_b16 a[192:193], v65 offset:32768
M v[148:151], a[200:203], v[28:31], v[148:151]
v_exp_f32 v12, v12
M v[152:155], a[200:203], v[32:35], v[152:155]
s_waitcnt lgkmcnt(5)
ds_read_b64_tr_b16 a[194:195], v65 offset:36864
v_add_f32 v91, v91, v12
M v[156:159], a[204:207], v[16:19], v[156:159]
v_exp_f32 v13, v13
M v[8:11], a[160:163], a[16:19], 0
v_exp_f32 v14, v14
M v[8:11], a[164:167], a[36:39], v[8:11]
v_cvt_pk_bf16_f32 v40, v12, v13
v_add_f32 v91, v91, v13
M v[8:11], a[168:171], a[56:59], v[8:11]
v_exp_f32 v15, v15
M v[8:11], a[172:175], a[76:79], v[8:11]
v_cvt_pk_bf16_f32 v41, v14, v15
v_add_f32 v91, v91, v14
M v[160:163], a[204:207], v[20:23], v[160:163]
s_add_u32 s46, s43, 90112
ds_read_b64_tr_b16 a[196:197], v66 offset:32768
v_add_f32 v91, v91, v15
M v[164:167], a[204:207], v[24:27], v[164:167]
s_and_b32 s46, s46, 131071
buffer_load_dwordx4 v70, s[16:19], s45 offen offset:1024 nt lds
M v[168:171], a[204:207], v[28:31], v[168:171]
s_add_u32 s46, s46, s32
v_exp_f32 v0, v0
M v[172:175], a[204:207], v[32:35], v[172:175]
s_waitcnt lgkmcnt(6)
v_exp_f32 v1, v1
M v[12:15], a[176:179], a[0:3], 0
s_waitcnt lgkmcnt(5)
ds_read_b64_tr_b16 a[198:199], v66 offset:36864
v_add_f32 v92, v92, v0
M v[12:15], a[180:183], a[20:23], v[12:15]
s_waitcnt lgkmcnt(5)
v_exp_f32 v2, v2
M v[12:15], a[184:187], a[40:43], v[12:15]
s_waitcnt lgkmcnt(4)
v_cvt_pk_bf16_f32 v44, v0, v1
v_add_f32 v92, v92, v1
M v[12:15], a[188:191], a[60:63], v[12:15]
s_waitcnt lgkmcnt(2)
v_exp_f32 v3, v3
M v[176:179], a[192:195], v[16:19], v[176:179]
v_cvt_pk_bf16_f32 v45, v2, v3
v_add_f32 v92, v92, v2
M v[180:183], a[192:195], v[20:23], v[180:183]
ds_read_b64_tr_b16 a[200:201], v67 offset:32768
v_add_f32 v92, v92, v3
M v[184:187], a[192:195], v[24:27], v[184:187]
buffer_load_dwordx4 v69, s[16:19], s45 offen offset:2048 nt lds
M v[188:191], a[192:195], v[28:31], v[188:191]
v_exp_f32 v4, v4
v_exp_f32 v5, v5
v_add_f32 v93, v93, v4
M v[0:3], a[176:179], a[4:7], 0
v_exp_f32 v6, v6
v_add_f32 v93, v93, v5
M v[0:3], a[180:183], a[24:27], v[0:3]
v_exp_f32 v7, v7
M v[0:3], a[184:187], a[44:47], v[0:3]
ds_read_b64_tr_b16 a[202:203], v67 offset:36864
v_add_f32 v93, v93, v6
M v[0:3], a[188:191], a[64:67], v[0:3]
v_cvt_pk_bf16_f32 v48, v4, v5
v_add_f32 v93, v93, v7
M v[192:195], a[192:195], v[32:35], v[192:195]
s_waitcnt lgkmcnt(2)
ds_read_b64_tr_b16 a[204:205], v68 offset:32768
v_cvt_pk_bf16_f32 v49, v6, v7
M v[196:199], a[196:199], v[16:19], v[196:199]
v_exp_f32 v8, v8
M v[200:203], a[196:199], v[20:23], v[200:203]
v_exp_f32 v9, v9
v_add_f32 v94, v94, v8
v_exp_f32 v10, v10
v_add_f32 v94, v94, v9
v_exp_f32 v11, v11
v_add_f32 v94, v94, v10
v_add_f32 v94, v94, v11
M v[204:207], a[196:199], v[24:27], v[204:207]
buffer_load_dwordx4 v70, s[16:19], s45 offen offset:3072 nt lds
ds_read_b64_tr_b16 a[206:207], v68 offset:36864
v_cvt_pk_bf16_f32 v52, v8, v9
v_cvt_pk_bf16_f32 v53, v10, v11
M v[4:7], a[176:179], a[8:11], 0
s_add_u32 m0, s36, 49152
v_exp_f32 v12, v12
v_exp_f32 v13, v13
M v[4:7], a[180:183], a[28:31], v[4:7]
v_cvt_pk_bf16_f32 v38, v12, v13
v_add_f32 v90, v90, v12
M v[4:7], a[184:187], a[48:51], v[4:7]
v_exp_f32 v14, v14
M v[4:7], a[188:191], a[68:71], v[4:7]
v_add_f32 v90, v90, v13
v_add_f32 v90, v90, v14
v_exp_f32 v15, v15
v_exp_f32 v0, v0
M v[208:211], a[196:199], v[28:31], v[208:211]
v_cvt_pk_bf16_f32 v39, v14, v15
v_add_f32 v90, v90, v15
M v[212:215], a[196:199], v[32:35], v[212:215]
s_waitcnt lgkmcnt(2)
v_exp_f32 v1, v1
M v[216:219], a[200:203], v[16:19], v[216:219]
v_cvt_pk_bf16_f32 v42, v0, v1
v_add_f32 v91, v91, v0
M v[220:223], a[200:203], v[20:23], v[220:223]
v_exp_f32 v2, v2
M v[8:11], a[176:179], a[12:15], 0
s_mov_b64 exec, 0
s_branch L_hop_b4
L_ret_b4:
s_mov_b64 exec, -1
s_mov_b64 exec, 0
s_branch L_hop_b5
L_ret_b5:
s_mov_b64 exec, -1
s_waitcnt vmcnt(16) lgkmcnt(0)
v_add_f32 v91, v91, v1
v_add_f32 v91, v91, v2
M v[8:11], a[180:183], a[32:35], v[8:11]
s_barrier
ds_read_b128 a[160:163], v57 offset:0
M v[8:11], a[184:187], a[52:55], v[8:11]
ds_read_b128 a[164:167], v58 offset:0
v_exp_f32 v3, v3
M v[8:11], a[188:191], a[72:75], v[8:11]
ds_read_b128 a[168:171], v59 offset:0
v_add_f32 v91, v91, v3
M v[224:227], a[200:203], v[24:27], v[224:227]
ds_read_b128 a[172:175], v60 offset:0
v_cvt_pk_bf16_f32 v43, v2, v3
M v[228:231], a[200:203], v[28:31], v[228:231]
ds_read_b64_tr_b16 a[192:193], v61 offset:49152
M v[232:235], a[200:203], v[32:35], v[232:235]
ds_read_b64_tr_b16 a[194:195], v61 offset:53248
buffer_load_dwordx4 v69, s[12:15], s46 offen nt lds
M v[236:239], a[204:207], v[16:19], v[236:239]
v_exp_f32 v4, v4
M v[12:15], a[176:179], a[16:19], 0
s_add_u32 s47, s43, 81920
v_exp_f32 v5, v5
M v[12:15], a[180:183], a[36:39], v[12:15]
s_and_b32 s47, s47, 131071
v_exp_f32 v6, v6
M v[12:15], a[184:187], a[56:59], v[12:15]
s_add_u32 s47, s47, s32
v_exp_f32 v7, v7
M v[12:15], a[188:191], a[76:79], v[12:15]
ds_read_b64_tr_b16 a[196:197], v62 offset:49152
v_cvt_pk_bf16_f32 v46, v4, v5
M v[240:243], a[204:207], v[20:23], v[240:243]
v_exp_f32 v8, v8
M v[244:247], a[204:207], v[24:27], v[244:247]
v_exp_f32 v9, v9
M v[248:251], a[204:207], v[28:31], v[248:251]
v_exp_f32 v10, v10
M v[252:255], a[204:207], v[32:35], v[252:255]
s_waitcnt lgkmcnt(6)
v_exp_f32 v11, v11
M v[0:3], a[160:163], a[0:3], 0
s_waitcnt lgkmcnt(5)
v_cvt_pk_bf16_f32 v47, v6, v7
v_add_f32 v92, v92, v4
M v[0:3], a[164:167], a[20:23], v[0:3]
s_waitcnt lgkmcnt(4)
ds_read_b64_tr_b16 a[198:199], v62 offset:53248
v_add_f32 v92, v92, v5
M v[0:3], a[168:171], a[40:43], v[0:3]
s_waitcnt lgkmcnt(4)
v_cvt_pk_bf16_f32 v50, v8, v9
v_cvt_pk_bf16_f32 v51, v10, v11
M v[0:3], a[172:175], a[60:63], v[0:3]
s_waitcnt lgkmcnt(2)
ds_read_b64_tr_b16 a[200:201], v63 offset:49152
v_add_f32 v92, v92, v6
M v[96:99], a[192:195], v[36:39], v[96:99]
v_add_f32 v92, v92, v7
v_add_f32 v93, v93, v8
v_exp_f32 v12, v12
M v[100:103], a[192:195], v[40:43], v[100:103]
buffer_load_dwordx4 v70, s[12:15], s46 offen offset:1024 nt lds
M v[104:107], a[192:195], v[44:47], v[104:107]
v_exp_f32 v13, v13
M v[108:111], a[192:195], v[48:51], v[108:111]
v_exp_f32 v14, v14
M v[4:7], a[160:163], a[4:7], 0
v_exp_f32 v15, v15
M v[4:7], a[164:167], a[24:27], v[4:7]
v_cvt_pk_bf16_f32 v54, v12, v13
v_cvt_pk_bf16_f32 v55, v14, v15
M v[4:7], a[168:171], a[44:47], v[4:7]
ds_read_b64_tr_b16 a[202:203], v63 offset:53248
v_add_f32 v93, v93, v9
M v[4:7], a[172:175], a[64:67], v[4:7]
v_add_f32 v93, v93, v10
v_add_f32 v94, v94, v12
M v[112:115], a[192:195], v[52:55], v[112:115]
s_waitcnt lgkmcnt(2)
v_add_f32 v93, v93, v11
v_add_f32 v94, v94, v13
M v[116:119], a[196:199], v[36:39], v[116:119]
buffer_load_dwordx4 v69, s[12:15], s46 offen offset:2048 nt lds
M v[120:123], a[196:199], v[40:43], v[120:123]
ds_read_b64_tr_b16 a[204:205], v64 offset:49152
v_add_f32 v94, v94, v14
M v[124:127], a[196:199], v[44:47], v[124:127]
ds_read_b64_tr_b16 a[206:207], v64 offset:53248
v_add_f32 v94, v94, v15
M v[8:11], a[160:163], a[8:11], 0
v_exp_f32 v0, v0
M v[8:11], a[164:167], a[28:31], v[8:11]
buffer_load_dwordx4 v70, s[12:15], s46 offen offset:3072 nt lds
M v[8:11], a[168:171], a[48:51], v[8:11]
s_add_u32 m0, s36, 98304
v_exp_f32 v1, v1
M v[8:11], a[172:175], a[68:71], v[8:11]
ds_read_b128 a[176:179], v57 offset:4096
v_add_f32 v90, v90, v0
M v[128:131], a[196:199], v[48:51], v[128:131]
v_exp_f32 v2, v2
M v[132:135], a[196:199], v[52:55], v[132:135]
s_waitcnt lgkmcnt(3)
v_cvt_pk_bf16_f32 v16, v0, v1
v_add_f32 v90, v90, v1
M v[136:139], a[200:203], v[36:39], v[136:139]
v_exp_f32 v3, v3
M v[140:143], a[200:203], v[40:43], v[140:143]
v_cvt_pk_bf16_f32 v17, v2, v3
v_add_f32 v90, v90, v2
M v[12:15], a[160:163], a[12:15], 0
ds_read_b128 a[180:183], v58 offset:4096
v_add_f32 v90, v90, v3
M v[12:15], a[164:167], a[32:35], v[12:15]
ds_read_b128 a[184:187], v59 offset:4096
M v[12:15], a[168:171], a[52:55], v[12:15]
buffer_load_dwordx4 v69, s[16:19], s47 offen nt lds
M v[12:15], a[172:175], a[72:75], v[12:15]
ds_read_b128 a[188:191], v60 offset:4096
M v[144:147], a[200:203], v[44:47], v[144:147]
ds_read_b64_tr_b16 a[192:193], v65 offset:49152
M v[148:151], a[200:203], v[48:51], v[148:151]
v_exp_f32 v4, v4
M v[152:155], a[200:203], v[52:55], v[152:155]
s_waitcnt lgkmcnt(5)
ds_read_b64_tr_b16 a[194:195], v65 offset:53248
v_add_f32 v91, v91, v4
M v[156:159], a[204:207], v[36:39], v[156:159]
v_exp_f32 v5, v5
M v[0:3], a[160:163], a[16:19], 0
v_exp_f32 v6, v6
M v[0:3], a[164:167], a[36:39], v[0:3]
v_cvt_pk_bf16_f32 v20, v4, v5
v_add_f32 v91, v91, v5
M v[0:3], a[168:171], a[56:59], v[0:3]
v_exp_f32 v7, v7
M v[0:3], a[172:175], a[76:79], v[0:3]
v_cvt_pk_bf16_f32 v21, v6, v7
v_add_f32 v91, v91, v6
M v[160:163], a[204:207], v[40:43], v[160:163]
s_add_u32 s48, s43, 98304
ds_read_b64_tr_b16 a[196:197], v66 offset:49152
v_add_f32 v91, v91, v7
M v[164:167], a[204:207], v[44:47], v[164:167]
s_and_b32 s48, s48, 131071
buffer_load_dwordx4 v70, s[16:19], s47 offen offset:1024 nt lds
M v[168:171], a[204:207], v[48:51], v[168:171]
s_add_u32 s48, s48, s32
v_exp_f32 v8, v8
M v[172:175], a[204:207], v[52:55], v[172:175]
s_waitcnt lgkmcnt(6)
v_exp_f32 v9, v9
M v[4:7], a[176:179], a[0:3], 0
s_waitcnt lgkmcnt(5)
ds_read_b64_tr_b16 a[198:199], v66 offset:53248
v_add_f32 v92, v92, v8
M v[4:7], a[180:183], a[20:23], v[4:7]
s_waitcnt lgkmcnt(5)
v_exp_f32 v10, v10
M v[4:7], a[184:187], a[40:43], v[4:7]
s_waitcnt lgkmcnt(4)
v_cvt_pk_bf16_f32 v24, v8, v9
v_add_f32 v92, v92, v9
M v[4:7], a[188:191], a[60:63], v[4:7]
s_waitcnt lgkmcnt(2)
v_exp_f32 v11, v11
M v[176:179], a[192:195], v[36:39], v[176:179]
v_cvt_pk_bf16_f32 v25, v10, v11
v_add_f32 v92, v92, v10
M v[180:183], a[192:195], v[40:43], v[180:183]
ds_read_b64_tr_b16 a[200:201], v67 offset:49152
v_add_f32 v92, v92, v11
M v[184:187], a[192:195], v[44:47], v[184:187]
buffer_load_dwordx4 v69, s[16:19], s47 offen offset:2048 nt lds
M v[188:191], a[192:195], v[48:51], v[188:191]
v_exp_f32 v12, v12
v_exp_f32 v13, v13
v_add_f32 v93, v93, v12
M v[8:11], a[176:179], a[4:7], 0
v_exp_f32 v14, v14
v_add_f32 v93, v93, v13
M v[8:11], a[180:183], a[24:27], v[8:11]
v_exp_f32 v15, v15
M v[8:11], a[184:187], a[44:47], v[8:11]
ds_read_b64_tr_b16 a[202:203], v67 offset:53248
v_add_f32 v93, v93, v14
M v[8:11], a[188:191], a[64:67], v[8:11]
v_cvt_pk_bf16_f32 v28, v12, v13
v_add_f32 v93, v93, v15
M v[192:195], a[192:195], v[52:55], v[192:195]
s_waitcnt lgkmcnt(2)
ds_read_b64_tr_b16 a[204:205], v68 offset:49152
v_cvt_pk_bf16_f32 v29, v14, v15
M v[196:199], a[196:199], v[36:39], v[196:199]
v_exp_f32 v0, v0
M v[200:203], a[196:199], v[40:43], v[200:203]
v_exp_f32 v1, v1
v_add_f32 v94, v94, v0
v_exp_f32 v2, v2
v_add_f32 v94, v94, v1
v_exp_f32 v3, v3
v_add_f32 v94, v94, v2
v_add_f32 v94, v94, v3
M v[204:207], a[196:199], v[44:47], v[204:207]
buffer_load_dwordx4 v70, s[16:19], s47 offen offset:3072 nt lds
ds_read_b64_tr_b16 a[206:207], v68 offset:53248
v_cvt_pk_bf16_f32 v32, v0, v1
v_cvt_pk_bf16_f32 v33, v2, v3
M v[12:15], a[176:179], a[8:11], 0
s_add_u32 m0, s36, 0
v_exp_f32 v4, v4
v_exp_f32 v5, v5
M v[12:15], a[180:183], a[28:31], v[12:15]
v_cvt_pk_bf16_f32 v18, v4, v5
v_add_f32 v90, v90, v4
M v[12:15], a[184:187], a[48:51], v[12:15]
v_exp_f32 v6, v6
M v[12:15], a[188:191], a[68:71], v[12:15]
v_add_f32 v90, v90, v5
v_add_f32 v90, v90, v6
v_exp_f32 v7, v7
v_exp_f32 v8, v8
M v[208:211], a[196:199], v[48:51], v[208:211]
v_cvt_pk_bf16_f32 v19, v6, v7
v_add_f32 v90, v90, v7
M v[212:215], a[196:199], v[52:55], v[212:215]
s_waitcnt lgkmcnt(2)
v_exp_f32 v9, v9
M v[216:219], a[200:203], v[36:39], v[216:219]
v_cvt_pk_bf16_f32 v22, v8, v9
v_add_f32 v91, v91, v8
M v[220:223], a[200:203], v[40:43], v[220:223]
v_exp_f32 v10, v10
M v[0:3], a[176:179], a[12:15], 0
s_mov_b64 exec, 0
s_branch L_hop_b6
L_ret_b6:
s_mov_b64 exec, -1
s_waitcnt vmcnt(16) lgkmcnt(0)
v_add_f32 v91, v91, v9
v_add_f32 v91, v91, v10
M v[0:3], a[180:183], a[32:35], v[0:3]
s_barrier
ds_read_b128 a[160:163], v57 offset:16384
M v[0:3], a[184:187], a[52:55], v[0:3]
ds_read_b128 a[164:167], v58 offset:16384
v_exp_f32 v11, v11
M v[0:3], a[188:191], a[72:75], v[0:3]
ds_read_b128 a[168:171], v59 offset:16384
v_add_f32 v91, v91, v11
M v[224:227], a[200:203], v[44:47], v[224:227]
ds_read_b128 a[172:175], v60 offset:16384
v_cvt_pk_bf16_f32 v23, v10, v11
M v[228:231], a[200:203], v[48:51], v[228:231]
ds_read_b64_tr_b16 a[192:193], v61 offset:0
M v[232:235], a[200:203], v[52:55], v[232:235]
ds_read_b64_tr_b16 a[194:195], v61 offset:4096
buffer_load_dwordx4 v69, s[12:15], s48 offen nt lds
M v[236:239], a[204:207], v[36:39], v[236:239]
v_exp_f32 v12, v12
M v[4:7], a[176:179], a[16:19], 0
s_add_u32 s49, s43, 90112
v_exp_f32 v13, v13
M v[4:7], a[180:183], a[36:39], v[4:7]
s_and_b32 s49, s49, 131071
v_exp_f32 v14, v14
M v[4:7], a[184:187], a[56:59], v[4:7]
s_add_u32 s49, s49, s32
v_exp_f32 v15, v15
M v[4:7], a[188:191], a[76:79], v[4:7]
ds_read_b64_tr_b16 a[196:197], v62 offset:0
v_cvt_pk_bf16_f32 v26, v12, v13
M v[240:243], a[204:207], v[40:43], v[240:243]
v_exp_f32 v0, v0
M v[244:247], a[204:207], v[44:47], v[244:247]
v_exp_f32 v1, v1
M v[248:251], a[204:207], v[48:51], v[248:251]
v_exp_f32 v2, v2
M v[252:255], a[204:207], v[52:55], v[252:255]
s_waitcnt lgkmcnt(6)
v_exp_f32 v3, v3
M v[8:11], a[160:163], a[0:3], 0
s_waitcnt lgkmcnt(5)
v_cvt_pk_bf16_f32 v27, v14, v15
v_add_f32 v92, v92, v12
M v[8:11], a[164:167], a[20:23], v[8:11]
s_waitcnt lgkmcnt(4)
ds_read_b64_tr_b16 a[198:199], v62 offset:4096
v_add_f32 v92, v92, v13
M v[8:11], a[168:171], a[40:43], v[8:11]
s_waitcnt lgkmcnt(4)
v_cvt_pk_bf16_f32 v30, v0, v1
v_cvt_pk_bf16_f32 v31, v2, v3
M v[8:11], a[172:175], a[60:63], v[8:11]
s_waitcnt lgkmcnt(2)
ds_read_b64_tr_b16 a[200:201], v63 offset:0
v_add_f32 v92, v92, v14
M v[96:99], a[192:195], v[16:19], v[96:99]
v_add_f32 v92, v92, v15
v_add_f32 v93, v93, v0
v_exp_f32 v4, v4
M v[100:103], a[192:195], v[20:23], v[100:103]
buffer_load_dwordx4 v70, s[12:15], s48 offen offset:1024 nt lds
M v[104:107], a[192:195], v[24:27], v[104:107]
v_exp_f32 v5, v5
M v[108:111], a[192:195], v[28:31], v[108:111]
v_exp_f32 v6, v6
M v[12:15], a[160:163], a[4:7], 0
v_exp_f32 v7, v7
M v[12:15], a[164:167], a[24:27], v[12:15]
v_cvt_pk_bf16_f32 v34, v4, v5
v_cvt_pk_bf16_f32 v35, v6, v7
M v[12:15], a[168:171], a[44:47], v[12:15]
ds_read_b64_tr_b16 a[202:203], v63 offset:4096
v_add_f32 v93, v93, v1
M v[12:15], a[172:175], a[64:67], v[12:15]
v_add_f32 v93, v93, v2
v_add_f32 v94, v94, v4
M v[112:115], a[192:195], v[32:35], v[112:115]
s_waitcnt lgkmcnt(2)
v_add_f32 v93, v93, v3
v_add_f32 v94, v94, v5
M v[116:119], a[196:199], v[16:19], v[116:119]
buffer_load_dwordx4 v69, s[12:15], s48 offen offset:2048 nt lds
M v[120:123], a[196:199], v[20:23], v[120:123]
ds_read_b64_tr_b16 a[204:205], v64 offset:0
v_add_f32 v94, v94, v6
M v[124:127], a[196:199], v[24:27], v[124:127]
ds_read_b64_tr_b16 a[206:207], v64 offset:4096
v_add_f32 v94, v94, v7
M v[0:3], a[160:163], a[8:11], 0
v_exp_f32 v8, v8
M v[0:3], a[164:167], a[28:31], v[0:3]
buffer_load_dwordx4 v70, s[12:15], s48 offen offset:3072 nt lds
M v[0:3], a[168:171], a[48:51], v[0:3]
s_add_u32 m0, s36, 114688
v_exp_f32 v9, v9
M v[0:3], a[172:175], a[68:71], v[0:3]
ds_read_b128 a[176:179], v57 offset:20480
v_add_f32 v90, v90, v8
M v[128:131], a[196:199], v[28:31], v[128:131]
v_exp_f32 v10, v10
M v[132:135], a[196:199], v[32:35], v[132:135]
s_waitcnt lgkmcnt(3)
v_cvt_pk_bf16_f32 v36, v8, v9
v_add_f32 v90, v90, v9
M v[136:139], a[200:203], v[16:19], v[136:139]
v_exp_f32 v11, v11
M v[140:143], a[200:203], v[20:23], v[140:143]
v_cvt_pk_bf16_f32 v37, v10, v11
v_add_f32 v90, v90, v10
M v[4:7], a[160:163], a[12:15], 0
ds_read_b128 a[180:183], v58 offset:20480
v_add_f32 v90, v90, v11
M v[4:7], a[164:167], a[32:35], v[4:7]
ds_read_b128 a[184:187], v59 offset:20480
M v[4:7], a[168:171], a[52:55], v[4:7]
buffer_load_dwordx4 v69, s[16:19], s49 offen nt lds
M v[4:7], a[172:175], a[72:75], v[4:7]
ds_read_b128 a[188:191], v60 offset:20480
M v[144:147], a[200:203], v[24:27], v[144:147]
ds_read_b64_tr_b16 a[192:193], v65 offset:0
M v[148:151], a[200:203], v[28:31], v[148:151]
v_exp_f32 v12, v12
M v[152:155], a[200:203], v[32:35], v[152:155]
s_waitcnt lgkmcnt(5)
ds_read_b64_tr_b16 a[194:195], v65 offset:4096
v_add_f32 v91, v91, v12
M v[156:159], a[204:207], v[16:19], v[156:159]
v_exp_f32 v13, v13
M v[8:11], a[160:163], a[16:19], 0
v_exp_f32 v14, v14
M v[8:11], a[164:167], a[36:39], v[8:11]
v_cvt_pk_bf16_f32 v40, v12, v13
v_add_f32 v91, v91, v13
M v[8:11], a[168:171], a[56:59], v[8:11]
v_exp_f32 v15, v15
M v[8:11], a[172:175], a[76:79], v[8:11]
v_cvt_pk_bf16_f32 v41, v14, v15
v_add_f32 v91, v91, v14
M v[160:163], a[204:207], v[20:23], v[160:163]
s_add_u32 s50, s43, 106496
ds_read_b64_tr_b16 a[196:197], v66 offset:0
v_add_f32 v91, v91, v15
M v[164:167], a[204:207], v[24:27], v[164:167]
s_and_b32 s50, s50, 131071
buffer_load_dwordx4 v70, s[16:19], s49 offen offset:1024 nt lds
M v[168:171], a[204:207], v[28:31], v[168:171]
s_add_u32 s50, s50, s32
v_exp_f32 v0, v0
M v[172:175], a[204:207], v[32:35], v[172:175]
s_waitcnt lgkmcnt(6)
v_exp_f32 v1, v1
M v[12:15], a[176:179], a[0:3], 0
s_waitcnt lgkmcnt(5)
ds_read_b64_tr_b16 a[198:199], v66 offset:4096
v_add_f32 v92, v92, v0
M v[12:15], a[180:183], a[20:23], v[12:15]
s_waitcnt lgkmcnt(5)
v_exp_f32 v2, v2
M v[12:15], a[184:187], a[40:43], v[12:15]
s_waitcnt lgkmcnt(4)
v_cvt_pk_bf16_f32 v44, v0, v1
v_add_f32 v92, v92, v1
M v[12:15], a[188:191], a[60:63], v[12:15]
s_waitcnt lgkmcnt(2)
v_exp_f32 v3, v3
M v[176:179], a[192:195], v[16:19], v[176:179]
v_cvt_pk_bf16_f32 v45, v2, v3
v_add_f32 v92, v92, v2
M v[180:183], a[192:195], v[20:23], v[180:183]
ds_read_b64_tr_b16 a[200:201], v67 offset:0
v_add_f32 v92, v92, v3
M v[184:187], a[192:195], v[24:27], v[184:187]
buffer_load_dwordx4 v69, s[16:19], s49 offen offset:2048 nt lds
M v[188:191], a[192:195], v[28:31], v[188:191]
v_exp_f32 v4, v4
v_exp_f32 v5, v5
v_add_f32 v93, v93, v4
M v[0:3], a[176:179], a[4:7], 0
v_exp_f32 v6, v6
v_add_f32 v93, v93, v5
M v[0:3], a[180:183], a[24:27], v[0:3]
v_exp_f32 v7, v7
M v[0:3], a[184:187], a[44:47], v[0:3]
ds_read_b64_tr_b16 a[202:203], v67 offset:4096
v_add_f32 v93, v93, v6
M v[0:3], a[188:191], a[64:67], v[0:3]
v_cvt_pk_bf16_f32 v48, v4, v5
v_add_f32 v93, v93, v7
M v[192:195], a[192:195], v[32:35], v[192:195]
s_waitcnt lgkmcnt(2)
ds_read_b64_tr_b16 a[204:205], v68 offset:0
v_cvt_pk_bf16_f32 v49, v6, v7
M v[196:199], a[196:199], v[16:19], v[196:199]
v_exp_f32 v8, v8
M v[200:203], a[196:199], v[20:23], v[200:203]
v_exp_f32 v9, v9
v_add_f32 v94, v94, v8
v_exp_f32 v10, v10
v_add_f32 v94, v94, v9
v_exp_f32 v11, v11
v_add_f32 v94, v94, v10
v_add_f32 v94, v94, v11
M v[204:207], a[196:199], v[24:27], v[204:207]
buffer_load_dwordx4 v70, s[16:19], s49 offen offset:3072 nt lds
ds_read_b64_tr_b16 a[206:207], v68 offset:4096
v_cvt_pk_bf16_f32 v52, v8, v9
v_cvt_pk_bf16_f32 v53, v10, v11
M v[4:7], a[176:179], a[8:11], 0
s_add_u32 m0, s36, 16384
v_exp_f32 v12, v12
v_exp_f32 v13, v13
M v[4:7], a[180:183], a[28:31], v[4:7]
v_cvt_pk_bf16_f32 v38, v12, v13
v_add_f32 v90, v90, v12
M v[4:7], a[184:187], a[48:51], v[4:7]
v_exp_f32 v14, v14
M v[4:7], a[188:191], a[68:71], v[4:7]
v_add_f32 v90, v90, v13
v_add_f32 v90, v90, v14
v_exp_f32 v15, v15
v_exp_f32 v0, v0
M v[208:211], a[196:199], v[28:31], v[208:211]
v_cvt_pk_bf16_f32 v39, v14, v15
v_add_f32 v90, v90, v15
M v[212:215], a[196:199], v[32:35], v[212:215]
s_waitcnt lgkmcnt(2)
v_exp_f32 v1, v1
M v[216:219], a[200:203], v[16:19], v[216:219]
v_cvt_pk_bf16_f32 v42, v0, v1
v_add_f32 v91, v91, v0
M v[220:223], a[200:203], v[20:23], v[220:223]
v_exp_f32 v2, v2
M v[8:11], a[176:179], a[12:15], 0
s_waitcnt vmcnt(16) lgkmcnt(0)
v_add_f32 v91, v91, v1
v_add_f32 v91, v91, v2
M v[8:11], a[180:183], a[32:35], v[8:11]
s_barrier
ds_read_b128 a[160:163], v57 offset:32768
M v[8:11], a[184:187], a[52:55], v[8:11]
ds_read_b128 a[164:167], v58 offset:32768
v_exp_f32 v3, v3
M v[8:11], a[188:191], a[72:75], v[8:11]
ds_read_b128 a[168:171], v59 offset:32768
v_add_f32 v91, v91, v3
M v[224:227], a[200:203], v[24:27], v[224:227]
ds_read_b128 a[172:175], v60 offset:32768
v_cvt_pk_bf16_f32 v43, v2, v3
M v[228:231], a[200:203], v[28:31], v[228:231]
ds_read_b64_tr_b16 a[192:193], v61 offset:16384
M v[232:235], a[200:203], v[32:35], v[232:235]
ds_read_b64_tr_b16 a[194:195], v61 offset:20480
buffer_load_dwordx4 v69, s[12:15], s50 offen nt lds
M v[236:239], a[204:207], v[16:19], v[236:239]
v_exp_f32 v4, v4
M v[12:15], a[176:179], a[16:19], 0
s_add_u32 s51, s43, 98304
v_exp_f32 v5, v5
M v[12:15], a[180:183], a[36:39], v[12:15]
s_and_b32 s51, s51, 131071
v_exp_f32 v6, v6
M v[12:15], a[184:187], a[56:59], v[12:15]
s_add_u32 s51, s51, s32
v_exp_f32 v7, v7
M v[12:15], a[188:191], a[76:79], v[12:15]
ds_read_b64_tr_b16 a[196:197], v62 offset:16384
v_cvt_pk_bf16_f32 v46, v4, v5
M v[240:243], a[204:207], v[20:23], v[240:243]
v_exp_f32 v8, v8
M v[244:247], a[204:207], v[24:27], v[244:247]
v_exp_f32 v9, v9
M v[248:251], a[204:207], v[28:31], v[248:251]
v_exp_f32 v10, v10
M v[252:255], a[204:207], v[32:35], v[252:255]
s_waitcnt lgkmcnt(6)
v_exp_f32 v11, v11
M v[0:3], a[160:163], a[0:3], 0
s_waitcnt lgkmcnt(5)
v_cvt_pk_bf16_f32 v47, v6, v7
v_add_f32 v92, v92, v4
M v[0:3], a[164:167], a[20:23], v[0:3]
s_waitcnt lgkmcnt(4)
ds_read_b64_tr_b16 a[198:199], v62 offset:20480
v_add_f32 v92, v92, v5
M v[0:3], a[168:171], a[40:43], v[0:3]
s_waitcnt lgkmcnt(4)
v_cvt_pk_bf16_f32 v50, v8, v9
v_cvt_pk_bf16_f32 v51, v10, v11
M v[0:3], a[172:175], a[60:63], v[0:3]
s_waitcnt lgkmcnt(2)
ds_read_b64_tr_b16 a[200:201], v63 offset:16384
v_add_f32 v92, v92, v6
M v[96:99], a[192:195], v[36:39], v[96:99]
v_add_f32 v92, v92, v7
v_add_f32 v93, v93, v8
v_exp_f32 v12, v12
M v[100:103], a[192:195], v[40:43], v[100:103]
buffer_load_dwordx4 v70, s[12:15], s50 offen offset:1024 nt lds
M v[104:107], a[192:195], v[44:47], v[104:107]
v_exp_f32 v13, v13
M v[108:111], a[192:195], v[48:51], v[108:111]
v_exp_f32 v14, v14
M v[4:7], a[160:163], a[4:7], 0
v_exp_f32 v15, v15
M v[4:7], a[164:167], a[24:27], v[4:7]
v_cvt_pk_bf16_f32 v54, v12, v13
v_cvt_pk_bf16_f32 v55, v14, v15
M v[4:7], a[168:171], a[44:47], v[4:7]
ds_read_b64_tr_b16 a[202:203], v63 offset:20480
v_add_f32 v93, v93, v9
M v[4:7], a[172:175], a[64:67], v[4:7]
v_add_f32 v93, v93, v10
v_add_f32 v94, v94, v12
M v[112:115], a[192:195], v[52:55], v[112:115]
s_waitcnt lgkmcnt(2)
v_add_f32 v93, v93, v11
v_add_f32 v94, v94, v13
M v[116:119], a[196:199], v[36:39], v[116:119]
buffer_load_dwordx4 v69, s[12:15], s50 offen offset:2048 nt lds
M v[120:123], a[196:199], v[40:43], v[120:123]
ds_read_b64_tr_b16 a[204:205], v64 offset:16384
v_add_f32 v94, v94, v14
M v[124:127], a[196:199], v[44:47], v[124:127]
ds_read_b64_tr_b16 a[206:207], v64 offset:20480
v_add_f32 v94, v94, v15
M v[8:11], a[160:163], a[8:11], 0
v_exp_f32 v0, v0
M v[8:11], a[164:167], a[28:31], v[8:11]
buffer_load_dwordx4 v70, s[12:15], s50 offen offset:3072 nt lds
M v[8:11], a[168:171], a[48:51], v[8:11]
s_add_u32 m0, s36, 65536
v_exp_f32 v1, v1
M v[8:11], a[172:175], a[68:71], v[8:11]
ds_read_b128 a[176:179], v57 offset:36864
v_add_f32 v90, v90, v0
M v[128:131], a[196:199], v[48:51], v[128:131]
v_exp_f32 v2, v2
M v[132:135], a[196:199], v[52:55], v[132:135]
s_waitcnt lgkmcnt(3)
v_cvt_pk_bf16_f32 v16, v0, v1
v_add_f32 v90, v90, v1
M v[136:139], a[200:203], v[36:39], v[136:139]
v_exp_f32 v3, v3
M v[140:143], a[200:203], v[40:43], v[140:143]
v_cvt_pk_bf16_f32 v17, v2, v3
v_add_f32 v90, v90, v2
M v[12:15], a[160:163], a[12:15], 0
ds_read_b128 a[180:183], v58 offset:36864
v_add_f32 v90, v90, v3
M v[12:15], a[164:167], a[32:35], v[12:15]
ds_read_b128 a[184:187], v59 offset:36864
M v[12:15], a[168:171], a[52:55], v[12:15]
buffer_load_dwordx4 v69, s[16:19], s51 offen nt lds
M v[12:15], a[172:175], a[72:75], v[12:15]
ds_read_b128 a[188:191], v60 offset:36864
M v[144:147], a[200:203], v[44:47], v[144:147]
ds_read_b64_tr_b16 a[192:193], v65 offset:16384
M v[148:151], a[200:203], v[48:51], v[148:151]
v_exp_f32 v4, v4
M v[152:155], a[200:203], v[52:55], v[152:155]
s_waitcnt lgkmcnt(5)
ds_read_b64_tr_b16 a[194:195], v65 offset:20480
v_add_f32 v91, v91, v4
M v[156:159], a[204:207], v[36:39], v[156:159]
v_exp_f32 v5, v5
M v[0:3], a[160:163], a[16:19], 0
v_exp_f32 v6, v6
M v[0:3], a[164:167], a[36:39], v[0:3]
v_cvt_pk_bf16_f32 v20, v4, v5
v_add_f32 v91, v91, v5
M v[0:3], a[168:171], a[56:59], v[0:3]
v_exp_f32 v7, v7
M v[0:3], a[172:175], a[76:79], v[0:3]
v_cvt_pk_bf16_f32 v21, v6, v7
v_add_f32 v91, v91, v6
M v[160:163], a[204:207], v[40:43], v[160:163]
s_add_u32 s44, s43, 114688
ds_read_b64_tr_b16 a[196:197], v66 offset:16384
v_add_f32 v91, v91, v7
M v[164:167], a[204:207], v[44:47], v[164:167]
s_and_b32 s44, s44, 131071
buffer_load_dwordx4 v70, s[16:19], s51 offen offset:1024 nt lds
M v[168:171], a[204:207], v[48:51], v[168:171]
s_add_u32 s44, s44, s32
v_exp_f32 v8, v8
M v[172:175], a[204:207], v[52:55], v[172:175]
s_waitcnt lgkmcnt(6)
v_exp_f32 v9, v9
M v[4:7], a[176:179], a[0:3], 0
s_waitcnt lgkmcnt(5)
ds_read_b64_tr_b16 a[198:199], v66 offset:20480
v_add_f32 v92, v92, v8
M v[4:7], a[180:183], a[20:23], v[4:7]
s_waitcnt lgkmcnt(5)
v_exp_f32 v10, v10
M v[4:7], a[184:187], a[40:43], v[4:7]
s_waitcnt lgkmcnt(4)
v_cvt_pk_bf16_f32 v24, v8, v9
v_add_f32 v92, v92, v9
M v[4:7], a[188:191], a[60:63], v[4:7]
s_waitcnt lgkmcnt(2)
v_exp_f32 v11, v11
M v[176:179], a[192:195], v[36:39], v[176:179]
v_cvt_pk_bf16_f32 v25, v10, v11
v_add_f32 v92, v92, v10
M v[180:183], a[192:195], v[40:43], v[180:183]
ds_read_b64_tr_b16 a[200:201], v67 offset:16384
v_add_f32 v92, v92, v11
M v[184:187], a[192:195], v[44:47], v[184:187]
buffer_load_dwordx4 v69, s[16:19], s51 offen offset:2048 nt lds
M v[188:191], a[192:195], v[48:51], v[188:191]
v_exp_f32 v12, v12
v_exp_f32 v13, v13
v_add_f32 v93, v93, v12
M v[8:11], a[176:179], a[4:7], 0
v_exp_f32 v14, v14
v_add_f32 v93, v93, v13
M v[8:11], a[180:183], a[24:27], v[8:11]
v_exp_f32 v15, v15
M v[8:11], a[184:187], a[44:47], v[8:11]
ds_read_b64_tr_b16 a[202:203], v67 offset:20480
v_add_f32 v93, v93, v14
M v[8:11], a[188:191], a[64:67], v[8:11]
v_cvt_pk_bf16_f32 v28, v12, v13
v_add_f32 v93, v93, v15
M v[192:195], a[192:195], v[52:55], v[192:195]
s_waitcnt lgkmcnt(2)
ds_read_b64_tr_b16 a[204:205], v68 offset:16384
v_cvt_pk_bf16_f32 v29, v14, v15
M v[196:199], a[196:199], v[36:39], v[196:199]
v_exp_f32 v0, v0
M v[200:203], a[196:199], v[40:43], v[200:203]
v_exp_f32 v1, v1
v_add_f32 v94, v94, v0
v_exp_f32 v2, v2
v_add_f32 v94, v94, v1
v_exp_f32 v3, v3
v_add_f32 v94, v94, v2
v_add_f32 v94, v94, v3
M v[204:207], a[196:199], v[44:47], v[204:207]
buffer_load_dwordx4 v70, s[16:19], s51 offen offset:3072 nt lds
ds_read_b64_tr_b16 a[206:207], v68 offset:20480
v_cvt_pk_bf16_f32 v32, v0, v1
v_cvt_pk_bf16_f32 v33, v2, v3
M v[12:15], a[176:179], a[8:11], 0
s_add_u32 m0, s36, 32768
v_exp_f32 v4, v4
v_exp_f32 v5, v5
M v[12:15], a[180:183], a[28:31], v[12:15]
v_cvt_pk_bf16_f32 v18, v4, v5
v_add_f32 v90, v90, v4
M v[12:15], a[184:187], a[48:51], v[12:15]
v_exp_f32 v6, v6
M v[12:15], a[188:191], a[68:71], v[12:15]
v_add_f32 v90, v90, v5
v_add_f32 v90, v90, v6
v_exp_f32 v7, v7
v_exp_f32 v8, v8
M v[208:211], a[196:199], v[48:51], v[208:211]
v_cvt_pk_bf16_f32 v19, v6, v7
v_add_f32 v90, v90, v7
M v[212:215], a[196:199], v[52:55], v[212:215]
s_waitcnt lgkmcnt(2)
v_exp_f32 v9, v9
M v[216:219], a[200:203], v[36:39], v[216:219]
v_cvt_pk_bf16_f32 v22, v8, v9
v_add_f32 v91, v91, v8
M v[220:223], a[200:203], v[40:43], v[220:223]
v_exp_f32 v10, v10
M v[0:3], a[176:179], a[12:15], 0
s_waitcnt vmcnt(16) lgkmcnt(0)
v_add_f32 v91, v91, v9
v_add_f32 v91, v91, v10
M v[0:3], a[180:183], a[32:35], v[0:3]
s_barrier
ds_read_b128 a[160:163], v57 offset:49152
M v[0:3], a[184:187], a[52:55], v[0:3]
ds_read_b128 a[164:167], v58 offset:49152
v_exp_f32 v11, v11
M v[0:3], a[188:191], a[72:75], v[0:3]
ds_read_b128 a[168:171], v59 offset:49152
v_add_f32 v91, v91, v11
M v[224:227], a[200:203], v[44:47], v[224:227]
ds_read_b128 a[172:175], v60 offset:49152
v_cvt_pk_bf16_f32 v23, v10, v11
M v[228:231], a[200:203], v[48:51], v[228:231]
ds_read_b64_tr_b16 a[192:193], v61 offset:32768
M v[232:235], a[200:203], v[52:55], v[232:235]
ds_read_b64_tr_b16 a[194:195], v61 offset:36864
buffer_load_dwordx4 v69, s[12:15], s44 offen nt lds
M v[236:239], a[204:207], v[36:39], v[236:239]
v_exp_f32 v12, v12
M v[4:7], a[176:179], a[16:19], 0
s_add_u32 s45, s43, 106496
v_exp_f32 v13, v13
M v[4:7], a[180:183], a[36:39], v[4:7]
s_and_b32 s45, s45, 131071
v_exp_f32 v14, v14
M v[4:7], a[184:187], a[56:59], v[4:7]
s_add_u32 s45, s45, s32
v_exp_f32 v15, v15
M v[4:7], a[188:191], a[76:79], v[4:7]
ds_read_b64_tr_b16 a[196:197], v62 offset:32768
v_cvt_pk_bf16_f32 v26, v12, v13
M v[240:243], a[204:207], v[40:43], v[240:243]
v_exp_f32 v0, v0
M v[244:247], a[204:207], v[44:47], v[244:247]
v_exp_f32 v1, v1
M v[248:251], a[204:207], v[48:51], v[248:251]
v_exp_f32 v2, v2
M v[252:255], a[204:207], v[52:55], v[252:255]
s_waitcnt lgkmcnt(6)
v_exp_f32 v3, v3
M v[8:11], a[160:163], a[0:3], 0
s_waitcnt lgkmcnt(5)
v_cvt_pk_bf16_f32 v27, v14, v15
v_add_f32 v92, v92, v12
M v[8:11], a[164:167], a[20:23], v[8:11]
s_waitcnt lgkmcnt(4)
ds_read_b64_tr_b16 a[198:199], v62 offset:36864
v_add_f32 v92, v92, v13
M v[8:11], a[168:171], a[40:43], v[8:11]
s_waitcnt lgkmcnt(4)
v_cvt_pk_bf16_f32 v30, v0, v1
v_cvt_pk_bf16_f32 v31, v2, v3
M v[8:11], a[172:175], a[60:63], v[8:11]
s_waitcnt lgkmcnt(2)
ds_read_b64_tr_b16 a[200:201], v63 offset:32768
v_add_f32 v92, v92, v14
M v[96:99], a[192:195], v[16:19], v[96:99]
v_add_f32 v92, v92, v15
v_add_f32 v93, v93, v0
v_exp_f32 v4, v4
M v[100:103], a[192:195], v[20:23], v[100:103]
buffer_load_dwordx4 v70, s[12:15], s44 offen offset:1024 nt lds
M v[104:107], a[192:195], v[24:27], v[104:107]
v_exp_f32 v5, v5
M v[108:111], a[192:195], v[28:31], v[108:111]
v_exp_f32 v6, v6
M v[12:15], a[160:163], a[4:7], 0
v_exp_f32 v7, v7
M v[12:15], a[164:167], a[24:27], v[12:15]
v_cvt_pk_bf16_f32 v34, v4, v5
v_cvt_pk_bf16_f32 v35, v6, v7
M v[12:15], a[168:171], a[44:47], v[12:15]
ds_read_b64_tr_b16 a[202:203], v63 offset:36864
v_add_f32 v93, v93, v1
M v[12:15], a[172:175], a[64:67], v[12:15]
v_add_f32 v93, v93, v2
v_add_f32 v94, v94, v4
M v[112:115], a[192:195], v[32:35], v[112:115]
s_waitcnt lgkmcnt(2)
v_add_f32 v93, v93, v3
v_add_f32 v94, v94, v5
M v[116:119], a[196:199], v[16:19], v[116:119]
buffer_load_dwordx4 v69, s[12:15], s44 offen offset:2048 nt lds
M v[120:123], a[196:199], v[20:23], v[120:123]
ds_read_b64_tr_b16 a[204:205], v64 offset:32768
v_add_f32 v94, v94, v6
M v[124:127], a[196:199], v[24:27], v[124:127]
ds_read_b64_tr_b16 a[206:207], v64 offset:36864
v_add_f32 v94, v94, v7
M v[0:3], a[160:163], a[8:11], 0
v_exp_f32 v8, v8
M v[0:3], a[164:167], a[28:31], v[0:3]
buffer_load_dwordx4 v70, s[12:15], s44 offen offset:3072 nt lds
M v[0:3], a[168:171], a[48:51], v[0:3]
s_add_u32 m0, s36, 81920
v_exp_f32 v9, v9
M v[0:3], a[172:175], a[68:71], v[0:3]
ds_read_b128 a[176:179], v57 offset:53248
v_add_f32 v90, v90, v8
M v[128:131], a[196:199], v[28:31], v[128:131]
v_exp_f32 v10, v10
M v[132:135], a[196:199], v[32:35], v[132:135]
s_waitcnt lgkmcnt(3)
v_cvt_pk_bf16_f32 v36, v8, v9
v_add_f32 v90, v90, v9
M v[136:139], a[200:203], v[16:19], v[136:139]
v_exp_f32 v11, v11
M v[140:143], a[200:203], v[20:23], v[140:143]
v_cvt_pk_bf16_f32 v37, v10, v11
v_add_f32 v90, v90, v10
M v[4:7], a[160:163], a[12:15], 0
ds_read_b128 a[180:183], v58 offset:53248
v_add_f32 v90, v90, v11
M v[4:7], a[164:167], a[32:35], v[4:7]
ds_read_b128 a[184:187], v59 offset:53248
M v[4:7], a[168:171], a[52:55], v[4:7]
buffer_load_dwordx4 v69, s[16:19], s45 offen nt lds
M v[4:7], a[172:175], a[72:75], v[4:7]
ds_read_b128 a[188:191], v60 offset:53248
M v[144:147], a[200:203], v[24:27], v[144:147]
ds_read_b64_tr_b16 a[192:193], v65 offset:32768
M v[148:151], a[200:203], v[28:31], v[148:151]
v_exp_f32 v12, v12
M v[152:155], a[200:203], v[32:35], v[152:155]
s_waitcnt lgkmcnt(5)
ds_read_b64_tr_b16 a[194:195], v65 offset:36864
v_add_f32 v91, v91, v12
M v[156:159], a[204:207], v[16:19], v[156:159]
v_exp_f32 v13, v13
M v[8:11], a[160:163], a[16:19], 0
v_exp_f32 v14, v14
M v[8:11], a[164:167], a[36:39], v[8:11]
v_cvt_pk_bf16_f32 v40, v12, v13
v_add_f32 v91, v91, v13
M v[8:11], a[168:171], a[56:59], v[8:11]
v_exp_f32 v15, v15
M v[8:11], a[172:175], a[76:79], v[8:11]
v_cvt_pk_bf16_f32 v41, v14, v15
v_add_f32 v91, v91, v14
M v[160:163], a[204:207], v[20:23], v[160:163]
s_add_u32 s46, s43, 122880
ds_read_b64_tr_b16 a[196:197], v66 offset:32768
v_add_f32 v91, v91, v15
M v[164:167], a[204:207], v[24:27], v[164:167]
s_and_b32 s46, s46, 131071
buffer_load_dwordx4 v70, s[16:19], s45 offen offset:1024 nt lds
M v[168:171], a[204:207], v[28:31], v[168:171]
s_add_u32 s46, s46, s32
v_exp_f32 v0, v0
M v[172:175], a[204:207], v[32:35], v[172:175]
s_waitcnt lgkmcnt(6)
v_exp_f32 v1, v1
M v[12:15], a[176:179], a[0:3], 0
s_waitcnt lgkmcnt(5)
ds_read_b64_tr_b16 a[198:199], v66 offset:36864
v_add_f32 v92, v92, v0
M v[12:15], a[180:183], a[20:23], v[12:15]
s_waitcnt lgkmcnt(5)
v_exp_f32 v2, v2
M v[12:15], a[184:187], a[40:43], v[12:15]
s_waitcnt lgkmcnt(4)
v_cvt_pk_bf16_f32 v44, v0, v1
v_add_f32 v92, v92, v1
M v[12:15], a[188:191], a[60:63], v[12:15]
s_waitcnt lgkmcnt(2)
v_exp_f32 v3, v3
M v[176:179], a[192:195], v[16:19], v[176:179]
v_cvt_pk_bf16_f32 v45, v2, v3
v_add_f32 v92, v92, v2
M v[180:183], a[192:195], v[20:23], v[180:183]
ds_read_b64_tr_b16 a[200:201], v67 offset:32768
v_add_f32 v92, v92, v3
M v[184:187], a[192:195], v[24:27], v[184:187]
buffer_load_dwordx4 v69, s[16:19], s45 offen offset:2048 nt lds
M v[188:191], a[192:195], v[28:31], v[188:191]
v_exp_f32 v4, v4
v_exp_f32 v5, v5
v_add_f32 v93, v93, v4
M v[0:3], a[176:179], a[4:7], 0
v_exp_f32 v6, v6
v_add_f32 v93, v93, v5
M v[0:3], a[180:183], a[24:27], v[0:3]
v_exp_f32 v7, v7
M v[0:3], a[184:187], a[44:47], v[0:3]
ds_read_b64_tr_b16 a[202:203], v67 offset:36864
v_add_f32 v93, v93, v6
M v[0:3], a[188:191], a[64:67], v[0:3]
v_cvt_pk_bf16_f32 v48, v4, v5
v_add_f32 v93, v93, v7
M v[192:195], a[192:195], v[32:35], v[192:195]
s_waitcnt lgkmcnt(2)
ds_read_b64_tr_b16 a[204:205], v68 offset:32768
v_cvt_pk_bf16_f32 v49, v6, v7
M v[196:199], a[196:199], v[16:19], v[196:199]
v_exp_f32 v8, v8
M v[200:203], a[196:199], v[20:23], v[200:203]
v_exp_f32 v9, v9
v_add_f32 v94, v94, v8
v_exp_f32 v10, v10
v_add_f32 v94, v94, v9
v_exp_f32 v11, v11
v_add_f32 v94, v94, v10
v_add_f32 v94, v94, v11
M v[204:207], a[196:199], v[24:27], v[204:207]
buffer_load_dwordx4 v70, s[16:19], s45 offen offset:3072 nt lds
ds_read_b64_tr_b16 a[206:207], v68 offset:36864
v_cvt_pk_bf16_f32 v52, v8, v9
v_cvt_pk_bf16_f32 v53, v10, v11
M v[4:7], a[176:179], a[8:11], 0
s_add_u32 m0, s36, 49152
v_exp_f32 v12, v12
v_exp_f32 v13, v13
M v[4:7], a[180:183], a[28:31], v[4:7]
v_cvt_pk_bf16_f32 v38, v12, v13
v_add_f32 v90, v90, v12
M v[4:7], a[184:187], a[48:51], v[4:7]
v_exp_f32 v14, v14
M v[4:7], a[188:191], a[68:71], v[4:7]
v_add_f32 v90, v90, v13
v_add_f32 v90, v90, v14
v_exp_f32 v15, v15
v_exp_f32 v0, v0
M v[208:211], a[196:199], v[28:31], v[208:211]
v_cvt_pk_bf16_f32 v39, v14, v15
v_add_f32 v90, v90, v15
M v[212:215], a[196:199], v[32:35], v[212:215]
s_waitcnt lgkmcnt(2)
v_exp_f32 v1, v1
M v[216:219], a[200:203], v[16:19], v[216:219]
v_cvt_pk_bf16_f32 v42, v0, v1
v_add_f32 v91, v91, v0
M v[220:223], a[200:203], v[20:23], v[220:223]
L_hop_b0:
s_cbranch_execz L_ret_b0
v_exp_f32 v2, v2
M v[8:11], a[176:179], a[12:15], 0
s_waitcnt vmcnt(16) lgkmcnt(0)
v_add_f32 v91, v91, v1
v_add_f32 v91, v91, v2
M v[8:11], a[180:183], a[32:35], v[8:11]
s_barrier
ds_read_b128 a[160:163], v57 offset:0
M v[8:11], a[184:187], a[52:55], v[8:11]
ds_read_b128 a[164:167], v58 offset:0
v_exp_f32 v3, v3
M v[8:11], a[188:191], a[72:75], v[8:11]
ds_read_b128 a[168:171], v59 offset:0
v_add_f32 v91, v91, v3
M v[224:227], a[200:203], v[24:27], v[224:227]
ds_read_b128 a[172:175], v60 offset:0
v_cvt_pk_bf16_f32 v43, v2, v3
M v[228:231], a[200:203], v[28:31], v[228:231]
ds_read_b64_tr_b16 a[192:193], v61 offset:49152
M v[232:235], a[200:203], v[32:35], v[232:235]
ds_read_b64_tr_b16 a[194:195], v61 offset:53248
buffer_load_dwordx4 v69, s[12:15], s46 offen nt lds
M v[236:239], a[204:207], v[16:19], v[236:239]
v_exp_f32 v4, v4
M v[12:15], a[176:179], a[16:19], 0
s_add_u32 s47, s43, 114688
v_exp_f32 v5, v5
M v[12:15], a[180:183], a[36:39], v[12:15]
s_and_b32 s47, s47, 131071
v_exp_f32 v6, v6
M v[12:15], a[184:187], a[56:59], v[12:15]
s_add_u32 s47, s47, s32
v_exp_f32 v7, v7
M v[12:15], a[188:191], a[76:79], v[12:15]
ds_read_b64_tr_b16 a[196:197], v62 offset:49152
v_cvt_pk_bf16_f32 v46, v4, v5
M v[240:243], a[204:207], v[20:23], v[240:243]
v_exp_f32 v8, v8
M v[244:247], a[204:207], v[24:27], v[244:247]
v_exp_f32 v9, v9
M v[248:251], a[204:207], v[28:31], v[248:251]
v_exp_f32 v10, v10
M v[252:255], a[204:207], v[32:35], v[252:255]
s_waitcnt lgkmcnt(6)
v_exp_f32 v11, v11
M v[0:3], a[160:163], a[0:3], 0
s_waitcnt lgkmcnt(5)
v_cvt_pk_bf16_f32 v47, v6, v7
v_add_f32 v92, v92, v4
M v[0:3], a[164:167], a[20:23], v[0:3]
s_waitcnt lgkmcnt(4)
ds_read_b64_tr_b16 a[198:199], v62 offset:53248
v_add_f32 v92, v92, v5
M v[0:3], a[168:171], a[40:43], v[0:3]
s_waitcnt lgkmcnt(4)
v_cvt_pk_bf16_f32 v50, v8, v9
v_cvt_pk_bf16_f32 v51, v10, v11
M v[0:3], a[172:175], a[60:63], v[0:3]
s_waitcnt lgkmcnt(2)
ds_read_b64_tr_b16 a[200:201], v63 offset:49152
v_add_f32 v92, v92, v6
M v[96:99], a[192:195], v[36:39], v[96:99]
v_add_f32 v92, v92, v7
v_add_f32 v93, v93, v8
v_exp_f32 v12, v12
M v[100:103], a[192:195], v[40:43], v[100:103]
buffer_load_dwordx4 v70, s[12:15], s46 offen offset:1024 nt lds
M v[104:107], a[192:195], v[44:47], v[104:107]
v_exp_f32 v13, v13
M v[108:111], a[192:195], v[48:51], v[108:111]
v_exp_f32 v14, v14
M v[4:7], a[160:163], a[4:7], 0
v_exp_f32 v15, v15
M v[4:7], a[164:167], a[24:27], v[4:7]
v_cvt_pk_bf16_f32 v54, v12, v13
v_cvt_pk_bf16_f32 v55, v14, v15
M v[4:7], a[168:171], a[44:47], v[4:7]
ds_read_b64_tr_b16 a[202:203], v63 offset:53248
v_add_f32 v93, v93, v9
M v[4:7], a[172:175], a[64:67], v[4:7]
v_add_f32 v93, v93, v10
v_add_f32 v94, v94, v12
M v[112:115], a[192:195], v[52:55], v[112:115]
s_waitcnt lgkmcnt(2)
v_add_f32 v93, v93, v11
v_add_f32 v94, v94, v13
M v[116:119], a[196:199], v[36:39], v[116:119]
buffer_load_dwordx4 v69, s[12:15], s46 offen offset:2048 nt lds
M v[120:123], a[196:199], v[40:43], v[120:123]
ds_read_b64_tr_b16 a[204:205], v64 offset:49152
v_add_f32 v94, v94, v14
M v[124:127], a[196:199], v[44:47], v[124:127]
ds_read_b64_tr_b16 a[206:207], v64 offset:53248
v_add_f32 v94, v94, v15
M v[8:11], a[160:163], a[8:11], 0
v_exp_f32 v0, v0
M v[8:11], a[164:167], a[28:31], v[8:11]
buffer_load_dwordx4 v70, s[12:15], s46 offen offset:3072 nt lds
M v[8:11], a[168:171], a[48:51], v[8:11]
s_add_u32 m0, s36, 98304
v_exp_f32 v1, v1
M v[8:11], a[172:175], a[68:71], v[8:11]
ds_read_b128 a[176:179], v57 offset:4096
v_add_f32 v90, v90, v0
M v[128:131], a[196:199], v[48:51], v[128:131]
v_exp_f32 v2, v2
M v[132:135], a[196:199], v[52:55], v[132:135]
s_waitcnt lgkmcnt(3)
v_cvt_pk_bf16_f32 v16, v0, v1
v_add_f32 v90, v90, v1
M v[136:139], a[200:203], v[36:39], v[136:139]
v_exp_f32 v3, v3
M v[140:143], a[200:203], v[40:43], v[140:143]
v_cvt_pk_bf16_f32 v17, v2, v3
v_add_f32 v90, v90, v2
M v[12:15], a[160:163], a[12:15], 0
ds_read_b128 a[180:183], v58 offset:4096
v_add_f32 v90, v90, v3
M v[12:15], a[164:167], a[32:35], v[12:15]
ds_read_b128 a[184:187], v59 offset:4096
M v[12:15], a[168:171], a[52:55], v[12:15]
buffer_load_dwordx4 v69, s[16:19], s47 offen nt lds
M v[12:15], a[172:175], a[72:75], v[12:15]
ds_read_b128 a[188:191], v60 offset:4096
M v[144:147], a[200:203], v[44:47], v[144:147]
ds_read_b64_tr_b16 a[192:193], v65 offset:49152
M v[148:151], a[200:203], v[48:51], v[148:151]
v_exp_f32 v4, v4
M v[152:155], a[200:203], v[52:55], v[152:155]
s_waitcnt lgkmcnt(5)
ds_read_b64_tr_b16 a[194:195], v65 offset:53248
v_add_f32 v91, v91, v4
M v[156:159], a[204:207], v[36:39], v[156:159]
v_exp_f32 v5, v5
M v[0:3], a[160:163], a[16:19], 0
v_exp_f32 v6, v6
M v[0:3], a[164:167], a[36:39], v[0:3]
v_cvt_pk_bf16_f32 v20, v4, v5
v_add_f32 v91, v91, v5
M v[0:3], a[168:171], a[56:59], v[0:3]
v_exp_f32 v7, v7
M v[0:3], a[172:175], a[76:79], v[0:3]
v_cvt_pk_bf16_f32 v21, v6, v7
v_add_f32 v91, v91, v6
M v[160:163], a[204:207], v[40:43], v[160:163]
ds_read_b64_tr_b16 a[196:197], v66 offset:49152
v_add_f32 v91, v91, v7
M v[164:167], a[204:207], v[44:47], v[164:167]
buffer_load_dwordx4 v70, s[16:19], s47 offen offset:1024 nt lds
M v[168:171], a[204:207], v[48:51], v[168:171]
v_exp_f32 v8, v8
M v[172:175], a[204:207], v[52:55], v[172:175]
s_waitcnt lgkmcnt(6)
v_exp_f32 v9, v9
M v[4:7], a[176:179], a[0:3], 0
s_waitcnt lgkmcnt(5)
ds_read_b64_tr_b16 a[198:199], v66 offset:53248
v_add_f32 v92, v92, v8
M v[4:7], a[180:183], a[20:23], v[4:7]
s_waitcnt lgkmcnt(5)
v_exp_f32 v10, v10
M v[4:7], a[184:187], a[40:43], v[4:7]
s_waitcnt lgkmcnt(4)
v_cvt_pk_bf16_f32 v24, v8, v9
v_add_f32 v92, v92, v9
M v[4:7], a[188:191], a[60:63], v[4:7]
s_waitcnt lgkmcnt(2)
v_exp_f32 v11, v11
M v[176:179], a[192:195], v[36:39], v[176:179]
s_add_u32 s48, s43, 122880
v_cvt_pk_bf16_f32 v25, v10, v11
v_add_f32 v92, v92, v10
M v[180:183], a[192:195], v[40:43], v[180:183]
s_and_b32 s48, s48, 131071
ds_read_b64_tr_b16 a[200:201], v67 offset:49152
v_add_f32 v92, v92, v11
M v[184:187], a[192:195], v[44:47], v[184:187]
s_add_u32 s48, s48, s32
buffer_load_dwordx4 v69, s[16:19], s47 offen offset:2048 nt lds
M v[188:191], a[192:195], v[48:51], v[188:191]
s_add_u32 s49, s43, 0
v_exp_f32 v12, v12
v_exp_f32 v13, v13
M v[8:11], a[176:179], a[4:7], 0
s_and_b32 s49, s49, 131071
ds_read_b64_tr_b16 a[202:203], v67 offset:53248
v_add_f32 v93, v93, v12
M v[8:11], a[180:183], a[24:27], v[8:11]
s_add_u32 s49, s49, s100
v_exp_f32 v14, v14
M v[8:11], a[184:187], a[44:47], v[8:11]
v_cvt_pk_bf16_f32 v28, v12, v13
v_add_f32 v93, v93, v13
v_exp_f32 v15, v15
v_add_f32 v93, v93, v14
v_add_f32 v93, v93, v15
v_cvt_pk_bf16_f32 v29, v14, v15
v_exp_f32 v0, v0
M v[8:11], a[188:191], a[64:67], v[8:11]
v_exp_f32 v1, v1
M v[192:195], a[192:195], v[52:55], v[192:195]
s_waitcnt lgkmcnt(2)
buffer_load_dwordx4 v70, s[16:19], s47 offen offset:3072 nt lds
M v[196:199], a[196:199], v[36:39], v[196:199]
s_add_u32 m0, s36, 114688
ds_read_b64_tr_b16 a[204:205], v68 offset:49152
v_add_f32 v94, v94, v0
v_exp_f32 v2, v2
v_add_f32 v94, v94, v1
M v[200:203], a[196:199], v[40:43], v[200:203]
v_exp_f32 v3, v3
v_add_f32 v94, v94, v2
v_add_f32 v94, v94, v3
v_cvt_pk_bf16_f32 v32, v0, v1
v_cvt_pk_bf16_f32 v33, v2, v3
v_exp_f32 v4, v4
v_exp_f32 v5, v5
M v[204:207], a[196:199], v[44:47], v[204:207]
ds_read_b64_tr_b16 a[206:207], v68 offset:53248
v_add_f32 v90, v90, v4
v_exp_f32 v6, v6
v_add_f32 v90, v90, v5
M v[12:15], a[176:179], a[8:11], 0
v_exp_f32 v7, v7
v_add_f32 v90, v90, v6
M v[12:15], a[180:183], a[28:31], v[12:15]
v_cvt_pk_bf16_f32 v18, v4, v5
v_add_f32 v90, v90, v7
M v[12:15], a[184:187], a[48:51], v[12:15]
v_cvt_pk_bf16_f32 v19, v6, v7
v_exp_f32 v8, v8
M v[12:15], a[188:191], a[68:71], v[12:15]
v_exp_f32 v9, v9
v_add_f32 v91, v91, v8
M v[208:211], a[196:199], v[48:51], v[208:211]
v_exp_f32 v10, v10
v_add_f32 v91, v91, v9
M v[212:215], a[196:199], v[52:55], v[212:215]
s_waitcnt lgkmcnt(2)
v_exp_f32 v11, v11
M v[216:219], a[200:203], v[36:39], v[216:219]
v_cvt_pk_bf16_f32 v22, v8, v9
v_add_f32 v91, v91, v10
M v[220:223], a[200:203], v[40:43], v[220:223]
v_cvt_pk_bf16_f32 v23, v10, v11
v_add_f32 v91, v91, v11
M v[0:3], a[176:179], a[12:15], 0
s_waitcnt vmcnt(16) lgkmcnt(0)
v_exp_f32 v12, v12
M v[0:3], a[180:183], a[32:35], v[0:3]
s_barrier
ds_read_b128 a[160:163], v57 offset:16384
v_add_f32 v92, v92, v12
M v[0:3], a[184:187], a[52:55], v[0:3]
ds_read_b128 a[164:167], v58 offset:16384
v_exp_f32 v13, v13
M v[0:3], a[188:191], a[72:75], v[0:3]
ds_read_b128 a[168:171], v59 offset:16384
v_cvt_pk_bf16_f32 v26, v12, v13
M v[224:227], a[200:203], v[44:47], v[224:227]
ds_read_b128 a[172:175], v60 offset:16384
v_add_f32 v92, v92, v13
M v[228:231], a[200:203], v[48:51], v[228:231]
ds_read_b64_tr_b16 a[192:193], v61 offset:0
M v[232:235], a[200:203], v[52:55], v[232:235]
ds_read_b64_tr_b16 a[194:195], v61 offset:4096
buffer_load_dwordx4 v69, s[16:19], s48 offen nt lds
M v[236:239], a[204:207], v[36:39], v[236:239]
v_exp_f32 v14, v14
M v[4:7], a[176:179], a[16:19], 0
v_exp_f32 v15, v15
M v[4:7], a[180:183], a[36:39], v[4:7]
ds_read_b64_tr_b16 a[196:197], v62 offset:0
v_cvt_pk_bf16_f32 v27, v14, v15
M v[4:7], a[184:187], a[56:59], v[4:7]
v_exp_f32 v0, v0
M v[4:7], a[188:191], a[76:79], v[4:7]
v_exp_f32 v1, v1
M v[240:243], a[204:207], v[40:43], v[240:243]
v_exp_f32 v2, v2
M v[244:247], a[204:207], v[44:47], v[244:247]
v_exp_f32 v3, v3
v_cvt_pk_bf16_f32 v30, v0, v1
v_cvt_pk_bf16_f32 v31, v2, v3
v_add_f32 v92, v92, v14
v_add_f32 v92, v92, v15
v_exp_f32 v4, v4
v_exp_f32 v5, v5
M v[248:251], a[204:207], v[48:51], v[248:251]
ds_read_b64_tr_b16 a[198:199], v62 offset:4096
v_cvt_pk_bf16_f32 v34, v4, v5
v_exp_f32 v6, v6
v_exp_f32 v7, v7
v_add_f32 v93, v93, v0
v_cvt_pk_bf16_f32 v35, v6, v7
v_add_f32 v93, v93, v1
v_add_f32 v93, v93, v2
M v[252:255], a[204:207], v[52:55], v[252:255]
s_waitcnt lgkmcnt(7)
ds_read_b64_tr_b16 a[200:201], v63 offset:0
v_add_f32 v93, v93, v3
v_add_f32 v94, v94, v4
v_add_f32 v94, v94, v5
v_add_f32 v94, v94, v6
v_add_f32 v94, v94, v7
M v[8:11], a[160:163], a[0:3], 0
s_waitcnt lgkmcnt(7)
ds_read_b64_tr_b16 a[202:203], v63 offset:4096
ds_read_b64_tr_b16 a[204:205], v64 offset:0
ds_read_b64_tr_b16 a[206:207], v64 offset:4096
M v[8:11], a[164:167], a[20:23], v[8:11]
s_waitcnt lgkmcnt(9)
ds_read_b128 a[176:179], v57 offset:20480
M v[8:11], a[168:171], a[40:43], v[8:11]
s_waitcnt lgkmcnt(9)
ds_read_b128 a[180:183], v58 offset:20480
M v[8:11], a[172:175], a[60:63], v[8:11]
s_waitcnt lgkmcnt(8)
ds_read_b128 a[184:187], v59 offset:20480
M v[96:99], a[192:195], v[16:19], v[96:99]
ds_read_b128 a[188:191], v60 offset:20480
M v[100:103], a[192:195], v[20:23], v[100:103]
M v[104:107], a[192:195], v[24:27], v[104:107]
buffer_load_dwordx4 v70, s[16:19], s48 offen offset:1024 nt lds
M v[108:111], a[192:195], v[28:31], v[108:111]
v_exp_f32 v8, v8
v_exp_f32 v9, v9
v_add_f32 v90, v90, v8
v_exp_f32 v10, v10
v_add_f32 v90, v90, v9
v_exp_f32 v11, v11
v_add_f32 v90, v90, v10
M v[12:15], a[160:163], a[4:7], 0
v_cvt_pk_bf16_f32 v36, v8, v9
v_add_f32 v90, v90, v11
v_cvt_pk_bf16_f32 v37, v10, v11
M v[12:15], a[164:167], a[24:27], v[12:15]
M v[12:15], a[168:171], a[44:47], v[12:15]
M v[12:15], a[172:175], a[64:67], v[12:15]
M v[112:115], a[192:195], v[32:35], v[112:115]
s_waitcnt lgkmcnt(8)
ds_read_b64_tr_b16 a[192:193], v65 offset:0
ds_read_b64_tr_b16 a[194:195], v65 offset:4096
M v[116:119], a[196:199], v[16:19], v[116:119]
M v[120:123], a[196:199], v[20:23], v[120:123]
M v[124:127], a[196:199], v[24:27], v[124:127]
M v[0:3], a[160:163], a[8:11], 0
v_exp_f32 v12, v12
v_exp_f32 v13, v13
v_add_f32 v91, v91, v12
v_exp_f32 v14, v14
v_add_f32 v91, v91, v13
v_exp_f32 v15, v15
v_add_f32 v91, v91, v14
M v[0:3], a[164:167], a[28:31], v[0:3]
v_cvt_pk_bf16_f32 v40, v12, v13
v_add_f32 v91, v91, v15
v_cvt_pk_bf16_f32 v41, v14, v15
M v[0:3], a[168:171], a[48:51], v[0:3]
M v[0:3], a[172:175], a[68:71], v[0:3]
M v[128:131], a[196:199], v[28:31], v[128:131]
M v[132:135], a[196:199], v[32:35], v[132:135]
s_waitcnt lgkmcnt(8)
ds_read_b64_tr_b16 a[196:197], v66 offset:0
ds_read_b64_tr_b16 a[198:199], v66 offset:4096
M v[136:139], a[200:203], v[16:19], v[136:139]
M v[140:143], a[200:203], v[20:23], v[140:143]
M v[4:7], a[160:163], a[12:15], 0
buffer_load_dwordx4 v69, s[16:19], s48 offen offset:2048 nt lds
v_exp_f32 v0, v0
v_exp_f32 v1, v1
v_add_f32 v92, v92, v0
v_exp_f32 v2, v2
v_add_f32 v92, v92, v1
v_exp_f32 v3, v3
M v[4:7], a[164:167], a[32:35], v[4:7]
v_cvt_pk_bf16_f32 v44, v0, v1
v_add_f32 v92, v92, v2
v_add_f32 v92, v92, v3
v_cvt_pk_bf16_f32 v45, v2, v3
M v[4:7], a[168:171], a[52:55], v[4:7]
M v[4:7], a[172:175], a[72:75], v[4:7]
M v[144:147], a[200:203], v[24:27], v[144:147]
M v[148:151], a[200:203], v[28:31], v[148:151]
M v[152:155], a[200:203], v[32:35], v[152:155]
s_waitcnt lgkmcnt(8)
ds_read_b64_tr_b16 a[200:201], v67 offset:0
ds_read_b64_tr_b16 a[202:203], v67 offset:4096
M v[156:159], a[204:207], v[16:19], v[156:159]
M v[8:11], a[160:163], a[16:19], 0
v_exp_f32 v4, v4
v_exp_f32 v5, v5
v_add_f32 v93, v93, v4
v_exp_f32 v6, v6
v_add_f32 v93, v93, v5
v_exp_f32 v7, v7
v_add_f32 v93, v93, v6
M v[8:11], a[164:167], a[36:39], v[8:11]
v_cvt_pk_bf16_f32 v48, v4, v5
v_add_f32 v93, v93, v7
v_cvt_pk_bf16_f32 v49, v6, v7
M v[8:11], a[168:171], a[56:59], v[8:11]
M v[8:11], a[172:175], a[76:79], v[8:11]
M v[160:163], a[204:207], v[20:23], v[160:163]
M v[164:167], a[204:207], v[24:27], v[164:167]
M v[168:171], a[204:207], v[28:31], v[168:171]
M v[172:175], a[204:207], v[32:35], v[172:175]
s_waitcnt lgkmcnt(9)
ds_read_b64_tr_b16 a[204:205], v68 offset:0
ds_read_b64_tr_b16 a[206:207], v68 offset:4096
M v[12:15], a[176:179], a[0:3], 0
s_waitcnt lgkmcnt(10)
v_exp_f32 v8, v8
v_exp_f32 v9, v9
v_add_f32 v94, v94, v8
v_exp_f32 v10, v10
v_add_f32 v94, v94, v9
v_exp_f32 v11, v11
v_add_f32 v94, v94, v10
M v[12:15], a[180:183], a[20:23], v[12:15]
s_waitcnt lgkmcnt(9)
v_cvt_pk_bf16_f32 v52, v8, v9
v_add_f32 v94, v94, v11
v_cvt_pk_bf16_f32 v53, v10, v11
M v[12:15], a[184:187], a[40:43], v[12:15]
s_waitcnt lgkmcnt(8)
buffer_load_dwordx4 v70, s[16:19], s48 offen offset:3072 nt lds
s_add_u32 m0, s36, 0
M v[12:15], a[188:191], a[60:63], v[12:15]
s_waitcnt lgkmcnt(6)
buffer_load_dwordx4 v69, s[12:15], s49 offen nt lds
buffer_load_dwordx4 v70, s[12:15], s49 offen offset:1024 nt lds
buffer_load_dwordx4 v69, s[12:15], s49 offen offset:2048 nt lds
buffer_load_dwordx4 v70, s[12:15], s49 offen offset:3072 nt lds
M v[176:179], a[192:195], v[16:19], v[176:179]
M v[180:183], a[192:195], v[20:23], v[180:183]
M v[184:187], a[192:195], v[24:27], v[184:187]
v_exp_f32 v12, v12
M v[188:191], a[192:195], v[28:31], v[188:191]
v_exp_f32 v13, v13
M v[0:3], a[176:179], a[4:7], 0
v_cvt_pk_bf16_f32 v38, v12, v13
v_add_f32 v90, v90, v12
M v[0:3], a[180:183], a[24:27], v[0:3]
v_exp_f32 v14, v14
M v[0:3], a[184:187], a[44:47], v[0:3]
v_add_f32 v90, v90, v13
v_add_f32 v90, v90, v14
M v[0:3], a[188:191], a[64:67], v[0:3]
v_exp_f32 v15, v15
M v[192:195], a[192:195], v[32:35], v[192:195]
s_waitcnt lgkmcnt(4)
v_cvt_pk_bf16_f32 v39, v14, v15
v_add_f32 v90, v90, v15
M v[196:199], a[196:199], v[16:19], v[196:199]
M v[200:203], a[196:199], v[20:23], v[200:203]
M v[204:207], a[196:199], v[24:27], v[204:207]
v_exp_f32 v0, v0
M v[4:7], a[176:179], a[8:11], 0
v_exp_f32 v1, v1
M v[4:7], a[180:183], a[28:31], v[4:7]
v_cvt_pk_bf16_f32 v42, v0, v1
v_add_f32 v91, v91, v0
M v[4:7], a[184:187], a[48:51], v[4:7]
v_exp_f32 v2, v2
M v[4:7], a[188:191], a[68:71], v[4:7]
v_add_f32 v91, v91, v1
v_add_f32 v91, v91, v2
M v[208:211], a[196:199], v[28:31], v[208:211]
v_exp_f32 v3, v3
M v[212:215], a[196:199], v[32:35], v[212:215]
s_waitcnt lgkmcnt(2)
v_cvt_pk_bf16_f32 v43, v2, v3
v_add_f32 v91, v91, v3
M v[216:219], a[200:203], v[16:19], v[216:219]
v_exp_f32 v4, v4
M v[220:223], a[200:203], v[20:23], v[220:223]
v_exp_f32 v5, v5
M v[8:11], a[176:179], a[12:15], 0
s_waitcnt vmcnt(16) lgkmcnt(0)
v_exp_f32 v6, v6
M v[8:11], a[180:183], a[32:35], v[8:11]
s_barrier
ds_read_b128 a[160:163], v57 offset:32768
v_cvt_pk_bf16_f32 v46, v4, v5
M v[8:11], a[184:187], a[52:55], v[8:11]
s_add_u32 s50, s43, 8192
ds_read_b128 a[164:167], v58 offset:32768
v_add_f32 v92, v92, v4
M v[8:11], a[188:191], a[72:75], v[8:11]
s_and_b32 s50, s50, 131071
ds_read_b128 a[168:171], v59 offset:32768
v_add_f32 v92, v92, v5
M v[224:227], a[200:203], v[24:27], v[224:227]
s_add_u32 m0, s36, 16384
ds_read_b128 a[172:175], v60 offset:32768
v_add_f32 v92, v92, v6
M v[228:231], a[200:203], v[28:31], v[228:231]
s_add_u32 s50, s50, s100
ds_read_b64_tr_b16 a[192:193], v61 offset:16384
M v[232:235], a[200:203], v[32:35], v[232:235]
ds_read_b64_tr_b16 a[194:195], v61 offset:20480
M v[236:239], a[204:207], v[16:19], v[236:239]
v_exp_f32 v7, v7
M v[12:15], a[176:179], a[16:19], 0
buffer_load_dwordx4 v69, s[12:15], s50 offen nt lds
M v[12:15], a[180:183], a[36:39], v[12:15]
ds_read_b64_tr_b16 a[196:197], v62 offset:16384
v_cvt_pk_bf16_f32 v47, v6, v7
M v[12:15], a[184:187], a[56:59], v[12:15]
v_exp_f32 v8, v8
M v[12:15], a[188:191], a[76:79], v[12:15]
v_exp_f32 v9, v9
M v[240:243], a[204:207], v[20:23], v[240:243]
s_add_u32 s51, s43, 0
v_exp_f32 v10, v10
M v[244:247], a[204:207], v[24:27], v[244:247]
s_and_b32 s51, s51, 131071
v_exp_f32 v11, v11
M v[248:251], a[204:207], v[28:31], v[248:251]
s_add_u32 s51, s51, s100
ds_read_b64_tr_b16 a[198:199], v62 offset:20480
v_cvt_pk_bf16_f32 v50, v8, v9
M v[252:255], a[204:207], v[32:35], v[252:255]
s_waitcnt lgkmcnt(7)
v_add_f32 v92, v92, v7
v_cvt_pk_bf16_f32 v51, v10, v11
M v[0:3], a[160:163], a[0:3], 0
s_waitcnt lgkmcnt(6)
v_exp_f32 v12, v12
M v[0:3], a[164:167], a[20:23], v[0:3]
s_waitcnt lgkmcnt(5)
v_exp_f32 v13, v13
M v[0:3], a[168:171], a[40:43], v[0:3]
s_waitcnt lgkmcnt(4)
v_exp_f32 v14, v14
M v[0:3], a[172:175], a[60:63], v[0:3]
s_waitcnt lgkmcnt(2)
v_exp_f32 v15, v15
M v[96:99], a[192:195], v[36:39], v[96:99]
v_cvt_pk_bf16_f32 v54, v12, v13
v_cvt_pk_bf16_f32 v55, v14, v15
M v[100:103], a[192:195], v[40:43], v[100:103]
buffer_load_dwordx4 v70, s[12:15], s50 offen offset:1024 nt lds
M v[104:107], a[192:195], v[44:47], v[104:107]
ds_read_b64_tr_b16 a[200:201], v63 offset:16384
v_add_f32 v93, v93, v8
M v[108:111], a[192:195], v[48:51], v[108:111]
ds_read_b64_tr_b16 a[202:203], v63 offset:20480
v_add_f32 v93, v93, v9
M v[4:7], a[160:163], a[4:7], 0
v_add_f32 v93, v93, v10
v_add_f32 v94, v94, v12
M v[4:7], a[164:167], a[24:27], v[4:7]
v_add_f32 v93, v93, v11
v_add_f32 v94, v94, v13
M v[4:7], a[168:171], a[44:47], v[4:7]
buffer_load_dwordx4 v69, s[12:15], s50 offen offset:2048 nt lds
M v[4:7], a[172:175], a[64:67], v[4:7]
ds_read_b64_tr_b16 a[204:205], v64 offset:16384
v_add_f32 v94, v94, v14
M v[112:115], a[192:195], v[52:55], v[112:115]
s_waitcnt lgkmcnt(3)
ds_read_b64_tr_b16 a[206:207], v64 offset:20480
v_add_f32 v94, v94, v15
M v[116:119], a[196:199], v[36:39], v[116:119]
v_exp_f32 v0, v0
M v[120:123], a[196:199], v[40:43], v[120:123]
v_exp_f32 v1, v1
M v[124:127], a[196:199], v[44:47], v[124:127]
ds_read_b128 a[176:179], v57 offset:36864
v_add_f32 v90, v90, v0
M v[8:11], a[160:163], a[8:11], 0
v_exp_f32 v2, v2
M v[8:11], a[164:167], a[28:31], v[8:11]
v_cvt_pk_bf16_f32 v16, v0, v1
v_add_f32 v90, v90, v1
M v[8:11], a[168:171], a[48:51], v[8:11]
v_exp_f32 v3, v3
M v[8:11], a[172:175], a[68:71], v[8:11]
buffer_load_dwordx4 v70, s[12:15], s50 offen offset:3072 nt lds
M v[128:131], a[196:199], v[48:51], v[128:131]
s_add_u32 m0, s36, 65536
v_cvt_pk_bf16_f32 v17, v2, v3
v_add_f32 v90, v90, v2
M v[132:135], a[196:199], v[52:55], v[132:135]
s_waitcnt lgkmcnt(3)
ds_read_b128 a[180:183], v58 offset:36864
v_add_f32 v90, v90, v3
M v[136:139], a[200:203], v[36:39], v[136:139]
ds_read_b128 a[184:187], v59 offset:36864
M v[140:143], a[200:203], v[40:43], v[140:143]
ds_read_b128 a[188:191], v60 offset:36864
M v[12:15], a[160:163], a[12:15], 0
ds_read_b64_tr_b16 a[192:193], v65 offset:16384
M v[12:15], a[164:167], a[32:35], v[12:15]
v_exp_f32 v4, v4
M v[12:15], a[168:171], a[52:55], v[12:15]
ds_read_b64_tr_b16 a[194:195], v65 offset:20480
v_add_f32 v91, v91, v4
M v[12:15], a[172:175], a[72:75], v[12:15]
v_exp_f32 v5, v5
M v[144:147], a[200:203], v[44:47], v[144:147]
v_exp_f32 v6, v6
M v[148:151], a[200:203], v[48:51], v[148:151]
v_cvt_pk_bf16_f32 v20, v4, v5
v_add_f32 v91, v91, v5
M v[152:155], a[200:203], v[52:55], v[152:155]
s_waitcnt lgkmcnt(6)
v_exp_f32 v7, v7
M v[156:159], a[204:207], v[36:39], v[156:159]
buffer_load_dwordx4 v69, s[16:19], s51 offen nt lds
M v[0:3], a[160:163], a[16:19], 0
v_cvt_pk_bf16_f32 v21, v6, v7
v_add_f32 v91, v91, v6
M v[0:3], a[164:167], a[36:39], v[0:3]
ds_read_b64_tr_b16 a[196:197], v66 offset:16384
v_add_f32 v91, v91, v7
M v[0:3], a[168:171], a[56:59], v[0:3]
v_exp_f32 v8, v8
M v[0:3], a[172:175], a[76:79], v[0:3]
v_exp_f32 v9, v9
M v[160:163], a[204:207], v[40:43], v[160:163]
ds_read_b64_tr_b16 a[198:199], v66 offset:20480
v_add_f32 v92, v92, v8
M v[164:167], a[204:207], v[44:47], v[164:167]
v_exp_f32 v10, v10
M v[168:171], a[204:207], v[48:51], v[168:171]
v_cvt_pk_bf16_f32 v24, v8, v9
v_add_f32 v92, v92, v9
M v[172:175], a[204:207], v[52:55], v[172:175]
s_waitcnt lgkmcnt(7)
v_exp_f32 v11, v11
M v[4:7], a[176:179], a[0:3], 0
s_waitcnt lgkmcnt(6)
v_cvt_pk_bf16_f32 v25, v10, v11
v_add_f32 v92, v92, v10
M v[4:7], a[180:183], a[20:23], v[4:7]
s_waitcnt lgkmcnt(5)
buffer_load_dwordx4 v70, s[16:19], s51 offen offset:1024 nt lds
M v[4:7], a[184:187], a[40:43], v[4:7]
s_waitcnt lgkmcnt(4)
ds_read_b64_tr_b16 a[200:201], v67 offset:16384
v_add_f32 v92, v92, v11
M v[4:7], a[188:191], a[60:63], v[4:7]
s_waitcnt lgkmcnt(3)
v_exp_f32 v12, v12
M v[176:179], a[192:195], v[36:39], v[176:179]
s_add_u32 s44, s64, 512
v_exp_f32 v13, v13
M v[180:183], a[192:195], v[40:43], v[180:183]
L_hop_b1:
s_cbranch_execz L_ret_b1
ds_read_b64_tr_b16 a[202:203], v67 offset:20480
v_add_f32 v93, v93, v12
M v[184:187], a[192:195], v[44:47], v[184:187]
v_exp_f32 v14, v14
M v[188:191], a[192:195], v[48:51], v[188:191]
v_cvt_pk_bf16_f32 v28, v12, v13
v_add_f32 v93, v93, v13
M v[8:11], a[176:179], a[4:7], 0
v_exp_f32 v15, v15
M v[8:11], a[180:183], a[24:27], v[8:11]
s_add_u32 s45, s64, 66048
v_cvt_pk_bf16_f32 v29, v14, v15
v_add_f32 v93, v93, v14
M v[8:11], a[184:187], a[44:47], v[8:11]
ds_read_b64_tr_b16 a[204:205], v68 offset:16384
v_add_f32 v93, v93, v15
M v[8:11], a[188:191], a[64:67], v[8:11]
buffer_load_dwordx4 v69, s[16:19], s51 offen offset:2048 nt lds
M v[192:195], a[192:195], v[52:55], v[192:195]
s_waitcnt lgkmcnt(3)
v_exp_f32 v0, v0
M v[196:199], a[196:199], v[36:39], v[196:199]
v_exp_f32 v1, v1
M v[200:203], a[196:199], v[40:43], v[200:203]
ds_read_b64_tr_b16 a[206:207], v68 offset:20480
v_add_f32 v94, v94, v0
v_exp_f32 v2, v2
v_add_f32 v94, v94, v1
v_exp_f32 v3, v3
v_add_f32 v94, v94, v2
M v[204:207], a[196:199], v[44:47], v[204:207]
v_cvt_pk_bf16_f32 v32, v0, v1
v_add_f32 v94, v94, v3
v_cvt_pk_bf16_f32 v33, v2, v3
v_exp_f32 v4, v4
M v[12:15], a[176:179], a[8:11], 0
buffer_load_dwordx4 v70, s[16:19], s51 offen offset:3072 nt lds
v_exp_f32 v5, v5
M v[12:15], a[180:183], a[28:31], v[12:15]
s_add_u32 m0, s36, 131072
v_cvt_pk_bf16_f32 v18, v4, v5
v_add_f32 v90, v90, v4
M v[12:15], a[184:187], a[48:51], v[12:15]
s_add_u32 s46, s64, 131584
v_exp_f32 v6, v6
M v[12:15], a[188:191], a[68:71], v[12:15]
v_add_f32 v90, v90, v5
v_add_f32 v90, v90, v6
v_exp_f32 v7, v7
M v[208:211], a[196:199], v[48:51], v[208:211]
v_cvt_pk_bf16_f32 v19, v6, v7
v_add_f32 v90, v90, v7
M v[212:215], a[196:199], v[52:55], v[212:215]
s_waitcnt lgkmcnt(2)
v_exp_f32 v8, v8
M v[216:219], a[200:203], v[36:39], v[216:219]
v_exp_f32 v9, v9
M v[220:223], a[200:203], v[40:43], v[220:223]
v_cvt_pk_bf16_f32 v22, v8, v9
v_add_f32 v91, v91, v8
M v[0:3], a[176:179], a[12:15], 0
s_waitcnt vmcnt(16) lgkmcnt(0)
v_exp_f32 v10, v10
M v[0:3], a[180:183], a[32:35], v[0:3]
s_barrier
ds_read_b128 a[160:163], v57 offset:49152
v_add_f32 v91, v91, v9
M v[0:3], a[184:187], a[52:55], v[0:3]
ds_read_b128 a[164:167], v58 offset:49152
v_add_f32 v91, v91, v10
M v[0:3], a[188:191], a[72:75], v[0:3]
s_add_u32 s47, s64, 197120
ds_read_b128 a[168:171], v59 offset:49152
v_exp_f32 v11, v11
M v[224:227], a[200:203], v[44:47], v[224:227]
ds_read_b128 a[172:175], v60 offset:49152
v_add_f32 v91, v91, v11
M v[228:231], a[200:203], v[48:51], v[228:231]
ds_read_b64_tr_b16 a[192:193], v61 offset:32768
v_cvt_pk_bf16_f32 v23, v10, v11
M v[232:235], a[200:203], v[52:55], v[232:235]
ds_read_b64_tr_b16 a[194:195], v61 offset:36864
M v[236:239], a[204:207], v[36:39], v[236:239]
v_exp_f32 v12, v12
M v[4:7], a[176:179], a[16:19], 0
buffer_load_dwordx4 v73, s[8:11], s44 offen lds
M v[4:7], a[180:183], a[36:39], v[4:7]
s_add_u32 m0, s36, 132096
v_exp_f32 v13, v13
M v[4:7], a[184:187], a[56:59], v[4:7]
v_exp_f32 v14, v14
M v[4:7], a[188:191], a[76:79], v[4:7]
v_exp_f32 v15, v15
M v[240:243], a[204:207], v[40:43], v[240:243]
s_add_u32 s48, s65, 512
ds_read_b64_tr_b16 a[196:197], v62 offset:32768
v_cvt_pk_bf16_f32 v26, v12, v13
M v[244:247], a[204:207], v[44:47], v[244:247]
v_exp_f32 v0, v0
M v[248:251], a[204:207], v[48:51], v[248:251]
v_exp_f32 v1, v1
M v[252:255], a[204:207], v[52:55], v[252:255]
s_waitcnt lgkmcnt(6)
v_exp_f32 v2, v2
M v[8:11], a[160:163], a[0:3], 0
s_waitcnt lgkmcnt(5)
v_exp_f32 v3, v3
M v[8:11], a[164:167], a[20:23], v[8:11]
s_waitcnt lgkmcnt(4)
v_cvt_pk_bf16_f32 v27, v14, v15
v_add_f32 v92, v92, v12
M v[8:11], a[168:171], a[40:43], v[8:11]
s_waitcnt lgkmcnt(3)
ds_read_b64_tr_b16 a[198:199], v62 offset:36864
v_add_f32 v92, v92, v13
M v[8:11], a[172:175], a[60:63], v[8:11]
s_waitcnt lgkmcnt(2)
v_cvt_pk_bf16_f32 v30, v0, v1
v_cvt_pk_bf16_f32 v31, v2, v3
M v[96:99], a[192:195], v[16:19], v[96:99]
ds_read_b64_tr_b16 a[200:201], v63 offset:32768
v_add_f32 v92, v92, v14
v_add_f32 v92, v92, v15
M v[100:103], a[192:195], v[20:23], v[100:103]
s_add_u32 s49, s65, 66048
v_exp_f32 v4, v4
M v[104:107], a[192:195], v[24:27], v[104:107]
v_exp_f32 v5, v5
M v[108:111], a[192:195], v[28:31], v[108:111]
v_exp_f32 v6, v6
M v[12:15], a[160:163], a[4:7], 0
v_exp_f32 v7, v7
M v[12:15], a[164:167], a[24:27], v[12:15]
v_cvt_pk_bf16_f32 v34, v4, v5
v_cvt_pk_bf16_f32 v35, v6, v7
M v[12:15], a[168:171], a[44:47], v[12:15]
buffer_load_dwordx4 v73, s[8:11], s45 offen lds
M v[12:15], a[172:175], a[64:67], v[12:15]
s_add_u32 m0, s36, 133120
ds_read_b64_tr_b16 a[202:203], v63 offset:36864
v_add_f32 v93, v93, v0
M v[112:115], a[192:195], v[32:35], v[112:115]
s_waitcnt lgkmcnt(2)
v_add_f32 v93, v93, v1
v_add_f32 v94, v94, v4
M v[116:119], a[196:199], v[16:19], v[116:119]
v_add_f32 v93, v93, v2
v_add_f32 v94, v94, v5
M v[120:123], a[196:199], v[20:23], v[120:123]
s_add_u32 s50, s65, 131584
ds_read_b64_tr_b16 a[204:205], v64 offset:32768
v_add_f32 v93, v93, v3
M v[124:127], a[196:199], v[24:27], v[124:127]
buffer_load_dwordx4 v73, s[8:11], s46 offen lds
M v[0:3], a[160:163], a[8:11], 0
s_add_u32 m0, s36, 134144
ds_read_b64_tr_b16 a[206:207], v64 offset:36864
v_add_f32 v94, v94, v6
M v[0:3], a[164:167], a[28:31], v[0:3]
ds_read_b128 a[176:179], v57 offset:53248
v_add_f32 v94, v94, v7
M v[0:3], a[168:171], a[48:51], v[0:3]
v_exp_f32 v8, v8
M v[0:3], a[172:175], a[68:71], v[0:3]
v_exp_f32 v9, v9
M v[128:131], a[196:199], v[28:31], v[128:131]
buffer_load_dwordx4 v73, s[8:11], s47 offen lds
M v[132:135], a[196:199], v[32:35], v[132:135]
s_waitcnt lgkmcnt(3)
v_cvt_pk_bf16_f32 v36, v8, v9
v_add_f32 v90, v90, v8
M v[136:139], a[200:203], v[16:19], v[136:139]
s_add_u32 m0, s36, 147456
v_exp_f32 v10, v10
M v[140:143], a[200:203], v[20:23], v[140:143]
s_add_u32 s51, s65, 197120
ds_read_b128 a[180:183], v58 offset:53248
v_add_f32 v90, v90, v9
M v[4:7], a[160:163], a[12:15], 0
v_exp_f32 v11, v11
M v[4:7], a[164:167], a[32:35], v[4:7]
v_cvt_pk_bf16_f32 v37, v10, v11
v_add_f32 v90, v90, v10
M v[4:7], a[168:171], a[52:55], v[4:7]
ds_read_b128 a[184:187], v59 offset:53248
v_add_f32 v90, v90, v11
M v[4:7], a[172:175], a[72:75], v[4:7]
ds_read_b128 a[188:191], v60 offset:53248
M v[144:147], a[200:203], v[24:27], v[144:147]
ds_read_b64_tr_b16 a[192:193], v65 offset:32768
M v[148:151], a[200:203], v[28:31], v[148:151]
v_exp_f32 v12, v12
M v[152:155], a[200:203], v[32:35], v[152:155]
s_waitcnt lgkmcnt(5)
ds_read_b64_tr_b16 a[194:195], v65 offset:36864
v_add_f32 v91, v91, v12
M v[156:159], a[204:207], v[16:19], v[156:159]
s_add_u32 s44, s72, 0
v_exp_f32 v13, v13
M v[8:11], a[160:163], a[16:19], 0
v_exp_f32 v14, v14
M v[8:11], a[164:167], a[36:39], v[8:11]
v_cvt_pk_bf16_f32 v40, v12, v13
v_add_f32 v91, v91, v13
M v[8:11], a[168:171], a[56:59], v[8:11]
s_add_u32 s45, s72, 8192
v_exp_f32 v15, v15
M v[8:11], a[172:175], a[76:79], v[8:11]
buffer_load_dwordx4 v73, s[8:11], s48 offen lds
M v[160:163], a[204:207], v[20:23], v[160:163]
s_add_u32 m0, s36, 148480
v_cvt_pk_bf16_f32 v41, v14, v15
v_add_f32 v91, v91, v14
M v[164:167], a[204:207], v[24:27], v[164:167]
ds_read_b64_tr_b16 a[196:197], v66 offset:32768
v_add_f32 v91, v91, v15
M v[168:171], a[204:207], v[28:31], v[168:171]
s_add_u32 s46, s72, 16384
v_exp_f32 v0, v0
M v[172:175], a[204:207], v[32:35], v[172:175]
s_waitcnt lgkmcnt(6)
v_exp_f32 v1, v1
M v[12:15], a[176:179], a[0:3], 0
s_waitcnt lgkmcnt(5)
ds_read_b64_tr_b16 a[198:199], v66 offset:36864
v_add_f32 v92, v92, v0
M v[12:15], a[180:183], a[20:23], v[12:15]
s_waitcnt lgkmcnt(5)
v_exp_f32 v2, v2
v_add_f32 v92, v92, v1
v_exp_f32 v3, v3
M v[12:15], a[184:187], a[40:43], v[12:15]
s_waitcnt lgkmcnt(4)
v_cvt_pk_bf16_f32 v44, v0, v1
v_add_f32 v92, v92, v2
M v[12:15], a[188:191], a[60:63], v[12:15]
s_waitcnt lgkmcnt(2)
buffer_load_dwordx4 v73, s[8:11], s49 offen lds
M v[176:179], a[192:195], v[16:19], v[176:179]
s_add_u32 m0, s36, 149504
v_cvt_pk_bf16_f32 v45, v2, v3
v_add_f32 v92, v92, v3
M v[180:183], a[192:195], v[20:23], v[180:183]
s_add_u32 s47, s72, 24576
v_exp_f32 v4, v4
M v[184:187], a[192:195], v[24:27], v[184:187]
s_add_u32 s48, s72, 32768
v_exp_f32 v5, v5
M v[188:191], a[192:195], v[28:31], v[188:191]
ds_read_b64_tr_b16 a[200:201], v67 offset:32768
v_add_f32 v93, v93, v4
v_exp_f32 v6, v6
v_add_f32 v93, v93, v5
M v[0:3], a[176:179], a[4:7], 0
v_exp_f32 v7, v7
M v[0:3], a[180:183], a[24:27], v[0:3]
ds_read_b64_tr_b16 a[202:203], v67 offset:36864
v_add_f32 v93, v93, v6
v_add_f32 v93, v93, v7
v_cvt_pk_bf16_f32 v48, v4, v5
v_cvt_pk_bf16_f32 v49, v6, v7
v_exp_f32 v8, v8
v_exp_f32 v9, v9
v_add_f32 v94, v94, v8
M v[0:3], a[184:187], a[44:47], v[0:3]
s_add_u32 s49, s73, 0
buffer_load_dwordx4 v73, s[8:11], s50 offen lds
v_exp_f32 v10, v10
v_add_f32 v94, v94, v9
v_exp_f32 v11, v11
v_add_f32 v94, v94, v10
v_add_f32 v94, v94, v11
s_add_u32 m0, s36, 150528
M v[0:3], a[188:191], a[64:67], v[0:3]
ds_read_b64_tr_b16 a[204:205], v68 offset:32768
v_cvt_pk_bf16_f32 v52, v8, v9
v_cvt_pk_bf16_f32 v53, v10, v11
v_exp_f32 v12, v12
v_exp_f32 v13, v13
v_add_f32 v90, v90, v12
v_exp_f32 v14, v14
v_add_f32 v90, v90, v13
M v[192:195], a[192:195], v[32:35], v[192:195]
s_waitcnt lgkmcnt(3)
ds_read_b64_tr_b16 a[206:207], v68 offset:36864
v_add_f32 v90, v90, v14
v_exp_f32 v15, v15
v_cvt_pk_bf16_f32 v38, v12, v13
M v[196:199], a[196:199], v[16:19], v[196:199]
v_cvt_pk_bf16_f32 v39, v14, v15
v_add_f32 v90, v90, v15
M v[200:203], a[196:199], v[20:23], v[200:203]
s_add_u32 s50, s73, 8192
v_exp_f32 v0, v0
M v[204:207], a[196:199], v[24:27], v[204:207]
buffer_load_dwordx4 v73, s[8:11], s51 offen lds
M v[4:7], a[176:179], a[8:11], 0
s_add_u32 m0, s37, 0
v_exp_f32 v1, v1
M v[4:7], a[180:183], a[28:31], v[4:7]
v_cvt_pk_bf16_f32 v42, v0, v1
v_add_f32 v91, v91, v0
M v[4:7], a[184:187], a[48:51], v[4:7]
s_add_u32 s51, s73, 16384
v_exp_f32 v2, v2
M v[4:7], a[188:191], a[68:71], v[4:7]
v_add_f32 v91, v91, v1
v_mov_b32 v0, v90
v_exp_f32 v3, v3
M v[208:211], a[196:199], v[28:31], v[208:211]
v_cvt_pk_bf16_f32 v43, v2, v3
v_add_f32 v91, v91, v2
M v[212:215], a[196:199], v[32:35], v[212:215]
s_waitcnt lgkmcnt(2)
v_add_f32 v91, v91, v3
v_mov_b32 v1, v91
M v[216:219], a[200:203], v[16:19], v[216:219]
v_exp_f32 v4, v4
M v[220:223], a[200:203], v[20:23], v[220:223]
v_exp_f32 v5, v5
M v[8:11], a[176:179], a[12:15], 0
s_waitcnt vmcnt(20) lgkmcnt(0)
v_exp_f32 v6, v6
M v[8:11], a[180:183], a[32:35], v[8:11]
s_barrier
ds_read_b64_tr_b16 a[192:193], v61 offset:49152
v_cvt_pk_bf16_f32 v46, v4, v5
v_exp_f32 v7, v7
M v[8:11], a[184:187], a[52:55], v[8:11]
ds_read_b64_tr_b16 a[194:195], v61 offset:53248
v_cvt_pk_bf16_f32 v47, v6, v7
v_add_f32 v92, v92, v4
v_add_f32 v92, v92, v5
v_add_f32 v92, v92, v6
v_add_f32 v92, v92, v7
M v[8:11], a[188:191], a[72:75], v[8:11]
buffer_load_dwordx4 v71, s[4:7], s44 offen lds
M v[224:227], a[200:203], v[24:27], v[224:227]
s_add_u32 m0, s37, 1024
ds_read_b64_tr_b16 a[196:197], v62 offset:49152
v_mov_b32 v2, v92
M v[228:231], a[200:203], v[28:31], v[228:231]
s_add_u32 s44, s73, 24576
ds_read_b64_tr_b16 a[198:199], v62 offset:53248
v_exp_f32 v8, v8
M v[232:235], a[200:203], v[32:35], v[232:235]
v_exp_f32 v9, v9
M v[236:239], a[204:207], v[16:19], v[236:239]
buffer_load_dwordx4 v72, s[4:7], s45 offen lds
M v[12:15], a[176:179], a[16:19], 0
s_add_u32 m0, s37, 2048
v_exp_f32 v10, v10
M v[12:15], a[180:183], a[36:39], v[12:15]
s_add_u32 s45, s73, 32768
v_exp_f32 v11, v11
M v[12:15], a[184:187], a[56:59], v[12:15]
ds_read_b64_tr_b16 a[200:201], v63 offset:49152
v_cvt_pk_bf16_f32 v50, v8, v9
M v[12:15], a[188:191], a[76:79], v[12:15]
buffer_load_dwordx4 v71, s[4:7], s46 offen lds
M v[240:243], a[204:207], v[20:23], v[240:243]
s_add_u32 m0, s37, 3072
ds_read_b64_tr_b16 a[202:203], v63 offset:53248
v_cvt_pk_bf16_f32 v51, v10, v11
M v[244:247], a[204:207], v[24:27], v[244:247]
v_add_f32 v93, v93, v8
v_add_f32 v93, v93, v9
v_exp_f32 v12, v12
M v[248:251], a[204:207], v[28:31], v[248:251]
v_exp_f32 v13, v13
M v[252:255], a[204:207], v[32:35], v[252:255]
s_waitcnt lgkmcnt(4)
v_exp_f32 v14, v14
M v[96:99], a[192:195], v[36:39], v[96:99]
v_exp_f32 v15, v15
M v[100:103], a[192:195], v[40:43], v[100:103]
v_cvt_pk_bf16_f32 v54, v12, v13
v_cvt_pk_bf16_f32 v55, v14, v15
M v[104:107], a[192:195], v[44:47], v[104:107]
buffer_load_dwordx4 v72, s[4:7], s47 offen lds
M v[108:111], a[192:195], v[48:51], v[108:111]
s_add_u32 m0, s37, 4096
ds_read_b64_tr_b16 a[204:205], v64 offset:49152
v_add_f32 v94, v94, v12
M v[112:115], a[192:195], v[52:55], v[112:115]
s_waitcnt lgkmcnt(3)
ds_read_b64_tr_b16 a[206:207], v64 offset:53248
v_add_f32 v94, v94, v13
M v[116:119], a[196:199], v[36:39], v[116:119]
ds_read_b64_tr_b16 a[192:193], v65 offset:49152
v_add_f32 v93, v93, v10
M v[120:123], a[196:199], v[40:43], v[120:123]
buffer_load_dwordx4 v71, s[4:7], s48 offen lds
M v[124:127], a[196:199], v[44:47], v[124:127]
s_add_u32 m0, s38, 0
ds_read_b64_tr_b16 a[194:195], v65 offset:53248
v_add_f32 v94, v94, v14
v_add_f32 v93, v93, v11
v_add_f32 v94, v94, v15
v_max3_f32 v8, v90, v91, v92
v_max3_f32 v8, v8, v93, v94
v_min3_f32 v9, v90, v91, v92
v_min3_f32 v9, v9, v93, v94
M v[128:131], a[196:199], v[48:51], v[128:131]
buffer_load_dwordx4 v71, s[4:7], s49 offen lds
s_add_u32 m0, s38, 1024
v_mul_f32 v8, s42, v8
M v[132:135], a[196:199], v[52:55], v[132:135]
s_waitcnt lgkmcnt(4)
ds_read_b64_tr_b16 a[196:197], v66 offset:49152
v_cmp_nle_f32 s[56:57], v8, 1.0
v_cmp_nge_f32 s[58:59], v9, s42
v_mov_b32 v11, s55
v_mov_b32 v3, v93
s_or_b64 s[56:57], s[56:57], s[58:59]
ds_read_b64_tr_b16 a[198:199], v66 offset:53248
s_or_b32 s56, s56, s57
M v[136:139], a[200:203], v[36:39], v[136:139]
v_mov_b32 v10, s56
v_mov_b32 v4, v94
v_permlane32_swap_b32 v0, v90
v_permlane32_swap_b32 v1, v91
M v[140:143], a[200:203], v[40:43], v[140:143]
buffer_load_dwordx4 v72, s[4:7], s50 offen lds
M v[144:147], a[200:203], v[44:47], v[144:147]
s_add_u32 m0, s38, 2048
ds_write_b32 v11, v10
v_add_f32 v90, v0, v90
M v[148:151], a[200:203], v[48:51], v[148:151]
v_add_f32 v91, v1, v91
v_mov_b32 v11, 0
M v[152:155], a[200:203], v[52:55], v[152:155]
s_waitcnt lgkmcnt(5)
ds_read_b64_tr_b16 a[200:201], v67 offset:49152
v_mov_b32 v0, v90
M v[156:159], a[204:207], v[36:39], v[156:159]
buffer_load_dwordx4 v71, s[4:7], s51 offen lds
M v[160:163], a[204:207], v[40:43], v[160:163]
s_add_u32 m0, s38, 3072
ds_read_b64_tr_b16 a[202:203], v67 offset:53248
v_mov_b32 v1, v91
M v[164:167], a[204:207], v[44:47], v[164:167]
v_permlane32_swap_b32 v2, v92
M v[168:171], a[204:207], v[48:51], v[168:171]
v_permlane32_swap_b32 v3, v93
M v[172:175], a[204:207], v[52:55], v[172:175]
s_waitcnt lgkmcnt(5)
ds_read_b64_tr_b16 a[204:205], v68 offset:49152
v_add_f32 v92, v2, v92
M v[176:179], a[192:195], v[36:39], v[176:179]
ds_read_b64_tr_b16 a[206:207], v68 offset:53248
v_add_f32 v93, v3, v93
M v[180:183], a[192:195], v[40:43], v[180:183]
buffer_load_dwordx4 v72, s[4:7], s44 offen lds
M v[184:187], a[192:195], v[44:47], v[184:187]
s_add_u32 m0, s38, 4096
v_permlane32_swap_b32 v4, v94
M v[188:191], a[192:195], v[48:51], v[188:191]
v_mov_b32 v2, v92
v_add_f32 v94, v4, v94
M v[192:195], a[192:195], v[52:55], v[192:195]
s_waitcnt lgkmcnt(5)
buffer_load_dwordx4 v71, s[4:7], s45 offen lds
M v[196:199], a[196:199], v[36:39], v[196:199]
v_mov_b32 v3, v93
v_mov_b32 v4, v94
M v[200:203], a[196:199], v[40:43], v[200:203]
v_permlane16_swap_b32 v0, v90
M v[204:207], a[196:199], v[44:47], v[204:207]
v_permlane16_swap_b32 v1, v91
M v[208:211], a[196:199], v[48:51], v[208:211]
s_waitcnt lgkmcnt(0)
v_permlane16_swap_b32 v2, v92
M v[212:215], a[196:199], v[52:55], v[212:215]
s_barrier
ds_read_b128 v[12:15], v11 offset:63488
v_add_f32 v90, v0, v90
M v[216:219], a[200:203], v[36:39], v[216:219]
v_permlane16_swap_b32 v3, v93
M v[220:223], a[200:203], v[40:43], v[220:223]
v_permlane16_swap_b32 v4, v94
M v[224:227], a[200:203], v[44:47], v[224:227]
v_add_f32 v91, v1, v91
v_add_f32 v92, v2, v92
M v[228:231], a[200:203], v[48:51], v[228:231]
v_add_f32 v93, v3, v93
v_add_f32 v94, v4, v94
M v[232:235], a[200:203], v[52:55], v[232:235]
v_rcp_f32 v90, v90
M v[236:239], a[204:207], v[36:39], v[236:239]
v_rcp_f32 v91, v91
M v[240:243], a[204:207], v[40:43], v[240:243]
v_rcp_f32 v92, v92
M v[244:247], a[204:207], v[44:47], v[244:247]
v_rcp_f32 v93, v93
M v[248:251], a[204:207], v[48:51], v[248:251]
v_rcp_f32 v94, v94
M v[252:255], a[204:207], v[52:55], v[252:255]
s_waitcnt lgkmcnt(0)
v_or3_b32 v12, v12, v13, v14
v_or_b32 v12, v12, v15
s_nop 0
v_readfirstlane_b32 s60, v12
s_nop 1
s_cmp_lg_u32 s60, 0
s_cbranch_scc1 L_slow0
L_back0:
s_waitcnt vmcnt(0)
s_barrier
ds_read_b128 a[40:43], v80 offset:0
v_mul_f32 v96, v90, v96
ds_read_b64_tr_b16 a[160:161], v74 offset:32768
v_mul_f32 v97, v90, v97
ds_read_b64_tr_b16 a[162:163], v74 offset:33280
v_mul_f32 v98, v90, v98
ds_read_b128 a[44:47], v81 offset:0
v_mul_f32 v99, v90, v99
ds_read_b64_tr_b16 a[164:165], v74 offset:36864
v_cvt_pk_bf16_f32 v96, v96, v97
ds_read_b64_tr_b16 a[166:167], v74 offset:37376
v_mul_f32 v116, v90, v116
ds_read_b128 a[48:51], v80 offset:2048
v_mul_f32 v117, v90, v117
ds_read_b128 a[52:55], v81 offset:2048
v_mul_f32 v118, v90, v118
ds_read_b128 a[56:59], v80 offset:4096
v_mul_f32 v119, v90, v119
ds_read_b128 a[60:63], v81 offset:4096
v_cvt_pk_bf16_f32 v97, v98, v99
ds_read_b128 a[64:67], v80 offset:6144
v_cvt_pk_bf16_f32 v98, v116, v117
ds_read_b128 a[68:71], v81 offset:6144
v_cvt_pk_bf16_f32 v99, v118, v119
ds_read_b128 a[72:75], v80 offset:8192
v_mul_f32 v100, v91, v100
ds_read_b128 a[76:79], v81 offset:8192
v_mul_f32 v101, v91, v101
ds_read_b64_tr_b16 a[168:169], v74 offset:32776
v_accvgpr_write_b32 a80, v96
ds_read_b64_tr_b16 a[170:171], v74 offset:33288
v_accvgpr_write_b32 a81, v97
v_accvgpr_write_b32 a82, v98
v_accvgpr_write_b32 a83, v99
s_waitcnt lgkmcnt(13)
M v[96:99], a[160:163], a[40:43], 0
s_waitcnt lgkmcnt(10)
v_mul_f32 v102, v91, v102
v_mul_f32 v103, v91, v103
v_cvt_pk_bf16_f32 v100, v100, v101
v_mul_f32 v120, v91, v120
v_mul_f32 v121, v91, v121
v_mul_f32 v122, v91, v122
v_mul_f32 v123, v91, v123
v_cvt_pk_bf16_f32 v101, v102, v103
M v[96:99], a[164:167], a[44:47], v[96:99]
s_waitcnt lgkmcnt(9)
s_add_u32 m0, s36, 98304
ds_read_b64_tr_b16 a[172:173], v74 offset:36872
s_add_u32 s46, s64, 640
v_cvt_pk_bf16_f32 v102, v120, v121
v_cvt_pk_bf16_f32 v103, v122, v123
v_mul_f32 v104, v92, v104
v_mul_f32 v105, v92, v105
v_accvgpr_write_b32 a84, v100
ds_read_b64_tr_b16 a[174:175], v74 offset:37384
buffer_load_dwordx4 v73, s[8:11], s46 offen lds
ds_read_b64_tr_b16 a[176:177], v75 offset:32768
v_accvgpr_write_b32 a85, v101
v_accvgpr_write_b32 a86, v102
v_accvgpr_write_b32 a87, v103
M v[100:103], a[160:163], a[48:51], 0
s_waitcnt lgkmcnt(11)
v_mul_f32 v106, v92, v106
v_mul_f32 v107, v92, v107
v_cvt_pk_bf16_f32 v104, v104, v105
v_mul_f32 v124, v92, v124
v_mul_f32 v125, v92, v125
v_mul_f32 v126, v92, v126
v_mul_f32 v127, v92, v127
v_cvt_pk_bf16_f32 v105, v106, v107
M v[100:103], a[164:167], a[52:55], v[100:103]
s_waitcnt lgkmcnt(10)
v_cvt_pk_bf16_f32 v106, v124, v125
v_cvt_pk_bf16_f32 v107, v126, v127
v_mul_f32 v108, v93, v108
v_mul_f32 v109, v93, v109
v_accvgpr_write_b32 a88, v104
v_accvgpr_write_b32 a89, v105
v_accvgpr_write_b32 a90, v106
v_accvgpr_write_b32 a91, v107
M v[104:107], a[160:163], a[56:59], 0
s_waitcnt lgkmcnt(9)
s_add_u32 m0, s36, 99328
ds_read_b64_tr_b16 a[178:179], v75 offset:33280
s_add_u32 s47, s64, 66176
v_mul_f32 v110, v93, v110
v_mul_f32 v111, v93, v111
v_cvt_pk_bf16_f32 v108, v108, v109
v_mul_f32 v128, v93, v128
v_mul_f32 v129, v93, v129
M v[104:107], a[164:167], a[60:63], v[104:107]
s_waitcnt lgkmcnt(9)
v_mul_f32 v130, v93, v130
v_mul_f32 v131, v93, v131
v_cvt_pk_bf16_f32 v109, v110, v111
v_cvt_pk_bf16_f32 v110, v128, v129
v_cvt_pk_bf16_f32 v111, v130, v131
v_mul_f32 v112, v94, v112
v_mul_f32 v113, v94, v113
v_accvgpr_write_b32 a92, v108
ds_read_b64_tr_b16 a[180:181], v75 offset:36864
buffer_load_dwordx4 v73, s[8:11], s47 offen lds
ds_read_b64_tr_b16 a[182:183], v75 offset:37376
v_accvgpr_write_b32 a93, v109
v_accvgpr_write_b32 a94, v110
v_accvgpr_write_b32 a95, v111
M v[108:111], a[160:163], a[64:67], 0
s_waitcnt lgkmcnt(10)
v_mul_f32 v114, v94, v114
v_mul_f32 v115, v94, v115
v_cvt_pk_bf16_f32 v112, v112, v113
v_mul_f32 v132, v94, v132
v_mul_f32 v133, v94, v133
v_mul_f32 v134, v94, v134
v_mul_f32 v135, v94, v135
v_cvt_pk_bf16_f32 v113, v114, v115
M v[108:111], a[164:167], a[68:71], v[108:111]
s_waitcnt lgkmcnt(9)
s_add_u32 s48, s64, 131712
s_add_u32 m0, s36, 100352
ds_read_b128 v[16:19], v82 offset:0
v_cvt_pk_bf16_f32 v114, v132, v133
v_cvt_pk_bf16_f32 v115, v134, v135
v_accvgpr_write_b32 a96, v112
v_accvgpr_write_b32 a97, v113
v_accvgpr_write_b32 a98, v114
v_accvgpr_write_b32 a99, v115
M v[112:115], a[160:163], a[72:75], 0
s_waitcnt lgkmcnt(9)
s_add_u32 s49, s64, 197248
ds_read_b128 v[20:23], v83 offset:0
buffer_load_dwordx4 v73, s[8:11], s48 offen lds
L_hop_b2:
s_cbranch_execz L_ret_b2
ds_read_b128 v[24:27], v82 offset:2048
s_add_u32 m0, s36, 101376
v_mul_f32 v136, v90, v136
v_mul_f32 v137, v90, v137
v_mul_f32 v138, v90, v138
M v[112:115], a[164:167], a[76:79], v[112:115]
s_waitcnt lgkmcnt(9)
ds_read_b128 v[28:31], v83 offset:2048
v_mul_f32 v139, v90, v139
v_cvt_pk_bf16_f32 v136, v136, v137
v_mul_f32 v156, v90, v156
v_mul_f32 v157, v90, v157
v_mul_f32 v158, v90, v158
v_mul_f32 v159, v90, v159
v_cvt_pk_bf16_f32 v137, v138, v139
M v[116:119], a[168:171], a[40:43], 0
s_waitcnt lgkmcnt(8)
buffer_load_dwordx4 v73, s[8:11], s49 offen lds
ds_read_b128 v[32:35], v82 offset:4096
v_cvt_pk_bf16_f32 v138, v156, v157
v_cvt_pk_bf16_f32 v139, v158, v159
v_mul_f32 v140, v91, v140
v_mul_f32 v141, v91, v141
v_accvgpr_write_b32 a100, v136
M v[116:119], a[172:175], a[44:47], v[116:119]
s_add_u32 m0, s36, 114688
ds_read_b128 v[36:39], v83 offset:4096
v_accvgpr_write_b32 a101, v137
v_accvgpr_write_b32 a102, v138
v_accvgpr_write_b32 a103, v139
s_add_u32 s50, s65, 640
ds_read_b128 v[40:43], v82 offset:6144
v_mul_f32 v142, v91, v142
v_mul_f32 v143, v91, v143
M v[120:123], a[168:171], a[48:51], 0
s_add_u32 s51, s65, 66176
ds_read_b128 v[44:47], v83 offset:6144
v_cvt_pk_bf16_f32 v140, v140, v141
v_mul_f32 v160, v91, v160
v_mul_f32 v161, v91, v161
v_mul_f32 v162, v91, v162
v_mul_f32 v163, v91, v163
v_cvt_pk_bf16_f32 v141, v142, v143
v_cvt_pk_bf16_f32 v142, v160, v161
M v[120:123], a[172:175], a[52:55], v[120:123]
s_add_u32 s44, s65, 131712
ds_read_b128 v[48:51], v82 offset:8192
v_cvt_pk_bf16_f32 v143, v162, v163
v_mul_f32 v144, v92, v144
v_mul_f32 v145, v92, v145
v_accvgpr_write_b32 a104, v140
v_accvgpr_write_b32 a105, v141
v_accvgpr_write_b32 a106, v142
v_accvgpr_write_b32 a107, v143
M v[124:127], a[168:171], a[56:59], 0
s_add_u32 s45, s65, 197248
ds_read_b128 v[52:55], v83 offset:8192
v_mul_f32 v146, v92, v146
v_mul_f32 v147, v92, v147
v_cvt_pk_bf16_f32 v144, v144, v145
v_mul_f32 v164, v92, v164
v_mul_f32 v165, v92, v165
v_mul_f32 v166, v92, v166
v_mul_f32 v167, v92, v167
M v[124:127], a[172:175], a[60:63], v[124:127]
s_add_u32 s46, s66, 512
ds_read_b64_tr_b16 a[184:185], v75 offset:32776
v_cvt_pk_bf16_f32 v145, v146, v147
v_cvt_pk_bf16_f32 v146, v164, v165
v_cvt_pk_bf16_f32 v147, v166, v167
v_mul_f32 v148, v93, v148
v_mul_f32 v149, v93, v149
v_accvgpr_write_b32 a108, v144
v_accvgpr_write_b32 a109, v145
M v[128:131], a[168:171], a[64:67], 0
s_add_u32 s47, s66, 66048
ds_read_b64_tr_b16 a[186:187], v75 offset:33288
v_accvgpr_write_b32 a110, v146
v_accvgpr_write_b32 a111, v147
v_mul_f32 v150, v93, v150
v_mul_f32 v151, v93, v151
v_cvt_pk_bf16_f32 v148, v148, v149
v_mul_f32 v168, v93, v168
v_mul_f32 v169, v93, v169
M v[128:131], a[172:175], a[68:71], v[128:131]
s_add_u32 s48, s66, 131584
ds_read_b64_tr_b16 a[188:189], v75 offset:36872
v_mul_f32 v170, v93, v170
v_mul_f32 v171, v93, v171
v_cvt_pk_bf16_f32 v149, v150, v151
v_cvt_pk_bf16_f32 v150, v168, v169
v_cvt_pk_bf16_f32 v151, v170, v171
v_mul_f32 v152, v94, v152
v_mul_f32 v153, v94, v153
M v[132:135], a[168:171], a[72:75], 0
s_add_u32 s49, s66, 197120
ds_read_b64_tr_b16 a[190:191], v75 offset:37384
v_accvgpr_write_b32 a112, v148
v_accvgpr_write_b32 a113, v149
v_accvgpr_write_b32 a114, v150
v_accvgpr_write_b32 a115, v151
v_mul_f32 v154, v94, v154
v_mul_f32 v155, v94, v155
v_cvt_pk_bf16_f32 v152, v152, v153
M v[132:135], a[172:175], a[76:79], v[132:135]
s_waitcnt lgkmcnt(15)
buffer_load_dwordx4 v73, s[8:11], s50 offen lds
M v[136:139], a[176:179], a[40:43], 0
s_waitcnt lgkmcnt(14)
s_add_u32 m0, s36, 115712
v_mul_f32 v172, v94, v172
v_mul_f32 v173, v94, v173
M v[136:139], a[180:183], a[44:47], v[136:139]
s_add_u32 s50, s74, 0
v_mul_f32 v174, v94, v174
v_mul_f32 v175, v94, v175
M v[140:143], a[176:179], a[48:51], 0
buffer_load_dwordx4 v73, s[8:11], s51 offen lds
M v[140:143], a[180:183], a[52:55], v[140:143]
s_add_u32 m0, s36, 116736
v_accvgpr_write_b32 a116, v152
v_cvt_pk_bf16_f32 v153, v154, v155
M v[144:147], a[176:179], a[56:59], 0
s_waitcnt lgkmcnt(0)
v_cvt_pk_bf16_f32 v154, v172, v173
v_cvt_pk_bf16_f32 v155, v174, v175
M v[144:147], a[180:183], a[60:63], v[144:147]
s_barrier
v_accvgpr_write_b32 a117, v153
v_accvgpr_write_b32 a118, v154
M v[148:151], a[176:179], a[64:67], 0
s_add_u32 s51, s74, 8192
buffer_load_dwordx4 v73, s[8:11], s44 offen lds
M v[148:151], a[180:183], a[68:71], v[148:151]
s_add_u32 m0, s36, 117760
ds_read_b64_tr_b16 a[160:161], v74 offset:49152
v_accvgpr_write_b32 a119, v155
s_add_u32 s44, s74, 16384
buffer_load_dwordx4 v73, s[8:11], s45 offen lds
M v[152:155], a[176:179], a[72:75], 0
s_add_u32 m0, s36, 131072
ds_read_b64_tr_b16 a[162:163], v74 offset:49664
v_mul_f32 v176, v90, v176
M v[152:155], a[180:183], a[76:79], v[152:155]
s_add_u32 s45, s74, 24576
buffer_load_dwordx4 v73, s[8:11], s46 offen lds
M v[156:159], a[184:187], a[40:43], 0
s_add_u32 m0, s36, 132096
ds_read_b64_tr_b16 a[164:165], v74 offset:53248
v_mul_f32 v177, v90, v177
M v[156:159], a[188:191], a[44:47], v[156:159]
s_add_u32 s46, s74, 32768
ds_read_b64_tr_b16 a[166:167], v74 offset:53760
v_mul_f32 v178, v90, v178
M v[160:163], a[184:187], a[48:51], 0
ds_read_b64_tr_b16 a[168:169], v74 offset:49160
v_mul_f32 v179, v90, v179
M v[160:163], a[188:191], a[52:55], v[160:163]
buffer_load_dwordx4 v73, s[8:11], s47 offen lds
M v[164:167], a[184:187], a[56:59], 0
s_add_u32 m0, s36, 133120
ds_read_b64_tr_b16 a[170:171], v74 offset:49672
v_cvt_pk_bf16_f32 v176, v176, v177
M v[164:167], a[188:191], a[60:63], v[164:167]
s_add_u32 s47, s66, 640
ds_read_b64_tr_b16 a[172:173], v74 offset:53256
v_mul_f32 v196, v90, v196
M v[168:171], a[184:187], a[64:67], 0
ds_read_b64_tr_b16 a[174:175], v74 offset:53768
v_mul_f32 v197, v90, v197
M v[168:171], a[188:191], a[68:71], v[168:171]
buffer_load_dwordx4 v73, s[8:11], s48 offen lds
M v[172:175], a[184:187], a[72:75], 0
s_add_u32 m0, s36, 134144
ds_read_b64_tr_b16 a[176:177], v75 offset:49152
v_mul_f32 v198, v90, v198
M v[172:175], a[188:191], a[76:79], v[172:175]
s_waitcnt lgkmcnt(7)
ds_read_b64_tr_b16 a[178:179], v75 offset:49664
v_mul_f32 v199, v90, v199
M v[96:99], a[160:163], v[16:19], v[96:99]
s_waitcnt lgkmcnt(6)
ds_read_b64_tr_b16 a[180:181], v75 offset:53248
v_cvt_pk_bf16_f32 v177, v178, v179
M v[96:99], a[164:167], v[20:23], v[96:99]
s_add_u32 s48, s66, 66176
buffer_load_dwordx4 v73, s[8:11], s49 offen lds
M v[100:103], a[160:163], v[24:27], v[100:103]
s_add_u32 m0, s37, 0
ds_read_b64_tr_b16 a[182:183], v75 offset:53760
v_cvt_pk_bf16_f32 v178, v196, v197
M v[100:103], a[164:167], v[28:31], v[100:103]
s_add_u32 s49, s66, 131712
ds_read_b64_tr_b16 a[184:185], v75 offset:49160
v_cvt_pk_bf16_f32 v179, v198, v199
M v[104:107], a[160:163], v[32:35], v[104:107]
ds_read_b64_tr_b16 a[186:187], v75 offset:49672
v_mul_f32 v180, v91, v180
M v[104:107], a[164:167], v[36:39], v[104:107]
ds_read_b64_tr_b16 a[188:189], v75 offset:53256
v_mul_f32 v181, v91, v181
M v[108:111], a[160:163], v[40:43], v[108:111]
buffer_load_dwordx4 v71, s[4:7], s50 offen lds
M v[108:111], a[164:167], v[44:47], v[108:111]
s_add_u32 m0, s37, 1024
ds_read_b64_tr_b16 a[190:191], v75 offset:53768
v_accvgpr_write_b32 a120, v176
M v[112:115], a[160:163], v[48:51], v[112:115]
s_add_u32 s50, s66, 197248
v_accvgpr_write_b32 a121, v177
v_accvgpr_write_b32 a122, v178
M v[112:115], a[164:167], v[52:55], v[112:115]
s_waitcnt lgkmcnt(10)
v_accvgpr_write_b32 a123, v179
v_mul_f32 v182, v91, v182
M v[116:119], a[168:171], v[16:19], v[116:119]
s_waitcnt lgkmcnt(8)
buffer_load_dwordx4 v72, s[4:7], s51 offen lds
M v[116:119], a[172:175], v[20:23], v[116:119]
s_add_u32 m0, s37, 2048
v_mul_f32 v183, v91, v183
v_cvt_pk_bf16_f32 v180, v180, v181
M v[120:123], a[168:171], v[24:27], v[120:123]
s_add_u32 s51, s75, 0
v_mul_f32 v200, v91, v200
v_mul_f32 v201, v91, v201
M v[120:123], a[172:175], v[28:31], v[120:123]
v_mul_f32 v202, v91, v202
v_mul_f32 v203, v91, v203
M v[124:127], a[168:171], v[32:35], v[124:127]
buffer_load_dwordx4 v71, s[4:7], s44 offen lds
M v[124:127], a[172:175], v[36:39], v[124:127]
s_add_u32 m0, s37, 3072
v_cvt_pk_bf16_f32 v181, v182, v183
v_mul_f32 v184, v92, v184
M v[128:131], a[168:171], v[40:43], v[128:131]
v_cvt_pk_bf16_f32 v182, v200, v201
v_cvt_pk_bf16_f32 v183, v202, v203
v_mul_f32 v185, v92, v185
v_accvgpr_write_b32 a124, v180
v_accvgpr_write_b32 a125, v181
v_accvgpr_write_b32 a126, v182
v_accvgpr_write_b32 a127, v183
v_mul_f32 v186, v92, v186
M v[128:131], a[172:175], v[44:47], v[128:131]
v_mul_f32 v187, v92, v187
v_cvt_pk_bf16_f32 v184, v184, v185
v_mul_f32 v204, v92, v204
v_mul_f32 v205, v92, v205
v_mul_f32 v206, v92, v206
v_mul_f32 v207, v92, v207
v_cvt_pk_bf16_f32 v185, v186, v187
M v[132:135], a[168:171], v[48:51], v[132:135]
buffer_load_dwordx4 v72, s[4:7], s45 offen lds
M v[132:135], a[172:175], v[52:55], v[132:135]
s_waitcnt lgkmcnt(6)
s_add_u32 m0, s37, 4096
v_cvt_pk_bf16_f32 v186, v204, v205
v_cvt_pk_bf16_f32 v187, v206, v207
M v[136:139], a[176:179], v[16:19], v[136:139]
s_waitcnt lgkmcnt(4)
v_mul_f32 v188, v93, v188
v_mul_f32 v189, v93, v189
M v[136:139], a[180:183], v[20:23], v[136:139]
v_accvgpr_write_b32 a128, v184
v_accvgpr_write_b32 a129, v185
M v[140:143], a[176:179], v[24:27], v[140:143]
buffer_load_dwordx4 v71, s[4:7], s46 offen lds
M v[140:143], a[180:183], v[28:31], v[140:143]
s_add_u32 m0, s36, 147456
v_accvgpr_write_b32 a130, v186
v_accvgpr_write_b32 a131, v187
M v[144:147], a[176:179], v[32:35], v[144:147]
s_waitcnt vmcnt(13) lgkmcnt(0)
v_mul_f32 v190, v93, v190
v_mul_f32 v191, v93, v191
M v[144:147], a[180:183], v[36:39], v[144:147]
s_barrier
ds_read_b64_tr_b16 a[160:161], v74 offset:0
v_cvt_pk_bf16_f32 v188, v188, v189
M v[148:151], a[176:179], v[40:43], v[148:151]
s_add_u32 s44, s75, 8192
buffer_load_dwordx4 v73, s[8:11], s47 offen lds
M v[148:151], a[180:183], v[44:47], v[148:151]
s_add_u32 m0, s36, 148480
ds_read_b64_tr_b16 a[162:163], v74 offset:512
v_mul_f32 v208, v93, v208
M v[152:155], a[176:179], v[48:51], v[152:155]
s_add_u32 s45, s75, 16384
ds_read_b64_tr_b16 a[164:165], v74 offset:4096
v_mul_f32 v209, v93, v209
M v[152:155], a[180:183], v[52:55], v[152:155]
s_add_u32 s46, s75, 24576
ds_read_b64_tr_b16 a[166:167], v74 offset:4608
v_mul_f32 v210, v93, v210
v_mul_f32 v211, v93, v211
v_cvt_pk_bf16_f32 v189, v190, v191
v_cvt_pk_bf16_f32 v190, v208, v209
v_cvt_pk_bf16_f32 v191, v210, v211
v_mul_f32 v192, v94, v192
v_mul_f32 v193, v94, v193
M v[156:159], a[184:187], v[16:19], v[156:159]
s_add_u32 s47, s75, 32768
buffer_load_dwordx4 v73, s[8:11], s48 offen lds
s_add_u32 m0, s36, 149504
ds_read_b64_tr_b16 a[168:169], v74 offset:8
v_accvgpr_write_b32 a132, v188
v_accvgpr_write_b32 a133, v189
v_accvgpr_write_b32 a134, v190
v_accvgpr_write_b32 a135, v191
M v[156:159], a[188:191], v[20:23], v[156:159]
s_add_u32 s48, s67, 512
ds_read_b64_tr_b16 a[170:171], v74 offset:520
v_mul_f32 v194, v94, v194
v_mul_f32 v195, v94, v195
v_cvt_pk_bf16_f32 v192, v192, v193
v_mul_f32 v212, v94, v212
v_mul_f32 v213, v94, v213
v_mul_f32 v214, v94, v214
v_mul_f32 v215, v94, v215
M v[160:163], a[184:187], v[24:27], v[160:163]
ds_read_b64_tr_b16 a[172:173], v74 offset:4104
v_cvt_pk_bf16_f32 v193, v194, v195
v_cvt_pk_bf16_f32 v194, v212, v213
v_cvt_pk_bf16_f32 v195, v214, v215
v_accvgpr_write_b32 a136, v192
v_accvgpr_write_b32 a137, v193
v_accvgpr_write_b32 a138, v194
v_accvgpr_write_b32 a139, v195
M v[160:163], a[188:191], v[28:31], v[160:163]
ds_read_b64_tr_b16 a[174:175], v74 offset:4616
v_mul_f32 v216, v90, v216
v_mul_f32 v217, v90, v217
v_mul_f32 v218, v90, v218
v_mul_f32 v219, v90, v219
v_cvt_pk_bf16_f32 v216, v216, v217
v_mul_f32 v236, v90, v236
v_mul_f32 v237, v90, v237
M v[164:167], a[184:187], v[32:35], v[164:167]
buffer_load_dwordx4 v73, s[8:11], s49 offen lds
s_add_u32 m0, s36, 150528
ds_read_b64_tr_b16 a[176:177], v75 offset:0
v_mul_f32 v238, v90, v238
v_mul_f32 v239, v90, v239
v_cvt_pk_bf16_f32 v217, v218, v219
v_cvt_pk_bf16_f32 v218, v236, v237
M v[164:167], a[188:191], v[36:39], v[164:167]
s_add_u32 s49, s67, 66048
ds_read_b64_tr_b16 a[178:179], v75 offset:512
v_cvt_pk_bf16_f32 v219, v238, v239
v_mul_f32 v220, v91, v220
v_mul_f32 v221, v91, v221
v_accvgpr_write_b32 a140, v216
v_accvgpr_write_b32 a141, v217
v_accvgpr_write_b32 a142, v218
v_accvgpr_write_b32 a143, v219
M v[168:171], a[184:187], v[40:43], v[168:171]
ds_read_b64_tr_b16 a[180:181], v75 offset:4096
v_mul_f32 v222, v91, v222
v_mul_f32 v223, v91, v223
v_cvt_pk_bf16_f32 v220, v220, v221
v_mul_f32 v240, v91, v240
v_mul_f32 v241, v91, v241
v_mul_f32 v242, v91, v242
v_mul_f32 v243, v91, v243
M v[168:171], a[188:191], v[44:47], v[168:171]
ds_read_b64_tr_b16 a[182:183], v75 offset:4608
v_cvt_pk_bf16_f32 v221, v222, v223
v_cvt_pk_bf16_f32 v222, v240, v241
v_cvt_pk_bf16_f32 v223, v242, v243
v_mul_f32 v224, v92, v224
v_mul_f32 v225, v92, v225
v_accvgpr_write_b32 a144, v220
v_accvgpr_write_b32 a145, v221
M v[172:175], a[184:187], v[48:51], v[172:175]
buffer_load_dwordx4 v73, s[8:11], s50 offen lds
s_add_u32 m0, s38, 0
ds_read_b64_tr_b16 a[184:185], v75 offset:8
v_accvgpr_write_b32 a146, v222
v_accvgpr_write_b32 a147, v223
v_mul_f32 v226, v92, v226
M v[172:175], a[188:191], v[52:55], v[172:175]
s_waitcnt lgkmcnt(11)
ds_read_b64_tr_b16 a[186:187], v75 offset:520
v_mul_f32 v227, v92, v227
M v[176:179], a[160:163], a[40:43], 0
s_waitcnt lgkmcnt(10)
ds_read_b64_tr_b16 a[188:189], v75 offset:4104
v_cvt_pk_bf16_f32 v224, v224, v225
M v[176:179], a[164:167], a[44:47], v[176:179]
s_add_u32 s50, s67, 131584
ds_read_b64_tr_b16 a[190:191], v75 offset:4616
v_mul_f32 v244, v92, v244
M v[180:183], a[160:163], a[48:51], 0
buffer_load_dwordx4 v71, s[4:7], s51 offen lds
M v[180:183], a[164:167], a[52:55], v[180:183]
s_add_u32 m0, s38, 1024
v_mul_f32 v245, v92, v245
v_mul_f32 v246, v92, v246
M v[184:187], a[160:163], a[56:59], 0
s_add_u32 s51, s67, 197120
v_mul_f32 v247, v92, v247
v_cvt_pk_bf16_f32 v225, v226, v227
M v[184:187], a[164:167], a[60:63], v[184:187]
s_add_u32 s63, s43, 32768
v_cvt_pk_bf16_f32 v226, v244, v245
v_cvt_pk_bf16_f32 v227, v246, v247
M v[188:191], a[160:163], a[64:67], 0
s_and_b32 s63, s63, 131071
v_mul_f32 v228, v93, v228
v_mul_f32 v229, v93, v229
M v[188:191], a[164:167], a[68:71], v[188:191]
s_add_u32 s63, s63, s100
buffer_load_dwordx4 v72, s[4:7], s44 offen lds
M v[192:195], a[160:163], a[72:75], 0
s_add_u32 m0, s38, 2048
v_accvgpr_write_b32 a148, v224
v_accvgpr_write_b32 a149, v225
M v[192:195], a[164:167], a[76:79], v[192:195]
s_waitcnt lgkmcnt(10)
v_accvgpr_write_b32 a150, v226
v_accvgpr_write_b32 a151, v227
M v[196:199], a[168:171], a[40:43], 0
s_waitcnt lgkmcnt(8)
v_mul_f32 v230, v93, v230
v_mul_f32 v231, v93, v231
M v[196:199], a[172:175], a[44:47], v[196:199]
buffer_load_dwordx4 v71, s[4:7], s45 offen lds
M v[200:203], a[168:171], a[48:51], 0
s_add_u32 m0, s38, 3072
v_mul_f32 v248, v93, v248
v_cvt_pk_bf16_f32 v228, v228, v229
M v[200:203], a[172:175], a[52:55], v[200:203]
v_mul_f32 v249, v93, v249
v_mul_f32 v250, v93, v250
M v[204:207], a[168:171], a[56:59], 0
v_mul_f32 v251, v93, v251
v_cvt_pk_bf16_f32 v229, v230, v231
M v[204:207], a[172:175], a[60:63], v[204:207]
buffer_load_dwordx4 v72, s[4:7], s46 offen lds
M v[208:211], a[168:171], a[64:67], 0
s_add_u32 m0, s38, 4096
v_cvt_pk_bf16_f32 v230, v248, v249
v_cvt_pk_bf16_f32 v231, v250, v251
M v[208:211], a[172:175], a[68:71], v[208:211]
v_mul_f32 v232, v94, v232
v_mul_f32 v233, v94, v233
M v[212:215], a[168:171], a[72:75], 0
v_accvgpr_write_b32 a152, v228
v_accvgpr_write_b32 a153, v229
M v[212:215], a[172:175], a[76:79], v[212:215]
s_waitcnt lgkmcnt(6)
buffer_load_dwordx4 v71, s[4:7], s47 offen lds
M v[216:219], a[176:179], a[40:43], 0
s_waitcnt lgkmcnt(4)
v_accvgpr_write_b32 a154, v230
v_accvgpr_write_b32 a155, v231
M v[216:219], a[180:183], a[44:47], v[216:219]
s_add_u32 m0, s36, 98304
v_mul_f32 v234, v94, v234
v_mul_f32 v235, v94, v235
M v[220:223], a[176:179], a[48:51], 0
v_mul_f32 v252, v94, v252
v_cvt_pk_bf16_f32 v232, v232, v233
M v[220:223], a[180:183], a[52:55], v[220:223]
s_waitcnt vmcnt(9) lgkmcnt(0)
v_mul_f32 v253, v94, v253
v_mul_f32 v254, v94, v254
M v[224:227], a[176:179], a[56:59], 0
s_barrier
v_mul_f32 v255, v94, v255
v_cvt_pk_bf16_f32 v233, v234, v235
M v[224:227], a[180:183], a[60:63], v[224:227]
v_cvt_pk_bf16_f32 v234, v252, v253
v_cvt_pk_bf16_f32 v235, v254, v255
M v[228:231], a[176:179], a[64:67], 0
v_accvgpr_write_b32 a156, v232
v_accvgpr_write_b32 a157, v233
M v[228:231], a[180:183], a[68:71], v[228:231]
v_accvgpr_write_b32 a158, v234
v_accvgpr_write_b32 a159, v235
M v[232:235], a[176:179], a[72:75], 0
s_add_u32 s44, s67, 640
ds_read_b64_tr_b16 a[160:161], v74 offset:16384
M v[232:235], a[180:183], a[76:79], v[232:235]
buffer_load_dwordx4 v73, s[8:11], s48 offen lds
M v[236:239], a[184:187], a[40:43], 0
s_add_u32 m0, s36, 99328
ds_read_b64_tr_b16 a[162:163], v74 offset:16896
M v[236:239], a[188:191], a[44:47], v[236:239]
ds_read_b64_tr_b16 a[164:165], v74 offset:20480
M v[240:243], a[184:187], a[48:51], 0
s_add_u32 s45, s67, 66176
ds_read_b64_tr_b16 a[166:167], v74 offset:20992
M v[240:243], a[188:191], a[52:55], v[240:243]
buffer_load_dwordx4 v73, s[8:11], s49 offen lds
M v[244:247], a[184:187], a[56:59], 0
s_add_u32 m0, s36, 100352
ds_read_b64_tr_b16 a[168:169], v74 offset:16392
M v[244:247], a[188:191], a[60:63], v[244:247]
ds_read_b64_tr_b16 a[170:171], v74 offset:16904
M v[248:251], a[184:187], a[64:67], 0
ds_read_b64_tr_b16 a[172:173], v74 offset:20488
M v[248:251], a[188:191], a[68:71], v[248:251]
s_add_u32 s46, s67, 131712
buffer_load_dwordx4 v73, s[8:11], s50 offen lds
M v[252:255], a[184:187], a[72:75], 0
s_add_u32 m0, s36, 101376
ds_read_b64_tr_b16 a[174:175], v74 offset:21000
M v[252:255], a[188:191], a[76:79], v[252:255]
s_waitcnt lgkmcnt(6)
ds_read_b64_tr_b16 a[176:177], v75 offset:16384
M v[176:179], a[160:163], v[16:19], v[176:179]
s_waitcnt lgkmcnt(5)
ds_read_b64_tr_b16 a[178:179], v75 offset:16896
M v[176:179], a[164:167], v[20:23], v[176:179]
s_add_u32 s47, s67, 197248
ds_read_b64_tr_b16 a[180:181], v75 offset:20480
M v[180:183], a[160:163], v[24:27], v[180:183]
buffer_load_dwordx4 v73, s[8:11], s51 offen lds
M v[180:183], a[164:167], v[28:31], v[180:183]
s_add_u32 m0, s36, 114688
ds_read_b64_tr_b16 a[182:183], v75 offset:20992
M v[184:187], a[160:163], v[32:35], v[184:187]
ds_read_b128 a[40:43], v80 offset:0
M v[184:187], a[164:167], v[36:39], v[184:187]
s_add_u32 s48, s76, 0
ds_read_b128 a[44:47], v81 offset:0
M v[188:191], a[160:163], v[40:43], v[188:191]
ds_read_b128 a[48:51], v80 offset:2048
M v[188:191], a[164:167], v[44:47], v[188:191]
buffer_load_dwordx4 a[208:211], v69, s[12:15], s63 offen offset:0 nt
M v[192:195], a[160:163], v[48:51], v[192:195]
ds_read_b128 a[52:55], v81 offset:2048
M v[192:195], a[164:167], v[52:55], v[192:195]
s_waitcnt lgkmcnt(10)
ds_read_b128 a[56:59], v80 offset:4096
M v[196:199], a[168:171], v[16:19], v[196:199]
s_waitcnt lgkmcnt(9)
ds_read_b128 a[60:63], v81 offset:4096
M v[196:199], a[172:175], v[20:23], v[196:199]
s_add_u32 s49, s76, 8192
buffer_load_dwordx4 a[212:215], v70, s[12:15], s63 offen offset:1024 nt
M v[200:203], a[168:171], v[24:27], v[200:203]
ds_read_b128 a[64:67], v80 offset:6144
M v[200:203], a[172:175], v[28:31], v[200:203]
ds_read_b128 a[68:71], v81 offset:6144
M v[204:207], a[168:171], v[32:35], v[204:207]
s_add_u32 s50, s76, 16384
ds_read_b128 a[72:75], v80 offset:8192
M v[204:207], a[172:175], v[36:39], v[204:207]
ds_read_b128 a[76:79], v81 offset:8192
M v[208:211], a[168:171], v[40:43], v[208:211]
buffer_load_dwordx4 a[216:219], v69, s[12:15], s63 offen offset:2048 nt
M v[208:211], a[172:175], v[44:47], v[208:211]
ds_read_b64_tr_b16 a[184:185], v75 offset:16392
M v[212:215], a[168:171], v[48:51], v[212:215]
s_add_u32 s51, s76, 24576
ds_read_b64_tr_b16 a[186:187], v75 offset:16904
M v[212:215], a[172:175], v[52:55], v[212:215]
s_waitcnt lgkmcnt(14)
ds_read_b64_tr_b16 a[188:189], v75 offset:20488
M v[216:219], a[176:179], v[16:19], v[216:219]
s_waitcnt lgkmcnt(13)
ds_read_b64_tr_b16 a[190:191], v75 offset:21000
M v[216:219], a[180:183], v[20:23], v[216:219]
buffer_load_dwordx4 a[220:223], v70, s[12:15], s63 offen offset:3072 nt
M v[220:223], a[176:179], v[24:27], v[220:223]
M v[220:223], a[180:183], v[28:31], v[220:223]
M v[224:227], a[176:179], v[32:35], v[224:227]
M v[224:227], a[180:183], v[36:39], v[224:227]
M v[228:231], a[176:179], v[40:43], v[228:231]
M v[228:231], a[180:183], v[44:47], v[228:231]
M v[232:235], a[176:179], v[48:51], v[232:235]
s_waitcnt lgkmcnt(0)
M v[232:235], a[180:183], v[52:55], v[232:235]
s_barrier
ds_read_b64_tr_b16 a[160:161], v74 offset:32768
buffer_load_dwordx4 v73, s[8:11], s44 offen lds
M v[236:239], a[184:187], v[16:19], v[236:239]
s_add_u32 m0, s36, 115712
ds_read_b64_tr_b16 a[162:163], v74 offset:33280
M v[236:239], a[188:191], v[20:23], v[236:239]
s_add_u32 s44, s76, 32768
ds_read_b64_tr_b16 a[164:165], v74 offset:36864
M v[240:243], a[184:187], v[24:27], v[240:243]
ds_read_b64_tr_b16 a[166:167], v74 offset:37376
M v[240:243], a[188:191], v[28:31], v[240:243]
buffer_load_dwordx4 v73, s[8:11], s45 offen lds
M v[244:247], a[184:187], v[32:35], v[244:247]
s_add_u32 m0, s36, 116736
ds_read_b64_tr_b16 a[168:169], v74 offset:32776
M v[244:247], a[188:191], v[36:39], v[244:247]
s_add_u32 s45, s68, 512
ds_read_b64_tr_b16 a[170:171], v74 offset:33288
M v[248:251], a[184:187], v[40:43], v[248:251]
L_hop_b3:
s_cbranch_execz L_ret_b3
ds_read_b64_tr_b16 a[172:173], v74 offset:36872
M v[248:251], a[188:191], v[44:47], v[248:251]
buffer_load_dwordx4 v73, s[8:11], s46 offen lds
M v[252:255], a[184:187], v[48:51], v[252:255]
s_add_u32 m0, s36, 117760
ds_read_b64_tr_b16 a[174:175], v74 offset:37384
M v[252:255], a[188:191], v[52:55], v[252:255]
s_waitcnt lgkmcnt(6)
ds_read_b64_tr_b16 a[176:177], v75 offset:32768
M v[96:99], a[160:163], a[40:43], v[96:99]
s_waitcnt lgkmcnt(5)
buffer_load_dwordx4 v73, s[8:11], s47 offen lds
M v[96:99], a[164:167], a[44:47], v[96:99]
s_add_u32 m0, s37, 0
ds_read_b64_tr_b16 a[178:179], v75 offset:33280
M v[100:103], a[160:163], a[48:51], v[100:103]
ds_read_b64_tr_b16 a[180:181], v75 offset:36864
M v[100:103], a[164:167], a[52:55], v[100:103]
s_add_u32 s46, s68, 66048
ds_read_b64_tr_b16 a[182:183], v75 offset:37376
M v[104:107], a[160:163], a[56:59], v[104:107]
ds_read_b64_tr_b16 a[184:185], v75 offset:32776
M v[104:107], a[164:167], a[60:63], v[104:107]
buffer_load_dwordx4 v71, s[4:7], s48 offen lds
M v[108:111], a[160:163], a[64:67], v[108:111]
s_add_u32 m0, s37, 1024
ds_read_b64_tr_b16 a[186:187], v75 offset:33288
M v[108:111], a[164:167], a[68:71], v[108:111]
ds_read_b64_tr_b16 a[188:189], v75 offset:36872
M v[112:115], a[160:163], a[72:75], v[112:115]
ds_read_b64_tr_b16 a[190:191], v75 offset:37384
M v[112:115], a[164:167], a[76:79], v[112:115]
s_waitcnt lgkmcnt(10)
buffer_load_dwordx4 v72, s[4:7], s49 offen lds
M v[116:119], a[168:171], a[40:43], v[116:119]
s_waitcnt lgkmcnt(8)
M v[116:119], a[172:175], a[44:47], v[116:119]
s_add_u32 m0, s37, 2048
M v[120:123], a[168:171], a[48:51], v[120:123]
M v[120:123], a[172:175], a[52:55], v[120:123]
s_add_u32 s47, s68, 131584
buffer_load_dwordx4 v71, s[4:7], s50 offen lds
M v[124:127], a[168:171], a[56:59], v[124:127]
s_add_u32 m0, s37, 3072
M v[124:127], a[172:175], a[60:63], v[124:127]
M v[128:131], a[168:171], a[64:67], v[128:131]
M v[128:131], a[172:175], a[68:71], v[128:131]
buffer_load_dwordx4 v72, s[4:7], s51 offen lds
M v[132:135], a[168:171], a[72:75], v[132:135]
s_add_u32 m0, s37, 4096
M v[132:135], a[172:175], a[76:79], v[132:135]
s_waitcnt lgkmcnt(6)
M v[136:139], a[176:179], a[40:43], v[136:139]
s_waitcnt lgkmcnt(4)
buffer_load_dwordx4 v71, s[4:7], s44 offen lds
M v[136:139], a[180:183], a[44:47], v[136:139]
M v[140:143], a[176:179], a[48:51], v[140:143]
M v[140:143], a[180:183], a[52:55], v[140:143]
s_waitcnt vmcnt(17) lgkmcnt(0)
M v[144:147], a[176:179], a[56:59], v[144:147]
s_barrier
ds_read_b64_tr_b16 a[160:161], v74 offset:49152
M v[144:147], a[180:183], a[60:63], v[144:147]
s_add_u32 m0, s36, 131072
ds_read_b64_tr_b16 a[162:163], v74 offset:49664
M v[148:151], a[176:179], a[64:67], v[148:151]
s_add_u32 s48, s68, 197120
ds_read_b64_tr_b16 a[164:165], v74 offset:53248
M v[148:151], a[180:183], a[68:71], v[148:151]
ds_read_b64_tr_b16 a[166:167], v74 offset:53760
M v[152:155], a[176:179], a[72:75], v[152:155]
s_add_u32 s49, s68, 640
buffer_load_dwordx4 v73, s[8:11], s45 offen lds
M v[152:155], a[180:183], a[76:79], v[152:155]
s_add_u32 m0, s36, 132096
ds_read_b64_tr_b16 a[168:169], v74 offset:49160
M v[156:159], a[184:187], a[40:43], v[156:159]
ds_read_b64_tr_b16 a[170:171], v74 offset:49672
M v[156:159], a[188:191], a[44:47], v[156:159]
ds_read_b64_tr_b16 a[172:173], v74 offset:53256
M v[160:163], a[184:187], a[48:51], v[160:163]
s_add_u32 s50, s68, 66176
ds_read_b64_tr_b16 a[174:175], v74 offset:53768
M v[160:163], a[188:191], a[52:55], v[160:163]
ds_read_b64_tr_b16 a[176:177], v75 offset:49152
M v[164:167], a[184:187], a[56:59], v[164:167]
ds_read_b64_tr_b16 a[178:179], v75 offset:49664
M v[164:167], a[188:191], a[60:63], v[164:167]
buffer_load_dwordx4 v73, s[8:11], s46 offen lds
M v[168:171], a[184:187], a[64:67], v[168:171]
s_add_u32 m0, s36, 133120
ds_read_b64_tr_b16 a[180:181], v75 offset:53248
M v[168:171], a[188:191], a[68:71], v[168:171]
s_add_u32 s51, s68, 131712
ds_read_b64_tr_b16 a[182:183], v75 offset:53760
M v[172:175], a[184:187], a[72:75], v[172:175]
ds_read_b128 v[16:19], v82 offset:0
M v[172:175], a[188:191], a[76:79], v[172:175]
s_waitcnt lgkmcnt(11)
ds_read_b128 v[20:23], v83 offset:0
M v[176:179], a[160:163], a[40:43], v[176:179]
s_waitcnt lgkmcnt(10)
ds_read_b128 v[24:27], v82 offset:2048
M v[176:179], a[164:167], a[44:47], v[176:179]
s_add_u32 s44, s68, 197248
ds_read_b128 v[28:31], v83 offset:2048
M v[180:183], a[160:163], a[48:51], v[180:183]
ds_read_b128 v[32:35], v82 offset:4096
M v[180:183], a[164:167], a[52:55], v[180:183]
ds_read_b128 v[36:39], v83 offset:4096
M v[184:187], a[160:163], a[56:59], v[184:187]
ds_read_b128 v[40:43], v82 offset:6144
M v[184:187], a[164:167], a[60:63], v[184:187]
s_add_u32 s45, s77, 0
buffer_load_dwordx4 v73, s[8:11], s47 offen lds
M v[188:191], a[160:163], a[64:67], v[188:191]
s_add_u32 m0, s36, 134144
ds_read_b128 v[44:47], v83 offset:6144
M v[188:191], a[164:167], a[68:71], v[188:191]
ds_read_b128 v[48:51], v82 offset:8192
M v[192:195], a[160:163], a[72:75], v[192:195]
ds_read_b128 v[52:55], v83 offset:8192
M v[192:195], a[164:167], a[76:79], v[192:195]
s_waitcnt lgkmcnt(15)
ds_read_b64_tr_b16 a[184:185], v75 offset:49160
M v[196:199], a[168:171], a[40:43], v[196:199]
s_waitcnt lgkmcnt(15)
ds_read_b64_tr_b16 a[186:187], v75 offset:49672
M v[196:199], a[172:175], a[44:47], v[196:199]
s_add_u32 s46, s77, 8192
ds_read_b64_tr_b16 a[188:189], v75 offset:53256
M v[200:203], a[168:171], a[48:51], v[200:203]
ds_read_b64_tr_b16 a[190:191], v75 offset:53768
M v[200:203], a[172:175], a[52:55], v[200:203]
M v[204:207], a[168:171], a[56:59], v[204:207]
s_add_u32 s47, s77, 16384
buffer_load_dwordx4 v73, s[8:11], s48 offen lds
M v[204:207], a[172:175], a[60:63], v[204:207]
s_add_u32 m0, s36, 147456
M v[208:211], a[168:171], a[64:67], v[208:211]
M v[208:211], a[172:175], a[68:71], v[208:211]
M v[212:215], a[168:171], a[72:75], v[212:215]
s_add_u32 s48, s77, 24576
M v[212:215], a[172:175], a[76:79], v[212:215]
s_waitcnt lgkmcnt(15)
M v[216:219], a[176:179], a[40:43], v[216:219]
s_waitcnt lgkmcnt(14)
M v[216:219], a[180:183], a[44:47], v[216:219]
M v[220:223], a[176:179], a[48:51], v[220:223]
M v[220:223], a[180:183], a[52:55], v[220:223]
s_waitcnt vmcnt(17) lgkmcnt(0)
M v[224:227], a[176:179], a[56:59], v[224:227]
s_barrier
ds_read_b64_tr_b16 a[160:161], v74 offset:0
M v[224:227], a[180:183], a[60:63], v[224:227]
buffer_load_dwordx4 v73, s[8:11], s49 offen lds
M v[228:231], a[176:179], a[64:67], v[228:231]
s_add_u32 m0, s36, 148480
ds_read_b64_tr_b16 a[162:163], v74 offset:512
M v[228:231], a[180:183], a[68:71], v[228:231]
s_add_u32 s49, s77, 32768
ds_read_b64_tr_b16 a[164:165], v74 offset:4096
M v[232:235], a[176:179], a[72:75], v[232:235]
ds_read_b64_tr_b16 a[166:167], v74 offset:4608
M v[232:235], a[180:183], a[76:79], v[232:235]
ds_read_b64_tr_b16 a[168:169], v74 offset:8
M v[236:239], a[184:187], a[40:43], v[236:239]
buffer_load_dwordx4 v73, s[8:11], s50 offen lds
M v[236:239], a[188:191], a[44:47], v[236:239]
s_add_u32 m0, s36, 149504
ds_read_b64_tr_b16 a[170:171], v74 offset:520
M v[240:243], a[184:187], a[48:51], v[240:243]
s_add_u32 s50, s69, 512
ds_read_b64_tr_b16 a[172:173], v74 offset:4104
M v[240:243], a[188:191], a[52:55], v[240:243]
ds_read_b64_tr_b16 a[174:175], v74 offset:4616
M v[244:247], a[184:187], a[56:59], v[244:247]
buffer_load_dwordx4 v73, s[8:11], s51 offen lds
M v[244:247], a[188:191], a[60:63], v[244:247]
s_add_u32 m0, s36, 150528
ds_read_b64_tr_b16 a[176:177], v75 offset:0
M v[248:251], a[184:187], a[64:67], v[248:251]
s_add_u32 s51, s69, 66048
ds_read_b64_tr_b16 a[178:179], v75 offset:512
M v[248:251], a[188:191], a[68:71], v[248:251]
ds_read_b64_tr_b16 a[180:181], v75 offset:4096
M v[252:255], a[184:187], a[72:75], v[252:255]
buffer_load_dwordx4 v73, s[8:11], s44 offen lds
M v[252:255], a[188:191], a[76:79], v[252:255]
s_waitcnt lgkmcnt(9)
ds_read_b64_tr_b16 a[182:183], v75 offset:4608
M v[96:99], a[160:163], v[16:19], v[96:99]
s_waitcnt lgkmcnt(8)
ds_read_b64_tr_b16 a[184:185], v75 offset:8
M v[96:99], a[164:167], v[20:23], v[96:99]
s_add_u32 m0, s38, 0
ds_read_b64_tr_b16 a[186:187], v75 offset:520
M v[100:103], a[160:163], v[24:27], v[100:103]
s_add_u32 s44, s69, 131584
buffer_load_dwordx4 v71, s[4:7], s45 offen lds
M v[100:103], a[164:167], v[28:31], v[100:103]
s_add_u32 m0, s38, 1024
ds_read_b64_tr_b16 a[188:189], v75 offset:4104
M v[104:107], a[160:163], v[32:35], v[104:107]
s_add_u32 s45, s69, 197120
ds_read_b64_tr_b16 a[190:191], v75 offset:4616
M v[104:107], a[164:167], v[36:39], v[104:107]
s_add_u32 s63, s43, 32768
M v[108:111], a[160:163], v[40:43], v[108:111]
s_and_b32 s63, s63, 131071
M v[108:111], a[164:167], v[44:47], v[108:111]
s_add_u32 s63, s63, s100
buffer_load_dwordx4 v72, s[4:7], s46 offen lds
M v[112:115], a[160:163], v[48:51], v[112:115]
s_add_u32 m0, s38, 2048
M v[112:115], a[164:167], v[52:55], v[112:115]
s_waitcnt lgkmcnt(10)
M v[116:119], a[168:171], v[16:19], v[116:119]
s_waitcnt lgkmcnt(8)
M v[116:119], a[172:175], v[20:23], v[116:119]
buffer_load_dwordx4 v71, s[4:7], s47 offen lds
M v[120:123], a[168:171], v[24:27], v[120:123]
s_add_u32 m0, s38, 3072
M v[120:123], a[172:175], v[28:31], v[120:123]
M v[124:127], a[168:171], v[32:35], v[124:127]
M v[124:127], a[172:175], v[36:39], v[124:127]
buffer_load_dwordx4 v72, s[4:7], s48 offen lds
M v[128:131], a[168:171], v[40:43], v[128:131]
s_add_u32 m0, s38, 4096
M v[128:131], a[172:175], v[44:47], v[128:131]
M v[132:135], a[168:171], v[48:51], v[132:135]
M v[132:135], a[172:175], v[52:55], v[132:135]
s_waitcnt lgkmcnt(6)
buffer_load_dwordx4 v71, s[4:7], s49 offen lds
M v[136:139], a[176:179], v[16:19], v[136:139]
s_waitcnt lgkmcnt(4)
M v[136:139], a[180:183], v[20:23], v[136:139]
s_add_u32 m0, s36, 98304
M v[140:143], a[176:179], v[24:27], v[140:143]
M v[140:143], a[180:183], v[28:31], v[140:143]
s_waitcnt vmcnt(13) lgkmcnt(0)
M v[144:147], a[176:179], v[32:35], v[144:147]
s_barrier
ds_read_b64_tr_b16 a[160:161], v74 offset:16384
M v[144:147], a[180:183], v[36:39], v[144:147]
buffer_load_dwordx4 v73, s[8:11], s50 offen lds
M v[148:151], a[176:179], v[40:43], v[148:151]
s_add_u32 m0, s36, 99328
ds_read_b64_tr_b16 a[162:163], v74 offset:16896
M v[148:151], a[180:183], v[44:47], v[148:151]
ds_read_b64_tr_b16 a[164:165], v74 offset:20480
M v[152:155], a[176:179], v[48:51], v[152:155]
s_add_u32 s46, s69, 640
ds_read_b64_tr_b16 a[166:167], v74 offset:20992
M v[152:155], a[180:183], v[52:55], v[152:155]
ds_read_b64_tr_b16 a[168:169], v74 offset:16392
M v[156:159], a[184:187], v[16:19], v[156:159]
buffer_load_dwordx4 v73, s[8:11], s51 offen lds
M v[156:159], a[188:191], v[20:23], v[156:159]
s_add_u32 m0, s36, 100352
ds_read_b64_tr_b16 a[170:171], v74 offset:16904
M v[160:163], a[184:187], v[24:27], v[160:163]
s_add_u32 s47, s69, 66176
ds_read_b64_tr_b16 a[172:173], v74 offset:20488
M v[160:163], a[188:191], v[28:31], v[160:163]
ds_read_b64_tr_b16 a[174:175], v74 offset:21000
M v[164:167], a[184:187], v[32:35], v[164:167]
ds_read_b64_tr_b16 a[176:177], v75 offset:16384
M v[164:167], a[188:191], v[36:39], v[164:167]
buffer_load_dwordx4 v73, s[8:11], s44 offen lds
M v[168:171], a[184:187], v[40:43], v[168:171]
s_add_u32 m0, s36, 101376
ds_read_b64_tr_b16 a[178:179], v75 offset:16896
M v[168:171], a[188:191], v[44:47], v[168:171]
s_add_u32 s48, s69, 131712
ds_read_b64_tr_b16 a[180:181], v75 offset:20480
M v[172:175], a[184:187], v[48:51], v[172:175]
ds_read_b64_tr_b16 a[182:183], v75 offset:20992
M v[172:175], a[188:191], v[52:55], v[172:175]
s_waitcnt lgkmcnt(10)
ds_read_b128 a[40:43], v80 offset:0
M v[176:179], a[160:163], v[16:19], v[176:179]
s_waitcnt lgkmcnt(9)
buffer_load_dwordx4 v73, s[8:11], s45 offen lds
M v[176:179], a[164:167], v[20:23], v[176:179]
s_add_u32 m0, s36, 114688
ds_read_b128 a[44:47], v81 offset:0
M v[180:183], a[160:163], v[24:27], v[180:183]
s_add_u32 s49, s69, 197248
ds_read_b128 a[48:51], v80 offset:2048
M v[180:183], a[164:167], v[28:31], v[180:183]
ds_read_b128 a[52:55], v81 offset:2048
M v[184:187], a[160:163], v[32:35], v[184:187]
ds_read_b128 a[56:59], v80 offset:4096
M v[184:187], a[164:167], v[36:39], v[184:187]
s_add_u32 s50, s78, 0
buffer_load_dwordx4 a[224:227], v69, s[16:19], s63 offen offset:0 nt
M v[188:191], a[160:163], v[40:43], v[188:191]
ds_read_b128 a[60:63], v81 offset:4096
M v[188:191], a[164:167], v[44:47], v[188:191]
ds_read_b128 a[64:67], v80 offset:6144
M v[192:195], a[160:163], v[48:51], v[192:195]
ds_read_b128 a[68:71], v81 offset:6144
M v[192:195], a[164:167], v[52:55], v[192:195]
s_waitcnt lgkmcnt(14)
buffer_load_dwordx4 a[228:231], v70, s[16:19], s63 offen offset:1024 nt
M v[196:199], a[168:171], v[16:19], v[196:199]
s_waitcnt lgkmcnt(12)
ds_read_b128 a[72:75], v80 offset:8192
M v[196:199], a[172:175], v[20:23], v[196:199]
s_add_u32 s51, s78, 8192
ds_read_b128 a[76:79], v81 offset:8192
M v[200:203], a[168:171], v[24:27], v[200:203]
ds_read_b64_tr_b16 a[184:185], v75 offset:16392
M v[200:203], a[172:175], v[28:31], v[200:203]
buffer_load_dwordx4 a[232:235], v69, s[16:19], s63 offen offset:2048 nt
M v[204:207], a[168:171], v[32:35], v[204:207]
s_add_u32 s44, s78, 16384
ds_read_b64_tr_b16 a[186:187], v75 offset:16904
M v[204:207], a[172:175], v[36:39], v[204:207]
ds_read_b64_tr_b16 a[188:189], v75 offset:20488
M v[208:211], a[168:171], v[40:43], v[208:211]
ds_read_b64_tr_b16 a[190:191], v75 offset:21000
M v[208:211], a[172:175], v[44:47], v[208:211]
buffer_load_dwordx4 a[236:239], v70, s[16:19], s63 offen offset:3072 nt
M v[212:215], a[168:171], v[48:51], v[212:215]
s_add_u32 s45, s78, 24576
M v[212:215], a[172:175], v[52:55], v[212:215]
s_waitcnt lgkmcnt(15)
M v[216:219], a[176:179], v[16:19], v[216:219]
s_waitcnt lgkmcnt(14)
M v[216:219], a[180:183], v[20:23], v[216:219]
M v[220:223], a[176:179], v[24:27], v[220:223]
M v[220:223], a[180:183], v[28:31], v[220:223]
M v[224:227], a[176:179], v[32:35], v[224:227]
s_waitcnt vmcnt(17) lgkmcnt(0)
M v[224:227], a[180:183], v[36:39], v[224:227]
s_barrier
ds_read_b64_tr_b16 a[160:161], v74 offset:32768
M v[228:231], a[176:179], v[40:43], v[228:231]
buffer_load_dwordx4 v73, s[8:11], s46 offen lds
M v[228:231], a[180:183], v[44:47], v[228:231]
s_add_u32 m0, s36, 115712
ds_read_b64_tr_b16 a[162:163], v74 offset:33280
M v[232:235], a[176:179], v[48:51], v[232:235]
s_add_u32 s46, s78, 32768
ds_read_b64_tr_b16 a[164:165], v74 offset:36864
M v[232:235], a[180:183], v[52:55], v[232:235]
ds_read_b64_tr_b16 a[166:167], v74 offset:37376
M v[236:239], a[184:187], v[16:19], v[236:239]
buffer_load_dwordx4 v73, s[8:11], s47 offen lds
M v[236:239], a[188:191], v[20:23], v[236:239]
s_add_u32 m0, s36, 116736
ds_read_b64_tr_b16 a[168:169], v74 offset:32776
M v[240:243], a[184:187], v[24:27], v[240:243]
ds_read_b64_tr_b16 a[170:171], v74 offset:33288
M v[240:243], a[188:191], v[28:31], v[240:243]
ds_read_b64_tr_b16 a[172:173], v74 offset:36872
M v[244:247], a[184:187], v[32:35], v[244:247]
s_add_u32 s47, s70, 512
buffer_load_dwordx4 v73, s[8:11], s48 offen lds
M v[244:247], a[188:191], v[36:39], v[244:247]
s_add_u32 m0, s36, 117760
ds_read_b64_tr_b16 a[174:175], v74 offset:37384
M v[248:251], a[184:187], v[40:43], v[248:251]
ds_read_b64_tr_b16 a[176:177], v75 offset:32768
M v[248:251], a[188:191], v[44:47], v[248:251]
ds_read_b64_tr_b16 a[178:179], v75 offset:33280
M v[252:255], a[184:187], v[48:51], v[252:255]
buffer_load_dwordx4 v73, s[8:11], s49 offen lds
M v[252:255], a[188:191], v[52:55], v[252:255]
s_waitcnt lgkmcnt(8)
ds_read_b64_tr_b16 a[180:181], v75 offset:36864
M v[96:99], a[160:163], a[40:43], v[96:99]
s_waitcnt lgkmcnt(7)
ds_read_b64_tr_b16 a[182:183], v75 offset:37376
v_bfe_u32 v12, v85, 2, 4
M v[96:99], a[164:167], a[44:47], v[96:99]
s_add_u32 m0, s37, 0
ds_read_b64_tr_b16 a[184:185], v75 offset:32776
v_and_b32 v13, 1, v85
M v[100:103], a[160:163], a[48:51], v[100:103]
buffer_load_dwordx4 v71, s[4:7], s50 offen lds
M v[100:103], a[164:167], a[52:55], v[100:103]
s_add_u32 m0, s37, 1024
ds_read_b64_tr_b16 a[186:187], v75 offset:33288
v_lshlrev_b32 v10, 7, v12
M v[104:107], a[160:163], a[56:59], v[104:107]
s_add_u32 s48, s70, 66048
ds_read_b64_tr_b16 a[188:189], v75 offset:36872
v_bfe_u32 v14, v85, 1, 1
M v[104:107], a[164:167], a[60:63], v[104:107]
ds_read_b64_tr_b16 a[190:191], v75 offset:37384
v_lshl_add_u32 v10, v13, 3, v10
M v[108:111], a[160:163], a[64:67], v[108:111]
v_bfe_u32 v8, v85, 7, 1
v_lshl_add_u32 v10, v14, 4, v10
M v[108:111], a[164:167], a[68:71], v[108:111]
buffer_load_dwordx4 v72, s[4:7], s51 offen lds
M v[112:115], a[160:163], a[72:75], v[112:115]
s_add_u32 m0, s37, 2048
v_lshl_add_u32 v10, v8, 14, v10
v_bfe_u32 v11, v12, 1, 2
M v[112:115], a[164:167], a[76:79], v[112:115]
s_waitcnt lgkmcnt(10)
v_add_u32 v10, 131072, v10
v_lshlrev_b32 v8, 1, v8
M v[116:119], a[168:171], a[40:43], v[116:119]
s_waitcnt lgkmcnt(8)
v_xor_b32 v11, v8, v11
v_xor_b32 v9, 0, v11
M v[116:119], a[172:175], a[44:47], v[116:119]
buffer_load_dwordx4 v71, s[4:7], s44 offen lds
M v[120:123], a[168:171], a[48:51], v[120:123]
s_add_u32 m0, s37, 3072
v_lshl_add_u32 v86, v9, 5, v10
v_xor_b32 v9, 1, v11
M v[120:123], a[172:175], a[52:55], v[120:123]
v_xor_b32 v88, 0x4000, v86
v_lshl_add_u32 v87, v9, 5, v10
M v[124:127], a[168:171], a[56:59], v[124:127]
v_xor_b32 v89, 0x4000, v87
M v[124:127], a[172:175], a[60:63], v[124:127]
buffer_load_dwordx4 v72, s[4:7], s45 offen lds
M v[128:131], a[168:171], a[64:67], v[128:131]
s_add_u32 m0, s37, 4096
M v[128:131], a[172:175], a[68:71], v[128:131]
M v[132:135], a[168:171], a[72:75], v[132:135]
M v[132:135], a[172:175], a[76:79], v[132:135]
s_waitcnt lgkmcnt(6)
buffer_load_dwordx4 v71, s[4:7], s46 offen lds
M v[136:139], a[176:179], a[40:43], v[136:139]
s_waitcnt lgkmcnt(4)
M v[136:139], a[180:183], a[44:47], v[136:139]
M v[140:143], a[176:179], a[48:51], v[140:143]
M v[140:143], a[180:183], a[52:55], v[140:143]
s_waitcnt vmcnt(17) lgkmcnt(0)
M v[144:147], a[176:179], a[56:59], v[144:147]
s_barrier
ds_read_b64_tr_b16 a[160:161], v74 offset:49152
M v[144:147], a[180:183], a[60:63], v[144:147]
s_add_u32 m0, s36, 131072
ds_read_b64_tr_b16 a[162:163], v74 offset:49664
M v[148:151], a[176:179], a[64:67], v[148:151]
s_add_u32 s49, s70, 131584
ds_read_b64_tr_b16 a[164:165], v74 offset:53248
M v[148:151], a[180:183], a[68:71], v[148:151]
s_add_u32 s50, s70, 197120
ds_read_b64_tr_b16 a[166:167], v74 offset:53760
M v[152:155], a[176:179], a[72:75], v[152:155]
s_add_u32 s51, s71, 512
buffer_load_dwordx4 v73, s[8:11], s47 offen lds
M v[152:155], a[180:183], a[76:79], v[152:155]
s_add_u32 m0, s36, 132096
ds_read_b64_tr_b16 a[168:169], v74 offset:49160
M v[156:159], a[184:187], a[40:43], v[156:159]
ds_read_b64_tr_b16 a[170:171], v74 offset:49672
M v[156:159], a[188:191], a[44:47], v[156:159]
ds_read_b64_tr_b16 a[172:173], v74 offset:53256
M v[160:163], a[184:187], a[48:51], v[160:163]
s_add_u32 s44, s71, 66048
ds_read_b64_tr_b16 a[174:175], v74 offset:53768
M v[160:163], a[188:191], a[52:55], v[160:163]
ds_read_b64_tr_b16 a[176:177], v75 offset:49152
M v[164:167], a[184:187], a[56:59], v[164:167]
ds_read_b64_tr_b16 a[178:179], v75 offset:49664
M v[164:167], a[188:191], a[60:63], v[164:167]
buffer_load_dwordx4 v73, s[8:11], s48 offen lds
M v[168:171], a[184:187], a[64:67], v[168:171]
s_add_u32 m0, s36, 133120
ds_read_b64_tr_b16 a[180:181], v75 offset:53248
M v[168:171], a[188:191], a[68:71], v[168:171]
s_add_u32 s45, s71, 131584
ds_read_b64_tr_b16 a[182:183], v75 offset:53760
M v[172:175], a[184:187], a[72:75], v[172:175]
ds_read_b128 v[16:19], v82 offset:0
M v[172:175], a[188:191], a[76:79], v[172:175]
s_waitcnt lgkmcnt(11)
ds_read_b128 v[20:23], v83 offset:0
M v[176:179], a[160:163], a[40:43], v[176:179]
s_waitcnt lgkmcnt(10)
ds_read_b128 v[24:27], v82 offset:2048
M v[176:179], a[164:167], a[44:47], v[176:179]
s_add_u32 s46, s71, 197120
ds_read_b128 v[28:31], v83 offset:2048
M v[180:183], a[160:163], a[48:51], v[180:183]
ds_read_b128 v[32:35], v82 offset:4096
M v[180:183], a[164:167], a[52:55], v[180:183]
ds_read_b128 v[36:39], v83 offset:4096
M v[184:187], a[160:163], a[56:59], v[184:187]
ds_read_b128 v[40:43], v82 offset:6144
M v[184:187], a[164:167], a[60:63], v[184:187]
s_add_u32 s47, s79, 0
buffer_load_dwordx4 v73, s[8:11], s49 offen lds
M v[188:191], a[160:163], a[64:67], v[188:191]
s_add_u32 m0, s36, 134144
ds_read_b128 v[44:47], v83 offset:6144
M v[188:191], a[164:167], a[68:71], v[188:191]
ds_read_b128 v[48:51], v82 offset:8192
M v[192:195], a[160:163], a[72:75], v[192:195]
ds_read_b128 v[52:55], v83 offset:8192
M v[192:195], a[164:167], a[76:79], v[192:195]
s_waitcnt lgkmcnt(15)
ds_read_b64_tr_b16 a[184:185], v75 offset:49160
M v[196:199], a[168:171], a[40:43], v[196:199]
s_waitcnt lgkmcnt(15)
ds_read_b64_tr_b16 a[186:187], v75 offset:49672
M v[196:199], a[172:175], a[44:47], v[196:199]
s_add_u32 s48, s79, 8192
ds_read_b64_tr_b16 a[188:189], v75 offset:53256
M v[200:203], a[168:171], a[48:51], v[200:203]
ds_read_b64_tr_b16 a[190:191], v75 offset:53768
M v[200:203], a[172:175], a[52:55], v[200:203]
M v[204:207], a[168:171], a[56:59], v[204:207]
s_add_u32 s49, s79, 16384
buffer_load_dwordx4 v73, s[8:11], s50 offen lds
M v[204:207], a[172:175], a[60:63], v[204:207]
s_add_u32 m0, s36, 147456
M v[208:211], a[168:171], a[64:67], v[208:211]
M v[208:211], a[172:175], a[68:71], v[208:211]
M v[212:215], a[168:171], a[72:75], v[212:215]
s_add_u32 s50, s79, 24576
M v[212:215], a[172:175], a[76:79], v[212:215]
s_waitcnt lgkmcnt(15)
M v[216:219], a[176:179], a[40:43], v[216:219]
s_waitcnt lgkmcnt(14)
M v[216:219], a[180:183], a[44:47], v[216:219]
M v[220:223], a[176:179], a[48:51], v[220:223]
M v[220:223], a[180:183], a[52:55], v[220:223]
s_waitcnt vmcnt(17) lgkmcnt(0)
M v[224:227], a[176:179], a[56:59], v[224:227]
s_barrier
ds_read_b64_tr_b16 a[160:161], v74 offset:0
M v[224:227], a[180:183], a[60:63], v[224:227]
buffer_load_dwordx4 v73, s[8:11], s51 offen lds
M v[228:231], a[176:179], a[64:67], v[228:231]
s_add_u32 m0, s36, 148480
ds_read_b64_tr_b16 a[162:163], v74 offset:512
M v[228:231], a[180:183], a[68:71], v[228:231]
s_add_u32 s51, s79, 32768
ds_read_b64_tr_b16 a[164:165], v74 offset:4096
M v[232:235], a[176:179], a[72:75], v[232:235]
L_hop_b4:
s_cbranch_execz L_ret_b4
ds_read_b64_tr_b16 a[166:167], v74 offset:4608
M v[232:235], a[180:183], a[76:79], v[232:235]
ds_read_b64_tr_b16 a[168:169], v74 offset:8
M v[236:239], a[184:187], a[40:43], v[236:239]
buffer_load_dwordx4 v73, s[8:11], s44 offen lds
M v[236:239], a[188:191], a[44:47], v[236:239]
s_add_u32 m0, s36, 149504
ds_read_b64_tr_b16 a[170:171], v74 offset:520
M v[240:243], a[184:187], a[48:51], v[240:243]
s_add_u32 s44, s70, 640
ds_read_b64_tr_b16 a[172:173], v74 offset:4104
M v[240:243], a[188:191], a[52:55], v[240:243]
ds_read_b64_tr_b16 a[174:175], v74 offset:4616
M v[244:247], a[184:187], a[56:59], v[244:247]
buffer_load_dwordx4 v73, s[8:11], s45 offen lds
M v[244:247], a[188:191], a[60:63], v[244:247]
s_add_u32 m0, s36, 150528
ds_read_b64_tr_b16 a[176:177], v75 offset:0
M v[248:251], a[184:187], a[64:67], v[248:251]
s_add_u32 s45, s70, 66176
ds_read_b64_tr_b16 a[178:179], v75 offset:512
M v[248:251], a[188:191], a[68:71], v[248:251]
ds_read_b64_tr_b16 a[180:181], v75 offset:4096
M v[252:255], a[184:187], a[72:75], v[252:255]
buffer_load_dwordx4 v73, s[8:11], s46 offen lds
M v[252:255], a[188:191], a[76:79], v[252:255]
s_waitcnt lgkmcnt(9)
ds_read_b64_tr_b16 a[182:183], v75 offset:4608
M v[96:99], a[160:163], v[16:19], v[96:99]
s_waitcnt lgkmcnt(8)
ds_read_b64_tr_b16 a[184:185], v75 offset:8
M v[96:99], a[164:167], v[20:23], v[96:99]
s_add_u32 m0, s38, 0
ds_read_b64_tr_b16 a[186:187], v75 offset:520
M v[100:103], a[160:163], v[24:27], v[100:103]
s_add_u32 s46, s70, 131712
buffer_load_dwordx4 v71, s[4:7], s47 offen lds
M v[100:103], a[164:167], v[28:31], v[100:103]
s_add_u32 m0, s38, 1024
ds_read_b64_tr_b16 a[188:189], v75 offset:4104
M v[104:107], a[160:163], v[32:35], v[104:107]
s_add_u32 s47, s70, 197248
ds_read_b64_tr_b16 a[190:191], v75 offset:4616
M v[104:107], a[164:167], v[36:39], v[104:107]
s_add_u32 s63, s43, 40960
M v[108:111], a[160:163], v[40:43], v[108:111]
s_and_b32 s63, s63, 131071
M v[108:111], a[164:167], v[44:47], v[108:111]
s_add_u32 s63, s63, s100
buffer_load_dwordx4 v72, s[4:7], s48 offen lds
M v[112:115], a[160:163], v[48:51], v[112:115]
s_add_u32 m0, s38, 2048
M v[112:115], a[164:167], v[52:55], v[112:115]
s_waitcnt lgkmcnt(10)
M v[116:119], a[168:171], v[16:19], v[116:119]
s_waitcnt lgkmcnt(8)
M v[116:119], a[172:175], v[20:23], v[116:119]
buffer_load_dwordx4 v71, s[4:7], s49 offen lds
M v[120:123], a[168:171], v[24:27], v[120:123]
s_add_u32 m0, s38, 3072
M v[120:123], a[172:175], v[28:31], v[120:123]
M v[124:127], a[168:171], v[32:35], v[124:127]
M v[124:127], a[172:175], v[36:39], v[124:127]
buffer_load_dwordx4 v72, s[4:7], s50 offen lds
M v[128:131], a[168:171], v[40:43], v[128:131]
s_add_u32 m0, s38, 4096
M v[128:131], a[172:175], v[44:47], v[128:131]
M v[132:135], a[168:171], v[48:51], v[132:135]
M v[132:135], a[172:175], v[52:55], v[132:135]
s_waitcnt lgkmcnt(6)
buffer_load_dwordx4 v71, s[4:7], s51 offen lds
M v[136:139], a[176:179], v[16:19], v[136:139]
s_waitcnt lgkmcnt(4)
M v[136:139], a[180:183], v[20:23], v[136:139]
s_add_u32 m0, s36, 98304
M v[140:143], a[176:179], v[24:27], v[140:143]
M v[140:143], a[180:183], v[28:31], v[140:143]
s_waitcnt vmcnt(13) lgkmcnt(0)
M v[144:147], a[176:179], v[32:35], v[144:147]
s_barrier
ds_read_b64_tr_b16 a[160:161], v74 offset:16384
M v[144:147], a[180:183], v[36:39], v[144:147]
buffer_load_dwordx4 v73, s[8:11], s44 offen lds
M v[148:151], a[176:179], v[40:43], v[148:151]
s_add_u32 m0, s36, 99328
ds_read_b64_tr_b16 a[162:163], v74 offset:16896
M v[148:151], a[180:183], v[44:47], v[148:151]
ds_read_b64_tr_b16 a[164:165], v74 offset:20480
M v[152:155], a[176:179], v[48:51], v[152:155]
ds_read_b64_tr_b16 a[166:167], v74 offset:20992
M v[152:155], a[180:183], v[52:55], v[152:155]
s_add_u32 s48, s71, 640
ds_read_b64_tr_b16 a[168:169], v74 offset:16392
M v[156:159], a[184:187], v[16:19], v[156:159]
buffer_load_dwordx4 v73, s[8:11], s45 offen lds
M v[156:159], a[188:191], v[20:23], v[156:159]
s_add_u32 m0, s36, 100352
ds_read_b64_tr_b16 a[170:171], v74 offset:16904
M v[160:163], a[184:187], v[24:27], v[160:163]
ds_read_b64_tr_b16 a[172:173], v74 offset:20488
M v[160:163], a[188:191], v[28:31], v[160:163]
ds_read_b64_tr_b16 a[174:175], v74 offset:21000
M v[164:167], a[184:187], v[32:35], v[164:167]
s_add_u32 s49, s71, 66176
ds_read_b64_tr_b16 a[176:177], v75 offset:16384
M v[164:167], a[188:191], v[36:39], v[164:167]
buffer_load_dwordx4 v73, s[8:11], s46 offen lds
M v[168:171], a[184:187], v[40:43], v[168:171]
s_add_u32 m0, s36, 101376
ds_read_b64_tr_b16 a[178:179], v75 offset:16896
M v[168:171], a[188:191], v[44:47], v[168:171]
ds_read_b64_tr_b16 a[180:181], v75 offset:20480
M v[172:175], a[184:187], v[48:51], v[172:175]
s_add_u32 s50, s71, 131712
ds_read_b64_tr_b16 a[182:183], v75 offset:20992
M v[172:175], a[188:191], v[52:55], v[172:175]
s_waitcnt lgkmcnt(10)
ds_read_b128 a[40:43], v80 offset:0
M v[176:179], a[160:163], v[16:19], v[176:179]
s_waitcnt lgkmcnt(9)
buffer_load_dwordx4 v73, s[8:11], s47 offen lds
M v[176:179], a[164:167], v[20:23], v[176:179]
s_add_u32 m0, s36, 114688
ds_read_b128 a[44:47], v81 offset:0
M v[180:183], a[160:163], v[24:27], v[180:183]
ds_read_b128 a[48:51], v80 offset:2048
M v[180:183], a[164:167], v[28:31], v[180:183]
s_add_u32 s51, s71, 197248
ds_read_b128 a[52:55], v81 offset:2048
M v[184:187], a[160:163], v[32:35], v[184:187]
ds_read_b128 a[56:59], v80 offset:4096
M v[184:187], a[164:167], v[36:39], v[184:187]
buffer_load_dwordx4 a[240:243], v69, s[12:15], s63 offen offset:0 nt
M v[188:191], a[160:163], v[40:43], v[188:191]
ds_read_b128 a[60:63], v81 offset:4096
M v[188:191], a[164:167], v[44:47], v[188:191]
ds_read_b128 a[64:67], v80 offset:6144
M v[192:195], a[160:163], v[48:51], v[192:195]
s_add_u32 s44, s43, 16384
ds_read_b128 a[68:71], v81 offset:6144
M v[192:195], a[164:167], v[52:55], v[192:195]
s_waitcnt lgkmcnt(14)
buffer_load_dwordx4 a[244:247], v70, s[12:15], s63 offen offset:1024 nt
M v[196:199], a[168:171], v[16:19], v[196:199]
s_waitcnt lgkmcnt(12)
ds_read_b128 a[72:75], v80 offset:8192
M v[196:199], a[172:175], v[20:23], v[196:199]
s_and_b32 s44, s44, 131071
ds_read_b128 a[76:79], v81 offset:8192
M v[200:203], a[168:171], v[24:27], v[200:203]
s_add_u32 s44, s44, s100
ds_read_b64_tr_b16 a[184:185], v75 offset:16392
M v[200:203], a[172:175], v[28:31], v[200:203]
buffer_load_dwordx4 a[248:251], v69, s[12:15], s63 offen offset:2048 nt
M v[204:207], a[168:171], v[32:35], v[204:207]
ds_read_b64_tr_b16 a[186:187], v75 offset:16904
M v[204:207], a[172:175], v[36:39], v[204:207]
ds_read_b64_tr_b16 a[188:189], v75 offset:20488
M v[208:211], a[168:171], v[40:43], v[208:211]
ds_read_b64_tr_b16 a[190:191], v75 offset:21000
M v[208:211], a[172:175], v[44:47], v[208:211]
buffer_load_dwordx4 a[252:255], v70, s[12:15], s63 offen offset:3072 nt
M v[212:215], a[168:171], v[48:51], v[212:215]
M v[212:215], a[172:175], v[52:55], v[212:215]
s_waitcnt lgkmcnt(15)
M v[216:219], a[176:179], v[16:19], v[216:219]
s_waitcnt lgkmcnt(14)
M v[216:219], a[180:183], v[20:23], v[216:219]
M v[220:223], a[176:179], v[24:27], v[220:223]
M v[220:223], a[180:183], v[28:31], v[220:223]
M v[224:227], a[176:179], v[32:35], v[224:227]
s_waitcnt vmcnt(8) lgkmcnt(0)
M v[224:227], a[180:183], v[36:39], v[224:227]
s_barrier
ds_read_b64_tr_b16 a[160:161], v74 offset:32768
M v[228:231], a[176:179], v[40:43], v[228:231]
buffer_load_dwordx4 v73, s[8:11], s48 offen lds
M v[228:231], a[180:183], v[44:47], v[228:231]
s_add_u32 m0, s36, 115712
ds_read_b64_tr_b16 a[162:163], v74 offset:33280
M v[232:235], a[176:179], v[48:51], v[232:235]
ds_read_b64_tr_b16 a[164:165], v74 offset:36864
M v[232:235], a[180:183], v[52:55], v[232:235]
ds_read_b64_tr_b16 a[166:167], v74 offset:37376
M v[236:239], a[184:187], v[16:19], v[236:239]
buffer_load_dwordx4 v73, s[8:11], s49 offen lds
M v[236:239], a[188:191], v[20:23], v[236:239]
s_add_u32 m0, s36, 116736
ds_read_b64_tr_b16 a[168:169], v74 offset:32776
M v[240:243], a[184:187], v[24:27], v[240:243]
ds_read_b64_tr_b16 a[170:171], v74 offset:33288
M v[240:243], a[188:191], v[28:31], v[240:243]
s_add_u32 s45, s43, 24576
ds_read_b64_tr_b16 a[172:173], v74 offset:36872
M v[244:247], a[184:187], v[32:35], v[244:247]
s_and_b32 s45, s45, 131071
ds_read_b64_tr_b16 a[174:175], v74 offset:37384
M v[244:247], a[188:191], v[36:39], v[244:247]
s_add_u32 s45, s45, s100
buffer_load_dwordx4 v73, s[8:11], s50 offen lds
M v[248:251], a[184:187], v[40:43], v[248:251]
s_add_u32 m0, s36, 117760
ds_read_b64_tr_b16 a[176:177], v75 offset:32768
M v[248:251], a[188:191], v[44:47], v[248:251]
ds_read_b64_tr_b16 a[178:179], v75 offset:33280
M v[252:255], a[184:187], v[48:51], v[252:255]
ds_read_b64_tr_b16 a[180:181], v75 offset:36864
M v[252:255], a[188:191], v[52:55], v[252:255]
s_waitcnt lgkmcnt(9)
ds_read_b64_tr_b16 a[182:183], v75 offset:37376
M v[96:99], a[160:163], a[40:43], v[96:99]
s_waitcnt lgkmcnt(8)
buffer_load_dwordx4 v73, s[8:11], s51 offen lds
M v[96:99], a[164:167], a[44:47], v[96:99]
s_add_u32 m0, s36, 32768
ds_read_b64_tr_b16 a[184:185], v75 offset:32776
M v[100:103], a[160:163], a[48:51], v[100:103]
ds_read_b64_tr_b16 a[186:187], v75 offset:33288
M v[100:103], a[164:167], a[52:55], v[100:103]
ds_read_b64_tr_b16 a[188:189], v75 offset:36872
M v[104:107], a[160:163], a[56:59], v[104:107]
buffer_load_dwordx4 v69, s[12:15], s44 offen nt lds
M v[104:107], a[164:167], a[60:63], v[104:107]
ds_read_b64_tr_b16 a[190:191], v75 offset:37384
M v[108:111], a[160:163], a[64:67], v[108:111]
ds_read_b128 v[16:19], v82 offset:0
M v[108:111], a[164:167], a[68:71], v[108:111]
ds_read_b128 v[20:23], v83 offset:0
M v[112:115], a[160:163], a[72:75], v[112:115]
ds_read_b128 v[24:27], v82 offset:2048
M v[112:115], a[164:167], a[76:79], v[112:115]
s_waitcnt lgkmcnt(13)
buffer_load_dwordx4 v70, s[12:15], s44 offen offset:1024 nt lds
M v[116:119], a[168:171], a[40:43], v[116:119]
s_waitcnt lgkmcnt(11)
ds_read_b128 v[28:31], v83 offset:2048
M v[116:119], a[172:175], a[44:47], v[116:119]
ds_read_b128 v[32:35], v82 offset:4096
M v[120:123], a[168:171], a[48:51], v[120:123]
ds_read_b128 v[36:39], v83 offset:4096
M v[120:123], a[172:175], a[52:55], v[120:123]
ds_read_b128 v[40:43], v82 offset:6144
M v[124:127], a[168:171], a[56:59], v[124:127]
buffer_load_dwordx4 v69, s[12:15], s44 offen offset:2048 nt lds
M v[124:127], a[172:175], a[60:63], v[124:127]
ds_read_b128 v[44:47], v83 offset:6144
M v[128:131], a[168:171], a[64:67], v[128:131]
ds_read_b128 v[48:51], v82 offset:8192
M v[128:131], a[172:175], a[68:71], v[128:131]
ds_read_b128 v[52:55], v83 offset:8192
M v[132:135], a[168:171], a[72:75], v[132:135]
M v[132:135], a[172:175], a[76:79], v[132:135]
s_waitcnt lgkmcnt(15)
buffer_load_dwordx4 v70, s[12:15], s44 offen offset:3072 nt lds
M v[136:139], a[176:179], a[40:43], v[136:139]
s_waitcnt lgkmcnt(14)
M v[136:139], a[180:183], a[44:47], v[136:139]
s_add_u32 m0, s36, 49152
M v[140:143], a[176:179], a[48:51], v[140:143]
M v[140:143], a[180:183], a[52:55], v[140:143]
M v[144:147], a[176:179], a[56:59], v[144:147]
M v[144:147], a[180:183], a[60:63], v[144:147]
s_waitcnt lgkmcnt(0)
M v[148:151], a[176:179], a[64:67], v[148:151]
s_barrier
ds_read_b64_tr_b16 a[160:161], v74 offset:49152
M v[148:151], a[180:183], a[68:71], v[148:151]
ds_read_b64_tr_b16 a[162:163], v74 offset:49664
M v[152:155], a[176:179], a[72:75], v[152:155]
ds_read_b64_tr_b16 a[164:165], v74 offset:53248
M v[152:155], a[180:183], a[76:79], v[152:155]
ds_read_b64_tr_b16 a[166:167], v74 offset:53760
M v[156:159], a[184:187], a[40:43], v[156:159]
buffer_load_dwordx4 v69, s[12:15], s45 offen nt lds
M v[156:159], a[188:191], a[44:47], v[156:159]
ds_read_b64_tr_b16 a[168:169], v74 offset:49160
M v[160:163], a[184:187], a[48:51], v[160:163]
ds_read_b64_tr_b16 a[170:171], v74 offset:49672
M v[160:163], a[188:191], a[52:55], v[160:163]
s_add_u32 s46, s43, 8192
ds_read_b64_tr_b16 a[172:173], v74 offset:53256
M v[164:167], a[184:187], a[56:59], v[164:167]
s_and_b32 s46, s46, 131071
ds_read_b64_tr_b16 a[174:175], v74 offset:53768
M v[164:167], a[188:191], a[60:63], v[164:167]
s_add_u32 s46, s46, s100
buffer_load_dwordx4 v70, s[12:15], s45 offen offset:1024 nt lds
M v[168:171], a[184:187], a[64:67], v[168:171]
ds_read_b64_tr_b16 a[176:177], v75 offset:49152
M v[168:171], a[188:191], a[68:71], v[168:171]
ds_read_b64_tr_b16 a[178:179], v75 offset:49664
M v[172:175], a[184:187], a[72:75], v[172:175]
ds_read_b64_tr_b16 a[180:181], v75 offset:53248
M v[172:175], a[188:191], a[76:79], v[172:175]
s_waitcnt lgkmcnt(9)
ds_read_b64_tr_b16 a[182:183], v75 offset:53760
M v[96:99], a[160:163], v[16:19], v[96:99]
s_waitcnt lgkmcnt(8)
ds_read_b64_tr_b16 a[184:185], v75 offset:49160
M v[96:99], a[164:167], v[20:23], v[96:99]
ds_read_b64_tr_b16 a[186:187], v75 offset:49672
M v[100:103], a[160:163], v[24:27], v[100:103]
ds_read_b64_tr_b16 a[188:189], v75 offset:53256
M v[100:103], a[164:167], v[28:31], v[100:103]
ds_read_b64_tr_b16 a[190:191], v75 offset:53768
M v[104:107], a[160:163], v[32:35], v[104:107]
buffer_load_dwordx4 v69, s[12:15], s45 offen offset:2048 nt lds
M v[104:107], a[164:167], v[36:39], v[104:107]
v_mul_f32 v96, s41, v96
v_mul_f32 v97, s41, v97
M v[108:111], a[160:163], v[40:43], v[108:111]
v_mul_f32 v98, s41, v98
v_mul_f32 v99, s41, v99
M v[108:111], a[164:167], v[44:47], v[108:111]
v_cvt_pk_bf16_f32 v96, v96, v97
v_mul_f32 v100, s41, v100
M v[112:115], a[160:163], v[48:51], v[112:115]
v_accvgpr_write_b32 a0, v96
v_cvt_pk_bf16_f32 v97, v98, v99
M v[112:115], a[164:167], v[52:55], v[112:115]
s_waitcnt lgkmcnt(10)
v_accvgpr_write_b32 a1, v97
v_mul_f32 v101, s41, v101
M v[116:119], a[168:171], v[16:19], v[116:119]
s_waitcnt lgkmcnt(8)
v_mul_f32 v102, s41, v102
v_mul_f32 v103, s41, v103
M v[116:119], a[172:175], v[20:23], v[116:119]
v_cvt_pk_bf16_f32 v100, v100, v101
v_mul_f32 v104, s41, v104
M v[120:123], a[168:171], v[24:27], v[120:123]
v_accvgpr_write_b32 a4, v100
v_cvt_pk_bf16_f32 v101, v102, v103
M v[120:123], a[172:175], v[28:31], v[120:123]
v_accvgpr_write_b32 a5, v101
v_mul_f32 v105, s41, v105
M v[124:127], a[168:171], v[32:35], v[124:127]
buffer_load_dwordx4 v70, s[12:15], s45 offen offset:3072 nt lds
M v[124:127], a[172:175], v[36:39], v[124:127]
v_mul_f32 v116, s41, v116
v_mul_f32 v117, s41, v117
M v[128:131], a[168:171], v[40:43], v[128:131]
v_mul_f32 v118, s41, v118
v_mul_f32 v119, s41, v119
M v[128:131], a[172:175], v[44:47], v[128:131]
v_cvt_pk_bf16_f32 v116, v116, v117
v_mul_f32 v120, s41, v120
M v[132:135], a[168:171], v[48:51], v[132:135]
v_accvgpr_write_b32 a2, v116
v_cvt_pk_bf16_f32 v117, v118, v119
M v[132:135], a[172:175], v[52:55], v[132:135]
s_waitcnt lgkmcnt(6)
v_accvgpr_write_b32 a3, v117
v_mul_f32 v121, s41, v121
M v[136:139], a[176:179], v[16:19], v[136:139]
s_waitcnt lgkmcnt(4)
v_mul_f32 v122, s41, v122
v_mul_f32 v123, s41, v123
M v[136:139], a[180:183], v[20:23], v[136:139]
v_cvt_pk_bf16_f32 v120, v120, v121
v_mul_f32 v124, s41, v124
M v[140:143], a[176:179], v[24:27], v[140:143]
v_accvgpr_write_b32 a6, v120
v_cvt_pk_bf16_f32 v121, v122, v123
M v[140:143], a[180:183], v[28:31], v[140:143]
s_waitcnt vmcnt(16) lgkmcnt(0)
v_accvgpr_write_b32 a7, v121
v_mul_f32 v125, s41, v125
M v[144:147], a[176:179], v[32:35], v[144:147]
s_barrier
ds_read_b64_tr_b16 a[160:161], v74 offset:0
v_mul_f32 v136, s41, v136
M v[144:147], a[180:183], v[36:39], v[144:147]
s_add_u32 m0, s36, 81920
ds_read_b64_tr_b16 a[162:163], v74 offset:512
v_mul_f32 v137, s41, v137
M v[148:151], a[176:179], v[40:43], v[148:151]
ds_read_b64_tr_b16 a[164:165], v74 offset:4096
v_mul_f32 v138, s41, v138
M v[148:151], a[180:183], v[44:47], v[148:151]
ds_read_b64_tr_b16 a[166:167], v74 offset:4608
v_mul_f32 v139, s41, v139
M v[152:155], a[176:179], v[48:51], v[152:155]
buffer_load_dwordx4 v69, s[16:19], s46 offen nt lds
M v[152:155], a[180:183], v[52:55], v[152:155]
ds_read_b64_tr_b16 a[168:169], v74 offset:8
v_cvt_pk_bf16_f32 v136, v136, v137
M v[156:159], a[184:187], v[16:19], v[156:159]
ds_read_b64_tr_b16 a[170:171], v74 offset:520
v_cvt_pk_bf16_f32 v137, v138, v139
M v[156:159], a[188:191], v[20:23], v[156:159]
ds_read_b64_tr_b16 a[172:173], v74 offset:4104
v_accvgpr_write_b32 a20, v136
M v[160:163], a[184:187], v[24:27], v[160:163]
ds_read_b64_tr_b16 a[174:175], v74 offset:4616
v_accvgpr_write_b32 a21, v137
M v[160:163], a[188:191], v[28:31], v[160:163]
s_add_u32 s47, s43, 16384
ds_read_b64_tr_b16 a[176:177], v75 offset:0
v_mul_f32 v140, s41, v140
M v[164:167], a[184:187], v[32:35], v[164:167]
s_and_b32 s47, s47, 131071
ds_read_b64_tr_b16 a[178:179], v75 offset:512
v_mul_f32 v156, s41, v156
M v[164:167], a[188:191], v[36:39], v[164:167]
s_add_u32 s47, s47, s100
buffer_load_dwordx4 v70, s[16:19], s46 offen offset:1024 nt lds
M v[168:171], a[184:187], v[40:43], v[168:171]
ds_read_b64_tr_b16 a[180:181], v75 offset:4096
v_mul_f32 v157, s41, v157
M v[168:171], a[188:191], v[44:47], v[168:171]
ds_read_b64_tr_b16 a[182:183], v75 offset:4608
v_mul_f32 v158, s41, v158
M v[172:175], a[184:187], v[48:51], v[172:175]
ds_read_b64_tr_b16 a[184:185], v75 offset:8
v_mul_f32 v159, s41, v159
M v[172:175], a[188:191], v[52:55], v[172:175]
s_waitcnt lgkmcnt(11)
ds_read_b64_tr_b16 a[186:187], v75 offset:520
v_cvt_pk_bf16_f32 v156, v156, v157
M v[176:179], a[160:163], a[40:43], v[176:179]
s_waitcnt lgkmcnt(10)
ds_read_b64_tr_b16 a[188:189], v75 offset:4104
v_cvt_pk_bf16_f32 v157, v158, v159
M v[176:179], a[164:167], a[44:47], v[176:179]
ds_read_b64_tr_b16 a[190:191], v75 offset:4616
v_accvgpr_write_b32 a22, v156
M v[180:183], a[160:163], a[48:51], v[180:183]
v_accvgpr_write_b32 a23, v157
v_mul_f32 v141, s41, v141
M v[180:183], a[164:167], a[52:55], v[180:183]
v_mul_f32 v160, s41, v160
v_mul_f32 v161, s41, v161
M v[184:187], a[160:163], a[56:59], v[184:187]
buffer_load_dwordx4 v69, s[16:19], s46 offen offset:2048 nt lds
M v[184:187], a[164:167], a[60:63], v[184:187]
v_mul_f32 v142, s41, v142
v_mul_f32 v143, s41, v143
M v[188:191], a[160:163], a[64:67], v[188:191]
v_cvt_pk_bf16_f32 v140, v140, v141
v_mul_f32 v162, s41, v162
M v[188:191], a[164:167], a[68:71], v[188:191]
v_mul_f32 v163, s41, v163
v_cvt_pk_bf16_f32 v160, v160, v161
M v[192:195], a[160:163], a[72:75], v[192:195]
v_cvt_pk_bf16_f32 v141, v142, v143
v_cvt_pk_bf16_f32 v161, v162, v163
M v[192:195], a[164:167], a[76:79], v[192:195]
s_waitcnt lgkmcnt(10)
v_accvgpr_write_b32 a24, v140
v_accvgpr_write_b32 a25, v141
M v[196:199], a[168:171], a[40:43], v[196:199]
s_waitcnt lgkmcnt(8)
v_accvgpr_write_b32 a26, v160
v_accvgpr_write_b32 a27, v161
M v[196:199], a[172:175], a[44:47], v[196:199]
v_mul_f32 v106, s41, v106
v_mul_f32 v107, s41, v107
M v[200:203], a[168:171], a[48:51], v[200:203]
v_cvt_pk_bf16_f32 v104, v104, v105
v_mul_f32 v126, s41, v126
M v[200:203], a[172:175], a[52:55], v[200:203]
v_mul_f32 v127, s41, v127
v_cvt_pk_bf16_f32 v124, v124, v125
M v[204:207], a[168:171], a[56:59], v[204:207]
buffer_load_dwordx4 v70, s[16:19], s46 offen offset:3072 nt lds
M v[204:207], a[172:175], a[60:63], v[204:207]
v_mul_f32 v144, s41, v144
v_mul_f32 v145, s41, v145
M v[208:211], a[168:171], a[64:67], v[208:211]
v_mul_f32 v164, s41, v164
v_mul_f32 v165, s41, v165
M v[208:211], a[172:175], a[68:71], v[208:211]
v_cvt_pk_bf16_f32 v105, v106, v107
v_cvt_pk_bf16_f32 v125, v126, v127
M v[212:215], a[168:171], a[72:75], v[212:215]
v_mul_f32 v146, s41, v146
v_mul_f32 v147, s41, v147
M v[212:215], a[172:175], a[76:79], v[212:215]
s_waitcnt lgkmcnt(6)
v_cvt_pk_bf16_f32 v144, v144, v145
v_mul_f32 v166, s41, v166
M v[216:219], a[176:179], a[40:43], v[216:219]
s_waitcnt lgkmcnt(4)
v_mul_f32 v167, s41, v167
v_cvt_pk_bf16_f32 v164, v164, v165
M v[216:219], a[180:183], a[44:47], v[216:219]
v_accvgpr_write_b32 a8, v104
v_accvgpr_write_b32 a9, v105
M v[220:223], a[176:179], a[48:51], v[220:223]
v_accvgpr_write_b32 a10, v124
v_accvgpr_write_b32 a11, v125
M v[220:223], a[180:183], a[52:55], v[220:223]
s_waitcnt vmcnt(12) lgkmcnt(0)
v_cvt_pk_bf16_f32 v145, v146, v147
v_cvt_pk_bf16_f32 v165, v166, v167
M v[224:227], a[176:179], a[56:59], v[224:227]
s_barrier
ds_read_b64_tr_b16 a[160:161], v74 offset:16384
v_accvgpr_write_b32 a28, v144
M v[224:227], a[180:183], a[60:63], v[224:227]
s_add_u32 m0, s36, 98304
ds_read_b64_tr_b16 a[162:163], v74 offset:16896
v_accvgpr_write_b32 a29, v145
M v[228:231], a[176:179], a[64:67], v[228:231]
ds_read_b64_tr_b16 a[164:165], v74 offset:20480
v_accvgpr_write_b32 a30, v164
M v[228:231], a[180:183], a[68:71], v[228:231]
ds_read_b64_tr_b16 a[166:167], v74 offset:20992
v_accvgpr_write_b32 a31, v165
M v[232:235], a[176:179], a[72:75], v[232:235]
buffer_load_dwordx4 v69, s[16:19], s47 offen nt lds
M v[232:235], a[180:183], a[76:79], v[232:235]
ds_read_b64_tr_b16 a[168:169], v74 offset:16392
v_mul_f32 v108, s41, v108
M v[236:239], a[184:187], a[40:43], v[236:239]
ds_read_b64_tr_b16 a[170:171], v74 offset:16904
v_mul_f32 v109, s41, v109
M v[236:239], a[188:191], a[44:47], v[236:239]
ds_read_b64_tr_b16 a[172:173], v74 offset:20488
v_mul_f32 v128, s41, v128
M v[240:243], a[184:187], a[48:51], v[240:243]
ds_read_b64_tr_b16 a[174:175], v74 offset:21000
v_mul_f32 v129, s41, v129
M v[240:243], a[188:191], a[52:55], v[240:243]
ds_read_b64_tr_b16 a[176:177], v75 offset:16384
v_mul_f32 v110, s41, v110
M v[244:247], a[184:187], a[56:59], v[244:247]
ds_read_b64_tr_b16 a[178:179], v75 offset:16896
v_mul_f32 v111, s41, v111
M v[244:247], a[188:191], a[60:63], v[244:247]
buffer_load_dwordx4 v70, s[16:19], s47 offen offset:1024 nt lds
M v[248:251], a[184:187], a[64:67], v[248:251]
ds_read_b64_tr_b16 a[180:181], v75 offset:20480
v_cvt_pk_bf16_f32 v108, v108, v109
M v[248:251], a[188:191], a[68:71], v[248:251]
ds_read_b64_tr_b16 a[182:183], v75 offset:20992
v_mul_f32 v130, s41, v130
M v[252:255], a[184:187], a[72:75], v[252:255]
ds_read_b64_tr_b16 a[184:185], v75 offset:16392
v_mul_f32 v131, s41, v131
M v[252:255], a[188:191], a[76:79], v[252:255]
s_waitcnt lgkmcnt(11)
ds_read_b64_tr_b16 a[186:187], v75 offset:16904
v_cvt_pk_bf16_f32 v128, v128, v129
M v[176:179], a[160:163], v[16:19], v[176:179]
s_waitcnt lgkmcnt(10)
ds_read_b64_tr_b16 a[188:189], v75 offset:20488
v_mul_f32 v148, s41, v148
M v[176:179], a[164:167], v[20:23], v[176:179]
ds_read_b64_tr_b16 a[190:191], v75 offset:21000
v_mul_f32 v149, s41, v149
M v[180:183], a[160:163], v[24:27], v[180:183]
v_mul_f32 v168, s41, v168
v_mul_f32 v169, s41, v169
M v[180:183], a[164:167], v[28:31], v[180:183]
v_cvt_pk_bf16_f32 v109, v110, v111
v_cvt_pk_bf16_f32 v129, v130, v131
M v[184:187], a[160:163], v[32:35], v[184:187]
L_hop_b5:
s_cbranch_execz L_ret_b5
buffer_load_dwordx4 v69, s[16:19], s47 offen offset:2048 nt lds
M v[184:187], a[164:167], v[36:39], v[184:187]
v_mul_f32 v176, s41, v176
v_mul_f32 v177, s41, v177
M v[188:191], a[160:163], v[40:43], v[188:191]
s_add_u32 s48, s43, 24576
v_mul_f32 v178, s41, v178
v_mul_f32 v179, s41, v179
M v[188:191], a[164:167], v[44:47], v[188:191]
s_and_b32 s48, s48, 131071
v_cvt_pk_bf16_f32 v176, v176, v177
v_mul_f32 v180, s41, v180
M v[192:195], a[160:163], v[48:51], v[192:195]
s_add_u32 s48, s48, s100
v_accvgpr_write_b32 a40, v176
v_cvt_pk_bf16_f32 v177, v178, v179
M v[192:195], a[164:167], v[52:55], v[192:195]
s_waitcnt lgkmcnt(10)
v_accvgpr_write_b32 a41, v177
v_mul_f32 v181, s41, v181
M v[196:199], a[168:171], v[16:19], v[196:199]
s_waitcnt lgkmcnt(8)
v_mul_f32 v182, s41, v182
v_mul_f32 v183, s41, v183
M v[196:199], a[172:175], v[20:23], v[196:199]
v_cvt_pk_bf16_f32 v180, v180, v181
v_mul_f32 v184, s41, v184
M v[200:203], a[168:171], v[24:27], v[200:203]
v_accvgpr_write_b32 a44, v180
v_cvt_pk_bf16_f32 v181, v182, v183
M v[200:203], a[172:175], v[28:31], v[200:203]
v_accvgpr_write_b32 a45, v181
v_mul_f32 v185, s41, v185
M v[204:207], a[168:171], v[32:35], v[204:207]
buffer_load_dwordx4 v70, s[16:19], s47 offen offset:3072 nt lds
M v[204:207], a[172:175], v[36:39], v[204:207]
v_mul_f32 v196, s41, v196
v_mul_f32 v197, s41, v197
M v[208:211], a[168:171], v[40:43], v[208:211]
v_mul_f32 v198, s41, v198
v_mul_f32 v199, s41, v199
M v[208:211], a[172:175], v[44:47], v[208:211]
v_cvt_pk_bf16_f32 v196, v196, v197
v_mul_f32 v200, s41, v200
M v[212:215], a[168:171], v[48:51], v[212:215]
v_accvgpr_write_b32 a42, v196
v_cvt_pk_bf16_f32 v197, v198, v199
v_accvgpr_write_b32 a43, v197
v_mul_f32 v201, s41, v201
v_mul_f32 v202, s41, v202
v_mul_f32 v203, s41, v203
v_cvt_pk_bf16_f32 v200, v200, v201
v_cvt_pk_bf16_f32 v201, v202, v203
M v[212:215], a[172:175], v[52:55], v[212:215]
s_waitcnt lgkmcnt(6)
v_accvgpr_write_b32 a46, v200
v_accvgpr_write_b32 a47, v201
s_add_u32 m0, s36, 114688
v_mul_f32 v204, s41, v204
v_mul_f32 v205, s41, v205
v_mul_f32 v186, s41, v186
v_mul_f32 v187, s41, v187
v_cvt_pk_bf16_f32 v184, v184, v185
M v[216:219], a[176:179], v[16:19], v[216:219]
s_waitcnt lgkmcnt(4)
v_mul_f32 v206, s41, v206
v_mul_f32 v207, s41, v207
v_cvt_pk_bf16_f32 v204, v204, v205
v_cvt_pk_bf16_f32 v185, v186, v187
v_cvt_pk_bf16_f32 v205, v206, v207
v_accvgpr_write_b32 a48, v184
v_accvgpr_write_b32 a49, v185
v_accvgpr_write_b32 a50, v204
M v[216:219], a[180:183], v[20:23], v[216:219]
v_accvgpr_write_b32 a51, v205
v_mul_f32 v150, s41, v150
v_mul_f32 v151, s41, v151
v_cvt_pk_bf16_f32 v148, v148, v149
v_mul_f32 v170, s41, v170
v_mul_f32 v171, s41, v171
v_cvt_pk_bf16_f32 v168, v168, v169
v_accvgpr_write_b32 a12, v108
M v[220:223], a[176:179], v[24:27], v[220:223]
v_mul_f32 v216, s41, v216
v_mul_f32 v217, s41, v217
v_mul_f32 v218, s41, v218
v_mul_f32 v219, s41, v219
v_cvt_pk_bf16_f32 v216, v216, v217
v_cvt_pk_bf16_f32 v217, v218, v219
v_accvgpr_write_b32 a60, v216
v_accvgpr_write_b32 a61, v217
M v[220:223], a[180:183], v[28:31], v[220:223]
v_accvgpr_write_b32 a13, v109
v_accvgpr_write_b32 a14, v128
v_accvgpr_write_b32 a15, v129
v_mul_f32 v188, s41, v188
v_mul_f32 v189, s41, v189
v_mul_f32 v208, s41, v208
v_mul_f32 v209, s41, v209
v_cvt_pk_bf16_f32 v149, v150, v151
M v[224:227], a[176:179], v[32:35], v[224:227]
v_mul_f32 v220, s41, v220
v_mul_f32 v221, s41, v221
v_mul_f32 v222, s41, v222
v_mul_f32 v223, s41, v223
v_cvt_pk_bf16_f32 v220, v220, v221
v_cvt_pk_bf16_f32 v221, v222, v223
v_accvgpr_write_b32 a64, v220
v_accvgpr_write_b32 a65, v221
M v[224:227], a[180:183], v[36:39], v[224:227]
s_waitcnt lgkmcnt(0)
v_cvt_pk_bf16_f32 v169, v170, v171
v_mul_f32 v190, s41, v190
v_mul_f32 v191, s41, v191
v_cvt_pk_bf16_f32 v188, v188, v189
v_mul_f32 v210, s41, v210
v_mul_f32 v211, s41, v211
v_cvt_pk_bf16_f32 v208, v208, v209
v_accvgpr_write_b32 a32, v148
M v[228:231], a[176:179], v[40:43], v[228:231]
s_barrier
ds_read_b128 a[160:163], v57 offset:0
v_mul_f32 v224, s41, v224
v_mul_f32 v225, s41, v225
v_mul_f32 v226, s41, v226
v_mul_f32 v227, s41, v227
v_cvt_pk_bf16_f32 v224, v224, v225
v_cvt_pk_bf16_f32 v225, v226, v227
v_accvgpr_write_b32 a68, v224
M v[228:231], a[180:183], v[44:47], v[228:231]
ds_read_b128 a[164:167], v58 offset:0
v_accvgpr_write_b32 a69, v225
v_accvgpr_write_b32 a33, v149
v_accvgpr_write_b32 a34, v168
v_accvgpr_write_b32 a35, v169
v_cvt_pk_bf16_f32 v189, v190, v191
v_cvt_pk_bf16_f32 v209, v210, v211
v_accvgpr_write_b32 a52, v188
M v[232:235], a[176:179], v[48:51], v[232:235]
ds_read_b128 a[168:171], v59 offset:0
v_mul_f32 v228, s41, v228
v_mul_f32 v229, s41, v229
v_mul_f32 v230, s41, v230
v_mul_f32 v231, s41, v231
v_cvt_pk_bf16_f32 v228, v228, v229
v_accvgpr_write_b32 a53, v189
v_accvgpr_write_b32 a54, v208
M v[232:235], a[180:183], v[52:55], v[232:235]
ds_read_b128 a[172:175], v60 offset:0
v_accvgpr_write_b32 a55, v209
v_mul_f32 v112, s41, v112
v_mul_f32 v113, s41, v113
v_mul_f32 v132, s41, v132
v_mul_f32 v133, s41, v133
v_cvt_pk_bf16_f32 v229, v230, v231
v_mul_f32 v114, s41, v114
M v[236:239], a[184:187], v[16:19], v[236:239]
ds_read_b128 a[176:179], v57 offset:4096
v_mul_f32 v115, s41, v115
v_cvt_pk_bf16_f32 v112, v112, v113
v_mul_f32 v134, s41, v134
v_mul_f32 v135, s41, v135
v_cvt_pk_bf16_f32 v132, v132, v133
v_accvgpr_write_b32 a72, v228
v_accvgpr_write_b32 a73, v229
M v[236:239], a[188:191], v[20:23], v[236:239]
ds_read_b128 a[180:183], v58 offset:4096
v_mul_f32 v152, s41, v152
v_mul_f32 v153, s41, v153
v_mul_f32 v172, s41, v172
v_mul_f32 v173, s41, v173
v_cvt_pk_bf16_f32 v113, v114, v115
v_cvt_pk_bf16_f32 v133, v134, v135
v_mul_f32 v154, s41, v154
M v[240:243], a[184:187], v[24:27], v[240:243]
v_mul_f32 v236, s41, v236
v_mul_f32 v237, s41, v237
v_mul_f32 v238, s41, v238
v_mul_f32 v239, s41, v239
v_cvt_pk_bf16_f32 v236, v236, v237
v_cvt_pk_bf16_f32 v237, v238, v239
v_accvgpr_write_b32 a62, v236
v_accvgpr_write_b32 a63, v237
M v[240:243], a[188:191], v[28:31], v[240:243]
v_mul_f32 v155, s41, v155
v_cvt_pk_bf16_f32 v152, v152, v153
v_mul_f32 v174, s41, v174
v_mul_f32 v175, s41, v175
v_cvt_pk_bf16_f32 v172, v172, v173
v_accvgpr_write_b32 a16, v112
v_accvgpr_write_b32 a17, v113
v_accvgpr_write_b32 a18, v132
M v[244:247], a[184:187], v[32:35], v[244:247]
v_mul_f32 v240, s41, v240
v_mul_f32 v241, s41, v241
v_mul_f32 v242, s41, v242
v_mul_f32 v243, s41, v243
v_cvt_pk_bf16_f32 v240, v240, v241
v_cvt_pk_bf16_f32 v241, v242, v243
v_accvgpr_write_b32 a66, v240
v_accvgpr_write_b32 a67, v241
M v[244:247], a[188:191], v[36:39], v[244:247]
v_accvgpr_write_b32 a19, v133
v_mul_f32 v192, s41, v192
v_mul_f32 v193, s41, v193
v_mul_f32 v212, s41, v212
v_mul_f32 v213, s41, v213
v_cvt_pk_bf16_f32 v153, v154, v155
v_cvt_pk_bf16_f32 v173, v174, v175
v_mul_f32 v194, s41, v194
M v[248:251], a[184:187], v[40:43], v[248:251]
v_mul_f32 v244, s41, v244
v_mul_f32 v245, s41, v245
v_mul_f32 v246, s41, v246
v_mul_f32 v247, s41, v247
v_cvt_pk_bf16_f32 v244, v244, v245
v_cvt_pk_bf16_f32 v245, v246, v247
v_accvgpr_write_b32 a70, v244
v_accvgpr_write_b32 a71, v245
M v[248:251], a[188:191], v[44:47], v[248:251]
v_mul_f32 v195, s41, v195
v_cvt_pk_bf16_f32 v192, v192, v193
v_mul_f32 v214, s41, v214
v_mul_f32 v215, s41, v215
v_cvt_pk_bf16_f32 v212, v212, v213
v_accvgpr_write_b32 a36, v152
v_accvgpr_write_b32 a37, v153
v_accvgpr_write_b32 a38, v172
M v[252:255], a[184:187], v[48:51], v[252:255]
v_mul_f32 v248, s41, v248
v_mul_f32 v249, s41, v249
v_mul_f32 v250, s41, v250
v_mul_f32 v251, s41, v251
v_cvt_pk_bf16_f32 v248, v248, v249
v_cvt_pk_bf16_f32 v249, v250, v251
v_accvgpr_write_b32 a74, v248
v_accvgpr_write_b32 a75, v249
M v[252:255], a[188:191], v[52:55], v[252:255]
s_waitcnt lgkmcnt(5)
ds_read_b128 a[184:187], v59 offset:4096
v_accvgpr_write_b32 a39, v173
v_mul_f32 v232, s41, v232
v_mul_f32 v233, s41, v233
v_cvt_pk_bf16_f32 v193, v194, v195
v_cvt_pk_bf16_f32 v213, v214, v215
v_mul_f32 v234, s41, v234
v_mul_f32 v235, s41, v235
M v[0:3], a[160:163], a[0:3], 0
s_waitcnt lgkmcnt(5)
buffer_load_dwordx4 v69, s[16:19], s48 offen nt lds
ds_read_b128 a[188:191], v60 offset:4096
v_mul_f32 v252, s41, v252
v_mul_f32 v253, s41, v253
v_cvt_pk_bf16_f32 v232, v232, v233
v_mul_f32 v254, s41, v254
v_mul_f32 v255, s41, v255
M v[0:3], a[164:167], a[20:23], v[0:3]
s_waitcnt lgkmcnt(5)
v_accvgpr_write_b32 a56, v192
v_cvt_pk_bf16_f32 v252, v252, v253
v_accvgpr_write_b32 a57, v193
v_accvgpr_write_b32 a58, v212
v_accvgpr_write_b32 a59, v213
v_cvt_pk_bf16_f32 v233, v234, v235
v_cvt_pk_bf16_f32 v253, v254, v255
v_accvgpr_write_b32 a76, v232
M v[0:3], a[168:171], a[40:43], v[0:3]
s_waitcnt lgkmcnt(4)
v_accvgpr_write_b32 a77, v233
v_accvgpr_write_b32 a78, v252
v_accvgpr_write_b32 a79, v253
M v[0:3], a[172:175], a[60:63], v[0:3]
M v[4:7], a[160:163], a[4:7], 0
M v[4:7], a[164:167], a[24:27], v[4:7]
M v[4:7], a[168:171], a[44:47], v[4:7]
M v[4:7], a[172:175], a[64:67], v[4:7]
M v[8:11], a[160:163], a[8:11], 0
buffer_load_dwordx4 v70, s[16:19], s48 offen offset:1024 nt lds
M v[8:11], a[164:167], a[28:31], v[8:11]
M v[8:11], a[168:171], a[48:51], v[8:11]
v_exp_f32 v0, v0
v_exp_f32 v1, v1
v_exp_f32 v2, v2
v_add_f32 v90, v0, v1
v_exp_f32 v3, v3
v_add_f32 v90, v90, v2
v_cvt_pk_bf16_f32 v16, v0, v1
M v[8:11], a[172:175], a[68:71], v[8:11]
v_cvt_pk_bf16_f32 v17, v2, v3
v_add_f32 v90, v90, v3
v_exp_f32 v4, v4
v_exp_f32 v5, v5
v_exp_f32 v6, v6
v_add_f32 v91, v4, v5
v_exp_f32 v7, v7
v_add_f32 v91, v91, v6
M v[12:15], a[160:163], a[12:15], 0
v_cvt_pk_bf16_f32 v20, v4, v5
v_cvt_pk_bf16_f32 v21, v6, v7
v_add_f32 v91, v91, v7
v_exp_f32 v8, v8
v_exp_f32 v9, v9
v_exp_f32 v10, v10
v_add_f32 v92, v8, v9
v_exp_f32 v11, v11
M v[12:15], a[164:167], a[32:35], v[12:15]
v_cvt_pk_bf16_f32 v24, v8, v9
v_add_f32 v92, v92, v10
v_cvt_pk_bf16_f32 v25, v10, v11
v_add_f32 v92, v92, v11
M v[12:15], a[168:171], a[52:55], v[12:15]
M v[12:15], a[172:175], a[72:75], v[12:15]
buffer_load_dwordx4 v69, s[16:19], s48 offen offset:2048 nt lds
M v[0:3], a[160:163], a[16:19], 0
M v[0:3], a[164:167], a[36:39], v[0:3]
M v[0:3], a[168:171], a[56:59], v[0:3]
M v[0:3], a[172:175], a[76:79], v[0:3]
s_waitcnt lgkmcnt(3)
M v[4:7], a[176:179], a[0:3], 0
s_waitcnt lgkmcnt(2)
v_exp_f32 v12, v12
v_exp_f32 v13, v13
v_exp_f32 v14, v14
v_add_f32 v93, v12, v13
v_exp_f32 v15, v15
v_add_f32 v93, v93, v14
v_cvt_pk_bf16_f32 v28, v12, v13
M v[4:7], a[180:183], a[20:23], v[4:7]
s_waitcnt lgkmcnt(1)
v_cvt_pk_bf16_f32 v29, v14, v15
v_add_f32 v93, v93, v15
v_exp_f32 v0, v0
v_exp_f32 v1, v1
v_exp_f32 v2, v2
v_add_f32 v94, v0, v1
v_exp_f32 v3, v3
v_add_f32 v94, v94, v2
M v[4:7], a[184:187], a[40:43], v[4:7]
s_waitcnt lgkmcnt(0)
v_cvt_pk_bf16_f32 v32, v0, v1
v_cvt_pk_bf16_f32 v33, v2, v3
v_add_f32 v94, v94, v3
M v[4:7], a[188:191], a[60:63], v[4:7]
s_barrier
buffer_load_dwordx4 v70, s[16:19], s48 offen offset:3072 nt lds
ds_read_b128 a[160:163], v57 offset:16384
M v[8:11], a[176:179], a[4:7], 0
ds_read_b128 a[164:167], v58 offset:16384
M v[8:11], a[180:183], a[24:27], v[8:11]
ds_read_b128 a[168:171], v59 offset:16384
M v[8:11], a[184:187], a[44:47], v[8:11]
v_exp_f32 v4, v4
v_exp_f32 v5, v5
v_add_f32 v90, v90, v4
v_exp_f32 v6, v6
v_add_f32 v90, v90, v5
v_exp_f32 v7, v7
v_add_f32 v90, v90, v6
M v[8:11], a[188:191], a[64:67], v[8:11]
ds_read_b128 a[172:175], v60 offset:16384
v_cvt_pk_bf16_f32 v18, v4, v5
v_cvt_pk_bf16_f32 v19, v6, v7
v_add_f32 v90, v90, v7
M v[12:15], a[176:179], a[8:11], 0
ds_read_b64_tr_b16 a[192:193], v61 offset:0
ds_read_b64_tr_b16 a[194:195], v61 offset:4096
ds_read_b64_tr_b16 a[196:197], v62 offset:0
v_exp_f32 v8, v8
v_exp_f32 v9, v9
v_add_f32 v91, v91, v8
v_exp_f32 v10, v10
M v[12:15], a[180:183], a[28:31], v[12:15]
v_cvt_pk_bf16_f32 v22, v8, v9
v_add_f32 v91, v91, v9
v_exp_f32 v11, v11
v_add_f32 v91, v91, v10
v_cvt_pk_bf16_f32 v23, v10, v11
v_add_f32 v91, v91, v11
M v[12:15], a[184:187], a[48:51], v[12:15]
ds_read_b64_tr_b16 a[198:199], v62 offset:4096
ds_read_b64_tr_b16 a[200:201], v63 offset:0
ds_read_b64_tr_b16 a[202:203], v63 offset:4096
M v[12:15], a[188:191], a[68:71], v[12:15]
ds_read_b64_tr_b16 a[204:205], v64 offset:0
M v[0:3], a[176:179], a[12:15], 0
ds_read_b64_tr_b16 a[206:207], v64 offset:4096
M v[0:3], a[180:183], a[32:35], v[0:3]
M v[0:3], a[184:187], a[52:55], v[0:3]
M v[0:3], a[188:191], a[72:75], v[0:3]
M v[4:7], a[176:179], a[16:19], 0
s_and_b32 s62, s3, 3
ds_read_b128 a[176:179], v57 offset:20480
v_lshrrev_b32 v56, 2, v85
s_lshl_b32 s62, s62, 13
s_getpc_b64 s[4:5]
L_rw:
s_mov_b32 s6, L_end-L_rw
v_lshlrev_b32 v56, 7, v56
s_add_u32 s62, s62, L_back1-4096-L_rw
buffer_load_dword v76, v56, s[4:7], s62 offen
M v[4:7], a[180:183], a[36:39], v[4:7]
v_exp_f32 v12, v12
v_exp_f32 v13, v13
v_exp_f32 v14, v14
v_exp_f32 v15, v15
v_exp_f32 v0, v0
v_exp_f32 v1, v1
v_exp_f32 v2, v2
M v[4:7], a[184:187], a[56:59], v[4:7]
v_exp_f32 v3, v3
v_cvt_pk_bf16_f32 v26, v12, v13
v_cvt_pk_bf16_f32 v27, v14, v15
M v[4:7], a[188:191], a[76:79], v[4:7]
s_waitcnt lgkmcnt(12)
v_cvt_pk_bf16_f32 v30, v0, v1
v_cvt_pk_bf16_f32 v31, v2, v3
M v[8:11], a[160:163], a[0:3], 0
s_waitcnt lgkmcnt(11)
v_add_f32 v92, v92, v12
v_add_f32 v93, v93, v0
v_add_f32 v92, v92, v13
M v[8:11], a[164:167], a[20:23], v[8:11]
s_waitcnt lgkmcnt(10)
v_add_f32 v92, v92, v14
v_add_f32 v93, v93, v1
v_add_f32 v92, v92, v15
M v[8:11], a[168:171], a[40:43], v[8:11]
s_waitcnt lgkmcnt(9)
v_exp_f32 v4, v4
M v[8:11], a[172:175], a[60:63], v[8:11]
s_waitcnt lgkmcnt(7)
v_exp_f32 v5, v5
v_exp_f32 v6, v6
v_exp_f32 v7, v7
v_cvt_pk_bf16_f32 v34, v4, v5
v_cvt_pk_bf16_f32 v35, v6, v7
v_add_f32 v93, v93, v2
v_add_f32 v93, v93, v3
M v[96:99], a[192:195], v[16:19], 0
ds_read_b128 a[180:183], v58 offset:20480
v_add_f32 v94, v94, v4
v_add_f32 v94, v94, v5
v_add_f32 v94, v94, v6
v_add_f32 v94, v94, v7
v_exp_f32 v8, v8
v_exp_f32 v9, v9
v_add_f32 v90, v90, v8
M v[100:103], a[192:195], v[20:23], 0
v_exp_f32 v10, v10
v_add_f32 v90, v90, v9
v_exp_f32 v11, v11
v_add_f32 v90, v90, v10
v_add_f32 v90, v90, v11
v_cvt_pk_bf16_f32 v36, v8, v9
v_cvt_pk_bf16_f32 v37, v10, v11
M v[104:107], a[192:195], v[24:27], 0
ds_read_b128 a[184:187], v59 offset:20480
M v[108:111], a[192:195], v[28:31], 0
ds_read_b128 a[188:191], v60 offset:20480
M v[12:15], a[160:163], a[4:7], 0
M v[12:15], a[164:167], a[24:27], v[12:15]
M v[12:15], a[168:171], a[44:47], v[12:15]
M v[12:15], a[172:175], a[64:67], v[12:15]
M v[112:115], a[192:195], v[32:35], 0
s_waitcnt lgkmcnt(8)
ds_read_b64_tr_b16 a[192:193], v65 offset:0
ds_read_b64_tr_b16 a[194:195], v65 offset:4096
M v[116:119], a[196:199], v[16:19], 0
M v[120:123], a[196:199], v[20:23], 0
M v[124:127], a[196:199], v[24:27], 0
M v[0:3], a[160:163], a[8:11], 0
v_exp_f32 v12, v12
v_exp_f32 v13, v13
v_add_f32 v91, v91, v12
v_exp_f32 v14, v14
v_add_f32 v91, v91, v13
v_exp_f32 v15, v15
v_add_f32 v91, v91, v14
M v[0:3], a[164:167], a[28:31], v[0:3]
v_cvt_pk_bf16_f32 v40, v12, v13
v_add_f32 v91, v91, v15
v_cvt_pk_bf16_f32 v41, v14, v15
M v[0:3], a[168:171], a[48:51], v[0:3]
M v[0:3], a[172:175], a[68:71], v[0:3]
M v[128:131], a[196:199], v[28:31], 0
M v[132:135], a[196:199], v[32:35], 0
s_waitcnt lgkmcnt(8)
ds_read_b64_tr_b16 a[196:197], v66 offset:0
ds_read_b64_tr_b16 a[198:199], v66 offset:4096
M v[136:139], a[200:203], v[16:19], 0
M v[140:143], a[200:203], v[20:23], 0
M v[4:7], a[160:163], a[12:15], 0
v_exp_f32 v0, v0
v_exp_f32 v1, v1
v_add_f32 v92, v92, v0
v_exp_f32 v2, v2
v_add_f32 v92, v92, v1
v_exp_f32 v3, v3
v_add_f32 v92, v92, v2
M v[4:7], a[164:167], a[32:35], v[4:7]
v_cvt_pk_bf16_f32 v44, v0, v1
v_add_f32 v92, v92, v3
v_cvt_pk_bf16_f32 v45, v2, v3
M v[4:7], a[168:171], a[52:55], v[4:7]
M v[4:7], a[172:175], a[72:75], v[4:7]
M v[144:147], a[200:203], v[24:27], 0
M v[148:151], a[200:203], v[28:31], 0
M v[152:155], a[200:203], v[32:35], 0
s_waitcnt lgkmcnt(8)
ds_read_b64_tr_b16 a[200:201], v67 offset:0
ds_read_b64_tr_b16 a[202:203], v67 offset:4096
M v[156:159], a[204:207], v[16:19], 0
M v[8:11], a[160:163], a[16:19], 0
v_exp_f32 v4, v4
v_exp_f32 v5, v5
v_add_f32 v93, v93, v4
v_exp_f32 v6, v6
v_add_f32 v93, v93, v5
v_exp_f32 v7, v7
v_add_f32 v93, v93, v6
M v[8:11], a[164:167], a[36:39], v[8:11]
v_cvt_pk_bf16_f32 v48, v4, v5
v_add_f32 v93, v93, v7
v_cvt_pk_bf16_f32 v49, v6, v7
M v[8:11], a[168:171], a[56:59], v[8:11]
M v[8:11], a[172:175], a[76:79], v[8:11]
M v[160:163], a[204:207], v[20:23], 0
M v[164:167], a[204:207], v[24:27], 0
M v[168:171], a[204:207], v[28:31], 0
M v[172:175], a[204:207], v[32:35], 0
s_waitcnt lgkmcnt(9)
ds_read_b64_tr_b16 a[204:205], v68 offset:0
ds_read_b64_tr_b16 a[206:207], v68 offset:4096
M v[12:15], a[176:179], a[0:3], 0
s_waitcnt lgkmcnt(10)
v_and_b32 v74, 63, v85
v_lshl_add_u32 v74, v74, 4, s36
v_exp_f32 v8, v8
v_exp_f32 v9, v9
v_add_u32 v75, 65536, v74
v_add_f32 v94, v94, v8
v_exp_f32 v10, v10
v_add_f32 v94, v94, v9
M v[12:15], a[180:183], a[20:23], v[12:15]
s_waitcnt lgkmcnt(9)
ds_write_b128 v74, a[208:211] offset:0
v_exp_f32 v11, v11
v_add_f32 v94, v94, v10
v_add_f32 v94, v94, v11
v_cvt_pk_bf16_f32 v52, v8, v9
v_cvt_pk_bf16_f32 v53, v10, v11
M v[12:15], a[184:187], a[40:43], v[12:15]
s_waitcnt lgkmcnt(9)
ds_write_b128 v74, a[212:215] offset:1024
M v[12:15], a[188:191], a[60:63], v[12:15]
s_waitcnt lgkmcnt(8)
M v[176:179], a[192:195], v[16:19], 0
ds_write_b128 v74, a[216:219] offset:2048
M v[180:183], a[192:195], v[20:23], 0
M v[184:187], a[192:195], v[24:27], 0
M v[188:191], a[192:195], v[28:31], 0
ds_write_b128 v74, a[220:223] offset:3072
M v[0:3], a[176:179], a[4:7], 0
v_exp_f32 v12, v12
M v[0:3], a[180:183], a[24:27], v[0:3]
v_exp_f32 v13, v13
M v[0:3], a[184:187], a[44:47], v[0:3]
v_cvt_pk_bf16_f32 v38, v12, v13
v_add_f32 v90, v90, v12
M v[0:3], a[188:191], a[64:67], v[0:3]
v_exp_f32 v14, v14
M v[192:195], a[192:195], v[32:35], 0
s_waitcnt lgkmcnt(8)
v_add_f32 v90, v90, v13
v_add_f32 v90, v90, v14
M v[196:199], a[196:199], v[16:19], 0
v_exp_f32 v15, v15
M v[200:203], a[196:199], v[20:23], 0
v_cvt_pk_bf16_f32 v39, v14, v15
v_add_f32 v90, v90, v15
M v[204:207], a[196:199], v[24:27], 0
v_exp_f32 v0, v0
M v[4:7], a[176:179], a[8:11], 0
v_exp_f32 v1, v1
M v[4:7], a[180:183], a[28:31], v[4:7]
v_cvt_pk_bf16_f32 v42, v0, v1
v_add_f32 v91, v91, v0
M v[4:7], a[184:187], a[48:51], v[4:7]
v_exp_f32 v2, v2
M v[4:7], a[188:191], a[68:71], v[4:7]
v_add_f32 v91, v91, v1
v_add_f32 v91, v91, v2
M v[208:211], a[196:199], v[28:31], 0
v_exp_f32 v3, v3
M v[212:215], a[196:199], v[32:35], 0
s_waitcnt lgkmcnt(6)
v_cvt_pk_bf16_f32 v43, v2, v3
v_add_f32 v91, v91, v3
M v[216:219], a[200:203], v[16:19], 0
v_exp_f32 v4, v4
M v[220:223], a[200:203], v[20:23], 0
v_exp_f32 v5, v5
M v[8:11], a[176:179], a[12:15], 0
s_waitcnt vmcnt(9) lgkmcnt(4)
v_exp_f32 v6, v6
M v[8:11], a[180:183], a[32:35], v[8:11]
s_barrier
ds_read_b128 a[160:163], v57 offset:32768
v_cvt_pk_bf16_f32 v46, v4, v5
M v[8:11], a[184:187], a[52:55], v[8:11]
ds_read_b128 a[164:167], v58 offset:32768
v_add_f32 v92, v92, v4
M v[8:11], a[188:191], a[72:75], v[8:11]
ds_read_b128 a[168:171], v59 offset:32768
v_add_f32 v92, v92, v5
M v[224:227], a[200:203], v[24:27], 0
ds_read_b128 a[172:175], v60 offset:32768
v_add_f32 v92, v92, v6
M v[228:231], a[200:203], v[28:31], 0
ds_read_b64_tr_b16 a[192:193], v61 offset:16384
M v[232:235], a[200:203], v[32:35], 0
ds_read_b64_tr_b16 a[194:195], v61 offset:20480
M v[236:239], a[204:207], v[16:19], 0
ds_write_b128 v74, a[240:243] offset:16384
M v[12:15], a[176:179], a[16:19], 0
v_exp_f32 v7, v7
M v[12:15], a[180:183], a[36:39], v[12:15]
ds_read_b64_tr_b16 a[196:197], v62 offset:16384
v_cvt_pk_bf16_f32 v47, v6, v7
M v[12:15], a[184:187], a[56:59], v[12:15]
v_exp_f32 v8, v8
M v[12:15], a[188:191], a[76:79], v[12:15]
v_exp_f32 v9, v9
M v[240:243], a[204:207], v[20:23], 0
v_exp_f32 v10, v10
M v[244:247], a[204:207], v[24:27], 0
v_exp_f32 v11, v11
M v[248:251], a[204:207], v[28:31], 0
ds_read_b64_tr_b16 a[198:199], v62 offset:20480
v_cvt_pk_bf16_f32 v50, v8, v9
M v[252:255], a[204:207], v[32:35], 0
s_waitcnt lgkmcnt(8)
v_add_f32 v92, v92, v7
v_cvt_pk_bf16_f32 v51, v10, v11
M v[0:3], a[160:163], a[0:3], 0
s_waitcnt lgkmcnt(7)
ds_write_b128 v74, a[244:247] offset:17408
M v[0:3], a[164:167], a[20:23], v[0:3]
s_waitcnt lgkmcnt(7)
v_exp_f32 v12, v12
M v[0:3], a[168:171], a[40:43], v[0:3]
s_waitcnt lgkmcnt(6)
v_exp_f32 v13, v13
M v[0:3], a[172:175], a[60:63], v[0:3]
s_waitcnt lgkmcnt(4)
v_exp_f32 v14, v14
M v[96:99], a[192:195], v[36:39], v[96:99]
v_exp_f32 v15, v15
M v[100:103], a[192:195], v[40:43], v[100:103]
L_hop_b6:
s_cbranch_execz L_ret_b6
v_cvt_pk_bf16_f32 v54, v12, v13
v_cvt_pk_bf16_f32 v55, v14, v15
M v[104:107], a[192:195], v[44:47], v[104:107]
ds_read_b64_tr_b16 a[200:201], v63 offset:16384
v_add_f32 v93, v93, v8
M v[108:111], a[192:195], v[48:51], v[108:111]
ds_read_b64_tr_b16 a[202:203], v63 offset:20480
v_add_f32 v93, v93, v9
M v[4:7], a[160:163], a[4:7], 0
v_add_f32 v93, v93, v10
v_add_f32 v94, v94, v12
M v[4:7], a[164:167], a[24:27], v[4:7]
ds_read_b64_tr_b16 a[204:205], v64 offset:16384
v_add_f32 v93, v93, v11
M v[4:7], a[168:171], a[44:47], v[4:7]
ds_write_b128 v74, a[248:251] offset:18432
M v[4:7], a[172:175], a[64:67], v[4:7]
v_add_f32 v94, v94, v13
v_add_f32 v94, v94, v14
M v[112:115], a[192:195], v[52:55], v[112:115]
s_waitcnt lgkmcnt(5)
ds_read_b64_tr_b16 a[206:207], v64 offset:20480
v_add_f32 v94, v94, v15
M v[116:119], a[196:199], v[36:39], v[116:119]
ds_read_b128 a[176:179], v57 offset:36864
M v[120:123], a[196:199], v[40:43], v[120:123]
v_exp_f32 v0, v0
M v[124:127], a[196:199], v[44:47], v[124:127]
ds_write_b128 v74, a[252:255] offset:19456
M v[8:11], a[160:163], a[8:11], 0
v_exp_f32 v1, v1
M v[8:11], a[164:167], a[28:31], v[8:11]
ds_read_b128 a[180:183], v58 offset:36864
v_add_f32 v90, v90, v0
M v[8:11], a[168:171], a[48:51], v[8:11]
v_exp_f32 v2, v2
M v[8:11], a[172:175], a[68:71], v[8:11]
v_cvt_pk_bf16_f32 v16, v0, v1
v_add_f32 v90, v90, v1
M v[128:131], a[196:199], v[48:51], v[128:131]
v_exp_f32 v3, v3
M v[132:135], a[196:199], v[52:55], v[132:135]
s_waitcnt lgkmcnt(6)
v_cvt_pk_bf16_f32 v17, v2, v3
v_add_f32 v90, v90, v2
M v[136:139], a[200:203], v[36:39], v[136:139]
ds_read_b128 a[184:187], v59 offset:36864
v_add_f32 v90, v90, v3
M v[140:143], a[200:203], v[40:43], v[140:143]
ds_read_b128 a[188:191], v60 offset:36864
M v[12:15], a[160:163], a[12:15], 0
ds_write_b128 v75, a[224:227] offset:0
M v[12:15], a[164:167], a[32:35], v[12:15]
v_exp_f32 v4, v4
M v[12:15], a[168:171], a[52:55], v[12:15]
ds_read_b64_tr_b16 a[192:193], v65 offset:16384
v_add_f32 v91, v91, v4
M v[12:15], a[172:175], a[72:75], v[12:15]
ds_read_b64_tr_b16 a[194:195], v65 offset:20480
M v[144:147], a[200:203], v[44:47], v[144:147]
v_exp_f32 v5, v5
M v[148:151], a[200:203], v[48:51], v[148:151]
v_exp_f32 v6, v6
M v[152:155], a[200:203], v[52:55], v[152:155]
s_waitcnt lgkmcnt(8)
v_cvt_pk_bf16_f32 v20, v4, v5
v_add_f32 v91, v91, v5
M v[156:159], a[204:207], v[36:39], v[156:159]
v_exp_f32 v7, v7
v_add_f32 v91, v91, v6
v_add_f32 v91, v91, v7
M v[0:3], a[160:163], a[16:19], 0
ds_read_b64_tr_b16 a[196:197], v66 offset:16384
v_cvt_pk_bf16_f32 v21, v6, v7
M v[0:3], a[164:167], a[36:39], v[0:3]
ds_write_b128 v75, a[228:231] offset:1024
M v[0:3], a[168:171], a[56:59], v[0:3]
v_exp_f32 v8, v8
M v[0:3], a[172:175], a[76:79], v[0:3]
v_exp_f32 v9, v9
M v[160:163], a[204:207], v[40:43], v[160:163]
s_add_u32 s49, s43, 49152
ds_read_b64_tr_b16 a[198:199], v66 offset:20480
v_add_f32 v92, v92, v8
M v[164:167], a[204:207], v[44:47], v[164:167]
s_and_b32 s49, s49, 131071
v_exp_f32 v10, v10
M v[168:171], a[204:207], v[48:51], v[168:171]
s_add_u32 m0, s36, 32768
v_cvt_pk_bf16_f32 v24, v8, v9
v_add_f32 v92, v92, v9
M v[172:175], a[204:207], v[52:55], v[172:175]
s_waitcnt lgkmcnt(10)
v_exp_f32 v11, v11
M v[4:7], a[176:179], a[0:3], 0
s_waitcnt lgkmcnt(8)
v_cvt_pk_bf16_f32 v25, v10, v11
v_add_f32 v92, v92, v10
M v[4:7], a[180:183], a[20:23], v[4:7]
s_waitcnt lgkmcnt(7)
ds_read_b64_tr_b16 a[200:201], v67 offset:16384
v_add_f32 v92, v92, v11
M v[4:7], a[184:187], a[40:43], v[4:7]
s_waitcnt lgkmcnt(7)
ds_write_b128 v75, a[232:235] offset:2048
M v[4:7], a[188:191], a[60:63], v[4:7]
s_waitcnt lgkmcnt(5)
v_exp_f32 v12, v12
M v[176:179], a[192:195], v[36:39], v[176:179]
s_add_u32 s49, s49, s100
v_exp_f32 v13, v13
M v[180:183], a[192:195], v[40:43], v[180:183]
ds_read_b64_tr_b16 a[202:203], v67 offset:20480
v_add_f32 v93, v93, v12
M v[184:187], a[192:195], v[44:47], v[184:187]
v_exp_f32 v14, v14
M v[188:191], a[192:195], v[48:51], v[188:191]
v_cvt_pk_bf16_f32 v28, v12, v13
v_add_f32 v93, v93, v13
M v[8:11], a[176:179], a[4:7], 0
v_exp_f32 v15, v15
M v[8:11], a[180:183], a[24:27], v[8:11]
v_cvt_pk_bf16_f32 v29, v14, v15
v_add_f32 v93, v93, v14
M v[8:11], a[184:187], a[44:47], v[8:11]
ds_read_b64_tr_b16 a[204:205], v68 offset:16384
v_add_f32 v93, v93, v15
M v[8:11], a[188:191], a[64:67], v[8:11]
ds_write_b128 v75, a[236:239] offset:3072
M v[192:195], a[192:195], v[52:55], v[192:195]
s_waitcnt lgkmcnt(5)
v_exp_f32 v0, v0
M v[196:199], a[196:199], v[36:39], v[196:199]
v_exp_f32 v1, v1
M v[200:203], a[196:199], v[40:43], v[200:203]
ds_read_b64_tr_b16 a[206:207], v68 offset:20480
v_add_f32 v94, v94, v0
v_exp_f32 v2, v2
v_add_f32 v94, v94, v1
v_exp_f32 v3, v3
M v[204:207], a[196:199], v[44:47], v[204:207]
v_cvt_pk_bf16_f32 v32, v0, v1
v_add_f32 v94, v94, v2
v_add_f32 v94, v94, v3
v_cvt_pk_bf16_f32 v33, v2, v3
M v[12:15], a[176:179], a[8:11], 0
v_exp_f32 v4, v4
v_exp_f32 v5, v5
M v[12:15], a[180:183], a[28:31], v[12:15]
v_cvt_pk_bf16_f32 v18, v4, v5
v_add_f32 v90, v90, v4
M v[12:15], a[184:187], a[48:51], v[12:15]
v_exp_f32 v6, v6
M v[12:15], a[188:191], a[68:71], v[12:15]
v_add_f32 v90, v90, v5
v_add_f32 v90, v90, v6
v_exp_f32 v7, v7
v_exp_f32 v8, v8
M v[208:211], a[196:199], v[48:51], v[208:211]
v_cvt_pk_bf16_f32 v19, v6, v7
v_add_f32 v90, v90, v7
M v[212:215], a[196:199], v[52:55], v[212:215]
s_waitcnt lgkmcnt(3)
v_exp_f32 v9, v9
M v[216:219], a[200:203], v[36:39], v[216:219]
v_cvt_pk_bf16_f32 v22, v8, v9
v_add_f32 v91, v91, v8
M v[220:223], a[200:203], v[40:43], v[220:223]
v_exp_f32 v10, v10
M v[0:3], a[176:179], a[12:15], 0
s_waitcnt vmcnt(5) lgkmcnt(0)
v_add_f32 v91, v91, v9
v_add_f32 v91, v91, v10
M v[0:3], a[180:183], a[32:35], v[0:3]
s_barrier
ds_read_b128 a[160:163], v57 offset:49152
M v[0:3], a[184:187], a[52:55], v[0:3]
ds_read_b128 a[164:167], v58 offset:49152
v_exp_f32 v11, v11
M v[0:3], a[188:191], a[72:75], v[0:3]
ds_read_b128 a[168:171], v59 offset:49152
v_add_f32 v91, v91, v11
M v[224:227], a[200:203], v[44:47], v[224:227]
ds_read_b128 a[172:175], v60 offset:49152
v_cvt_pk_bf16_f32 v23, v10, v11
M v[228:231], a[200:203], v[48:51], v[228:231]
ds_read_b64_tr_b16 a[192:193], v61 offset:32768
M v[232:235], a[200:203], v[52:55], v[232:235]
ds_read_b64_tr_b16 a[194:195], v61 offset:36864
buffer_load_dwordx4 v69, s[12:15], s49 offen nt lds
M v[236:239], a[204:207], v[36:39], v[236:239]
v_exp_f32 v12, v12
M v[4:7], a[176:179], a[16:19], 0
s_add_u32 s50, s43, 40960
v_exp_f32 v13, v13
M v[4:7], a[180:183], a[36:39], v[4:7]
s_and_b32 s50, s50, 131071
v_exp_f32 v14, v14
M v[4:7], a[184:187], a[56:59], v[4:7]
s_add_u32 s50, s50, s100
v_exp_f32 v15, v15
M v[4:7], a[188:191], a[76:79], v[4:7]
ds_read_b64_tr_b16 a[196:197], v62 offset:32768
v_cvt_pk_bf16_f32 v26, v12, v13
M v[240:243], a[204:207], v[40:43], v[240:243]
v_exp_f32 v0, v0
M v[244:247], a[204:207], v[44:47], v[244:247]
v_exp_f32 v1, v1
M v[248:251], a[204:207], v[48:51], v[248:251]
v_exp_f32 v2, v2
M v[252:255], a[204:207], v[52:55], v[252:255]
s_waitcnt lgkmcnt(6)
v_exp_f32 v3, v3
M v[8:11], a[160:163], a[0:3], 0
s_waitcnt lgkmcnt(5)
v_cvt_pk_bf16_f32 v27, v14, v15
v_add_f32 v92, v92, v12
M v[8:11], a[164:167], a[20:23], v[8:11]
s_waitcnt lgkmcnt(4)
ds_read_b64_tr_b16 a[198:199], v62 offset:36864
v_add_f32 v92, v92, v13
M v[8:11], a[168:171], a[40:43], v[8:11]
s_waitcnt lgkmcnt(4)
v_cvt_pk_bf16_f32 v30, v0, v1
v_cvt_pk_bf16_f32 v31, v2, v3
M v[8:11], a[172:175], a[60:63], v[8:11]
s_waitcnt lgkmcnt(2)
ds_read_b64_tr_b16 a[200:201], v63 offset:32768
v_add_f32 v92, v92, v14
M v[96:99], a[192:195], v[16:19], v[96:99]
v_add_f32 v92, v92, v15
v_add_f32 v93, v93, v0
v_exp_f32 v4, v4
M v[100:103], a[192:195], v[20:23], v[100:103]
buffer_load_dwordx4 v70, s[12:15], s49 offen offset:1024 nt lds
M v[104:107], a[192:195], v[24:27], v[104:107]
v_exp_f32 v5, v5
M v[108:111], a[192:195], v[28:31], v[108:111]
v_exp_f32 v6, v6
M v[12:15], a[160:163], a[4:7], 0
v_exp_f32 v7, v7
M v[12:15], a[164:167], a[24:27], v[12:15]
v_cvt_pk_bf16_f32 v34, v4, v5
v_cvt_pk_bf16_f32 v35, v6, v7
M v[12:15], a[168:171], a[44:47], v[12:15]
ds_read_b64_tr_b16 a[202:203], v63 offset:36864
v_add_f32 v93, v93, v1
M v[12:15], a[172:175], a[64:67], v[12:15]
v_add_f32 v93, v93, v2
v_add_f32 v94, v94, v4
M v[112:115], a[192:195], v[32:35], v[112:115]
s_waitcnt lgkmcnt(2)
v_add_f32 v93, v93, v3
v_add_f32 v94, v94, v5
M v[116:119], a[196:199], v[16:19], v[116:119]
buffer_load_dwordx4 v69, s[12:15], s49 offen offset:2048 nt lds
M v[120:123], a[196:199], v[20:23], v[120:123]
ds_read_b64_tr_b16 a[204:205], v64 offset:32768
v_add_f32 v94, v94, v6
M v[124:127], a[196:199], v[24:27], v[124:127]
ds_read_b64_tr_b16 a[206:207], v64 offset:36864
v_add_f32 v94, v94, v7
M v[0:3], a[160:163], a[8:11], 0
v_exp_f32 v8, v8
M v[0:3], a[164:167], a[28:31], v[0:3]
buffer_load_dwordx4 v70, s[12:15], s49 offen offset:3072 nt lds
M v[0:3], a[168:171], a[48:51], v[0:3]
s_add_u32 m0, s36, 81920
v_exp_f32 v9, v9
M v[0:3], a[172:175], a[68:71], v[0:3]
ds_read_b128 a[176:179], v57 offset:53248
v_add_f32 v90, v90, v8
M v[128:131], a[196:199], v[28:31], v[128:131]
v_exp_f32 v10, v10
M v[132:135], a[196:199], v[32:35], v[132:135]
s_waitcnt lgkmcnt(3)
v_cvt_pk_bf16_f32 v36, v8, v9
v_add_f32 v90, v90, v9
M v[136:139], a[200:203], v[16:19], v[136:139]
v_exp_f32 v11, v11
M v[140:143], a[200:203], v[20:23], v[140:143]
v_cvt_pk_bf16_f32 v37, v10, v11
v_add_f32 v90, v90, v10
M v[4:7], a[160:163], a[12:15], 0
ds_read_b128 a[180:183], v58 offset:53248
v_add_f32 v90, v90, v11
M v[4:7], a[164:167], a[32:35], v[4:7]
ds_read_b128 a[184:187], v59 offset:53248
M v[4:7], a[168:171], a[52:55], v[4:7]
buffer_load_dwordx4 v69, s[16:19], s50 offen nt lds
M v[4:7], a[172:175], a[72:75], v[4:7]
ds_read_b128 a[188:191], v60 offset:53248
M v[144:147], a[200:203], v[24:27], v[144:147]
ds_read_b64_tr_b16 a[192:193], v65 offset:32768
M v[148:151], a[200:203], v[28:31], v[148:151]
v_exp_f32 v12, v12
M v[152:155], a[200:203], v[32:35], v[152:155]
s_waitcnt lgkmcnt(5)
ds_read_b64_tr_b16 a[194:195], v65 offset:36864
v_add_f32 v91, v91, v12
M v[156:159], a[204:207], v[16:19], v[156:159]
v_exp_f32 v13, v13
M v[8:11], a[160:163], a[16:19], 0
v_exp_f32 v14, v14
M v[8:11], a[164:167], a[36:39], v[8:11]
v_cvt_pk_bf16_f32 v40, v12, v13
v_add_f32 v91, v91, v13
M v[8:11], a[168:171], a[56:59], v[8:11]
v_exp_f32 v15, v15
M v[8:11], a[172:175], a[76:79], v[8:11]
v_cvt_pk_bf16_f32 v41, v14, v15
v_add_f32 v91, v91, v14
M v[160:163], a[204:207], v[20:23], v[160:163]
s_add_u32 s51, s43, 57344
ds_read_b64_tr_b16 a[196:197], v66 offset:32768
v_add_f32 v91, v91, v15
M v[164:167], a[204:207], v[24:27], v[164:167]
s_and_b32 s51, s51, 131071
buffer_load_dwordx4 v70, s[16:19], s50 offen offset:1024 nt lds
M v[168:171], a[204:207], v[28:31], v[168:171]
s_add_u32 s51, s51, s100
v_exp_f32 v0, v0
M v[172:175], a[204:207], v[32:35], v[172:175]
s_waitcnt lgkmcnt(6)
v_exp_f32 v1, v1
M v[12:15], a[176:179], a[0:3], 0
s_waitcnt lgkmcnt(5)
ds_read_b64_tr_b16 a[198:199], v66 offset:36864
v_add_f32 v92, v92, v0
M v[12:15], a[180:183], a[20:23], v[12:15]
s_waitcnt lgkmcnt(5)
v_exp_f32 v2, v2
M v[12:15], a[184:187], a[40:43], v[12:15]
s_waitcnt lgkmcnt(4)
v_cvt_pk_bf16_f32 v44, v0, v1
v_add_f32 v92, v92, v1
M v[12:15], a[188:191], a[60:63], v[12:15]
s_waitcnt lgkmcnt(2)
v_exp_f32 v3, v3
M v[176:179], a[192:195], v[16:19], v[176:179]
v_cvt_pk_bf16_f32 v45, v2, v3
v_add_f32 v92, v92, v2
M v[180:183], a[192:195], v[20:23], v[180:183]
ds_read_b64_tr_b16 a[200:201], v67 offset:32768
v_add_f32 v92, v92, v3
M v[184:187], a[192:195], v[24:27], v[184:187]
buffer_load_dwordx4 v69, s[16:19], s50 offen offset:2048 nt lds
M v[188:191], a[192:195], v[28:31], v[188:191]
v_exp_f32 v4, v4
v_exp_f32 v5, v5
v_add_f32 v93, v93, v4
M v[0:3], a[176:179], a[4:7], 0
v_exp_f32 v6, v6
v_add_f32 v93, v93, v5
M v[0:3], a[180:183], a[24:27], v[0:3]
v_exp_f32 v7, v7
M v[0:3], a[184:187], a[44:47], v[0:3]
ds_read_b64_tr_b16 a[202:203], v67 offset:36864
v_add_f32 v93, v93, v6
M v[0:3], a[188:191], a[64:67], v[0:3]
v_cvt_pk_bf16_f32 v48, v4, v5
v_add_f32 v93, v93, v7
M v[192:195], a[192:195], v[32:35], v[192:195]
s_waitcnt lgkmcnt(2)
ds_read_b64_tr_b16 a[204:205], v68 offset:32768
v_cvt_pk_bf16_f32 v49, v6, v7
M v[196:199], a[196:199], v[16:19], v[196:199]
v_exp_f32 v8, v8
M v[200:203], a[196:199], v[20:23], v[200:203]
v_exp_f32 v9, v9
v_add_f32 v94, v94, v8
v_exp_f32 v10, v10
v_add_f32 v94, v94, v9
v_exp_f32 v11, v11
v_add_f32 v94, v94, v10
v_add_f32 v94, v94, v11
M v[204:207], a[196:199], v[24:27], v[204:207]
buffer_load_dwordx4 v70, s[16:19], s50 offen offset:3072 nt lds
ds_read_b64_tr_b16 a[206:207], v68 offset:36864
v_cvt_pk_bf16_f32 v52, v8, v9
v_cvt_pk_bf16_f32 v53, v10, v11
M v[4:7], a[176:179], a[8:11], 0
s_add_u32 m0, s36, 49152
v_exp_f32 v12, v12
v_exp_f32 v13, v13
M v[4:7], a[180:183], a[28:31], v[4:7]
v_cvt_pk_bf16_f32 v38, v12, v13
v_add_f32 v90, v90, v12
M v[4:7], a[184:187], a[48:51], v[4:7]
v_exp_f32 v14, v14
M v[4:7], a[188:191], a[68:71], v[4:7]
v_add_f32 v90, v90, v13
v_add_f32 v90, v90, v14
v_exp_f32 v15, v15
v_exp_f32 v0, v0
M v[208:211], a[196:199], v[28:31], v[208:211]
v_cvt_pk_bf16_f32 v39, v14, v15
v_add_f32 v90, v90, v15
M v[212:215], a[196:199], v[32:35], v[212:215]
s_waitcnt lgkmcnt(2)
v_exp_f32 v1, v1
M v[216:219], a[200:203], v[16:19], v[216:219]
v_cvt_pk_bf16_f32 v42, v0, v1
v_add_f32 v91, v91, v0
M v[220:223], a[200:203], v[20:23], v[220:223]
v_exp_f32 v2, v2
M v[8:11], a[176:179], a[12:15], 0
s_waitcnt vmcnt(9) lgkmcnt(0)
v_add_f32 v91, v91, v1
v_add_f32 v91, v91, v2
M v[8:11], a[180:183], a[32:35], v[8:11]
s_barrier
ds_read_b128 a[160:163], v57 offset:0
M v[8:11], a[184:187], a[52:55], v[8:11]
ds_read_b128 a[164:167], v58 offset:0
v_exp_f32 v3, v3
M v[8:11], a[188:191], a[72:75], v[8:11]
ds_read_b128 a[168:171], v59 offset:0
v_add_f32 v91, v91, v3
M v[224:227], a[200:203], v[24:27], v[224:227]
ds_read_b128 a[172:175], v60 offset:0
v_cvt_pk_bf16_f32 v43, v2, v3
M v[228:231], a[200:203], v[28:31], v[228:231]
ds_read_b64_tr_b16 a[192:193], v61 offset:49152
M v[232:235], a[200:203], v[32:35], v[232:235]
ds_read_b64_tr_b16 a[194:195], v61 offset:53248
buffer_load_dwordx4 v69, s[12:15], s51 offen nt lds
M v[236:239], a[204:207], v[16:19], v[236:239]
v_exp_f32 v4, v4
M v[12:15], a[176:179], a[16:19], 0
s_add_u32 s44, s43, 49152
v_exp_f32 v5, v5
M v[12:15], a[180:183], a[36:39], v[12:15]
s_and_b32 s44, s44, 131071
v_exp_f32 v6, v6
M v[12:15], a[184:187], a[56:59], v[12:15]
s_add_u32 s44, s44, s100
v_exp_f32 v7, v7
M v[12:15], a[188:191], a[76:79], v[12:15]
ds_read_b64_tr_b16 a[196:197], v62 offset:49152
v_cvt_pk_bf16_f32 v46, v4, v5
M v[240:243], a[204:207], v[20:23], v[240:243]
v_exp_f32 v8, v8
M v[244:247], a[204:207], v[24:27], v[244:247]
v_exp_f32 v9, v9
M v[248:251], a[204:207], v[28:31], v[248:251]
v_exp_f32 v10, v10
M v[252:255], a[204:207], v[32:35], v[252:255]
s_waitcnt lgkmcnt(6)
v_exp_f32 v11, v11
M v[0:3], a[160:163], a[0:3], 0
s_waitcnt lgkmcnt(5)
v_cvt_pk_bf16_f32 v47, v6, v7
v_add_f32 v92, v92, v4
M v[0:3], a[164:167], a[20:23], v[0:3]
s_waitcnt lgkmcnt(4)
ds_read_b64_tr_b16 a[198:199], v62 offset:53248
v_add_f32 v92, v92, v5
M v[0:3], a[168:171], a[40:43], v[0:3]
s_waitcnt lgkmcnt(4)
v_cvt_pk_bf16_f32 v50, v8, v9
v_cvt_pk_bf16_f32 v51, v10, v11
M v[0:3], a[172:175], a[60:63], v[0:3]
s_waitcnt lgkmcnt(2)
ds_read_b64_tr_b16 a[200:201], v63 offset:49152
v_add_f32 v92, v92, v6
M v[96:99], a[192:195], v[36:39], v[96:99]
v_add_f32 v92, v92, v7
v_add_f32 v93, v93, v8
v_exp_f32 v12, v12
M v[100:103], a[192:195], v[40:43], v[100:103]
buffer_load_dwordx4 v70, s[12:15], s51 offen offset:1024 nt lds
M v[104:107], a[192:195], v[44:47], v[104:107]
v_exp_f32 v13, v13
M v[108:111], a[192:195], v[48:51], v[108:111]
v_exp_f32 v14, v14
M v[4:7], a[160:163], a[4:7], 0
v_exp_f32 v15, v15
M v[4:7], a[164:167], a[24:27], v[4:7]
v_cvt_pk_bf16_f32 v54, v12, v13
v_cvt_pk_bf16_f32 v55, v14, v15
M v[4:7], a[168:171], a[44:47], v[4:7]
ds_read_b64_tr_b16 a[202:203], v63 offset:53248
v_add_f32 v93, v93, v9
M v[4:7], a[172:175], a[64:67], v[4:7]
v_add_f32 v93, v93, v10
v_add_f32 v94, v94, v12
M v[112:115], a[192:195], v[52:55], v[112:115]
s_waitcnt lgkmcnt(2)
v_add_f32 v93, v93, v11
v_add_f32 v94, v94, v13
M v[116:119], a[196:199], v[36:39], v[116:119]
buffer_load_dwordx4 v69, s[12:15], s51 offen offset:2048 nt lds
M v[120:123], a[196:199], v[40:43], v[120:123]
ds_read_b64_tr_b16 a[204:205], v64 offset:49152
v_add_f32 v94, v94, v14
M v[124:127], a[196:199], v[44:47], v[124:127]
ds_read_b64_tr_b16 a[206:207], v64 offset:53248
v_add_f32 v94, v94, v15
M v[8:11], a[160:163], a[8:11], 0
v_exp_f32 v0, v0
M v[8:11], a[164:167], a[28:31], v[8:11]
buffer_load_dwordx4 v70, s[12:15], s51 offen offset:3072 nt lds
M v[8:11], a[168:171], a[48:51], v[8:11]
s_add_u32 m0, s36, 98304
v_exp_f32 v1, v1
M v[8:11], a[172:175], a[68:71], v[8:11]
ds_read_b128 a[176:179], v57 offset:4096
v_add_f32 v90, v90, v0
M v[128:131], a[196:199], v[48:51], v[128:131]
v_exp_f32 v2, v2
M v[132:135], a[196:199], v[52:55], v[132:135]
s_waitcnt lgkmcnt(3)
v_cvt_pk_bf16_f32 v16, v0, v1
v_add_f32 v90, v90, v1
M v[136:139], a[200:203], v[36:39], v[136:139]
v_exp_f32 v3, v3
M v[140:143], a[200:203], v[40:43], v[140:143]
v_cvt_pk_bf16_f32 v17, v2, v3
v_add_f32 v90, v90, v2
M v[12:15], a[160:163], a[12:15], 0
ds_read_b128 a[180:183], v58 offset:4096
v_add_f32 v90, v90, v3
M v[12:15], a[164:167], a[32:35], v[12:15]
ds_read_b128 a[184:187], v59 offset:4096
M v[12:15], a[168:171], a[52:55], v[12:15]
buffer_load_dwordx4 v69, s[16:19], s44 offen nt lds
M v[12:15], a[172:175], a[72:75], v[12:15]
ds_read_b128 a[188:191], v60 offset:4096
M v[144:147], a[200:203], v[44:47], v[144:147]
ds_read_b64_tr_b16 a[192:193], v65 offset:49152
M v[148:151], a[200:203], v[48:51], v[148:151]
v_exp_f32 v4, v4
M v[152:155], a[200:203], v[52:55], v[152:155]
s_waitcnt lgkmcnt(5)
ds_read_b64_tr_b16 a[194:195], v65 offset:53248
v_add_f32 v91, v91, v4
M v[156:159], a[204:207], v[36:39], v[156:159]
v_exp_f32 v5, v5
M v[0:3], a[160:163], a[16:19], 0
v_exp_f32 v6, v6
M v[0:3], a[164:167], a[36:39], v[0:3]
v_cvt_pk_bf16_f32 v20, v4, v5
v_add_f32 v91, v91, v5
M v[0:3], a[168:171], a[56:59], v[0:3]
v_exp_f32 v7, v7
M v[0:3], a[172:175], a[76:79], v[0:3]
v_cvt_pk_bf16_f32 v21, v6, v7
v_add_f32 v91, v91, v6
M v[160:163], a[204:207], v[40:43], v[160:163]
s_add_u32 s45, s43, 65536
ds_read_b64_tr_b16 a[196:197], v66 offset:49152
v_add_f32 v91, v91, v7
M v[164:167], a[204:207], v[44:47], v[164:167]
s_and_b32 s45, s45, 131071
buffer_load_dwordx4 v70, s[16:19], s44 offen offset:1024 nt lds
M v[168:171], a[204:207], v[48:51], v[168:171]
s_add_u32 s45, s45, s100
v_exp_f32 v8, v8
M v[172:175], a[204:207], v[52:55], v[172:175]
s_waitcnt lgkmcnt(6)
v_exp_f32 v9, v9
M v[4:7], a[176:179], a[0:3], 0
s_waitcnt lgkmcnt(5)
ds_read_b64_tr_b16 a[198:199], v66 offset:53248
v_add_f32 v92, v92, v8
M v[4:7], a[180:183], a[20:23], v[4:7]
s_waitcnt lgkmcnt(5)
v_exp_f32 v10, v10
M v[4:7], a[184:187], a[40:43], v[4:7]
s_waitcnt lgkmcnt(4)
v_cvt_pk_bf16_f32 v24, v8, v9
v_add_f32 v92, v92, v9
M v[4:7], a[188:191], a[60:63], v[4:7]
s_waitcnt lgkmcnt(2)
v_exp_f32 v11, v11
M v[176:179], a[192:195], v[36:39], v[176:179]
v_cvt_pk_bf16_f32 v25, v10, v11
v_add_f32 v92, v92, v10
M v[180:183], a[192:195], v[40:43], v[180:183]
ds_read_b64_tr_b16 a[200:201], v67 offset:49152
v_add_f32 v92, v92, v11
M v[184:187], a[192:195], v[44:47], v[184:187]
buffer_load_dwordx4 v69, s[16:19], s44 offen offset:2048 nt lds
M v[188:191], a[192:195], v[48:51], v[188:191]
v_exp_f32 v12, v12
v_exp_f32 v13, v13
v_add_f32 v93, v93, v12
M v[8:11], a[176:179], a[4:7], 0
v_exp_f32 v14, v14
v_add_f32 v93, v93, v13
M v[8:11], a[180:183], a[24:27], v[8:11]
v_exp_f32 v15, v15
M v[8:11], a[184:187], a[44:47], v[8:11]
ds_read_b64_tr_b16 a[202:203], v67 offset:53248
v_add_f32 v93, v93, v14
M v[8:11], a[188:191], a[64:67], v[8:11]
v_cvt_pk_bf16_f32 v28, v12, v13
v_add_f32 v93, v93, v15
M v[192:195], a[192:195], v[52:55], v[192:195]
s_waitcnt lgkmcnt(2)
ds_read_b64_tr_b16 a[204:205], v68 offset:49152
v_cvt_pk_bf16_f32 v29, v14, v15
M v[196:199], a[196:199], v[36:39], v[196:199]
v_exp_f32 v0, v0
M v[200:203], a[196:199], v[40:43], v[200:203]
v_exp_f32 v1, v1
v_add_f32 v94, v94, v0
v_exp_f32 v2, v2
v_add_f32 v94, v94, v1
v_exp_f32 v3, v3
v_add_f32 v94, v94, v2
v_add_f32 v94, v94, v3
M v[204:207], a[196:199], v[44:47], v[204:207]
buffer_load_dwordx4 v70, s[16:19], s44 offen offset:3072 nt lds
ds_read_b64_tr_b16 a[206:207], v68 offset:53248
v_cvt_pk_bf16_f32 v32, v0, v1
v_cvt_pk_bf16_f32 v33, v2, v3
M v[12:15], a[176:179], a[8:11], 0
s_add_u32 m0, s36, 0
v_exp_f32 v4, v4
v_exp_f32 v5, v5
M v[12:15], a[180:183], a[28:31], v[12:15]
v_cvt_pk_bf16_f32 v18, v4, v5
v_add_f32 v90, v90, v4
M v[12:15], a[184:187], a[48:51], v[12:15]
v_exp_f32 v6, v6
M v[12:15], a[188:191], a[68:71], v[12:15]
v_add_f32 v90, v90, v5
v_add_f32 v90, v90, v6
v_exp_f32 v7, v7
v_exp_f32 v8, v8
M v[208:211], a[196:199], v[48:51], v[208:211]
v_cvt_pk_bf16_f32 v19, v6, v7
v_add_f32 v90, v90, v7
M v[212:215], a[196:199], v[52:55], v[212:215]
s_waitcnt lgkmcnt(2)
v_exp_f32 v9, v9
M v[216:219], a[200:203], v[36:39], v[216:219]
v_cvt_pk_bf16_f32 v22, v8, v9
v_add_f32 v91, v91, v8
M v[220:223], a[200:203], v[40:43], v[220:223]
v_exp_f32 v10, v10
M v[0:3], a[176:179], a[12:15], 0
s_waitcnt lgkmcnt(0)
v_add_f32 v91, v91, v9
v_add_f32 v91, v91, v10
M v[0:3], a[180:183], a[32:35], v[0:3]
s_barrier
ds_read_b128 a[160:163], v57 offset:16384
M v[0:3], a[184:187], a[52:55], v[0:3]
ds_read_b128 a[164:167], v58 offset:16384
v_exp_f32 v11, v11
M v[0:3], a[188:191], a[72:75], v[0:3]
ds_read_b128 a[168:171], v59 offset:16384
v_add_f32 v91, v91, v11
M v[224:227], a[200:203], v[44:47], v[224:227]
ds_read_b128 a[172:175], v60 offset:16384
v_cvt_pk_bf16_f32 v23, v10, v11
M v[228:231], a[200:203], v[48:51], v[228:231]
ds_read_b64_tr_b16 a[192:193], v61 offset:0
M v[232:235], a[200:203], v[52:55], v[232:235]
ds_read_b64_tr_b16 a[194:195], v61 offset:4096
buffer_load_dwordx4 v69, s[12:15], s45 offen nt lds
M v[236:239], a[204:207], v[36:39], v[236:239]
v_exp_f32 v12, v12
M v[4:7], a[176:179], a[16:19], 0
s_add_u32 s46, s43, 57344
v_exp_f32 v13, v13
M v[4:7], a[180:183], a[36:39], v[4:7]
s_and_b32 s46, s46, 131071
v_exp_f32 v14, v14
M v[4:7], a[184:187], a[56:59], v[4:7]
s_add_u32 s46, s46, s100
v_exp_f32 v15, v15
M v[4:7], a[188:191], a[76:79], v[4:7]
ds_read_b64_tr_b16 a[196:197], v62 offset:0
v_cvt_pk_bf16_f32 v26, v12, v13
M v[240:243], a[204:207], v[40:43], v[240:243]
v_exp_f32 v0, v0
M v[244:247], a[204:207], v[44:47], v[244:247]
v_exp_f32 v1, v1
M v[248:251], a[204:207], v[48:51], v[248:251]
v_exp_f32 v2, v2
M v[252:255], a[204:207], v[52:55], v[252:255]
s_waitcnt lgkmcnt(6)
v_exp_f32 v3, v3
M v[8:11], a[160:163], a[0:3], 0
s_waitcnt lgkmcnt(5)
v_cvt_pk_bf16_f32 v27, v14, v15
v_add_f32 v92, v92, v12
M v[8:11], a[164:167], a[20:23], v[8:11]
s_waitcnt lgkmcnt(4)
ds_read_b64_tr_b16 a[198:199], v62 offset:4096
v_add_f32 v92, v92, v13
M v[8:11], a[168:171], a[40:43], v[8:11]
s_waitcnt lgkmcnt(4)
v_cvt_pk_bf16_f32 v30, v0, v1
v_cvt_pk_bf16_f32 v31, v2, v3
M v[8:11], a[172:175], a[60:63], v[8:11]
s_waitcnt lgkmcnt(2)
ds_read_b64_tr_b16 a[200:201], v63 offset:0
v_add_f32 v92, v92, v14
M v[96:99], a[192:195], v[16:19], v[96:99]
v_add_f32 v92, v92, v15
v_add_f32 v93, v93, v0
v_exp_f32 v4, v4
M v[100:103], a[192:195], v[20:23], v[100:103]
buffer_load_dwordx4 v70, s[12:15], s45 offen offset:1024 nt lds
M v[104:107], a[192:195], v[24:27], v[104:107]
v_exp_f32 v5, v5
M v[108:111], a[192:195], v[28:31], v[108:111]
v_exp_f32 v6, v6
M v[12:15], a[160:163], a[4:7], 0
v_exp_f32 v7, v7
M v[12:15], a[164:167], a[24:27], v[12:15]
v_cvt_pk_bf16_f32 v34, v4, v5
v_cvt_pk_bf16_f32 v35, v6, v7
M v[12:15], a[168:171], a[44:47], v[12:15]
ds_read_b64_tr_b16 a[202:203], v63 offset:4096
v_add_f32 v93, v93, v1
M v[12:15], a[172:175], a[64:67], v[12:15]
v_add_f32 v93, v93, v2
v_add_f32 v94, v94, v4
M v[112:115], a[192:195], v[32:35], v[112:115]
s_waitcnt lgkmcnt(2)
v_add_f32 v93, v93, v3
v_add_f32 v94, v94, v5
M v[116:119], a[196:199], v[16:19], v[116:119]
buffer_load_dwordx4 v69, s[12:15], s45 offen offset:2048 nt lds
M v[120:123], a[196:199], v[20:23], v[120:123]
ds_read_b64_tr_b16 a[204:205], v64 offset:0
v_add_f32 v94, v94, v6
M v[124:127], a[196:199], v[24:27], v[124:127]
ds_read_b64_tr_b16 a[206:207], v64 offset:4096
v_add_f32 v94, v94, v7
M v[0:3], a[160:163], a[8:11], 0
v_exp_f32 v8, v8
M v[0:3], a[164:167], a[28:31], v[0:3]
buffer_load_dwordx4 v70, s[12:15], s45 offen offset:3072 nt lds
M v[0:3], a[168:171], a[48:51], v[0:3]
s_add_u32 m0, s36, 114688
v_exp_f32 v9, v9
M v[0:3], a[172:175], a[68:71], v[0:3]
ds_read_b128 a[176:179], v57 offset:20480
v_add_f32 v90, v90, v8
M v[128:131], a[196:199], v[28:31], v[128:131]
v_exp_f32 v10, v10
M v[132:135], a[196:199], v[32:35], v[132:135]
s_waitcnt lgkmcnt(3)
v_cvt_pk_bf16_f32 v36, v8, v9
v_add_f32 v90, v90, v9
M v[136:139], a[200:203], v[16:19], v[136:139]
v_exp_f32 v11, v11
M v[140:143], a[200:203], v[20:23], v[140:143]
v_cvt_pk_bf16_f32 v37, v10, v11
v_add_f32 v90, v90, v10
M v[4:7], a[160:163], a[12:15], 0
ds_read_b128 a[180:183], v58 offset:20480
v_add_f32 v90, v90, v11
M v[4:7], a[164:167], a[32:35], v[4:7]
ds_read_b128 a[184:187], v59 offset:20480
M v[4:7], a[168:171], a[52:55], v[4:7]
buffer_load_dwordx4 v69, s[16:19], s46 offen nt lds
M v[4:7], a[172:175], a[72:75], v[4:7]
ds_read_b128 a[188:191], v60 offset:20480
M v[144:147], a[200:203], v[24:27], v[144:147]
ds_read_b64_tr_b16 a[192:193], v65 offset:0
M v[148:151], a[200:203], v[28:31], v[148:151]
v_exp_f32 v12, v12
M v[152:155], a[200:203], v[32:35], v[152:155]
s_waitcnt lgkmcnt(5)
ds_read_b64_tr_b16 a[194:195], v65 offset:4096
v_add_f32 v91, v91, v12
M v[156:159], a[204:207], v[16:19], v[156:159]
v_exp_f32 v13, v13
M v[8:11], a[160:163], a[16:19], 0
v_exp_f32 v14, v14
M v[8:11], a[164:167], a[36:39], v[8:11]
v_cvt_pk_bf16_f32 v40, v12, v13
v_add_f32 v91, v91, v13
M v[8:11], a[168:171], a[56:59], v[8:11]
v_exp_f32 v15, v15
M v[8:11], a[172:175], a[76:79], v[8:11]
v_cvt_pk_bf16_f32 v41, v14, v15
v_add_f32 v91, v91, v14
M v[160:163], a[204:207], v[20:23], v[160:163]
s_add_u32 s47, s43, 73728
ds_read_b64_tr_b16 a[196:197], v66 offset:0
v_add_f32 v91, v91, v15
M v[164:167], a[204:207], v[24:27], v[164:167]
s_and_b32 s47, s47, 131071
buffer_load_dwordx4 v70, s[16:19], s46 offen offset:1024 nt lds
M v[168:171], a[204:207], v[28:31], v[168:171]
s_add_u32 s47, s47, s100
v_exp_f32 v0, v0
M v[172:175], a[204:207], v[32:35], v[172:175]
s_waitcnt lgkmcnt(6)
v_exp_f32 v1, v1
M v[12:15], a[176:179], a[0:3], 0
s_waitcnt lgkmcnt(5)
ds_read_b64_tr_b16 a[198:199], v66 offset:4096
v_add_f32 v92, v92, v0
M v[12:15], a[180:183], a[20:23], v[12:15]
s_waitcnt lgkmcnt(5)
v_exp_f32 v2, v2
M v[12:15], a[184:187], a[40:43], v[12:15]
s_waitcnt lgkmcnt(4)
v_cvt_pk_bf16_f32 v44, v0, v1
v_add_f32 v92, v92, v1
M v[12:15], a[188:191], a[60:63], v[12:15]
s_waitcnt lgkmcnt(2)
v_exp_f32 v3, v3
M v[176:179], a[192:195], v[16:19], v[176:179]
v_cvt_pk_bf16_f32 v45, v2, v3
v_add_f32 v92, v92, v2
M v[180:183], a[192:195], v[20:23], v[180:183]
ds_read_b64_tr_b16 a[200:201], v67 offset:0
v_add_f32 v92, v92, v3
M v[184:187], a[192:195], v[24:27], v[184:187]
buffer_load_dwordx4 v69, s[16:19], s46 offen offset:2048 nt lds
M v[188:191], a[192:195], v[28:31], v[188:191]
v_exp_f32 v4, v4
v_exp_f32 v5, v5
v_add_f32 v93, v93, v4
M v[0:3], a[176:179], a[4:7], 0
v_exp_f32 v6, v6
v_add_f32 v93, v93, v5
M v[0:3], a[180:183], a[24:27], v[0:3]
v_exp_f32 v7, v7
M v[0:3], a[184:187], a[44:47], v[0:3]
ds_read_b64_tr_b16 a[202:203], v67 offset:4096
v_add_f32 v93, v93, v6
M v[0:3], a[188:191], a[64:67], v[0:3]
v_cvt_pk_bf16_f32 v48, v4, v5
v_add_f32 v93, v93, v7
M v[192:195], a[192:195], v[32:35], v[192:195]
s_waitcnt lgkmcnt(2)
ds_read_b64_tr_b16 a[204:205], v68 offset:0
v_cvt_pk_bf16_f32 v49, v6, v7
M v[196:199], a[196:199], v[16:19], v[196:199]
v_exp_f32 v8, v8
M v[200:203], a[196:199], v[20:23], v[200:203]
v_exp_f32 v9, v9
v_add_f32 v94, v94, v8
v_exp_f32 v10, v10
v_add_f32 v94, v94, v9
v_exp_f32 v11, v11
v_add_f32 v94, v94, v10
v_add_f32 v94, v94, v11
M v[204:207], a[196:199], v[24:27], v[204:207]
buffer_load_dwordx4 v70, s[16:19], s46 offen offset:3072 nt lds
ds_read_b64_tr_b16 a[206:207], v68 offset:4096
v_cvt_pk_bf16_f32 v52, v8, v9
v_cvt_pk_bf16_f32 v53, v10, v11
M v[4:7], a[176:179], a[8:11], 0
s_add_u32 m0, s36, 16384
v_exp_f32 v12, v12
v_exp_f32 v13, v13
M v[4:7], a[180:183], a[28:31], v[4:7]
v_cvt_pk_bf16_f32 v38, v12, v13
v_add_f32 v90, v90, v12
M v[4:7], a[184:187], a[48:51], v[4:7]
v_exp_f32 v14, v14
M v[4:7], a[188:191], a[68:71], v[4:7]
v_add_f32 v90, v90, v13
v_add_f32 v90, v90, v14
v_exp_f32 v15, v15
v_exp_f32 v0, v0
M v[208:211], a[196:199], v[28:31], v[208:211]
v_cvt_pk_bf16_f32 v39, v14, v15
v_add_f32 v90, v90, v15
M v[212:215], a[196:199], v[32:35], v[212:215]
s_waitcnt lgkmcnt(2)
v_exp_f32 v1, v1
M v[216:219], a[200:203], v[16:19], v[216:219]
v_cvt_pk_bf16_f32 v42, v0, v1
v_add_f32 v91, v91, v0
M v[220:223], a[200:203], v[20:23], v[220:223]
v_exp_f32 v2, v2
M v[8:11], a[176:179], a[12:15], 0
s_mov_b64 exec, 0
s_branch L_hop_c0
L_ret_c0:
s_mov_b64 exec, -1
s_mov_b64 exec, 0
s_branch L_hop_c1
L_ret_c1:
s_mov_b64 exec, -1
s_waitcnt vmcnt(16) lgkmcnt(0)
v_add_f32 v91, v91, v1
v_add_f32 v91, v91, v2
M v[8:11], a[180:183], a[32:35], v[8:11]
s_barrier
ds_read_b128 a[160:163], v57 offset:32768
M v[8:11], a[184:187], a[52:55], v[8:11]
ds_read_b128 a[164:167], v58 offset:32768
v_exp_f32 v3, v3
M v[8:11], a[188:191], a[72:75], v[8:11]
ds_read_b128 a[168:171], v59 offset:32768
v_add_f32 v91, v91, v3
M v[224:227], a[200:203], v[24:27], v[224:227]
ds_read_b128 a[172:175], v60 offset:32768
v_cvt_pk_bf16_f32 v43, v2, v3
M v[228:231], a[200:203], v[28:31], v[228:231]
ds_read_b64_tr_b16 a[192:193], v61 offset:16384
M v[232:235], a[200:203], v[32:35], v[232:235]
ds_read_b64_tr_b16 a[194:195], v61 offset:20480
buffer_load_dwordx4 v69, s[12:15], s47 offen nt lds
M v[236:239], a[204:207], v[16:19], v[236:239]
v_exp_f32 v4, v4
M v[12:15], a[176:179], a[16:19], 0
s_add_u32 s48, s43, 65536
v_exp_f32 v5, v5
M v[12:15], a[180:183], a[36:39], v[12:15]
s_and_b32 s48, s48, 131071
v_exp_f32 v6, v6
M v[12:15], a[184:187], a[56:59], v[12:15]
s_add_u32 s48, s48, s100
v_exp_f32 v7, v7
M v[12:15], a[188:191], a[76:79], v[12:15]
ds_read_b64_tr_b16 a[196:197], v62 offset:16384
v_cvt_pk_bf16_f32 v46, v4, v5
M v[240:243], a[204:207], v[20:23], v[240:243]
v_exp_f32 v8, v8
M v[244:247], a[204:207], v[24:27], v[244:247]
v_exp_f32 v9, v9
M v[248:251], a[204:207], v[28:31], v[248:251]
v_exp_f32 v10, v10
M v[252:255], a[204:207], v[32:35], v[252:255]
s_waitcnt lgkmcnt(6)
v_exp_f32 v11, v11
M v[0:3], a[160:163], a[0:3], 0
s_waitcnt lgkmcnt(5)
v_cvt_pk_bf16_f32 v47, v6, v7
v_add_f32 v92, v92, v4
M v[0:3], a[164:167], a[20:23], v[0:3]
s_waitcnt lgkmcnt(4)
ds_read_b64_tr_b16 a[198:199], v62 offset:20480
v_add_f32 v92, v92, v5
M v[0:3], a[168:171], a[40:43], v[0:3]
s_waitcnt lgkmcnt(4)
v_cvt_pk_bf16_f32 v50, v8, v9
v_cvt_pk_bf16_f32 v51, v10, v11
M v[0:3], a[172:175], a[60:63], v[0:3]
s_waitcnt lgkmcnt(2)
ds_read_b64_tr_b16 a[200:201], v63 offset:16384
v_add_f32 v92, v92, v6
M v[96:99], a[192:195], v[36:39], v[96:99]
v_add_f32 v92, v92, v7
v_add_f32 v93, v93, v8
v_exp_f32 v12, v12
M v[100:103], a[192:195], v[40:43], v[100:103]
buffer_load_dwordx4 v70, s[12:15], s47 offen offset:1024 nt lds
M v[104:107], a[192:195], v[44:47], v[104:107]
v_exp_f32 v13, v13
M v[108:111], a[192:195], v[48:51], v[108:111]
v_exp_f32 v14, v14
M v[4:7], a[160:163], a[4:7], 0
v_exp_f32 v15, v15
M v[4:7], a[164:167], a[24:27], v[4:7]
v_cvt_pk_bf16_f32 v54, v12, v13
v_cvt_pk_bf16_f32 v55, v14, v15
M v[4:7], a[168:171], a[44:47], v[4:7]
ds_read_b64_tr_b16 a[202:203], v63 offset:20480
v_add_f32 v93, v93, v9
M v[4:7], a[172:175], a[64:67], v[4:7]
v_add_f32 v93, v93, v10
v_add_f32 v94, v94, v12
M v[112:115], a[192:195], v[52:55], v[112:115]
s_waitcnt lgkmcnt(2)
v_add_f32 v93, v93, v11
v_add_f32 v94, v94, v13
M v[116:119], a[196:199], v[36:39], v[116:119]
buffer_load_dwordx4 v69, s[12:15], s47 offen offset:2048 nt lds
M v[120:123], a[196:199], v[40:43], v[120:123]
ds_read_b64_tr_b16 a[204:205], v64 offset:16384
v_add_f32 v94, v94, v14
M v[124:127], a[196:199], v[44:47], v[124:127]
ds_read_b64_tr_b16 a[206:207], v64 offset:20480
v_add_f32 v94, v94, v15
M v[8:11], a[160:163], a[8:11], 0
v_exp_f32 v0, v0
M v[8:11], a[164:167], a[28:31], v[8:11]
buffer_load_dwordx4 v70, s[12:15], s47 offen offset:3072 nt lds
M v[8:11], a[168:171], a[48:51], v[8:11]
s_add_u32 m0, s36, 65536
v_exp_f32 v1, v1
M v[8:11], a[172:175], a[68:71], v[8:11]
ds_read_b128 a[176:179], v57 offset:36864
v_add_f32 v90, v90, v0
M v[128:131], a[196:199], v[48:51], v[128:131]
v_exp_f32 v2, v2
M v[132:135], a[196:199], v[52:55], v[132:135]
s_waitcnt lgkmcnt(3)
v_cvt_pk_bf16_f32 v16, v0, v1
v_add_f32 v90, v90, v1
M v[136:139], a[200:203], v[36:39], v[136:139]
v_exp_f32 v3, v3
M v[140:143], a[200:203], v[40:43], v[140:143]
v_cvt_pk_bf16_f32 v17, v2, v3
v_add_f32 v90, v90, v2
M v[12:15], a[160:163], a[12:15], 0
ds_read_b128 a[180:183], v58 offset:36864
v_add_f32 v90, v90, v3
M v[12:15], a[164:167], a[32:35], v[12:15]
ds_read_b128 a[184:187], v59 offset:36864
M v[12:15], a[168:171], a[52:55], v[12:15]
buffer_load_dwordx4 v69, s[16:19], s48 offen nt lds
M v[12:15], a[172:175], a[72:75], v[12:15]
ds_read_b128 a[188:191], v60 offset:36864
M v[144:147], a[200:203], v[44:47], v[144:147]
ds_read_b64_tr_b16 a[192:193], v65 offset:16384
M v[148:151], a[200:203], v[48:51], v[148:151]
v_exp_f32 v4, v4
M v[152:155], a[200:203], v[52:55], v[152:155]
s_waitcnt lgkmcnt(5)
ds_read_b64_tr_b16 a[194:195], v65 offset:20480
v_add_f32 v91, v91, v4
M v[156:159], a[204:207], v[36:39], v[156:159]
v_exp_f32 v5, v5
M v[0:3], a[160:163], a[16:19], 0
v_exp_f32 v6, v6
M v[0:3], a[164:167], a[36:39], v[0:3]
v_cvt_pk_bf16_f32 v20, v4, v5
v_add_f32 v91, v91, v5
M v[0:3], a[168:171], a[56:59], v[0:3]
v_exp_f32 v7, v7
M v[0:3], a[172:175], a[76:79], v[0:3]
v_cvt_pk_bf16_f32 v21, v6, v7
v_add_f32 v91, v91, v6
M v[160:163], a[204:207], v[40:43], v[160:163]
s_add_u32 s49, s43, 81920
ds_read_b64_tr_b16 a[196:197], v66 offset:16384
v_add_f32 v91, v91, v7
M v[164:167], a[204:207], v[44:47], v[164:167]
s_and_b32 s49, s49, 131071
buffer_load_dwordx4 v70, s[16:19], s48 offen offset:1024 nt lds
M v[168:171], a[204:207], v[48:51], v[168:171]
s_add_u32 s49, s49, s100
v_exp_f32 v8, v8
M v[172:175], a[204:207], v[52:55], v[172:175]
s_waitcnt lgkmcnt(6)
v_exp_f32 v9, v9
M v[4:7], a[176:179], a[0:3], 0
s_waitcnt lgkmcnt(5)
ds_read_b64_tr_b16 a[198:199], v66 offset:20480
v_add_f32 v92, v92, v8
M v[4:7], a[180:183], a[20:23], v[4:7]
s_waitcnt lgkmcnt(5)
v_exp_f32 v10, v10
M v[4:7], a[184:187], a[40:43], v[4:7]
s_waitcnt lgkmcnt(4)
v_cvt_pk_bf16_f32 v24, v8, v9
v_add_f32 v92, v92, v9
M v[4:7], a[188:191], a[60:63], v[4:7]
s_waitcnt lgkmcnt(2)
v_exp_f32 v11, v11
M v[176:179], a[192:195], v[36:39], v[176:179]
v_cvt_pk_bf16_f32 v25, v10, v11
v_add_f32 v92, v92, v10
M v[180:183], a[192:195], v[40:43], v[180:183]
ds_read_b64_tr_b16 a[200:201], v67 offset:16384
v_add_f32 v92, v92, v11
M v[184:187], a[192:195], v[44:47], v[184:187]
buffer_load_dwordx4 v69, s[16:19], s48 offen offset:2048 nt lds
M v[188:191], a[192:195], v[48:51], v[188:191]
v_exp_f32 v12, v12
v_exp_f32 v13, v13
v_add_f32 v93, v93, v12
M v[8:11], a[176:179], a[4:7], 0
v_exp_f32 v14, v14
v_add_f32 v93, v93, v13
M v[8:11], a[180:183], a[24:27], v[8:11]
v_exp_f32 v15, v15
M v[8:11], a[184:187], a[44:47], v[8:11]
ds_read_b64_tr_b16 a[202:203], v67 offset:20480
v_add_f32 v93, v93, v14
M v[8:11], a[188:191], a[64:67], v[8:11]
v_cvt_pk_bf16_f32 v28, v12, v13
v_add_f32 v93, v93, v15
M v[192:195], a[192:195], v[52:55], v[192:195]
s_waitcnt lgkmcnt(2)
ds_read_b64_tr_b16 a[204:205], v68 offset:16384
v_cvt_pk_bf16_f32 v29, v14, v15
M v[196:199], a[196:199], v[36:39], v[196:199]
v_exp_f32 v0, v0
M v[200:203], a[196:199], v[40:43], v[200:203]
v_exp_f32 v1, v1
v_add_f32 v94, v94, v0
v_exp_f32 v2, v2
v_add_f32 v94, v94, v1
v_exp_f32 v3, v3
v_add_f32 v94, v94, v2
v_add_f32 v94, v94, v3
M v[204:207], a[196:199], v[44:47], v[204:207]
buffer_load_dwordx4 v70, s[16:19], s48 offen offset:3072 nt lds
ds_read_b64_tr_b16 a[206:207], v68 offset:20480
v_cvt_pk_bf16_f32 v32, v0, v1
v_cvt_pk_bf16_f32 v33, v2, v3
M v[12:15], a[176:179], a[8:11], 0
s_add_u32 m0, s36, 32768
v_exp_f32 v4, v4
v_exp_f32 v5, v5
M v[12:15], a[180:183], a[28:31], v[12:15]
v_cvt_pk_bf16_f32 v18, v4, v5
v_add_f32 v90, v90, v4
M v[12:15], a[184:187], a[48:51], v[12:15]
v_exp_f32 v6, v6
M v[12:15], a[188:191], a[68:71], v[12:15]
v_add_f32 v90, v90, v5
v_add_f32 v90, v90, v6
v_exp_f32 v7, v7
v_exp_f32 v8, v8
M v[208:211], a[196:199], v[48:51], v[208:211]
v_cvt_pk_bf16_f32 v19, v6, v7
v_add_f32 v90, v90, v7
M v[212:215], a[196:199], v[52:55], v[212:215]
s_waitcnt lgkmcnt(2)
v_exp_f32 v9, v9
M v[216:219], a[200:203], v[36:39], v[216:219]
v_cvt_pk_bf16_f32 v22, v8, v9
v_add_f32 v91, v91, v8
M v[220:223], a[200:203], v[40:43], v[220:223]
v_exp_f32 v10, v10
M v[0:3], a[176:179], a[12:15], 0
s_mov_b64 exec, 0
s_branch L_hop_c2
L_ret_c2:
s_mov_b64 exec, -1
s_mov_b64 exec, 0
s_branch L_hop_c3
L_ret_c3:
s_mov_b64 exec, -1
s_waitcnt vmcnt(16) lgkmcnt(0)
v_add_f32 v91, v91, v9
v_add_f32 v91, v91, v10
M v[0:3], a[180:183], a[32:35], v[0:3]
s_barrier
ds_read_b128 a[160:163], v57 offset:49152
M v[0:3], a[184:187], a[52:55], v[0:3]
ds_read_b128 a[164:167], v58 offset:49152
v_exp_f32 v11, v11
M v[0:3], a[188:191], a[72:75], v[0:3]
ds_read_b128 a[168:171], v59 offset:49152
v_add_f32 v91, v91, v11
M v[224:227], a[200:203], v[44:47], v[224:227]
ds_read_b128 a[172:175], v60 offset:49152
v_cvt_pk_bf16_f32 v23, v10, v11
M v[228:231], a[200:203], v[48:51], v[228:231]
ds_read_b64_tr_b16 a[192:193], v61 offset:32768
M v[232:235], a[200:203], v[52:55], v[232:235]
ds_read_b64_tr_b16 a[194:195], v61 offset:36864
buffer_load_dwordx4 v69, s[12:15], s49 offen nt lds
M v[236:239], a[204:207], v[36:39], v[236:239]
v_exp_f32 v12, v12
M v[4:7], a[176:179], a[16:19], 0
s_add_u32 s50, s43, 73728
v_exp_f32 v13, v13
M v[4:7], a[180:183], a[36:39], v[4:7]
s_and_b32 s50, s50, 131071
v_exp_f32 v14, v14
M v[4:7], a[184:187], a[56:59], v[4:7]
s_add_u32 s50, s50, s100
v_exp_f32 v15, v15
M v[4:7], a[188:191], a[76:79], v[4:7]
ds_read_b64_tr_b16 a[196:197], v62 offset:32768
v_cvt_pk_bf16_f32 v26, v12, v13
M v[240:243], a[204:207], v[40:43], v[240:243]
v_exp_f32 v0, v0
M v[244:247], a[204:207], v[44:47], v[244:247]
v_exp_f32 v1, v1
M v[248:251], a[204:207], v[48:51], v[248:251]
v_exp_f32 v2, v2
M v[252:255], a[204:207], v[52:55], v[252:255]
s_waitcnt lgkmcnt(6)
v_exp_f32 v3, v3
M v[8:11], a[160:163], a[0:3], 0
s_waitcnt lgkmcnt(5)
v_cvt_pk_bf16_f32 v27, v14, v15
v_add_f32 v92, v92, v12
M v[8:11], a[164:167], a[20:23], v[8:11]
s_waitcnt lgkmcnt(4)
ds_read_b64_tr_b16 a[198:199], v62 offset:36864
v_add_f32 v92, v92, v13
M v[8:11], a[168:171], a[40:43], v[8:11]
s_waitcnt lgkmcnt(4)
v_cvt_pk_bf16_f32 v30, v0, v1
v_cvt_pk_bf16_f32 v31, v2, v3
M v[8:11], a[172:175], a[60:63], v[8:11]
s_waitcnt lgkmcnt(2)
ds_read_b64_tr_b16 a[200:201], v63 offset:32768
v_add_f32 v92, v92, v14
M v[96:99], a[192:195], v[16:19], v[96:99]
v_add_f32 v92, v92, v15
v_add_f32 v93, v93, v0
v_exp_f32 v4, v4
M v[100:103], a[192:195], v[20:23], v[100:103]
buffer_load_dwordx4 v70, s[12:15], s49 offen offset:1024 nt lds
M v[104:107], a[192:195], v[24:27], v[104:107]
v_exp_f32 v5, v5
M v[108:111], a[192:195], v[28:31], v[108:111]
v_exp_f32 v6, v6
M v[12:15], a[160:163], a[4:7], 0
v_exp_f32 v7, v7
M v[12:15], a[164:167], a[24:27], v[12:15]
v_cvt_pk_bf16_f32 v34, v4, v5
v_cvt_pk_bf16_f32 v35, v6, v7
M v[12:15], a[168:171], a[44:47], v[12:15]
ds_read_b64_tr_b16 a[202:203], v63 offset:36864
v_add_f32 v93, v93, v1
M v[12:15], a[172:175], a[64:67], v[12:15]
v_add_f32 v93, v93, v2
v_add_f32 v94, v94, v4
M v[112:115], a[192:195], v[32:35], v[112:115]
s_waitcnt lgkmcnt(2)
v_add_f32 v93, v93, v3
v_add_f32 v94, v94, v5
M v[116:119], a[196:199], v[16:19], v[116:119]
buffer_load_dwordx4 v69, s[12:15], s49 offen offset:2048 nt lds
M v[120:123], a[196:199], v[20:23], v[120:123]
ds_read_b64_tr_b16 a[204:205], v64 offset:32768
v_add_f32 v94, v94, v6
M v[124:127], a[196:199], v[24:27], v[124:127]
ds_read_b64_tr_b16 a[206:207], v64 offset:36864
v_add_f32 v94, v94, v7
M v[0:3], a[160:163], a[8:11], 0
v_exp_f32 v8, v8
M v[0:3], a[164:167], a[28:31], v[0:3]
buffer_load_dwordx4 v70, s[12:15], s49 offen offset:3072 nt lds
M v[0:3], a[168:171], a[48:51], v[0:3]
s_add_u32 m0, s36, 81920
v_exp_f32 v9, v9
M v[0:3], a[172:175], a[68:71], v[0:3]
ds_read_b128 a[176:179], v57 offset:53248
v_add_f32 v90, v90, v8
M v[128:131], a[196:199], v[28:31], v[128:131]
v_exp_f32 v10, v10
M v[132:135], a[196:199], v[32:35], v[132:135]
s_waitcnt lgkmcnt(3)
v_cvt_pk_bf16_f32 v36, v8, v9
v_add_f32 v90, v90, v9
M v[136:139], a[200:203], v[16:19], v[136:139]
v_exp_f32 v11, v11
M v[140:143], a[200:203], v[20:23], v[140:143]
v_cvt_pk_bf16_f32 v37, v10, v11
v_add_f32 v90, v90, v10
M v[4:7], a[160:163], a[12:15], 0
ds_read_b128 a[180:183], v58 offset:53248
v_add_f32 v90, v90, v11
M v[4:7], a[164:167], a[32:35], v[4:7]
ds_read_b128 a[184:187], v59 offset:53248
M v[4:7], a[168:171], a[52:55], v[4:7]
buffer_load_dwordx4 v69, s[16:19], s50 offen nt lds
M v[4:7], a[172:175], a[72:75], v[4:7]
ds_read_b128 a[188:191], v60 offset:53248
M v[144:147], a[200:203], v[24:27], v[144:147]
ds_read_b64_tr_b16 a[192:193], v65 offset:32768
M v[148:151], a[200:203], v[28:31], v[148:151]
v_exp_f32 v12, v12
M v[152:155], a[200:203], v[32:35], v[152:155]
s_waitcnt lgkmcnt(5)
ds_read_b64_tr_b16 a[194:195], v65 offset:36864
v_add_f32 v91, v91, v12
M v[156:159], a[204:207], v[16:19], v[156:159]
v_exp_f32 v13, v13
M v[8:11], a[160:163], a[16:19], 0
v_exp_f32 v14, v14
M v[8:11], a[164:167], a[36:39], v[8:11]
v_cvt_pk_bf16_f32 v40, v12, v13
v_add_f32 v91, v91, v13
M v[8:11], a[168:171], a[56:59], v[8:11]
v_exp_f32 v15, v15
M v[8:11], a[172:175], a[76:79], v[8:11]
v_cvt_pk_bf16_f32 v41, v14, v15
v_add_f32 v91, v91, v14
M v[160:163], a[204:207], v[20:23], v[160:163]
s_add_u32 s51, s43, 90112
ds_read_b64_tr_b16 a[196:197], v66 offset:32768
v_add_f32 v91, v91, v15
M v[164:167], a[204:207], v[24:27], v[164:167]
s_and_b32 s51, s51, 131071
buffer_load_dwordx4 v70, s[16:19], s50 offen offset:1024 nt lds
M v[168:171], a[204:207], v[28:31], v[168:171]
s_add_u32 s51, s51, s100
v_exp_f32 v0, v0
M v[172:175], a[204:207], v[32:35], v[172:175]
s_waitcnt lgkmcnt(6)
v_exp_f32 v1, v1
M v[12:15], a[176:179], a[0:3], 0
s_waitcnt lgkmcnt(5)
ds_read_b64_tr_b16 a[198:199], v66 offset:36864
v_add_f32 v92, v92, v0
M v[12:15], a[180:183], a[20:23], v[12:15]
s_waitcnt lgkmcnt(5)
v_exp_f32 v2, v2
M v[12:15], a[184:187], a[40:43], v[12:15]
s_waitcnt lgkmcnt(4)
v_cvt_pk_bf16_f32 v44, v0, v1
v_add_f32 v92, v92, v1
M v[12:15], a[188:191], a[60:63], v[12:15]
s_waitcnt lgkmcnt(2)
v_exp_f32 v3, v3
M v[176:179], a[192:195], v[16:19], v[176:179]
v_cvt_pk_bf16_f32 v45, v2, v3
v_add_f32 v92, v92, v2
M v[180:183], a[192:195], v[20:23], v[180:183]
ds_read_b64_tr_b16 a[200:201], v67 offset:32768
v_add_f32 v92, v92, v3
M v[184:187], a[192:195], v[24:27], v[184:187]
buffer_load_dwordx4 v69, s[16:19], s50 offen offset:2048 nt lds
M v[188:191], a[192:195], v[28:31], v[188:191]
v_exp_f32 v4, v4
v_exp_f32 v5, v5
v_add_f32 v93, v93, v4
M v[0:3], a[176:179], a[4:7], 0
v_exp_f32 v6, v6
v_add_f32 v93, v93, v5
M v[0:3], a[180:183], a[24:27], v[0:3]
v_exp_f32 v7, v7
M v[0:3], a[184:187], a[44:47], v[0:3]
ds_read_b64_tr_b16 a[202:203], v67 offset:36864
v_add_f32 v93, v93, v6
M v[0:3], a[188:191], a[64:67], v[0:3]
v_cvt_pk_bf16_f32 v48, v4, v5
v_add_f32 v93, v93, v7
M v[192:195], a[192:195], v[32:35], v[192:195]
s_waitcnt lgkmcnt(2)
ds_read_b64_tr_b16 a[204:205], v68 offset:32768
v_cvt_pk_bf16_f32 v49, v6, v7
M v[196:199], a[196:199], v[16:19], v[196:199]
v_exp_f32 v8, v8
M v[200:203], a[196:199], v[20:23], v[200:203]
v_exp_f32 v9, v9
v_add_f32 v94, v94, v8
v_exp_f32 v10, v10
v_add_f32 v94, v94, v9
v_exp_f32 v11, v11
v_add_f32 v94, v94, v10
v_add_f32 v94, v94, v11
M v[204:207], a[196:199], v[24:27], v[204:207]
buffer_load_dwordx4 v70, s[16:19], s50 offen offset:3072 nt lds
ds_read_b64_tr_b16 a[206:207], v68 offset:36864
v_cvt_pk_bf16_f32 v52, v8, v9
v_cvt_pk_bf16_f32 v53, v10, v11
M v[4:7], a[176:179], a[8:11], 0
s_add_u32 m0, s36, 49152
v_exp_f32 v12, v12
v_exp_f32 v13, v13
M v[4:7], a[180:183], a[28:31], v[4:7]
v_cvt_pk_bf16_f32 v38, v12, v13
v_add_f32 v90, v90, v12
M v[4:7], a[184:187], a[48:51], v[4:7]
v_exp_f32 v14, v14
M v[4:7], a[188:191], a[68:71], v[4:7]
v_add_f32 v90, v90, v13
v_add_f32 v90, v90, v14
v_exp_f32 v15, v15
v_exp_f32 v0, v0
M v[208:211], a[196:199], v[28:31], v[208:211]
v_cvt_pk_bf16_f32 v39, v14, v15
v_add_f32 v90, v90, v15
M v[212:215], a[196:199], v[32:35], v[212:215]
s_waitcnt lgkmcnt(2)
v_exp_f32 v1, v1
M v[216:219], a[200:203], v[16:19], v[216:219]
v_cvt_pk_bf16_f32 v42, v0, v1
v_add_f32 v91, v91, v0
M v[220:223], a[200:203], v[20:23], v[220:223]
v_exp_f32 v2, v2
M v[8:11], a[176:179], a[12:15], 0
s_mov_b64 exec, 0
s_branch L_hop_c4
L_ret_c4:
s_mov_b64 exec, -1
s_mov_b64 exec, 0
s_branch L_hop_c5
L_ret_c5:
s_mov_b64 exec, -1
s_waitcnt vmcnt(16) lgkmcnt(0)
v_add_f32 v91, v91, v1
v_add_f32 v91, v91, v2
M v[8:11], a[180:183], a[32:35], v[8:11]
s_barrier
ds_read_b128 a[160:163], v57 offset:0
M v[8:11], a[184:187], a[52:55], v[8:11]
ds_read_b128 a[164:167], v58 offset:0
v_exp_f32 v3, v3
M v[8:11], a[188:191], a[72:75], v[8:11]
ds_read_b128 a[168:171], v59 offset:0
v_add_f32 v91, v91, v3
M v[224:227], a[200:203], v[24:27], v[224:227]
ds_read_b128 a[172:175], v60 offset:0
v_cvt_pk_bf16_f32 v43, v2, v3
M v[228:231], a[200:203], v[28:31], v[228:231]
ds_read_b64_tr_b16 a[192:193], v61 offset:49152
M v[232:235], a[200:203], v[32:35], v[232:235]
ds_read_b64_tr_b16 a[194:195], v61 offset:53248
buffer_load_dwordx4 v69, s[12:15], s51 offen nt lds
M v[236:239], a[204:207], v[16:19], v[236:239]
v_exp_f32 v4, v4
M v[12:15], a[176:179], a[16:19], 0
s_add_u32 s44, s43, 81920
v_exp_f32 v5, v5
M v[12:15], a[180:183], a[36:39], v[12:15]
s_and_b32 s44, s44, 131071
v_exp_f32 v6, v6
M v[12:15], a[184:187], a[56:59], v[12:15]
s_add_u32 s44, s44, s100
v_exp_f32 v7, v7
M v[12:15], a[188:191], a[76:79], v[12:15]
ds_read_b64_tr_b16 a[196:197], v62 offset:49152
v_cvt_pk_bf16_f32 v46, v4, v5
M v[240:243], a[204:207], v[20:23], v[240:243]
v_exp_f32 v8, v8
M v[244:247], a[204:207], v[24:27], v[244:247]
v_exp_f32 v9, v9
M v[248:251], a[204:207], v[28:31], v[248:251]
v_exp_f32 v10, v10
M v[252:255], a[204:207], v[32:35], v[252:255]
s_waitcnt lgkmcnt(6)
v_exp_f32 v11, v11
M v[0:3], a[160:163], a[0:3], 0
s_waitcnt lgkmcnt(5)
v_cvt_pk_bf16_f32 v47, v6, v7
v_add_f32 v92, v92, v4
M v[0:3], a[164:167], a[20:23], v[0:3]
s_waitcnt lgkmcnt(4)
ds_read_b64_tr_b16 a[198:199], v62 offset:53248
v_add_f32 v92, v92, v5
M v[0:3], a[168:171], a[40:43], v[0:3]
s_waitcnt lgkmcnt(4)
v_cvt_pk_bf16_f32 v50, v8, v9
v_cvt_pk_bf16_f32 v51, v10, v11
M v[0:3], a[172:175], a[60:63], v[0:3]
s_waitcnt lgkmcnt(2)
ds_read_b64_tr_b16 a[200:201], v63 offset:49152
v_add_f32 v92, v92, v6
M v[96:99], a[192:195], v[36:39], v[96:99]
v_add_f32 v92, v92, v7
v_add_f32 v93, v93, v8
v_exp_f32 v12, v12
M v[100:103], a[192:195], v[40:43], v[100:103]
buffer_load_dwordx4 v70, s[12:15], s51 offen offset:1024 nt lds
M v[104:107], a[192:195], v[44:47], v[104:107]
v_exp_f32 v13, v13
M v[108:111], a[192:195], v[48:51], v[108:111]
v_exp_f32 v14, v14
M v[4:7], a[160:163], a[4:7], 0
v_exp_f32 v15, v15
M v[4:7], a[164:167], a[24:27], v[4:7]
v_cvt_pk_bf16_f32 v54, v12, v13
v_cvt_pk_bf16_f32 v55, v14, v15
M v[4:7], a[168:171], a[44:47], v[4:7]
ds_read_b64_tr_b16 a[202:203], v63 offset:53248
v_add_f32 v93, v93, v9
M v[4:7], a[172:175], a[64:67], v[4:7]
v_add_f32 v93, v93, v10
v_add_f32 v94, v94, v12
M v[112:115], a[192:195], v[52:55], v[112:115]
s_waitcnt lgkmcnt(2)
v_add_f32 v93, v93, v11
v_add_f32 v94, v94, v13
M v[116:119], a[196:199], v[36:39], v[116:119]
buffer_load_dwordx4 v69, s[12:15], s51 offen offset:2048 nt lds
M v[120:123], a[196:199], v[40:43], v[120:123]
ds_read_b64_tr_b16 a[204:205], v64 offset:49152
v_add_f32 v94, v94, v14
M v[124:127], a[196:199], v[44:47], v[124:127]
ds_read_b64_tr_b16 a[206:207], v64 offset:53248
v_add_f32 v94, v94, v15
M v[8:11], a[160:163], a[8:11], 0
v_exp_f32 v0, v0
M v[8:11], a[164:167], a[28:31], v[8:11]
buffer_load_dwordx4 v70, s[12:15], s51 offen offset:3072 nt lds
M v[8:11], a[168:171], a[48:51], v[8:11]
s_add_u32 m0, s36, 98304
v_exp_f32 v1, v1
M v[8:11], a[172:175], a[68:71], v[8:11]
ds_read_b128 a[176:179], v57 offset:4096
v_add_f32 v90, v90, v0
M v[128:131], a[196:199], v[48:51], v[128:131]
v_exp_f32 v2, v2
M v[132:135], a[196:199], v[52:55], v[132:135]
s_waitcnt lgkmcnt(3)
v_cvt_pk_bf16_f32 v16, v0, v1
v_add_f32 v90, v90, v1
M v[136:139], a[200:203], v[36:39], v[136:139]
v_exp_f32 v3, v3
M v[140:143], a[200:203], v[40:43], v[140:143]
v_cvt_pk_bf16_f32 v17, v2, v3
v_add_f32 v90, v90, v2
M v[12:15], a[160:163], a[12:15], 0
ds_read_b128 a[180:183], v58 offset:4096
v_add_f32 v90, v90, v3
M v[12:15], a[164:167], a[32:35], v[12:15]
ds_read_b128 a[184:187], v59 offset:4096
M v[12:15], a[168:171], a[52:55], v[12:15]
buffer_load_dwordx4 v69, s[16:19], s44 offen nt lds
M v[12:15], a[172:175], a[72:75], v[12:15]
ds_read_b128 a[188:191], v60 offset:4096
M v[144:147], a[200:203], v[44:47], v[144:147]
ds_read_b64_tr_b16 a[192:193], v65 offset:49152
M v[148:151], a[200:203], v[48:51], v[148:151]
v_exp_f32 v4, v4
M v[152:155], a[200:203], v[52:55], v[152:155]
s_waitcnt lgkmcnt(5)
ds_read_b64_tr_b16 a[194:195], v65 offset:53248
v_add_f32 v91, v91, v4
M v[156:159], a[204:207], v[36:39], v[156:159]
v_exp_f32 v5, v5
M v[0:3], a[160:163], a[16:19], 0
v_exp_f32 v6, v6
M v[0:3], a[164:167], a[36:39], v[0:3]
v_cvt_pk_bf16_f32 v20, v4, v5
v_add_f32 v91, v91, v5
M v[0:3], a[168:171], a[56:59], v[0:3]
v_exp_f32 v7, v7
M v[0:3], a[172:175], a[76:79], v[0:3]
v_cvt_pk_bf16_f32 v21, v6, v7
v_add_f32 v91, v91, v6
M v[160:163], a[204:207], v[40:43], v[160:163]
s_add_u32 s45, s43, 98304
ds_read_b64_tr_b16 a[196:197], v66 offset:49152
v_add_f32 v91, v91, v7
M v[164:167], a[204:207], v[44:47], v[164:167]
s_and_b32 s45, s45, 131071
buffer_load_dwordx4 v70, s[16:19], s44 offen offset:1024 nt lds
M v[168:171], a[204:207], v[48:51], v[168:171]
s_add_u32 s45, s45, s100
v_exp_f32 v8, v8
M v[172:175], a[204:207], v[52:55], v[172:175]
s_waitcnt lgkmcnt(6)
v_exp_f32 v9, v9
M v[4:7], a[176:179], a[0:3], 0
s_waitcnt lgkmcnt(5)
ds_read_b64_tr_b16 a[198:199], v66 offset:53248
v_add_f32 v92, v92, v8
M v[4:7], a[180:183], a[20:23], v[4:7]
s_waitcnt lgkmcnt(5)
v_exp_f32 v10, v10
M v[4:7], a[184:187], a[40:43], v[4:7]
s_waitcnt lgkmcnt(4)
v_cvt_pk_bf16_f32 v24, v8, v9
v_add_f32 v92, v92, v9
M v[4:7], a[188:191], a[60:63], v[4:7]
s_waitcnt lgkmcnt(2)
v_exp_f32 v11, v11
M v[176:179], a[192:195], v[36:39], v[176:179]
s_add_u32 s58, s53, 0
v_cvt_pk_bf16_f32 v25, v10, v11
v_add_f32 v92, v92, v10
M v[180:183], a[192:195], v[40:43], v[180:183]
s_and_b32 s58, s58, 7
ds_read_b64_tr_b16 a[200:201], v67 offset:49152
v_add_f32 v92, v92, v11
M v[184:187], a[192:195], v[44:47], v[184:187]
s_mul_i32 s64, s58, 128
buffer_load_dwordx4 v69, s[16:19], s44 offen offset:2048 nt lds
M v[188:191], a[192:195], v[48:51], v[188:191]
s_mul_i32 s72, s58, 20480
v_exp_f32 v12, v12
v_exp_f32 v13, v13
v_add_f32 v93, v93, v12
M v[8:11], a[176:179], a[4:7], 0
s_add_u32 s58, s53, 1
v_exp_f32 v14, v14
v_add_f32 v93, v93, v13
M v[8:11], a[180:183], a[24:27], v[8:11]
s_and_b32 s58, s58, 7
v_exp_f32 v15, v15
M v[8:11], a[184:187], a[44:47], v[8:11]
s_mul_i32 s65, s58, 128
ds_read_b64_tr_b16 a[202:203], v67 offset:53248
v_add_f32 v93, v93, v14
M v[8:11], a[188:191], a[64:67], v[8:11]
s_mul_i32 s73, s58, 20480
v_cvt_pk_bf16_f32 v28, v12, v13
v_add_f32 v93, v93, v15
M v[192:195], a[192:195], v[52:55], v[192:195]
s_waitcnt lgkmcnt(2)
ds_read_b64_tr_b16 a[204:205], v68 offset:49152
v_cvt_pk_bf16_f32 v29, v14, v15
M v[196:199], a[196:199], v[36:39], v[196:199]
s_add_u32 s64, s64, s35
v_exp_f32 v0, v0
M v[200:203], a[196:199], v[40:43], v[200:203]
s_add_u32 s72, s72, s40
v_exp_f32 v1, v1
v_add_f32 v94, v94, v0
v_exp_f32 v2, v2
v_add_f32 v94, v94, v1
v_exp_f32 v3, v3
v_add_f32 v94, v94, v2
v_add_f32 v94, v94, v3
M v[204:207], a[196:199], v[44:47], v[204:207]
s_add_u32 s65, s65, s35
buffer_load_dwordx4 v70, s[16:19], s44 offen offset:3072 nt lds
ds_read_b64_tr_b16 a[206:207], v68 offset:53248
v_cvt_pk_bf16_f32 v32, v0, v1
v_cvt_pk_bf16_f32 v33, v2, v3
M v[12:15], a[176:179], a[8:11], 0
s_add_u32 m0, s36, 0
v_exp_f32 v4, v4
v_exp_f32 v5, v5
M v[12:15], a[180:183], a[28:31], v[12:15]
s_add_u32 s73, s73, s40
v_cvt_pk_bf16_f32 v18, v4, v5
v_add_f32 v90, v90, v4
M v[12:15], a[184:187], a[48:51], v[12:15]
v_exp_f32 v6, v6
M v[12:15], a[188:191], a[68:71], v[12:15]
v_add_f32 v90, v90, v5
v_add_f32 v90, v90, v6
v_exp_f32 v7, v7
v_exp_f32 v8, v8
M v[208:211], a[196:199], v[48:51], v[208:211]
v_cvt_pk_bf16_f32 v19, v6, v7
v_add_f32 v90, v90, v7
M v[212:215], a[196:199], v[52:55], v[212:215]
s_waitcnt lgkmcnt(2)
v_exp_f32 v9, v9
M v[216:219], a[200:203], v[36:39], v[216:219]
v_cvt_pk_bf16_f32 v22, v8, v9
v_add_f32 v91, v91, v8
M v[220:223], a[200:203], v[40:43], v[220:223]
v_exp_f32 v10, v10
M v[0:3], a[176:179], a[12:15], 0
s_mov_b64 exec, 0
s_branch L_hop_c6
L_ret_c6:
s_mov_b64 exec, -1
s_mov_b64 exec, 0
s_branch L_hop_c7
L_ret_c7:
s_mov_b64 exec, -1
s_waitcnt vmcnt(16) lgkmcnt(0)
v_add_f32 v91, v91, v9
v_add_f32 v91, v91, v10
M v[0:3], a[180:183], a[32:35], v[0:3]
s_barrier
ds_read_b128 a[160:163], v57 offset:16384
M v[0:3], a[184:187], a[52:55], v[0:3]
ds_read_b128 a[164:167], v58 offset:16384
v_exp_f32 v11, v11
M v[0:3], a[188:191], a[72:75], v[0:3]
ds_read_b128 a[168:171], v59 offset:16384
v_add_f32 v91, v91, v11
M v[224:227], a[200:203], v[44:47], v[224:227]
ds_read_b128 a[172:175], v60 offset:16384
v_cvt_pk_bf16_f32 v23, v10, v11
M v[228:231], a[200:203], v[48:51], v[228:231]
ds_read_b64_tr_b16 a[192:193], v61 offset:0
M v[232:235], a[200:203], v[52:55], v[232:235]
ds_read_b64_tr_b16 a[194:195], v61 offset:4096
buffer_load_dwordx4 v69, s[12:15], s45 offen nt lds
M v[236:239], a[204:207], v[36:39], v[236:239]
v_exp_f32 v12, v12
M v[4:7], a[176:179], a[16:19], 0
s_add_u32 s46, s43, 90112
v_exp_f32 v13, v13
M v[4:7], a[180:183], a[36:39], v[4:7]
s_and_b32 s46, s46, 131071
v_exp_f32 v14, v14
M v[4:7], a[184:187], a[56:59], v[4:7]
s_add_u32 s46, s46, s100
v_exp_f32 v15, v15
M v[4:7], a[188:191], a[76:79], v[4:7]
ds_read_b64_tr_b16 a[196:197], v62 offset:0
v_cvt_pk_bf16_f32 v26, v12, v13
M v[240:243], a[204:207], v[40:43], v[240:243]
v_exp_f32 v0, v0
M v[244:247], a[204:207], v[44:47], v[244:247]
v_exp_f32 v1, v1
M v[248:251], a[204:207], v[48:51], v[248:251]
v_exp_f32 v2, v2
M v[252:255], a[204:207], v[52:55], v[252:255]
s_waitcnt lgkmcnt(6)
v_exp_f32 v3, v3
M v[8:11], a[160:163], a[0:3], 0
s_waitcnt lgkmcnt(5)
v_cvt_pk_bf16_f32 v27, v14, v15
v_add_f32 v92, v92, v12
M v[8:11], a[164:167], a[20:23], v[8:11]
s_waitcnt lgkmcnt(4)
ds_read_b64_tr_b16 a[198:199], v62 offset:4096
v_add_f32 v92, v92, v13
M v[8:11], a[168:171], a[40:43], v[8:11]
s_waitcnt lgkmcnt(4)
v_cvt_pk_bf16_f32 v30, v0, v1
v_cvt_pk_bf16_f32 v31, v2, v3
M v[8:11], a[172:175], a[60:63], v[8:11]
s_waitcnt lgkmcnt(2)
ds_read_b64_tr_b16 a[200:201], v63 offset:0
v_add_f32 v92, v92, v14
M v[96:99], a[192:195], v[16:19], v[96:99]
v_add_f32 v92, v92, v15
v_add_f32 v93, v93, v0
v_exp_f32 v4, v4
M v[100:103], a[192:195], v[20:23], v[100:103]
buffer_load_dwordx4 v70, s[12:15], s45 offen offset:1024 nt lds
M v[104:107], a[192:195], v[24:27], v[104:107]
v_exp_f32 v5, v5
M v[108:111], a[192:195], v[28:31], v[108:111]
v_exp_f32 v6, v6
M v[12:15], a[160:163], a[4:7], 0
v_exp_f32 v7, v7
M v[12:15], a[164:167], a[24:27], v[12:15]
v_cvt_pk_bf16_f32 v34, v4, v5
v_cvt_pk_bf16_f32 v35, v6, v7
M v[12:15], a[168:171], a[44:47], v[12:15]
ds_read_b64_tr_b16 a[202:203], v63 offset:4096
v_add_f32 v93, v93, v1
M v[12:15], a[172:175], a[64:67], v[12:15]
v_add_f32 v93, v93, v2
v_add_f32 v94, v94, v4
M v[112:115], a[192:195], v[32:35], v[112:115]
s_waitcnt lgkmcnt(2)
v_add_f32 v93, v93, v3
v_add_f32 v94, v94, v5
M v[116:119], a[196:199], v[16:19], v[116:119]
buffer_load_dwordx4 v69, s[12:15], s45 offen offset:2048 nt lds
M v[120:123], a[196:199], v[20:23], v[120:123]
ds_read_b64_tr_b16 a[204:205], v64 offset:0
v_add_f32 v94, v94, v6
M v[124:127], a[196:199], v[24:27], v[124:127]
ds_read_b64_tr_b16 a[206:207], v64 offset:4096
v_add_f32 v94, v94, v7
M v[0:3], a[160:163], a[8:11], 0
v_exp_f32 v8, v8
M v[0:3], a[164:167], a[28:31], v[0:3]
buffer_load_dwordx4 v70, s[12:15], s45 offen offset:3072 nt lds
M v[0:3], a[168:171], a[48:51], v[0:3]
s_add_u32 m0, s36, 114688
v_exp_f32 v9, v9
M v[0:3], a[172:175], a[68:71], v[0:3]
ds_read_b128 a[176:179], v57 offset:20480
v_add_f32 v90, v90, v8
M v[128:131], a[196:199], v[28:31], v[128:131]
v_exp_f32 v10, v10
M v[132:135], a[196:199], v[32:35], v[132:135]
s_waitcnt lgkmcnt(3)
v_cvt_pk_bf16_f32 v36, v8, v9
v_add_f32 v90, v90, v9
M v[136:139], a[200:203], v[16:19], v[136:139]
v_exp_f32 v11, v11
M v[140:143], a[200:203], v[20:23], v[140:143]
v_cvt_pk_bf16_f32 v37, v10, v11
v_add_f32 v90, v90, v10
M v[4:7], a[160:163], a[12:15], 0
ds_read_b128 a[180:183], v58 offset:20480
v_add_f32 v90, v90, v11
M v[4:7], a[164:167], a[32:35], v[4:7]
ds_read_b128 a[184:187], v59 offset:20480
M v[4:7], a[168:171], a[52:55], v[4:7]
buffer_load_dwordx4 v69, s[16:19], s46 offen nt lds
M v[4:7], a[172:175], a[72:75], v[4:7]
ds_read_b128 a[188:191], v60 offset:20480
M v[144:147], a[200:203], v[24:27], v[144:147]
ds_read_b64_tr_b16 a[192:193], v65 offset:0
M v[148:151], a[200:203], v[28:31], v[148:151]
v_exp_f32 v12, v12
M v[152:155], a[200:203], v[32:35], v[152:155]
s_waitcnt lgkmcnt(5)
ds_read_b64_tr_b16 a[194:195], v65 offset:4096
v_add_f32 v91, v91, v12
M v[156:159], a[204:207], v[16:19], v[156:159]
v_exp_f32 v13, v13
M v[8:11], a[160:163], a[16:19], 0
v_exp_f32 v14, v14
M v[8:11], a[164:167], a[36:39], v[8:11]
v_cvt_pk_bf16_f32 v40, v12, v13
v_add_f32 v91, v91, v13
M v[8:11], a[168:171], a[56:59], v[8:11]
v_exp_f32 v15, v15
M v[8:11], a[172:175], a[76:79], v[8:11]
v_cvt_pk_bf16_f32 v41, v14, v15
v_add_f32 v91, v91, v14
M v[160:163], a[204:207], v[20:23], v[160:163]
s_add_u32 s47, s43, 106496
ds_read_b64_tr_b16 a[196:197], v66 offset:0
v_add_f32 v91, v91, v15
M v[164:167], a[204:207], v[24:27], v[164:167]
s_and_b32 s47, s47, 131071
buffer_load_dwordx4 v70, s[16:19], s46 offen offset:1024 nt lds
M v[168:171], a[204:207], v[28:31], v[168:171]
s_add_u32 s47, s47, s100
v_exp_f32 v0, v0
M v[172:175], a[204:207], v[32:35], v[172:175]
s_waitcnt lgkmcnt(6)
v_exp_f32 v1, v1
M v[12:15], a[176:179], a[0:3], 0
s_waitcnt lgkmcnt(5)
ds_read_b64_tr_b16 a[198:199], v66 offset:4096
v_add_f32 v92, v92, v0
M v[12:15], a[180:183], a[20:23], v[12:15]
s_waitcnt lgkmcnt(5)
v_exp_f32 v2, v2
M v[12:15], a[184:187], a[40:43], v[12:15]
s_waitcnt lgkmcnt(4)
v_cvt_pk_bf16_f32 v44, v0, v1
v_add_f32 v92, v92, v1
M v[12:15], a[188:191], a[60:63], v[12:15]
s_waitcnt lgkmcnt(2)
v_exp_f32 v3, v3
M v[176:179], a[192:195], v[16:19], v[176:179]
v_cvt_pk_bf16_f32 v45, v2, v3
v_add_f32 v92, v92, v2
M v[180:183], a[192:195], v[20:23], v[180:183]
ds_read_b64_tr_b16 a[200:201], v67 offset:0
v_add_f32 v92, v92, v3
M v[184:187], a[192:195], v[24:27], v[184:187]
buffer_load_dwordx4 v69, s[16:19], s46 offen offset:2048 nt lds
M v[188:191], a[192:195], v[28:31], v[188:191]
v_exp_f32 v4, v4
v_exp_f32 v5, v5
v_add_f32 v93, v93, v4
M v[0:3], a[176:179], a[4:7], 0
v_exp_f32 v6, v6
v_add_f32 v93, v93, v5
M v[0:3], a[180:183], a[24:27], v[0:3]
v_exp_f32 v7, v7
M v[0:3], a[184:187], a[44:47], v[0:3]
ds_read_b64_tr_b16 a[202:203], v67 offset:4096
v_add_f32 v93, v93, v6
M v[0:3], a[188:191], a[64:67], v[0:3]
v_cvt_pk_bf16_f32 v48, v4, v5
v_add_f32 v93, v93, v7
M v[192:195], a[192:195], v[32:35], v[192:195]
s_waitcnt lgkmcnt(2)
ds_read_b64_tr_b16 a[204:205], v68 offset:0
v_cvt_pk_bf16_f32 v49, v6, v7
M v[196:199], a[196:199], v[16:19], v[196:199]
v_exp_f32 v8, v8
M v[200:203], a[196:199], v[20:23], v[200:203]
v_exp_f32 v9, v9
v_add_f32 v94, v94, v8
v_exp_f32 v10, v10
v_add_f32 v94, v94, v9
v_exp_f32 v11, v11
v_add_f32 v94, v94, v10
v_add_f32 v94, v94, v11
M v[204:207], a[196:199], v[24:27], v[204:207]
buffer_load_dwordx4 v70, s[16:19], s46 offen offset:3072 nt lds
ds_read_b64_tr_b16 a[206:207], v68 offset:4096
v_cvt_pk_bf16_f32 v52, v8, v9
v_cvt_pk_bf16_f32 v53, v10, v11
M v[4:7], a[176:179], a[8:11], 0
s_add_u32 m0, s36, 16384
v_exp_f32 v12, v12
v_exp_f32 v13, v13
M v[4:7], a[180:183], a[28:31], v[4:7]
v_cvt_pk_bf16_f32 v38, v12, v13
v_add_f32 v90, v90, v12
M v[4:7], a[184:187], a[48:51], v[4:7]
v_exp_f32 v14, v14
M v[4:7], a[188:191], a[68:71], v[4:7]
v_add_f32 v90, v90, v13
v_add_f32 v90, v90, v14
v_exp_f32 v15, v15
v_exp_f32 v0, v0
M v[208:211], a[196:199], v[28:31], v[208:211]
v_cvt_pk_bf16_f32 v39, v14, v15
v_add_f32 v90, v90, v15
M v[212:215], a[196:199], v[32:35], v[212:215]
s_waitcnt lgkmcnt(2)
v_exp_f32 v1, v1
M v[216:219], a[200:203], v[16:19], v[216:219]
v_cvt_pk_bf16_f32 v42, v0, v1
v_add_f32 v91, v91, v0
M v[220:223], a[200:203], v[20:23], v[220:223]
v_exp_f32 v2, v2
M v[8:11], a[176:179], a[12:15], 0
s_mov_b64 exec, 0
s_branch L_hop_c8
L_ret_c8:
s_mov_b64 exec, -1
s_waitcnt vmcnt(16) lgkmcnt(0)
v_add_f32 v91, v91, v1
v_add_f32 v91, v91, v2
M v[8:11], a[180:183], a[32:35], v[8:11]
s_barrier
ds_read_b128 a[160:163], v57 offset:32768
M v[8:11], a[184:187], a[52:55], v[8:11]
s_add_u32 s58, s53, 2
ds_read_b128 a[164:167], v58 offset:32768
v_exp_f32 v3, v3
M v[8:11], a[188:191], a[72:75], v[8:11]
s_and_b32 s58, s58, 7
ds_read_b128 a[168:171], v59 offset:32768
v_add_f32 v91, v91, v3
M v[224:227], a[200:203], v[24:27], v[224:227]
s_mul_i32 s66, s58, 128
ds_read_b128 a[172:175], v60 offset:32768
v_cvt_pk_bf16_f32 v43, v2, v3
M v[228:231], a[200:203], v[28:31], v[228:231]
s_mul_i32 s74, s58, 20480
ds_read_b64_tr_b16 a[192:193], v61 offset:16384
M v[232:235], a[200:203], v[32:35], v[232:235]
s_add_u32 s66, s66, s35
ds_read_b64_tr_b16 a[194:195], v61 offset:20480
buffer_load_dwordx4 v69, s[12:15], s47 offen nt lds
M v[236:239], a[204:207], v[16:19], v[236:239]
s_add_u32 s74, s74, s40
v_exp_f32 v4, v4
M v[12:15], a[176:179], a[16:19], 0
s_add_u32 s58, s53, 3
v_exp_f32 v5, v5
M v[12:15], a[180:183], a[36:39], v[12:15]
s_and_b32 s58, s58, 7
v_exp_f32 v6, v6
M v[12:15], a[184:187], a[56:59], v[12:15]
s_mul_i32 s67, s58, 128
v_exp_f32 v7, v7
M v[12:15], a[188:191], a[76:79], v[12:15]
s_mul_i32 s75, s58, 20480
ds_read_b64_tr_b16 a[196:197], v62 offset:16384
v_cvt_pk_bf16_f32 v46, v4, v5
M v[240:243], a[204:207], v[20:23], v[240:243]
s_add_u32 s67, s67, s35
v_exp_f32 v8, v8
M v[244:247], a[204:207], v[24:27], v[244:247]
s_add_u32 s75, s75, s40
v_exp_f32 v9, v9
M v[248:251], a[204:207], v[28:31], v[248:251]
s_add_u32 s58, s53, 4
v_exp_f32 v10, v10
M v[252:255], a[204:207], v[32:35], v[252:255]
s_waitcnt lgkmcnt(6)
v_exp_f32 v11, v11
M v[0:3], a[160:163], a[0:3], 0
s_waitcnt lgkmcnt(5)
v_cvt_pk_bf16_f32 v47, v6, v7
v_add_f32 v92, v92, v4
M v[0:3], a[164:167], a[20:23], v[0:3]
s_waitcnt lgkmcnt(4)
ds_read_b64_tr_b16 a[198:199], v62 offset:20480
v_add_f32 v92, v92, v5
M v[0:3], a[168:171], a[40:43], v[0:3]
s_waitcnt lgkmcnt(4)
v_cvt_pk_bf16_f32 v50, v8, v9
v_cvt_pk_bf16_f32 v51, v10, v11
M v[0:3], a[172:175], a[60:63], v[0:3]
s_waitcnt lgkmcnt(2)
ds_read_b64_tr_b16 a[200:201], v63 offset:16384
v_add_f32 v92, v92, v6
M v[96:99], a[192:195], v[36:39], v[96:99]
s_and_b32 s58, s58, 7
v_add_f32 v92, v92, v7
v_add_f32 v93, v93, v8
v_exp_f32 v12, v12
M v[100:103], a[192:195], v[40:43], v[100:103]
s_mul_i32 s68, s58, 128
buffer_load_dwordx4 v70, s[12:15], s47 offen offset:1024 nt lds
M v[104:107], a[192:195], v[44:47], v[104:107]
s_mul_i32 s76, s58, 20480
v_exp_f32 v13, v13
M v[108:111], a[192:195], v[48:51], v[108:111]
s_add_u32 s68, s68, s35
v_exp_f32 v14, v14
M v[4:7], a[160:163], a[4:7], 0
s_add_u32 s76, s76, s40
v_exp_f32 v15, v15
M v[4:7], a[164:167], a[24:27], v[4:7]
L_hop_c0:
s_cbranch_execz L_ret_c0
s_add_u32 s58, s53, 5
v_cvt_pk_bf16_f32 v54, v12, v13
v_cvt_pk_bf16_f32 v55, v14, v15
M v[4:7], a[168:171], a[44:47], v[4:7]
s_and_b32 s58, s58, 7
ds_read_b64_tr_b16 a[202:203], v63 offset:20480
v_add_f32 v93, v93, v9
M v[4:7], a[172:175], a[64:67], v[4:7]
s_mul_i32 s69, s58, 128
v_add_f32 v93, v93, v10
v_add_f32 v94, v94, v12
M v[112:115], a[192:195], v[52:55], v[112:115]
s_waitcnt lgkmcnt(2)
v_add_f32 v93, v93, v11
v_add_f32 v94, v94, v13
M v[116:119], a[196:199], v[36:39], v[116:119]
s_mul_i32 s77, s58, 20480
buffer_load_dwordx4 v69, s[12:15], s47 offen offset:2048 nt lds
M v[120:123], a[196:199], v[40:43], v[120:123]
s_add_u32 s69, s69, s35
ds_read_b64_tr_b16 a[204:205], v64 offset:16384
v_add_f32 v94, v94, v14
M v[124:127], a[196:199], v[44:47], v[124:127]
s_add_u32 s77, s77, s40
ds_read_b64_tr_b16 a[206:207], v64 offset:20480
v_add_f32 v94, v94, v15
M v[8:11], a[160:163], a[8:11], 0
s_add_u32 s58, s53, 6
buffer_load_dwordx4 v70, s[12:15], s47 offen offset:3072 nt lds
M v[8:11], a[164:167], a[28:31], v[8:11]
s_and_b32 s58, s58, 7
v_exp_f32 v0, v0
M v[8:11], a[168:171], a[48:51], v[8:11]
s_mul_i32 s70, s58, 128
v_exp_f32 v1, v1
M v[8:11], a[172:175], a[68:71], v[8:11]
s_mul_i32 s78, s58, 20480
ds_read_b128 a[176:179], v57 offset:36864
v_add_f32 v90, v90, v0
M v[128:131], a[196:199], v[48:51], v[128:131]
s_add_u32 s70, s70, s35
v_exp_f32 v2, v2
M v[132:135], a[196:199], v[52:55], v[132:135]
s_waitcnt lgkmcnt(3)
v_cvt_pk_bf16_f32 v16, v0, v1
v_add_f32 v90, v90, v1
M v[136:139], a[200:203], v[36:39], v[136:139]
s_add_u32 s78, s78, s40
v_exp_f32 v3, v3
M v[140:143], a[200:203], v[40:43], v[140:143]
s_add_u32 s58, s53, 7
v_cvt_pk_bf16_f32 v17, v2, v3
v_add_f32 v90, v90, v2
M v[12:15], a[160:163], a[12:15], 0
s_and_b32 s58, s58, 7
s_mul_i32 s71, s58, 128
s_mul_i32 s79, s58, 20480
M v[12:15], a[164:167], a[32:35], v[12:15]
s_add_u32 s71, s71, s35
s_add_u32 s79, s79, s40
v_add_f32 v90, v90, v3
M v[12:15], a[168:171], a[52:55], v[12:15]
s_add_u32 s48, s43, 98304
ds_read_b128 a[180:183], v58 offset:36864
M v[12:15], a[172:175], a[72:75], v[12:15]
s_and_b32 s48, s48, 131071
ds_read_b128 a[184:187], v59 offset:36864
M v[144:147], a[200:203], v[44:47], v[144:147]
s_add_u32 m0, s36, 65536
ds_read_b128 a[188:191], v60 offset:36864
M v[148:151], a[200:203], v[48:51], v[148:151]
s_add_u32 s48, s48, s100
buffer_load_dwordx4 v69, s[16:19], s48 offen nt lds
M v[152:155], a[200:203], v[52:55], v[152:155]
s_waitcnt lgkmcnt(4)
ds_read_b64_tr_b16 a[192:193], v65 offset:16384
v_exp_f32 v4, v4
M v[156:159], a[204:207], v[36:39], v[156:159]
ds_read_b64_tr_b16 a[194:195], v65 offset:20480
v_add_f32 v91, v91, v4
v_exp_f32 v5, v5
M v[0:3], a[160:163], a[16:19], 0
v_exp_f32 v6, v6
M v[0:3], a[164:167], a[36:39], v[0:3]
v_cvt_pk_bf16_f32 v20, v4, v5
v_add_f32 v91, v91, v5
M v[0:3], a[168:171], a[56:59], v[0:3]
v_exp_f32 v7, v7
M v[0:3], a[172:175], a[76:79], v[0:3]
v_cvt_pk_bf16_f32 v21, v6, v7
v_add_f32 v91, v91, v6
M v[160:163], a[204:207], v[40:43], v[160:163]
s_add_u32 s49, s43, 114688
ds_read_b64_tr_b16 a[196:197], v66 offset:16384
v_add_f32 v91, v91, v7
M v[164:167], a[204:207], v[44:47], v[164:167]
s_and_b32 s49, s49, 131071
buffer_load_dwordx4 v70, s[16:19], s48 offen offset:1024 nt lds
M v[168:171], a[204:207], v[48:51], v[168:171]
s_add_u32 s49, s49, s100
v_exp_f32 v8, v8
M v[172:175], a[204:207], v[52:55], v[172:175]
s_waitcnt lgkmcnt(6)
v_exp_f32 v9, v9
M v[4:7], a[176:179], a[0:3], 0
s_waitcnt lgkmcnt(5)
ds_read_b64_tr_b16 a[198:199], v66 offset:20480
v_add_f32 v92, v92, v8
M v[4:7], a[180:183], a[20:23], v[4:7]
s_waitcnt lgkmcnt(5)
v_exp_f32 v10, v10
M v[4:7], a[184:187], a[40:43], v[4:7]
s_waitcnt lgkmcnt(4)
v_cvt_pk_bf16_f32 v24, v8, v9
v_add_f32 v92, v92, v9
M v[4:7], a[188:191], a[60:63], v[4:7]
s_waitcnt lgkmcnt(2)
v_exp_f32 v11, v11
M v[176:179], a[192:195], v[36:39], v[176:179]
v_cvt_pk_bf16_f32 v25, v10, v11
v_add_f32 v92, v92, v10
M v[180:183], a[192:195], v[40:43], v[180:183]
ds_read_b64_tr_b16 a[200:201], v67 offset:16384
v_add_f32 v92, v92, v11
M v[184:187], a[192:195], v[44:47], v[184:187]
buffer_load_dwordx4 v69, s[16:19], s48 offen offset:2048 nt lds
M v[188:191], a[192:195], v[48:51], v[188:191]
v_exp_f32 v12, v12
v_exp_f32 v13, v13
v_add_f32 v93, v93, v12
M v[8:11], a[176:179], a[4:7], 0
v_exp_f32 v14, v14
v_add_f32 v93, v93, v13
M v[8:11], a[180:183], a[24:27], v[8:11]
v_exp_f32 v15, v15
M v[8:11], a[184:187], a[44:47], v[8:11]
ds_read_b64_tr_b16 a[202:203], v67 offset:20480
v_add_f32 v93, v93, v14
M v[8:11], a[188:191], a[64:67], v[8:11]
v_cvt_pk_bf16_f32 v28, v12, v13
v_add_f32 v93, v93, v15
M v[192:195], a[192:195], v[52:55], v[192:195]
s_waitcnt lgkmcnt(2)
ds_read_b64_tr_b16 a[204:205], v68 offset:16384
v_cvt_pk_bf16_f32 v29, v14, v15
M v[196:199], a[196:199], v[36:39], v[196:199]
v_exp_f32 v0, v0
v_exp_f32 v1, v1
v_add_f32 v94, v94, v0
M v[200:203], a[196:199], v[40:43], v[200:203]
buffer_load_dwordx4 v70, s[16:19], s48 offen offset:3072 nt lds
v_exp_f32 v2, v2
v_add_f32 v94, v94, v1
v_exp_f32 v3, v3
v_add_f32 v94, v94, v2
v_add_f32 v94, v94, v3
v_cvt_pk_bf16_f32 v32, v0, v1
M v[204:207], a[196:199], v[44:47], v[204:207]
s_add_u32 m0, s36, 32768
ds_read_b64_tr_b16 a[206:207], v68 offset:20480
v_cvt_pk_bf16_f32 v33, v2, v3
v_exp_f32 v4, v4
v_exp_f32 v5, v5
M v[12:15], a[176:179], a[8:11], 0
v_cvt_pk_bf16_f32 v18, v4, v5
v_add_f32 v90, v90, v4
v_exp_f32 v6, v6
M v[12:15], a[180:183], a[28:31], v[12:15]
v_add_f32 v90, v90, v5
v_add_f32 v90, v90, v6
M v[12:15], a[184:187], a[48:51], v[12:15]
v_exp_f32 v7, v7
M v[12:15], a[188:191], a[68:71], v[12:15]
v_cvt_pk_bf16_f32 v19, v6, v7
v_add_f32 v90, v90, v7
v_exp_f32 v8, v8
M v[208:211], a[196:199], v[48:51], v[208:211]
v_exp_f32 v9, v9
M v[212:215], a[196:199], v[52:55], v[212:215]
s_waitcnt lgkmcnt(2)
v_cvt_pk_bf16_f32 v22, v8, v9
v_add_f32 v91, v91, v8
M v[216:219], a[200:203], v[36:39], v[216:219]
v_exp_f32 v10, v10
M v[220:223], a[200:203], v[40:43], v[220:223]
v_add_f32 v91, v91, v9
v_add_f32 v91, v91, v10
M v[0:3], a[176:179], a[12:15], 0
s_waitcnt vmcnt(16) lgkmcnt(0)
v_exp_f32 v11, v11
M v[0:3], a[180:183], a[32:35], v[0:3]
s_barrier
ds_read_b128 a[160:163], v57 offset:49152
v_add_f32 v91, v91, v11
M v[0:3], a[184:187], a[52:55], v[0:3]
ds_read_b128 a[164:167], v58 offset:49152
v_cvt_pk_bf16_f32 v23, v10, v11
M v[0:3], a[188:191], a[72:75], v[0:3]
ds_read_b128 a[168:171], v59 offset:49152
v_exp_f32 v12, v12
M v[224:227], a[200:203], v[44:47], v[224:227]
ds_read_b128 a[172:175], v60 offset:49152
v_add_f32 v92, v92, v12
M v[228:231], a[200:203], v[48:51], v[228:231]
ds_read_b64_tr_b16 a[192:193], v61 offset:32768
M v[232:235], a[200:203], v[52:55], v[232:235]
ds_read_b64_tr_b16 a[194:195], v61 offset:36864
buffer_load_dwordx4 v69, s[12:15], s49 offen nt lds
M v[236:239], a[204:207], v[36:39], v[236:239]
v_exp_f32 v13, v13
M v[4:7], a[176:179], a[16:19], 0
s_add_u32 s50, s43, 106496
v_exp_f32 v14, v14
M v[4:7], a[180:183], a[36:39], v[4:7]
s_and_b32 s50, s50, 131071
v_exp_f32 v15, v15
M v[4:7], a[184:187], a[56:59], v[4:7]
s_add_u32 s50, s50, s100
ds_read_b64_tr_b16 a[196:197], v62 offset:32768
v_cvt_pk_bf16_f32 v26, v12, v13
M v[4:7], a[188:191], a[76:79], v[4:7]
v_exp_f32 v0, v0
M v[240:243], a[204:207], v[40:43], v[240:243]
v_exp_f32 v1, v1
M v[244:247], a[204:207], v[44:47], v[244:247]
v_cvt_pk_bf16_f32 v27, v14, v15
v_mov_b32 v56, s54
M v[248:251], a[204:207], v[48:51], v[248:251]
buffer_load_dword v56, v56, s[28:31], 0 offen sc1
M v[252:255], a[204:207], v[52:55], v[252:255]
s_waitcnt lgkmcnt(6)
v_exp_f32 v2, v2
M v[8:11], a[160:163], a[0:3], 0
s_waitcnt lgkmcnt(5)
v_exp_f32 v3, v3
M v[8:11], a[164:167], a[20:23], v[8:11]
s_waitcnt lgkmcnt(4)
ds_read_b64_tr_b16 a[198:199], v62 offset:36864
v_add_f32 v92, v92, v13
M v[8:11], a[168:171], a[40:43], v[8:11]
s_waitcnt lgkmcnt(4)
v_cvt_pk_bf16_f32 v30, v0, v1
v_cvt_pk_bf16_f32 v31, v2, v3
M v[8:11], a[172:175], a[60:63], v[8:11]
s_waitcnt lgkmcnt(2)
ds_read_b64_tr_b16 a[200:201], v63 offset:32768
v_add_f32 v92, v92, v14
M v[96:99], a[192:195], v[16:19], v[96:99]
v_add_f32 v92, v92, v15
v_add_f32 v93, v93, v0
v_exp_f32 v4, v4
M v[100:103], a[192:195], v[20:23], v[100:103]
buffer_load_dwordx4 v70, s[12:15], s49 offen offset:1024 nt lds
M v[104:107], a[192:195], v[24:27], v[104:107]
v_exp_f32 v5, v5
M v[108:111], a[192:195], v[28:31], v[108:111]
v_exp_f32 v6, v6
M v[12:15], a[160:163], a[4:7], 0
v_exp_f32 v7, v7
M v[12:15], a[164:167], a[24:27], v[12:15]
v_cvt_pk_bf16_f32 v34, v4, v5
v_cvt_pk_bf16_f32 v35, v6, v7
M v[12:15], a[168:171], a[44:47], v[12:15]
ds_read_b64_tr_b16 a[202:203], v63 offset:36864
v_add_f32 v93, v93, v1
M v[12:15], a[172:175], a[64:67], v[12:15]
v_add_f32 v93, v93, v2
v_add_f32 v94, v94, v4
M v[112:115], a[192:195], v[32:35], v[112:115]
s_waitcnt lgkmcnt(2)
v_add_f32 v93, v93, v3
v_add_f32 v94, v94, v5
M v[116:119], a[196:199], v[16:19], v[116:119]
buffer_load_dwordx4 v69, s[12:15], s49 offen offset:2048 nt lds
M v[120:123], a[196:199], v[20:23], v[120:123]
ds_read_b64_tr_b16 a[204:205], v64 offset:32768
v_add_f32 v94, v94, v6
M v[124:127], a[196:199], v[24:27], v[124:127]
ds_read_b64_tr_b16 a[206:207], v64 offset:36864
v_add_f32 v94, v94, v7
M v[0:3], a[160:163], a[8:11], 0
v_exp_f32 v8, v8
M v[0:3], a[164:167], a[28:31], v[0:3]
buffer_load_dwordx4 v70, s[12:15], s49 offen offset:3072 nt lds
M v[0:3], a[168:171], a[48:51], v[0:3]
s_add_u32 m0, s36, 81920
v_exp_f32 v9, v9
M v[0:3], a[172:175], a[68:71], v[0:3]
ds_read_b128 a[176:179], v57 offset:53248
v_add_f32 v90, v90, v8
M v[128:131], a[196:199], v[28:31], v[128:131]
v_exp_f32 v10, v10
M v[132:135], a[196:199], v[32:35], v[132:135]
s_waitcnt lgkmcnt(3)
v_cvt_pk_bf16_f32 v36, v8, v9
v_add_f32 v90, v90, v9
M v[136:139], a[200:203], v[16:19], v[136:139]
v_exp_f32 v11, v11
M v[140:143], a[200:203], v[20:23], v[140:143]
v_cvt_pk_bf16_f32 v37, v10, v11
v_add_f32 v90, v90, v10
M v[4:7], a[160:163], a[12:15], 0
ds_read_b128 a[180:183], v58 offset:53248
v_add_f32 v90, v90, v11
M v[4:7], a[164:167], a[32:35], v[4:7]
ds_read_b128 a[184:187], v59 offset:53248
M v[4:7], a[168:171], a[52:55], v[4:7]
buffer_load_dwordx4 v69, s[16:19], s50 offen nt lds
M v[4:7], a[172:175], a[72:75], v[4:7]
ds_read_b128 a[188:191], v60 offset:53248
M v[144:147], a[200:203], v[24:27], v[144:147]
ds_read_b64_tr_b16 a[192:193], v65 offset:32768
M v[148:151], a[200:203], v[28:31], v[148:151]
v_exp_f32 v12, v12
M v[152:155], a[200:203], v[32:35], v[152:155]
s_waitcnt lgkmcnt(5)
ds_read_b64_tr_b16 a[194:195], v65 offset:36864
v_add_f32 v91, v91, v12
M v[156:159], a[204:207], v[16:19], v[156:159]
v_exp_f32 v13, v13
M v[8:11], a[160:163], a[16:19], 0
v_exp_f32 v14, v14
M v[8:11], a[164:167], a[36:39], v[8:11]
v_cvt_pk_bf16_f32 v40, v12, v13
v_add_f32 v91, v91, v13
M v[8:11], a[168:171], a[56:59], v[8:11]
v_exp_f32 v15, v15
M v[8:11], a[172:175], a[76:79], v[8:11]
v_cvt_pk_bf16_f32 v41, v14, v15
v_add_f32 v91, v91, v14
M v[160:163], a[204:207], v[20:23], v[160:163]
s_add_u32 s51, s43, 122880
ds_read_b64_tr_b16 a[196:197], v66 offset:32768
v_add_f32 v91, v91, v15
M v[164:167], a[204:207], v[24:27], v[164:167]
s_and_b32 s51, s51, 131071
buffer_load_dwordx4 v70, s[16:19], s50 offen offset:1024 nt lds
M v[168:171], a[204:207], v[28:31], v[168:171]
s_add_u32 s51, s51, s100
v_exp_f32 v0, v0
M v[172:175], a[204:207], v[32:35], v[172:175]
s_waitcnt lgkmcnt(6)
v_exp_f32 v1, v1
M v[12:15], a[176:179], a[0:3], 0
s_waitcnt lgkmcnt(5)
ds_read_b64_tr_b16 a[198:199], v66 offset:36864
v_add_f32 v92, v92, v0
M v[12:15], a[180:183], a[20:23], v[12:15]
s_waitcnt lgkmcnt(5)
v_exp_f32 v2, v2
M v[12:15], a[184:187], a[40:43], v[12:15]
s_waitcnt lgkmcnt(4)
v_cvt_pk_bf16_f32 v44, v0, v1
v_add_f32 v92, v92, v1
M v[12:15], a[188:191], a[60:63], v[12:15]
s_waitcnt lgkmcnt(2)
v_exp_f32 v3, v3
M v[176:179], a[192:195], v[16:19], v[176:179]
v_cvt_pk_bf16_f32 v45, v2, v3
v_add_f32 v92, v92, v2
M v[180:183], a[192:195], v[20:23], v[180:183]
ds_read_b64_tr_b16 a[200:201], v67 offset:32768
v_add_f32 v92, v92, v3
M v[184:187], a[192:195], v[24:27], v[184:187]
buffer_load_dwordx4 v69, s[16:19], s50 offen offset:2048 nt lds
M v[188:191], a[192:195], v[28:31], v[188:191]
v_exp_f32 v4, v4
v_exp_f32 v5, v5
v_add_f32 v93, v93, v4
M v[0:3], a[176:179], a[4:7], 0
v_exp_f32 v6, v6
v_add_f32 v93, v93, v5
M v[0:3], a[180:183], a[24:27], v[0:3]
v_exp_f32 v7, v7
M v[0:3], a[184:187], a[44:47], v[0:3]
ds_read_b64_tr_b16 a[202:203], v67 offset:36864
v_add_f32 v93, v93, v6
M v[0:3], a[188:191], a[64:67], v[0:3]
v_cvt_pk_bf16_f32 v48, v4, v5
v_add_f32 v93, v93, v7
M v[192:195], a[192:195], v[32:35], v[192:195]
s_waitcnt lgkmcnt(2)
ds_read_b64_tr_b16 a[204:205], v68 offset:32768
v_cvt_pk_bf16_f32 v49, v6, v7
M v[196:199], a[196:199], v[16:19], v[196:199]
v_exp_f32 v8, v8
M v[200:203], a[196:199], v[20:23], v[200:203]
v_exp_f32 v9, v9
v_add_f32 v94, v94, v8
v_exp_f32 v10, v10
v_add_f32 v94, v94, v9
v_exp_f32 v11, v11
v_add_f32 v94, v94, v10
v_add_f32 v94, v94, v11
M v[204:207], a[196:199], v[24:27], v[204:207]
buffer_load_dwordx4 v70, s[16:19], s50 offen offset:3072 nt lds
ds_read_b64_tr_b16 a[206:207], v68 offset:36864
v_cvt_pk_bf16_f32 v52, v8, v9
v_cvt_pk_bf16_f32 v53, v10, v11
M v[4:7], a[176:179], a[8:11], 0
s_add_u32 m0, s36, 49152
v_exp_f32 v12, v12
v_exp_f32 v13, v13
M v[4:7], a[180:183], a[28:31], v[4:7]
v_cvt_pk_bf16_f32 v38, v12, v13
v_add_f32 v90, v90, v12
M v[4:7], a[184:187], a[48:51], v[4:7]
v_exp_f32 v14, v14
M v[4:7], a[188:191], a[68:71], v[4:7]
v_add_f32 v90, v90, v13
v_add_f32 v90, v90, v14
v_exp_f32 v15, v15
v_exp_f32 v0, v0
M v[208:211], a[196:199], v[28:31], v[208:211]
v_cvt_pk_bf16_f32 v39, v14, v15
v_add_f32 v90, v90, v15
M v[212:215], a[196:199], v[32:35], v[212:215]
s_waitcnt lgkmcnt(2)
v_exp_f32 v1, v1
M v[216:219], a[200:203], v[16:19], v[216:219]
v_cvt_pk_bf16_f32 v42, v0, v1
v_add_f32 v91, v91, v0
M v[220:223], a[200:203], v[20:23], v[220:223]
v_exp_f32 v2, v2
M v[8:11], a[176:179], a[12:15], 0
s_waitcnt vmcnt(17) lgkmcnt(0)
v_add_f32 v91, v91, v1
v_add_f32 v91, v91, v2
M v[8:11], a[180:183], a[32:35], v[8:11]
s_barrier
ds_read_b128 a[160:163], v57 offset:0
M v[8:11], a[184:187], a[52:55], v[8:11]
ds_read_b128 a[164:167], v58 offset:0
v_exp_f32 v3, v3
M v[8:11], a[188:191], a[72:75], v[8:11]
ds_read_b128 a[168:171], v59 offset:0
v_add_f32 v91, v91, v3
M v[224:227], a[200:203], v[24:27], v[224:227]
ds_read_b128 a[172:175], v60 offset:0
v_cvt_pk_bf16_f32 v43, v2, v3
M v[228:231], a[200:203], v[28:31], v[228:231]
ds_read_b64_tr_b16 a[192:193], v61 offset:49152
M v[232:235], a[200:203], v[32:35], v[232:235]
ds_read_b64_tr_b16 a[194:195], v61 offset:53248
buffer_load_dwordx4 v69, s[12:15], s51 offen nt lds
M v[236:239], a[204:207], v[16:19], v[236:239]
v_exp_f32 v4, v4
M v[12:15], a[176:179], a[16:19], 0
s_add_u32 s44, s43, 114688
v_exp_f32 v5, v5
M v[12:15], a[180:183], a[36:39], v[12:15]
s_and_b32 s44, s44, 131071
v_exp_f32 v6, v6
M v[12:15], a[184:187], a[56:59], v[12:15]
s_add_u32 s44, s44, s100
v_exp_f32 v7, v7
M v[12:15], a[188:191], a[76:79], v[12:15]
ds_read_b64_tr_b16 a[196:197], v62 offset:49152
v_cvt_pk_bf16_f32 v46, v4, v5
M v[240:243], a[204:207], v[20:23], v[240:243]
v_exp_f32 v8, v8
M v[244:247], a[204:207], v[24:27], v[244:247]
v_exp_f32 v9, v9
M v[248:251], a[204:207], v[28:31], v[248:251]
v_exp_f32 v10, v10
M v[252:255], a[204:207], v[32:35], v[252:255]
s_waitcnt lgkmcnt(6)
v_exp_f32 v11, v11
M v[0:3], a[160:163], a[0:3], 0
s_waitcnt lgkmcnt(5)
v_cvt_pk_bf16_f32 v47, v6, v7
v_add_f32 v92, v92, v4
M v[0:3], a[164:167], a[20:23], v[0:3]
s_waitcnt lgkmcnt(4)
ds_read_b64_tr_b16 a[198:199], v62 offset:53248
v_add_f32 v92, v92, v5
M v[0:3], a[168:171], a[40:43], v[0:3]
s_waitcnt lgkmcnt(4)
v_cvt_pk_bf16_f32 v50, v8, v9
v_cvt_pk_bf16_f32 v51, v10, v11
M v[0:3], a[172:175], a[60:63], v[0:3]
s_waitcnt lgkmcnt(2)
ds_read_b64_tr_b16 a[200:201], v63 offset:49152
v_add_f32 v92, v92, v6
M v[96:99], a[192:195], v[36:39], v[96:99]
v_add_f32 v92, v92, v7
v_add_f32 v93, v93, v8
v_exp_f32 v12, v12
M v[100:103], a[192:195], v[40:43], v[100:103]
buffer_load_dwordx4 v70, s[12:15], s51 offen offset:1024 nt lds
M v[104:107], a[192:195], v[44:47], v[104:107]
v_exp_f32 v13, v13
M v[108:111], a[192:195], v[48:51], v[108:111]
v_exp_f32 v14, v14
M v[4:7], a[160:163], a[4:7], 0
v_exp_f32 v15, v15
M v[4:7], a[164:167], a[24:27], v[4:7]
v_cvt_pk_bf16_f32 v54, v12, v13
v_cvt_pk_bf16_f32 v55, v14, v15
M v[4:7], a[168:171], a[44:47], v[4:7]
ds_read_b64_tr_b16 a[202:203], v63 offset:53248
v_add_f32 v93, v93, v9
M v[4:7], a[172:175], a[64:67], v[4:7]
v_add_f32 v93, v93, v10
v_add_f32 v94, v94, v12
M v[112:115], a[192:195], v[52:55], v[112:115]
s_waitcnt lgkmcnt(2)
v_add_f32 v93, v93, v11
v_add_f32 v94, v94, v13
M v[116:119], a[196:199], v[36:39], v[116:119]
buffer_load_dwordx4 v69, s[12:15], s51 offen offset:2048 nt lds
M v[120:123], a[196:199], v[40:43], v[120:123]
ds_read_b64_tr_b16 a[204:205], v64 offset:49152
v_add_f32 v94, v94, v14
M v[124:127], a[196:199], v[44:47], v[124:127]
ds_read_b64_tr_b16 a[206:207], v64 offset:53248
v_add_f32 v94, v94, v15
M v[8:11], a[160:163], a[8:11], 0
v_exp_f32 v0, v0
M v[8:11], a[164:167], a[28:31], v[8:11]
buffer_load_dwordx4 v70, s[12:15], s51 offen offset:3072 nt lds
M v[8:11], a[168:171], a[48:51], v[8:11]
s_add_u32 m0, s36, 98304
v_exp_f32 v1, v1
M v[8:11], a[172:175], a[68:71], v[8:11]
v_lshlrev_b32 v80, 4, v85
v_add_f32 v90, v90, v0
M v[128:131], a[196:199], v[48:51], v[128:131]
v_exp_f32 v2, v2
M v[132:135], a[196:199], v[52:55], v[132:135]
s_waitcnt lgkmcnt(2)
v_xor_b32 v81, 0x800, v80
v_add_f32 v90, v90, v1
M v[136:139], a[200:203], v[36:39], v[136:139]
v_exp_f32 v3, v3
M v[140:143], a[200:203], v[40:43], v[140:143]
ds_read_b128 a[176:179], v57 offset:4096
v_add_f32 v90, v90, v2
M v[12:15], a[160:163], a[12:15], 0
v_cvt_pk_bf16_f32 v16, v0, v1
v_add_f32 v90, v90, v3
M v[12:15], a[164:167], a[32:35], v[12:15]
ds_read_b128 a[180:183], v58 offset:4096
v_cvt_pk_bf16_f32 v17, v2, v3
M v[12:15], a[168:171], a[52:55], v[12:15]
ds_read_b128 a[184:187], v59 offset:4096
M v[12:15], a[172:175], a[72:75], v[12:15]
buffer_load_dwordx4 v69, s[16:19], s44 offen nt lds
M v[144:147], a[200:203], v[44:47], v[144:147]
ds_read_b128 a[188:191], v60 offset:4096
M v[148:151], a[200:203], v[48:51], v[148:151]
ds_read_b64_tr_b16 a[192:193], v65 offset:49152
M v[152:155], a[200:203], v[52:55], v[152:155]
s_waitcnt lgkmcnt(5)
v_exp_f32 v4, v4
M v[156:159], a[204:207], v[36:39], v[156:159]
ds_read_b64_tr_b16 a[194:195], v65 offset:53248
v_add_f32 v91, v91, v4
v_exp_f32 v5, v5
M v[0:3], a[160:163], a[16:19], 0
v_exp_f32 v6, v6
M v[0:3], a[164:167], a[36:39], v[0:3]
v_cvt_pk_bf16_f32 v20, v4, v5
v_add_f32 v91, v91, v5
M v[0:3], a[168:171], a[56:59], v[0:3]
v_exp_f32 v7, v7
M v[0:3], a[172:175], a[76:79], v[0:3]
v_cvt_pk_bf16_f32 v21, v6, v7
v_add_f32 v91, v91, v6
M v[160:163], a[204:207], v[40:43], v[160:163]
ds_read_b64_tr_b16 a[196:197], v66 offset:49152
v_add_f32 v91, v91, v7
M v[164:167], a[204:207], v[44:47], v[164:167]
buffer_load_dwordx4 v70, s[16:19], s44 offen offset:1024 nt lds
M v[168:171], a[204:207], v[48:51], v[168:171]
v_exp_f32 v8, v8
M v[172:175], a[204:207], v[52:55], v[172:175]
s_waitcnt lgkmcnt(6)
v_exp_f32 v9, v9
M v[4:7], a[176:179], a[0:3], 0
s_waitcnt lgkmcnt(5)
ds_read_b64_tr_b16 a[198:199], v66 offset:53248
v_add_f32 v92, v92, v8
M v[4:7], a[180:183], a[20:23], v[4:7]
s_waitcnt lgkmcnt(5)
v_exp_f32 v10, v10
M v[4:7], a[184:187], a[40:43], v[4:7]
s_waitcnt lgkmcnt(4)
v_cvt_pk_bf16_f32 v24, v8, v9
v_add_f32 v92, v92, v9
M v[4:7], a[188:191], a[60:63], v[4:7]
s_waitcnt lgkmcnt(2)
v_exp_f32 v11, v11
M v[176:179], a[192:195], v[36:39], v[176:179]
v_cvt_pk_bf16_f32 v25, v10, v11
v_add_f32 v92, v92, v10
M v[180:183], a[192:195], v[40:43], v[180:183]
s_add_u32 s45, s43, 122880
ds_read_b64_tr_b16 a[200:201], v67 offset:49152
v_add_f32 v92, v92, v11
M v[184:187], a[192:195], v[44:47], v[184:187]
s_and_b32 s45, s45, 131071
buffer_load_dwordx4 v69, s[16:19], s44 offen offset:2048 nt lds
M v[188:191], a[192:195], v[48:51], v[188:191]
s_add_u32 s45, s45, s100
v_exp_f32 v12, v12
v_exp_f32 v13, v13
M v[8:11], a[176:179], a[4:7], 0
ds_read_b64_tr_b16 a[202:203], v67 offset:53248
v_add_f32 v93, v93, v12
M v[8:11], a[180:183], a[24:27], v[8:11]
v_exp_f32 v14, v14
M v[8:11], a[184:187], a[44:47], v[8:11]
v_cvt_pk_bf16_f32 v28, v12, v13
v_add_f32 v93, v93, v13
M v[8:11], a[188:191], a[64:67], v[8:11]
v_exp_f32 v15, v15
M v[192:195], a[192:195], v[52:55], v[192:195]
s_waitcnt lgkmcnt(2)
v_cvt_pk_bf16_f32 v29, v14, v15
v_add_f32 v93, v93, v14
M v[196:199], a[196:199], v[36:39], v[196:199]
ds_read_b64_tr_b16 a[204:205], v68 offset:49152
v_add_f32 v93, v93, v15
M v[200:203], a[196:199], v[40:43], v[200:203]
v_exp_f32 v0, v0
v_exp_f32 v1, v1
v_add_f32 v94, v94, v0
v_exp_f32 v2, v2
v_add_f32 v94, v94, v1
v_exp_f32 v3, v3
M v[204:207], a[196:199], v[44:47], v[204:207]
buffer_load_dwordx4 v70, s[16:19], s44 offen offset:3072 nt lds
v_add_f32 v94, v94, v2
v_add_f32 v94, v94, v3
v_cvt_pk_bf16_f32 v32, v0, v1
M v[12:15], a[176:179], a[8:11], 0
s_add_u32 m0, s36, 114688
ds_read_b64_tr_b16 a[206:207], v68 offset:53248
v_cvt_pk_bf16_f32 v33, v2, v3
v_exp_f32 v4, v4
M v[12:15], a[180:183], a[28:31], v[12:15]
v_exp_f32 v5, v5
M v[12:15], a[184:187], a[48:51], v[12:15]
v_cvt_pk_bf16_f32 v18, v4, v5
v_add_f32 v90, v90, v4
M v[12:15], a[188:191], a[68:71], v[12:15]
v_exp_f32 v6, v6
v_add_f32 v90, v90, v5
v_exp_f32 v7, v7
v_add_f32 v90, v90, v6
v_add_f32 v90, v90, v7
v_cvt_pk_bf16_f32 v19, v6, v7
v_exp_f32 v8, v8
M v[208:211], a[196:199], v[48:51], v[208:211]
L_hop_c1:
s_cbranch_execz L_ret_c1
v_exp_f32 v9, v9
M v[212:215], a[196:199], v[52:55], v[212:215]
s_waitcnt lgkmcnt(2)
v_cvt_pk_bf16_f32 v22, v8, v9
v_add_f32 v91, v91, v8
M v[216:219], a[200:203], v[36:39], v[216:219]
v_exp_f32 v10, v10
M v[220:223], a[200:203], v[40:43], v[220:223]
v_add_f32 v91, v91, v9
v_add_f32 v91, v91, v10
M v[0:3], a[176:179], a[12:15], 0
s_waitcnt vmcnt(17) lgkmcnt(0)
v_exp_f32 v11, v11
M v[0:3], a[180:183], a[32:35], v[0:3]
s_barrier
ds_read_b128 a[160:163], v57 offset:16384
v_add_f32 v91, v91, v11
M v[0:3], a[184:187], a[52:55], v[0:3]
ds_read_b128 a[164:167], v58 offset:16384
v_cvt_pk_bf16_f32 v23, v10, v11
M v[0:3], a[188:191], a[72:75], v[0:3]
ds_read_b128 a[168:171], v59 offset:16384
v_exp_f32 v12, v12
M v[224:227], a[200:203], v[44:47], v[224:227]
ds_read_b128 a[172:175], v60 offset:16384
v_add_f32 v92, v92, v12
M v[228:231], a[200:203], v[48:51], v[228:231]
ds_read_b64_tr_b16 a[192:193], v61 offset:0
M v[232:235], a[200:203], v[52:55], v[232:235]
ds_read_b64_tr_b16 a[194:195], v61 offset:4096
v_exp_f32 v13, v13
M v[236:239], a[204:207], v[36:39], v[236:239]
v_exp_f32 v14, v14
M v[4:7], a[176:179], a[16:19], 0
v_exp_f32 v15, v15
M v[4:7], a[180:183], a[36:39], v[4:7]
ds_read_b64_tr_b16 a[196:197], v62 offset:0
v_cvt_pk_bf16_f32 v26, v12, v13
M v[4:7], a[184:187], a[56:59], v[4:7]
v_exp_f32 v0, v0
M v[4:7], a[188:191], a[76:79], v[4:7]
v_exp_f32 v1, v1
M v[240:243], a[204:207], v[40:43], v[240:243]
v_exp_f32 v2, v2
M v[244:247], a[204:207], v[44:47], v[244:247]
v_exp_f32 v3, v3
M v[248:251], a[204:207], v[48:51], v[248:251]
ds_read_b64_tr_b16 a[198:199], v62 offset:4096
v_cvt_pk_bf16_f32 v27, v14, v15
M v[252:255], a[204:207], v[52:55], v[252:255]
s_waitcnt lgkmcnt(7)
v_add_f32 v92, v92, v13
v_cvt_pk_bf16_f32 v30, v0, v1
M v[8:11], a[160:163], a[0:3], 0
s_waitcnt lgkmcnt(6)
v_add_f32 v92, v92, v14
v_cvt_pk_bf16_f32 v31, v2, v3
M v[8:11], a[164:167], a[20:23], v[8:11]
s_waitcnt lgkmcnt(5)
ds_read_b64_tr_b16 a[200:201], v63 offset:0
v_add_f32 v92, v92, v15
M v[8:11], a[168:171], a[40:43], v[8:11]
s_waitcnt lgkmcnt(5)
buffer_load_dwordx4 v69, s[16:19], s45 offen nt lds
M v[8:11], a[172:175], a[60:63], v[8:11]
s_waitcnt lgkmcnt(3)
ds_write_b128 v80, a[80:83] offset:0
M v[96:99], a[192:195], v[16:19], v[96:99]
v_exp_f32 v4, v4
M v[100:103], a[192:195], v[20:23], v[100:103]
v_exp_f32 v5, v5
M v[104:107], a[192:195], v[24:27], v[104:107]
v_exp_f32 v6, v6
M v[108:111], a[192:195], v[28:31], v[108:111]
v_exp_f32 v7, v7
M v[12:15], a[160:163], a[4:7], 0
v_cvt_pk_bf16_f32 v34, v4, v5
v_cvt_pk_bf16_f32 v35, v6, v7
M v[12:15], a[164:167], a[24:27], v[12:15]
ds_read_b64_tr_b16 a[202:203], v63 offset:4096
v_add_f32 v93, v93, v0
M v[12:15], a[168:171], a[44:47], v[12:15]
v_add_f32 v93, v93, v1
v_add_f32 v94, v94, v4
M v[12:15], a[172:175], a[64:67], v[12:15]
v_add_f32 v93, v93, v2
v_add_f32 v94, v94, v5
M v[112:115], a[192:195], v[32:35], v[112:115]
s_waitcnt lgkmcnt(3)
ds_read_b64_tr_b16 a[204:205], v64 offset:0
v_add_f32 v93, v93, v3
M v[116:119], a[196:199], v[16:19], v[116:119]
ds_read_b64_tr_b16 a[206:207], v64 offset:4096
v_add_f32 v94, v94, v6
M v[120:123], a[196:199], v[20:23], v[120:123]
ds_read_b128 a[176:179], v57 offset:20480
v_add_f32 v94, v94, v7
M v[124:127], a[196:199], v[24:27], v[124:127]
buffer_load_dwordx4 v70, s[16:19], s45 offen offset:1024 nt lds
M v[0:3], a[160:163], a[8:11], 0
ds_write_b128 v80, a[100:103] offset:4096
M v[0:3], a[164:167], a[28:31], v[0:3]
v_exp_f32 v8, v8
M v[0:3], a[168:171], a[48:51], v[0:3]
v_exp_f32 v9, v9
M v[0:3], a[172:175], a[68:71], v[0:3]
v_cvt_pk_bf16_f32 v36, v8, v9
v_add_f32 v90, v90, v8
M v[128:131], a[196:199], v[28:31], v[128:131]
v_exp_f32 v10, v10
M v[132:135], a[196:199], v[32:35], v[132:135]
s_waitcnt lgkmcnt(4)
ds_read_b128 a[180:183], v58 offset:20480
v_add_f32 v90, v90, v9
M v[136:139], a[200:203], v[16:19], v[136:139]
v_exp_f32 v11, v11
M v[140:143], a[200:203], v[20:23], v[140:143]
v_cvt_pk_bf16_f32 v37, v10, v11
v_add_f32 v90, v90, v10
M v[4:7], a[160:163], a[12:15], 0
ds_read_b128 a[184:187], v59 offset:20480
v_add_f32 v90, v90, v11
M v[4:7], a[164:167], a[32:35], v[4:7]
ds_read_b128 a[188:191], v60 offset:20480
M v[4:7], a[168:171], a[52:55], v[4:7]
ds_read_b64_tr_b16 a[192:193], v65 offset:0
M v[4:7], a[172:175], a[72:75], v[4:7]
v_exp_f32 v12, v12
M v[144:147], a[200:203], v[24:27], v[144:147]
ds_read_b64_tr_b16 a[194:195], v65 offset:4096
v_add_f32 v91, v91, v12
M v[148:151], a[200:203], v[28:31], v[148:151]
v_exp_f32 v13, v13
M v[152:155], a[200:203], v[32:35], v[152:155]
s_waitcnt lgkmcnt(7)
v_exp_f32 v14, v14
M v[156:159], a[204:207], v[16:19], v[156:159]
v_cvt_pk_bf16_f32 v40, v12, v13
v_add_f32 v91, v91, v13
M v[8:11], a[160:163], a[16:19], 0
v_exp_f32 v15, v15
M v[8:11], a[164:167], a[36:39], v[8:11]
v_cvt_pk_bf16_f32 v41, v14, v15
v_add_f32 v91, v91, v14
M v[8:11], a[168:171], a[56:59], v[8:11]
ds_read_b64_tr_b16 a[196:197], v66 offset:0
v_add_f32 v91, v91, v15
v_exp_f32 v0, v0
M v[8:11], a[172:175], a[76:79], v[8:11]
buffer_load_dwordx4 v69, s[16:19], s45 offen offset:2048 nt lds
M v[160:163], a[204:207], v[20:23], v[160:163]
v_exp_f32 v1, v1
M v[164:167], a[204:207], v[24:27], v[164:167]
ds_read_b64_tr_b16 a[198:199], v66 offset:4096
v_add_f32 v92, v92, v0
M v[168:171], a[204:207], v[28:31], v[168:171]
v_exp_f32 v2, v2
M v[172:175], a[204:207], v[32:35], v[172:175]
s_waitcnt lgkmcnt(8)
v_cvt_pk_bf16_f32 v44, v0, v1
v_add_f32 v92, v92, v1
M v[12:15], a[176:179], a[0:3], 0
s_waitcnt lgkmcnt(6)
v_exp_f32 v3, v3
M v[12:15], a[180:183], a[20:23], v[12:15]
s_waitcnt lgkmcnt(5)
v_cvt_pk_bf16_f32 v45, v2, v3
v_add_f32 v92, v92, v2
M v[12:15], a[184:187], a[40:43], v[12:15]
s_waitcnt lgkmcnt(4)
ds_read_b64_tr_b16 a[200:201], v67 offset:0
v_add_f32 v92, v92, v3
v_exp_f32 v4, v4
M v[12:15], a[188:191], a[60:63], v[12:15]
s_waitcnt lgkmcnt(3)
ds_write_b128 v80, a[120:123] offset:8192
M v[176:179], a[192:195], v[16:19], v[176:179]
s_add_u32 s46, s64, 0
v_exp_f32 v5, v5
M v[180:183], a[192:195], v[20:23], v[180:183]
ds_read_b64_tr_b16 a[202:203], v67 offset:4096
v_add_f32 v93, v93, v4
M v[184:187], a[192:195], v[24:27], v[184:187]
v_exp_f32 v6, v6
M v[188:191], a[192:195], v[28:31], v[188:191]
v_cvt_pk_bf16_f32 v48, v4, v5
v_add_f32 v93, v93, v5
M v[0:3], a[176:179], a[4:7], 0
v_exp_f32 v7, v7
M v[0:3], a[180:183], a[24:27], v[0:3]
s_add_u32 s47, s64, 8192
v_cvt_pk_bf16_f32 v49, v6, v7
v_add_f32 v93, v93, v6
M v[0:3], a[184:187], a[44:47], v[0:3]
ds_read_b64_tr_b16 a[204:205], v68 offset:0
v_add_f32 v93, v93, v7
M v[0:3], a[188:191], a[64:67], v[0:3]
v_exp_f32 v8, v8
M v[192:195], a[192:195], v[32:35], v[192:195]
s_waitcnt lgkmcnt(4)
v_exp_f32 v9, v9
M v[196:199], a[196:199], v[16:19], v[196:199]
buffer_load_dwordx4 v70, s[16:19], s45 offen offset:3072 nt lds
v_add_f32 v94, v94, v8
M v[200:203], a[196:199], v[20:23], v[200:203]
s_add_u32 m0, s39, 131072
v_exp_f32 v10, v10
v_add_f32 v94, v94, v9
v_exp_f32 v11, v11
v_add_f32 v94, v94, v10
v_add_f32 v94, v94, v11
v_cvt_pk_bf16_f32 v52, v8, v9
v_cvt_pk_bf16_f32 v53, v10, v11
M v[204:207], a[196:199], v[24:27], v[204:207]
ds_read_b64_tr_b16 a[206:207], v68 offset:4096
ds_write_b128 v80, a[140:143] offset:12288
M v[4:7], a[176:179], a[8:11], 0
v_exp_f32 v12, v12
v_exp_f32 v13, v13
M v[4:7], a[180:183], a[28:31], v[4:7]
v_cvt_pk_bf16_f32 v38, v12, v13
v_add_f32 v90, v90, v12
M v[4:7], a[184:187], a[48:51], v[4:7]
s_add_u32 s48, s64, 16384
v_exp_f32 v14, v14
M v[4:7], a[188:191], a[68:71], v[4:7]
v_add_f32 v90, v90, v13
v_add_f32 v90, v90, v14
v_exp_f32 v15, v15
v_exp_f32 v0, v0
v_add_f32 v90, v90, v15
v_cvt_pk_bf16_f32 v39, v14, v15
M v[208:211], a[196:199], v[28:31], v[208:211]
v_exp_f32 v1, v1
v_add_f32 v91, v91, v0
M v[212:215], a[196:199], v[32:35], v[212:215]
s_waitcnt lgkmcnt(3)
v_exp_f32 v2, v2
M v[216:219], a[200:203], v[16:19], v[216:219]
v_cvt_pk_bf16_f32 v42, v0, v1
v_add_f32 v91, v91, v1
M v[220:223], a[200:203], v[20:23], v[220:223]
v_exp_f32 v3, v3
M v[8:11], a[176:179], a[12:15], 0
s_waitcnt vmcnt(12) lgkmcnt(1)
v_cvt_pk_bf16_f32 v43, v2, v3
v_add_f32 v91, v91, v2
M v[8:11], a[180:183], a[32:35], v[8:11]
s_barrier
ds_read_b128 a[160:163], v57 offset:32768
v_add_f32 v91, v91, v3
M v[8:11], a[184:187], a[52:55], v[8:11]
ds_read_b128 a[164:167], v58 offset:32768
v_exp_f32 v4, v4
M v[8:11], a[188:191], a[72:75], v[8:11]
s_add_u32 s49, s64, 24576
ds_read_b128 a[168:171], v59 offset:32768
v_add_f32 v92, v92, v4
M v[224:227], a[200:203], v[24:27], v[224:227]
ds_read_b128 a[172:175], v60 offset:32768
M v[228:231], a[200:203], v[28:31], v[228:231]
ds_read_b64_tr_b16 a[192:193], v61 offset:16384
ds_read_b64_tr_b16 a[194:195], v61 offset:20480
M v[232:235], a[200:203], v[32:35], v[232:235]
v_exp_f32 v5, v5
M v[236:239], a[204:207], v[16:19], v[236:239]
v_exp_f32 v6, v6
M v[12:15], a[176:179], a[16:19], 0
buffer_load_dwordx4 v84, s[20:23], s46 offen lds
M v[12:15], a[180:183], a[36:39], v[12:15]
s_add_u32 m0, s39, 132096
v_exp_f32 v7, v7
M v[12:15], a[184:187], a[56:59], v[12:15]
ds_read_b64_tr_b16 a[196:197], v62 offset:16384
v_cvt_pk_bf16_f32 v46, v4, v5
M v[12:15], a[188:191], a[76:79], v[12:15]
v_exp_f32 v8, v8
M v[240:243], a[204:207], v[20:23], v[240:243]
s_add_u32 s50, s64, 32768
v_exp_f32 v9, v9
M v[244:247], a[204:207], v[24:27], v[244:247]
v_exp_f32 v10, v10
M v[248:251], a[204:207], v[28:31], v[248:251]
v_exp_f32 v11, v11
M v[252:255], a[204:207], v[32:35], v[252:255]
s_waitcnt lgkmcnt(6)
ds_read_b64_tr_b16 a[198:199], v62 offset:20480
v_cvt_pk_bf16_f32 v47, v6, v7
M v[0:3], a[160:163], a[0:3], 0
s_waitcnt lgkmcnt(6)
v_add_f32 v92, v92, v5
v_cvt_pk_bf16_f32 v50, v8, v9
M v[0:3], a[164:167], a[20:23], v[0:3]
s_waitcnt lgkmcnt(5)
v_add_f32 v92, v92, v6
v_cvt_pk_bf16_f32 v51, v10, v11
M v[0:3], a[168:171], a[40:43], v[0:3]
s_waitcnt lgkmcnt(4)
ds_read_b64_tr_b16 a[200:201], v63 offset:16384
v_add_f32 v92, v92, v7
v_exp_f32 v12, v12
M v[0:3], a[172:175], a[60:63], v[0:3]
s_waitcnt lgkmcnt(3)
ds_write_b128 v80, a[84:87] offset:16384
M v[96:99], a[192:195], v[36:39], v[96:99]
v_exp_f32 v13, v13
M v[100:103], a[192:195], v[40:43], v[100:103]
s_add_u32 s51, s64, 40960
v_exp_f32 v14, v14
M v[104:107], a[192:195], v[44:47], v[104:107]
v_exp_f32 v15, v15
M v[108:111], a[192:195], v[48:51], v[108:111]
v_cvt_pk_bf16_f32 v54, v12, v13
v_cvt_pk_bf16_f32 v55, v14, v15
M v[4:7], a[160:163], a[4:7], 0
buffer_load_dwordx4 v84, s[20:23], s47 offen lds
M v[4:7], a[164:167], a[24:27], v[4:7]
s_add_u32 m0, s39, 133120
ds_read_b64_tr_b16 a[202:203], v63 offset:20480
v_add_f32 v93, v93, v8
M v[4:7], a[168:171], a[44:47], v[4:7]
v_add_f32 v93, v93, v9
v_add_f32 v94, v94, v12
M v[4:7], a[172:175], a[64:67], v[4:7]
v_add_f32 v93, v93, v10
v_add_f32 v94, v94, v13
M v[112:115], a[192:195], v[52:55], v[112:115]
s_waitcnt lgkmcnt(3)
ds_read_b64_tr_b16 a[204:205], v64 offset:16384
v_add_f32 v93, v93, v11
M v[116:119], a[196:199], v[36:39], v[116:119]
buffer_load_dwordx4 v84, s[20:23], s48 offen lds
M v[120:123], a[196:199], v[40:43], v[120:123]
s_add_u32 m0, s39, 134144
ds_read_b64_tr_b16 a[206:207], v64 offset:20480
v_add_f32 v94, v94, v14
M v[124:127], a[196:199], v[44:47], v[124:127]
s_add_u32 s44, s64, 49152
ds_read_b128 a[176:179], v57 offset:36864
v_add_f32 v94, v94, v15
M v[8:11], a[160:163], a[8:11], 0
ds_write_b128 v80, a[104:107] offset:20480
M v[8:11], a[164:167], a[28:31], v[8:11]
v_exp_f32 v0, v0
M v[8:11], a[168:171], a[48:51], v[8:11]
v_exp_f32 v1, v1
M v[8:11], a[172:175], a[68:71], v[8:11]
buffer_load_dwordx4 v84, s[20:23], s49 offen lds
M v[128:131], a[196:199], v[48:51], v[128:131]
s_add_u32 m0, s39, 135168
v_cvt_pk_bf16_f32 v16, v0, v1
v_add_f32 v90, v90, v0
M v[132:135], a[196:199], v[52:55], v[132:135]
s_waitcnt lgkmcnt(4)
v_exp_f32 v2, v2
M v[136:139], a[200:203], v[36:39], v[136:139]
ds_read_b128 a[180:183], v58 offset:36864
v_add_f32 v90, v90, v1
M v[140:143], a[200:203], v[40:43], v[140:143]
s_add_u32 s45, s64, 57344
v_exp_f32 v3, v3
M v[12:15], a[160:163], a[12:15], 0
v_cvt_pk_bf16_f32 v17, v2, v3
v_add_f32 v90, v90, v2
M v[12:15], a[164:167], a[32:35], v[12:15]
ds_read_b128 a[184:187], v59 offset:36864
v_add_f32 v90, v90, v3
M v[12:15], a[168:171], a[52:55], v[12:15]
ds_read_b128 a[188:191], v60 offset:36864
v_exp_f32 v4, v4
M v[12:15], a[172:175], a[72:75], v[12:15]
ds_read_b64_tr_b16 a[192:193], v65 offset:16384
v_add_f32 v91, v91, v4
M v[144:147], a[200:203], v[44:47], v[144:147]
ds_read_b64_tr_b16 a[194:195], v65 offset:20480
M v[148:151], a[200:203], v[48:51], v[148:151]
v_exp_f32 v5, v5
M v[152:155], a[200:203], v[52:55], v[152:155]
s_waitcnt lgkmcnt(7)
v_exp_f32 v6, v6
M v[156:159], a[204:207], v[36:39], v[156:159]
v_cvt_pk_bf16_f32 v20, v4, v5
v_add_f32 v91, v91, v5
M v[0:3], a[160:163], a[16:19], 0
v_exp_f32 v7, v7
M v[0:3], a[164:167], a[36:39], v[0:3]
buffer_load_dwordx4 v84, s[20:23], s50 offen lds
M v[0:3], a[168:171], a[56:59], v[0:3]
s_add_u32 m0, s39, 136192
v_cvt_pk_bf16_f32 v21, v6, v7
v_add_f32 v91, v91, v6
v_add_f32 v91, v91, v7
v_exp_f32 v8, v8
v_exp_f32 v9, v9
M v[0:3], a[172:175], a[76:79], v[0:3]
ds_read_b64_tr_b16 a[196:197], v66 offset:16384
v_add_f32 v92, v92, v8
M v[160:163], a[204:207], v[40:43], v[160:163]
v_exp_f32 v10, v10
M v[164:167], a[204:207], v[44:47], v[164:167]
ds_read_b64_tr_b16 a[198:199], v66 offset:20480
v_add_f32 v92, v92, v9
M v[168:171], a[204:207], v[48:51], v[168:171]
v_exp_f32 v11, v11
M v[172:175], a[204:207], v[52:55], v[172:175]
s_waitcnt lgkmcnt(8)
v_cvt_pk_bf16_f32 v24, v8, v9
v_add_f32 v92, v92, v10
v_add_f32 v92, v92, v11
M v[4:7], a[176:179], a[0:3], 0
s_waitcnt lgkmcnt(6)
buffer_load_dwordx4 v84, s[20:23], s51 offen lds
M v[4:7], a[180:183], a[20:23], v[4:7]
s_waitcnt lgkmcnt(5)
ds_write_b128 v80, a[124:127] offset:24576
M v[4:7], a[184:187], a[40:43], v[4:7]
s_waitcnt lgkmcnt(5)
v_cvt_pk_bf16_f32 v25, v10, v11
M v[4:7], a[188:191], a[60:63], v[4:7]
s_waitcnt lgkmcnt(3)
v_exp_f32 v12, v12
M v[176:179], a[192:195], v[36:39], v[176:179]
s_add_u32 m0, s39, 137216
v_exp_f32 v13, v13
M v[180:183], a[192:195], v[40:43], v[180:183]
s_add_u32 s46, s65, 0
ds_read_b64_tr_b16 a[200:201], v67 offset:16384
v_add_f32 v93, v93, v12
M v[184:187], a[192:195], v[44:47], v[184:187]
v_exp_f32 v14, v14
M v[188:191], a[192:195], v[48:51], v[188:191]
ds_read_b64_tr_b16 a[202:203], v67 offset:20480
v_add_f32 v93, v93, v13
v_exp_f32 v15, v15
M v[8:11], a[176:179], a[4:7], 0
v_cvt_pk_bf16_f32 v28, v12, v13
v_add_f32 v93, v93, v14
M v[8:11], a[180:183], a[24:27], v[8:11]
s_add_u32 s47, s65, 8192
v_cvt_pk_bf16_f32 v29, v14, v15
v_add_f32 v93, v93, v15
M v[8:11], a[184:187], a[44:47], v[8:11]
buffer_load_dwordx4 v84, s[20:23], s44 offen lds
M v[8:11], a[188:191], a[64:67], v[8:11]
s_add_u32 m0, s39, 138240
v_exp_f32 v0, v0
M v[192:195], a[192:195], v[52:55], v[192:195]
s_waitcnt lgkmcnt(3)
v_exp_f32 v1, v1
M v[196:199], a[196:199], v[36:39], v[196:199]
ds_read_b64_tr_b16 a[204:205], v68 offset:16384
v_add_f32 v94, v94, v0
v_exp_f32 v2, v2
M v[200:203], a[196:199], v[40:43], v[200:203]
ds_read_b64_tr_b16 a[206:207], v68 offset:20480
v_add_f32 v94, v94, v1
v_exp_f32 v3, v3
v_add_f32 v94, v94, v2
v_add_f32 v94, v94, v3
v_cvt_pk_bf16_f32 v32, v0, v1
v_cvt_pk_bf16_f32 v33, v2, v3
v_exp_f32 v4, v4
M v[204:207], a[196:199], v[44:47], v[204:207]
buffer_load_dwordx4 v84, s[20:23], s45 offen lds
ds_write_b128 v80, a[144:147] offset:28672
M v[12:15], a[176:179], a[8:11], 0
s_add_u32 m0, s39, 65536
v_exp_f32 v5, v5
M v[12:15], a[180:183], a[28:31], v[12:15]
v_cvt_pk_bf16_f32 v18, v4, v5
v_add_f32 v90, v90, v4
M v[12:15], a[184:187], a[48:51], v[12:15]
s_add_u32 s48, s65, 16384
v_exp_f32 v6, v6
M v[12:15], a[188:191], a[68:71], v[12:15]
v_add_f32 v90, v90, v5
v_add_f32 v90, v90, v6
v_exp_f32 v7, v7
v_exp_f32 v8, v8
v_add_f32 v90, v90, v7
v_cvt_pk_bf16_f32 v19, v6, v7
M v[208:211], a[196:199], v[48:51], v[208:211]
v_exp_f32 v9, v9
v_add_f32 v91, v91, v8
v_exp_f32 v10, v10
M v[212:215], a[196:199], v[52:55], v[212:215]
s_waitcnt lgkmcnt(3)
v_cvt_pk_bf16_f32 v22, v8, v9
v_add_f32 v91, v91, v9
M v[216:219], a[200:203], v[36:39], v[216:219]
v_exp_f32 v11, v11
M v[220:223], a[200:203], v[40:43], v[220:223]
v_cvt_pk_bf16_f32 v23, v10, v11
v_add_f32 v91, v91, v10
M v[0:3], a[176:179], a[12:15], 0
s_waitcnt vmcnt(12) lgkmcnt(1)
v_add_f32 v91, v91, v11
M v[0:3], a[180:183], a[32:35], v[0:3]
s_barrier
ds_read_b128 a[160:163], v57 offset:49152
v_exp_f32 v12, v12
M v[0:3], a[184:187], a[52:55], v[0:3]
ds_read_b128 a[164:167], v58 offset:49152
v_add_f32 v92, v92, v12
M v[0:3], a[188:191], a[72:75], v[0:3]
s_add_u32 s49, s65, 24576
ds_read_b128 a[168:171], v59 offset:49152
M v[224:227], a[200:203], v[44:47], v[224:227]
ds_read_b128 a[172:175], v60 offset:49152
v_exp_f32 v13, v13
M v[228:231], a[200:203], v[48:51], v[228:231]
ds_read_b64_tr_b16 a[192:193], v61 offset:32768
v_cvt_pk_bf16_f32 v26, v12, v13
M v[232:235], a[200:203], v[52:55], v[232:235]
ds_read_b64_tr_b16 a[194:195], v61 offset:36864
v_add_f32 v92, v92, v13
M v[236:239], a[204:207], v[36:39], v[236:239]
v_exp_f32 v14, v14
M v[4:7], a[176:179], a[16:19], 0
buffer_load_dwordx4 v84, s[20:23], s46 offen lds
M v[4:7], a[180:183], a[36:39], v[4:7]
s_add_u32 m0, s39, 66560
v_exp_f32 v15, v15
M v[4:7], a[184:187], a[56:59], v[4:7]
ds_read_b64_tr_b16 a[196:197], v62 offset:32768
v_cvt_pk_bf16_f32 v27, v14, v15
M v[4:7], a[188:191], a[76:79], v[4:7]
v_exp_f32 v0, v0
M v[240:243], a[204:207], v[40:43], v[240:243]
s_add_u32 s50, s65, 32768
v_exp_f32 v1, v1
M v[244:247], a[204:207], v[44:47], v[244:247]
v_exp_f32 v2, v2
M v[248:251], a[204:207], v[48:51], v[248:251]
v_exp_f32 v3, v3
M v[252:255], a[204:207], v[52:55], v[252:255]
s_waitcnt lgkmcnt(6)
ds_read_b64_tr_b16 a[198:199], v62 offset:36864
v_cvt_pk_bf16_f32 v30, v0, v1
M v[8:11], a[160:163], a[0:3], 0
s_waitcnt lgkmcnt(6)
v_add_f32 v92, v92, v14
v_cvt_pk_bf16_f32 v31, v2, v3
M v[8:11], a[164:167], a[20:23], v[8:11]
s_waitcnt lgkmcnt(5)
v_readfirstlane_b32 s101, v56
v_add_f32 v92, v92, v15
M v[8:11], a[168:171], a[40:43], v[8:11]
s_waitcnt lgkmcnt(4)
ds_write_b128 v80, a[88:91] offset:32768
M v[8:11], a[172:175], a[60:63], v[8:11]
s_waitcnt lgkmcnt(3)
v_exp_f32 v4, v4
M v[96:99], a[192:195], v[16:19], v[96:99]
v_exp_f32 v5, v5
M v[100:103], a[192:195], v[20:23], v[100:103]
s_add_u32 s51, s65, 40960
v_exp_f32 v6, v6
M v[104:107], a[192:195], v[24:27], v[104:107]
v_exp_f32 v7, v7
M v[108:111], a[192:195], v[28:31], v[108:111]
v_cvt_pk_bf16_f32 v34, v4, v5
v_cvt_pk_bf16_f32 v35, v6, v7
M v[12:15], a[160:163], a[4:7], 0
buffer_load_dwordx4 v84, s[20:23], s47 offen lds
M v[12:15], a[164:167], a[24:27], v[12:15]
s_add_u32 m0, s39, 67584
ds_read_b64_tr_b16 a[200:201], v63 offset:32768
v_add_f32 v93, v93, v0
M v[12:15], a[168:171], a[44:47], v[12:15]
ds_read_b64_tr_b16 a[202:203], v63 offset:36864
v_add_f32 v93, v93, v1
M v[12:15], a[172:175], a[64:67], v[12:15]
v_add_f32 v93, v93, v2
v_add_f32 v94, v94, v4
M v[112:115], a[192:195], v[32:35], v[112:115]
s_waitcnt lgkmcnt(3)
v_add_f32 v93, v93, v3
v_add_f32 v94, v94, v5
M v[116:119], a[196:199], v[16:19], v[116:119]
buffer_load_dwordx4 v84, s[20:23], s48 offen lds
M v[120:123], a[196:199], v[20:23], v[120:123]
s_add_u32 m0, s39, 68608
ds_read_b64_tr_b16 a[204:205], v64 offset:32768
v_add_f32 v94, v94, v6
M v[124:127], a[196:199], v[24:27], v[124:127]
s_add_u32 s44, s65, 49152
ds_read_b64_tr_b16 a[206:207], v64 offset:36864
v_add_f32 v94, v94, v7
M v[0:3], a[160:163], a[8:11], 0
ds_write_b128 v80, a[108:111] offset:36864
M v[0:3], a[164:167], a[28:31], v[0:3]
v_exp_f32 v8, v8
M v[0:3], a[168:171], a[48:51], v[0:3]
v_exp_f32 v9, v9
M v[0:3], a[172:175], a[68:71], v[0:3]
buffer_load_dwordx4 v84, s[20:23], s49 offen lds
M v[128:131], a[196:199], v[28:31], v[128:131]
s_add_u32 m0, s39, 69632
ds_read_b128 a[176:179], v57 offset:53248
v_add_f32 v90, v90, v8
M v[132:135], a[196:199], v[32:35], v[132:135]
s_waitcnt lgkmcnt(4)
v_exp_f32 v10, v10
M v[136:139], a[200:203], v[16:19], v[136:139]
v_cvt_pk_bf16_f32 v36, v8, v9
v_add_f32 v90, v90, v9
M v[140:143], a[200:203], v[20:23], v[140:143]
s_add_u32 s45, s65, 57344
v_exp_f32 v11, v11
M v[4:7], a[160:163], a[12:15], 0
v_cvt_pk_bf16_f32 v37, v10, v11
v_add_f32 v90, v90, v10
M v[4:7], a[164:167], a[32:35], v[4:7]
ds_read_b128 a[180:183], v58 offset:53248
v_add_f32 v90, v90, v11
v_exp_f32 v12, v12
M v[4:7], a[168:171], a[52:55], v[4:7]
ds_read_b128 a[184:187], v59 offset:53248
v_add_f32 v91, v91, v12
M v[4:7], a[172:175], a[72:75], v[4:7]
ds_read_b128 a[188:191], v60 offset:53248
M v[144:147], a[200:203], v[24:27], v[144:147]
ds_read_b64_tr_b16 a[192:193], v65 offset:32768
ds_read_b64_tr_b16 a[194:195], v65 offset:36864
M v[148:151], a[200:203], v[28:31], v[148:151]
v_exp_f32 v13, v13
M v[152:155], a[200:203], v[32:35], v[152:155]
s_waitcnt lgkmcnt(7)
v_exp_f32 v14, v14
M v[156:159], a[204:207], v[16:19], v[156:159]
v_cvt_pk_bf16_f32 v40, v12, v13
v_add_f32 v91, v91, v13
M v[8:11], a[160:163], a[16:19], 0
L_hop_c2:
s_cbranch_execz L_ret_c2
v_exp_f32 v15, v15
M v[8:11], a[164:167], a[36:39], v[8:11]
buffer_load_dwordx4 v84, s[20:23], s50 offen lds
M v[8:11], a[168:171], a[56:59], v[8:11]
s_add_u32 m0, s39, 70656
v_cvt_pk_bf16_f32 v41, v14, v15
v_add_f32 v91, v91, v14
v_add_f32 v91, v91, v15
v_exp_f32 v0, v0
v_exp_f32 v1, v1
M v[8:11], a[172:175], a[76:79], v[8:11]
ds_read_b64_tr_b16 a[196:197], v66 offset:32768
v_add_f32 v92, v92, v0
M v[160:163], a[204:207], v[20:23], v[160:163]
v_exp_f32 v2, v2
M v[164:167], a[204:207], v[24:27], v[164:167]
ds_read_b64_tr_b16 a[198:199], v66 offset:36864
v_add_f32 v92, v92, v1
M v[168:171], a[204:207], v[28:31], v[168:171]
v_exp_f32 v3, v3
M v[172:175], a[204:207], v[32:35], v[172:175]
s_waitcnt lgkmcnt(7)
v_cvt_pk_bf16_f32 v44, v0, v1
v_add_f32 v92, v92, v2
v_add_f32 v92, v92, v3
M v[12:15], a[176:179], a[0:3], 0
s_waitcnt lgkmcnt(6)
buffer_load_dwordx4 v84, s[20:23], s51 offen lds
M v[12:15], a[180:183], a[20:23], v[12:15]
s_waitcnt lgkmcnt(5)
ds_write_b128 v80, a[128:131] offset:40960
M v[12:15], a[184:187], a[40:43], v[12:15]
s_waitcnt lgkmcnt(5)
v_cvt_pk_bf16_f32 v45, v2, v3
M v[12:15], a[188:191], a[60:63], v[12:15]
s_waitcnt lgkmcnt(3)
v_exp_f32 v4, v4
M v[176:179], a[192:195], v[16:19], v[176:179]
s_add_u32 m0, s39, 71680
v_exp_f32 v5, v5
M v[180:183], a[192:195], v[20:23], v[180:183]
ds_read_b64_tr_b16 a[200:201], v67 offset:32768
v_add_f32 v93, v93, v4
M v[184:187], a[192:195], v[24:27], v[184:187]
v_exp_f32 v6, v6
M v[188:191], a[192:195], v[28:31], v[188:191]
ds_read_b64_tr_b16 a[202:203], v67 offset:36864
v_add_f32 v93, v93, v5
v_exp_f32 v7, v7
v_add_f32 v93, v93, v6
v_add_f32 v93, v93, v7
v_cvt_pk_bf16_f32 v48, v4, v5
M v[0:3], a[176:179], a[4:7], 0
buffer_load_dwordx4 v84, s[20:23], s44 offen lds
M v[0:3], a[180:183], a[24:27], v[0:3]
s_add_u32 m0, s39, 72704
ds_read_b64_tr_b16 a[204:205], v68 offset:32768
v_cvt_pk_bf16_f32 v49, v6, v7
v_exp_f32 v8, v8
v_exp_f32 v9, v9
v_add_f32 v94, v94, v8
v_exp_f32 v10, v10
M v[0:3], a[184:187], a[44:47], v[0:3]
ds_read_b64_tr_b16 a[206:207], v68 offset:36864
v_add_f32 v94, v94, v9
v_exp_f32 v11, v11
v_add_f32 v94, v94, v10
v_add_f32 v94, v94, v11
v_cvt_pk_bf16_f32 v52, v8, v9
v_cvt_pk_bf16_f32 v53, v10, v11
v_exp_f32 v12, v12
M v[0:3], a[188:191], a[64:67], v[0:3]
ds_write_b128 v80, a[148:151] offset:45056
v_exp_f32 v13, v13
v_add_f32 v90, v90, v12
v_exp_f32 v14, v14
v_add_f32 v90, v90, v13
M v[192:195], a[192:195], v[32:35], v[192:195]
s_waitcnt lgkmcnt(6)
v_exp_f32 v15, v15
v_add_f32 v90, v90, v14
M v[196:199], a[196:199], v[16:19], v[196:199]
v_cvt_pk_bf16_f32 v38, v12, v13
v_add_f32 v90, v90, v15
M v[200:203], a[196:199], v[20:23], v[200:203]
v_cvt_pk_bf16_f32 v39, v14, v15
v_exp_f32 v0, v0
M v[204:207], a[196:199], v[24:27], v[204:207]
buffer_load_dwordx4 v84, s[20:23], s45 offen lds
M v[4:7], a[176:179], a[8:11], 0
v_exp_f32 v1, v1
v_add_f32 v91, v91, v0
v_exp_f32 v2, v2
M v[4:7], a[180:183], a[28:31], v[4:7]
v_cvt_pk_bf16_f32 v42, v0, v1
v_add_f32 v91, v91, v1
M v[4:7], a[184:187], a[48:51], v[4:7]
v_exp_f32 v3, v3
M v[4:7], a[188:191], a[68:71], v[4:7]
v_cvt_pk_bf16_f32 v43, v2, v3
v_add_f32 v91, v91, v2
M v[208:211], a[196:199], v[28:31], v[208:211]
v_add_f32 v91, v91, v3
v_mov_b32 v0, v90
M v[212:215], a[196:199], v[32:35], v[212:215]
s_waitcnt lgkmcnt(3)
v_mov_b32 v1, v91
v_exp_f32 v4, v4
M v[216:219], a[200:203], v[16:19], v[216:219]
v_exp_f32 v5, v5
M v[220:223], a[200:203], v[20:23], v[220:223]
v_exp_f32 v6, v6
M v[8:11], a[176:179], a[12:15], 0
s_waitcnt vmcnt(16) lgkmcnt(1)
v_exp_f32 v7, v7
M v[8:11], a[180:183], a[32:35], v[8:11]
s_barrier
ds_read_b64_tr_b16 a[192:193], v61 offset:49152
v_cvt_pk_bf16_f32 v46, v4, v5
v_cvt_pk_bf16_f32 v47, v6, v7
v_add_f32 v92, v92, v4
M v[8:11], a[184:187], a[52:55], v[8:11]
ds_read_b64_tr_b16 a[194:195], v61 offset:53248
v_add_f32 v92, v92, v5
v_add_f32 v92, v92, v6
v_add_f32 v92, v92, v7
M v[8:11], a[188:191], a[72:75], v[8:11]
ds_read_b64_tr_b16 a[196:197], v62 offset:49152
v_mov_b32 v2, v92
M v[224:227], a[200:203], v[24:27], v[224:227]
ds_read_b64_tr_b16 a[198:199], v62 offset:53248
M v[228:231], a[200:203], v[28:31], v[228:231]
M v[232:235], a[200:203], v[32:35], v[232:235]
ds_read_b64_tr_b16 a[200:201], v63 offset:49152
ds_read_b64_tr_b16 a[202:203], v63 offset:53248
v_exp_f32 v8, v8
v_exp_f32 v9, v9
v_exp_f32 v10, v10
M v[236:239], a[204:207], v[16:19], v[236:239]
v_exp_f32 v11, v11
M v[12:15], a[176:179], a[16:19], 0
v_cvt_pk_bf16_f32 v50, v8, v9
v_cvt_pk_bf16_f32 v51, v10, v11
M v[12:15], a[180:183], a[36:39], v[12:15]
v_add_f32 v93, v93, v8
v_add_f32 v93, v93, v9
M v[12:15], a[184:187], a[56:59], v[12:15]
ds_write_b128 v80, a[92:95] offset:49152
M v[12:15], a[188:191], a[76:79], v[12:15]
v_add_f32 v93, v93, v10
v_max3_f32 v8, v90, v91, v92
M v[240:243], a[204:207], v[20:23], v[240:243]
v_add_f32 v93, v93, v11
v_min3_f32 v9, v90, v91, v92
M v[244:247], a[204:207], v[24:27], v[244:247]
v_mov_b32 v11, s55
v_mov_b32 v3, v93
v_exp_f32 v12, v12
M v[248:251], a[204:207], v[28:31], v[248:251]
v_exp_f32 v13, v13
M v[252:255], a[204:207], v[32:35], v[252:255]
s_waitcnt lgkmcnt(5)
v_exp_f32 v14, v14
M v[96:99], a[192:195], v[36:39], v[96:99]
v_exp_f32 v15, v15
M v[100:103], a[192:195], v[40:43], v[100:103]
v_cvt_pk_bf16_f32 v54, v12, v13
v_cvt_pk_bf16_f32 v55, v14, v15
M v[104:107], a[192:195], v[44:47], v[104:107]
ds_read_b64_tr_b16 a[204:205], v64 offset:49152
v_add_f32 v94, v94, v12
M v[108:111], a[192:195], v[48:51], v[108:111]
ds_read_b64_tr_b16 a[206:207], v64 offset:53248
v_add_f32 v94, v94, v13
M v[112:115], a[192:195], v[52:55], v[112:115]
s_waitcnt lgkmcnt(5)
ds_write_b128 v80, a[112:115] offset:53248
M v[116:119], a[196:199], v[36:39], v[116:119]
v_add_f32 v94, v94, v14
v_add_f32 v94, v94, v15
M v[120:123], a[196:199], v[40:43], v[120:123]
ds_read_b64_tr_b16 a[192:193], v65 offset:49152
v_max3_f32 v8, v8, v93, v94
M v[124:127], a[196:199], v[44:47], v[124:127]
ds_read_b64_tr_b16 a[194:195], v65 offset:53248
v_min3_f32 v9, v9, v93, v94
M v[128:131], a[196:199], v[48:51], v[128:131]
ds_write_b128 v80, a[132:135] offset:57344
M v[132:135], a[196:199], v[52:55], v[132:135]
s_waitcnt lgkmcnt(7)
v_mul_f32 v8, s42, v8
v_cmp_nge_f32 s[58:59], v9, s42
M v[136:139], a[200:203], v[36:39], v[136:139]
ds_read_b64_tr_b16 a[196:197], v66 offset:49152
v_cmp_nle_f32 s[56:57], v8, 1.0
M v[140:143], a[200:203], v[40:43], v[140:143]
ds_read_b64_tr_b16 a[198:199], v66 offset:53248
v_mov_b32 v4, v94
M v[144:147], a[200:203], v[44:47], v[144:147]
s_or_b64 s[56:57], s[56:57], s[58:59]
v_permlane32_swap_b32 v0, v90
M v[148:151], a[200:203], v[48:51], v[148:151]
s_or_b32 s56, s56, s57
v_mov_b32 v10, s56
v_add_f32 v90, v0, v90
M v[152:155], a[200:203], v[52:55], v[152:155]
s_waitcnt lgkmcnt(6)
ds_write_b32 v11, v10
v_mov_b32 v0, v90
M v[156:159], a[204:207], v[36:39], v[156:159]
ds_read_b64_tr_b16 a[200:201], v67 offset:49152
v_mov_b32 v11, 0
M v[160:163], a[204:207], v[40:43], v[160:163]
ds_read_b64_tr_b16 a[202:203], v67 offset:53248
M v[164:167], a[204:207], v[44:47], v[164:167]
v_permlane32_swap_b32 v1, v91
M v[168:171], a[204:207], v[48:51], v[168:171]
v_permlane32_swap_b32 v2, v92
M v[172:175], a[204:207], v[52:55], v[172:175]
s_waitcnt lgkmcnt(6)
ds_read_b64_tr_b16 a[204:205], v68 offset:49152
v_add_f32 v91, v1, v91
M v[176:179], a[192:195], v[36:39], v[176:179]
ds_read_b64_tr_b16 a[206:207], v68 offset:53248
v_add_f32 v92, v2, v92
M v[180:183], a[192:195], v[40:43], v[180:183]
v_permlane32_swap_b32 v3, v93
M v[184:187], a[192:195], v[44:47], v[184:187]
v_permlane32_swap_b32 v4, v94
M v[188:191], a[192:195], v[48:51], v[188:191]
v_add_f32 v93, v3, v93
v_add_f32 v94, v4, v94
M v[192:195], a[192:195], v[52:55], v[192:195]
s_waitcnt lgkmcnt(5)
v_mov_b32 v1, v91
v_mov_b32 v2, v92
M v[196:199], a[196:199], v[36:39], v[196:199]
v_mov_b32 v3, v93
v_mov_b32 v4, v94
M v[200:203], a[196:199], v[40:43], v[200:203]
v_permlane16_swap_b32 v0, v90
M v[204:207], a[196:199], v[44:47], v[204:207]
v_permlane16_swap_b32 v1, v91
M v[208:211], a[196:199], v[48:51], v[208:211]
s_waitcnt lgkmcnt(0)
v_permlane16_swap_b32 v2, v92
M v[212:215], a[196:199], v[52:55], v[212:215]
s_barrier
ds_read_b128 v[12:15], v11 offset:63488
v_add_f32 v90, v0, v90
M v[216:219], a[200:203], v[36:39], v[216:219]
v_permlane16_swap_b32 v3, v93
M v[220:223], a[200:203], v[40:43], v[220:223]
v_permlane16_swap_b32 v4, v94
M v[224:227], a[200:203], v[44:47], v[224:227]
v_add_f32 v91, v1, v91
v_add_f32 v92, v2, v92
M v[228:231], a[200:203], v[48:51], v[228:231]
v_add_f32 v93, v3, v93
v_add_f32 v94, v4, v94
M v[232:235], a[200:203], v[52:55], v[232:235]
v_rcp_f32 v90, v90
M v[236:239], a[204:207], v[36:39], v[236:239]
v_rcp_f32 v91, v91
M v[240:243], a[204:207], v[40:43], v[240:243]
v_rcp_f32 v92, v92
M v[244:247], a[204:207], v[44:47], v[244:247]
v_rcp_f32 v93, v93
M v[248:251], a[204:207], v[48:51], v[248:251]
v_rcp_f32 v94, v94
M v[252:255], a[204:207], v[52:55], v[252:255]
s_waitcnt lgkmcnt(0)
v_or3_b32 v12, v12, v13, v14
v_or_b32 v12, v12, v15
s_nop 0
v_readfirstlane_b32 s60, v12
s_nop 1
s_cmp_lg_u32 s60, 0
s_cbranch_scc1 L_slow1
L_back1:
s_cmp_lg_u32 s101, 1024
s_cbranch_scc1 L_spin
L_ready:
s_waitcnt vmcnt(8)
s_barrier
ds_read_b64_tr_b16 a[160:161], v86 offset:0
ds_read_b64_tr_b16 a[162:163], v86 offset:2048
ds_read_b64_tr_b16 a[164:165], v86 offset:4096
ds_read_b64_tr_b16 a[166:167], v86 offset:6144
ds_read_b128 a[0:3], v81 offset:0
s_add_u32 m0, s39, 98304
ds_read_b128 a[20:23], v81 offset:4096
s_add_u32 s46, s66, 0
s_add_u32 s47, s66, 8192
s_add_u32 s48, s66, 16384
ds_read_b128 a[40:43], v81 offset:8192
s_add_u32 s49, s66, 24576
s_add_u32 s50, s66, 32768
s_add_u32 s51, s66, 40960
ds_read_b128 a[60:63], v81 offset:12288
s_waitcnt lgkmcnt(6)
M v[0:3], a[160:163], a[80:83], 0
s_waitcnt lgkmcnt(4)
ds_read_b128 a[4:7], v81 offset:16384
ds_read_b64_tr_b16 a[168:169], v86 offset:8192
buffer_load_dwordx4 v84, s[20:23], s46 offen lds
ds_read_b64_tr_b16 a[170:171], v86 offset:10240
ds_read_b64_tr_b16 a[172:173], v86 offset:12288
ds_read_b64_tr_b16 a[174:175], v86 offset:14336
ds_read_b64_tr_b16 a[176:177], v87 offset:0
ds_read_b64_tr_b16 a[178:179], v87 offset:2048
M v[0:3], a[164:167], a[100:103], v[0:3]
s_waitcnt lgkmcnt(4)
ds_read_b64_tr_b16 a[180:181], v87 offset:4096
ds_read_b64_tr_b16 a[182:183], v87 offset:6144
ds_read_b64_tr_b16 a[184:185], v87 offset:8192
ds_read_b64_tr_b16 a[186:187], v87 offset:10240
s_add_u32 m0, s39, 99328
ds_read_b64_tr_b16 a[188:189], v87 offset:12288
ds_read_b64_tr_b16 a[190:191], v87 offset:14336
ds_read_b64_tr_b16 a[192:193], v88 offset:0
M v[0:3], a[168:171], a[120:123], v[0:3]
s_waitcnt lgkmcnt(9)
ds_read_b64_tr_b16 a[194:195], v88 offset:2048
v_lshrrev_b32 v76, 6, v85
M v[0:3], a[172:175], a[140:143], v[0:3]
s_barrier
ds_read_b64_tr_b16 a[196:197], v88 offset:4096
v_lshlrev_b32 v76, 12, v76
M v[4:7], a[160:163], a[84:87], 0
s_add_u32 s44, s66, 49152
ds_read_b64_tr_b16 a[198:199], v88 offset:6144
v_lshl_add_u32 v85, v85, 4, v76
M v[4:7], a[164:167], a[104:107], v[4:7]
s_add_u32 s45, s66, 57344
buffer_load_dwordx4 v84, s[20:23], s47 offen lds
s_add_u32 m0, s39, 100352
ds_read_b64_tr_b16 a[200:201], v88 offset:8192
ds_read_b64_tr_b16 a[202:203], v88 offset:10240
ds_read_b64_tr_b16 a[204:205], v88 offset:12288
ds_read_b64_tr_b16 a[206:207], v88 offset:14336
ds_read_b128 a[24:27], v81 offset:20480
M v[4:7], a[168:171], a[124:127], v[4:7]
ds_write_b128 v80, a[152:155] offset:0
M v[4:7], a[172:175], a[144:147], v[4:7]
v_mul_f32 v96, v90, v96
v_subrev_u32 v86, 65536, v86
M v[8:11], a[160:163], a[88:91], 0
v_mul_f32 v97, v90, v97
v_mul_f32 v98, v90, v98
M v[8:11], a[164:167], a[108:111], v[8:11]
ds_read_b128 a[44:47], v81 offset:24576
v_mul_f32 v99, v90, v99
M v[8:11], a[168:171], a[128:131], v[8:11]
ds_write_b128 v80, a[96:99] offset:4096
buffer_load_dwordx4 v84, s[20:23], s48 offen lds
s_add_u32 m0, s39, 101376
M v[8:11], a[172:175], a[148:151], v[8:11]
v_mul_f32 v116, v90, v116
v_cvt_pk_bf16_f32 v96, v96, v97
M v[12:15], a[160:163], a[92:95], 0
ds_read_b128 a[64:67], v81 offset:28672
v_mul_f32 v117, v90, v117
M v[12:15], a[164:167], a[112:115], v[12:15]
ds_read_b128 a[8:11], v81 offset:32768
v_mul_f32 v118, v90, v118
M v[12:15], a[168:171], a[132:135], v[12:15]
ds_write_b128 v80, a[116:119] offset:8192
M v[12:15], a[172:175], a[152:155], v[12:15]
buffer_load_dwordx4 v84, s[20:23], s49 offen lds
s_add_u32 m0, s39, 102400
M v[16:19], a[160:163], a[96:99], 0
ds_read_b128 a[28:31], v81 offset:36864
v_mul_f32 v119, v90, v119
M v[16:19], a[164:167], a[116:119], v[16:19]
ds_read_b128 a[48:51], v81 offset:40960
v_cvt_pk_bf16_f32 v97, v98, v99
M v[16:19], a[168:171], a[136:139], v[16:19]
ds_write_b128 v80, a[136:139] offset:12288
M v[16:19], a[172:175], a[156:159], v[16:19]
s_waitcnt lgkmcnt(15)
v_cvt_pk_bf16_f32 v98, v116, v117
v_cvt_pk_bf16_f32 v99, v118, v119
M v[20:23], a[176:179], a[80:83], 0
s_waitcnt lgkmcnt(15)
buffer_load_dwordx4 v84, s[20:23], s50 offen lds
s_add_u32 m0, s39, 103424
ds_read_b128 a[68:71], v81 offset:45056
M v[20:23], a[180:183], a[100:103], v[20:23]
s_waitcnt lgkmcnt(15)
ds_read_b128 a[12:15], v81 offset:49152
v_mul_f32 v136, v90, v136
M v[20:23], a[184:187], a[120:123], v[20:23]
s_waitcnt lgkmcnt(15)
ds_write_b128 v80, a[156:159] offset:16384
M v[20:23], a[188:191], a[140:143], v[20:23]
v_mul_f32 v137, v90, v137
v_mul_f32 v138, v90, v138
M v[24:27], a[176:179], a[84:87], 0
v_mul_f32 v139, v90, v139
v_cvt_pk_bf16_f32 v136, v136, v137
M v[24:27], a[180:183], a[104:107], v[24:27]
buffer_load_dwordx4 v84, s[20:23], s51 offen lds
M v[24:27], a[184:187], a[124:127], v[24:27]
s_add_u32 m0, s39, 104448
ds_read_b128 a[32:35], v81 offset:53248
v_mul_f32 v156, v90, v156
M v[24:27], a[188:191], a[144:147], v[24:27]
ds_read_b128 a[52:55], v81 offset:57344
v_mul_f32 v157, v90, v157
M v[28:31], a[176:179], a[88:91], 0
ds_read_b64_tr_b16 a[160:161], v89 offset:0
v_mul_f32 v158, v90, v158
M v[28:31], a[180:183], a[108:111], v[28:31]
ds_read_b64_tr_b16 a[162:163], v89 offset:2048
v_mul_f32 v159, v90, v159
M v[28:31], a[184:187], a[128:131], v[28:31]
buffer_load_dwordx4 v84, s[20:23], s44 offen lds
M v[28:31], a[188:191], a[148:151], v[28:31]
s_add_u32 m0, s39, 105472
ds_read_b64_tr_b16 a[164:165], v89 offset:4096
v_cvt_pk_bf16_f32 v137, v138, v139
M v[32:35], a[176:179], a[92:95], 0
ds_read_b64_tr_b16 a[166:167], v89 offset:6144
v_cvt_pk_bf16_f32 v138, v156, v157
M v[32:35], a[180:183], a[112:115], v[32:35]
ds_read_b64_tr_b16 a[168:169], v89 offset:8192
v_cvt_pk_bf16_f32 v139, v158, v159
M v[32:35], a[184:187], a[132:135], v[32:35]
ds_read_b64_tr_b16 a[170:171], v89 offset:10240
v_subrev_u32 v87, 65536, v87
M v[32:35], a[188:191], a[152:155], v[32:35]
s_waitcnt lgkmcnt(8)
buffer_load_dwordx4 v84, s[20:23], s45 offen lds
M v[36:39], a[176:179], a[96:99], 0
s_barrier
ds_read_b128 a[72:75], v81 offset:0
v_mul_f32 v176, v90, v176
M v[36:39], a[180:183], a[116:119], v[36:39]
s_add_u32 m0, s39, 131072
ds_read_b128 a[16:19], v81 offset:4096
v_mul_f32 v177, v90, v177
M v[36:39], a[184:187], a[136:139], v[36:39]
s_add_u32 s46, s64, 262144
ds_read_b128 a[36:39], v81 offset:8192
v_mul_f32 v178, v90, v178
M v[36:39], a[188:191], a[156:159], v[36:39]
s_add_u32 s47, s64, 270336
ds_read_b128 a[56:59], v81 offset:12288
v_mul_f32 v179, v90, v179
M v[0:3], a[192:195], a[0:3], v[0:3]
ds_read_b128 a[76:79], v81 offset:16384
v_cvt_pk_bf16_f32 v176, v176, v177
M v[0:3], a[196:199], a[20:23], v[0:3]
ds_read_b64_tr_b16 a[172:173], v89 offset:12288
v_mul_f32 v196, v90, v196
M v[0:3], a[200:203], a[40:43], v[0:3]
ds_read_b64_tr_b16 a[174:175], v89 offset:14336
v_mul_f32 v197, v90, v197
M v[0:3], a[204:207], a[60:63], v[0:3]
v_mul_f32 v198, v90, v198
v_mul_f32 v199, v90, v199
M v[4:7], a[192:195], a[4:7], v[4:7]
v_cvt_pk_bf16_f32 v177, v178, v179
v_mul_f32 v216, v90, v216
M v[4:7], a[196:199], a[24:27], v[4:7]
v_cvt_pk_bf16_f32 v178, v196, v197
v_cvt_pk_bf16_f32 v179, v198, v199
M v[4:7], a[200:203], a[44:47], v[4:7]
v_mul_f32 v217, v90, v217
v_mul_f32 v218, v90, v218
M v[4:7], a[204:207], a[64:67], v[4:7]
s_add_u32 s48, s64, 278528
v_mul_f32 v219, v90, v219
v_cvt_pk_bf16_f32 v216, v216, v217
M v[8:11], a[192:195], a[8:11], v[8:11]
v_mul_f32 v236, v90, v236
v_mul_f32 v237, v90, v237
M v[8:11], a[196:199], a[28:31], v[8:11]
v_mul_f32 v238, v90, v238
v_mul_f32 v239, v90, v239
M v[8:11], a[200:203], a[48:51], v[8:11]
v_cvt_pk_bf16_f32 v217, v218, v219
v_subrev_u32 v88, 65536, v88
M v[8:11], a[204:207], a[68:71], v[8:11]
v_cvt_pk_bf16_f32 v218, v236, v237
v_cvt_pk_bf16_f32 v219, v238, v239
M v[12:15], a[192:195], a[12:15], v[12:15]
s_waitcnt lgkmcnt(14)
v_mul_f32 v100, v91, v100
v_mul_f32 v101, v91, v101
M v[12:15], a[196:199], a[32:35], v[12:15]
s_waitcnt lgkmcnt(13)
v_mul_f32 v102, v91, v102
v_mul_f32 v103, v91, v103
M v[12:15], a[200:203], a[52:55], v[12:15]
s_waitcnt lgkmcnt(6)
v_mul_f32 v120, v91, v120
v_cvt_pk_bf16_f32 v100, v100, v101
M v[12:15], a[204:207], a[72:75], v[12:15]
s_waitcnt lgkmcnt(5)
v_mul_f32 v121, v91, v121
v_mul_f32 v122, v91, v122
M v[16:19], a[192:195], a[16:19], v[16:19]
s_waitcnt lgkmcnt(4)
v_mul_f32 v123, v91, v123
v_cvt_pk_bf16_f32 v101, v102, v103
M v[16:19], a[196:199], a[36:39], v[16:19]
s_waitcnt lgkmcnt(3)
v_cvt_pk_bf16_f32 v102, v120, v121
v_cvt_pk_bf16_f32 v103, v122, v123
M v[16:19], a[200:203], a[56:59], v[16:19]
s_waitcnt lgkmcnt(2)
v_mul_f32 v140, v91, v140
v_mul_f32 v141, v91, v141
M v[16:19], a[204:207], a[76:79], v[16:19]
v_mul_f32 v142, v91, v142
v_mul_f32 v143, v91, v143
M v[20:23], a[160:163], a[0:3], v[20:23]
v_mul_f32 v160, v91, v160
v_cvt_pk_bf16_f32 v140, v140, v141
M v[20:23], a[164:167], a[20:23], v[20:23]
s_waitcnt vmcnt(8) lgkmcnt(0)
v_mul_f32 v161, v91, v161
v_mul_f32 v162, v91, v162
M v[20:23], a[168:171], a[40:43], v[20:23]
s_barrier
ds_read_b64_tr_b16 a[176:177], v86 offset:0
v_mul_f32 v163, v91, v163
M v[20:23], a[172:175], a[60:63], v[20:23]
s_add_u32 s49, s64, 286720
ds_read_b64_tr_b16 a[178:179], v86 offset:2048
v_cvt_pk_bf16_f32 v141, v142, v143
M v[24:27], a[160:163], a[4:7], v[24:27]
s_add_u32 s50, s64, 294912
ds_read_b64_tr_b16 a[180:181], v86 offset:4096
v_cvt_pk_bf16_f32 v142, v160, v161
M v[24:27], a[164:167], a[24:27], v[24:27]
ds_read_b64_tr_b16 a[182:183], v86 offset:6144
v_cvt_pk_bf16_f32 v143, v162, v163
M v[24:27], a[168:171], a[44:47], v[24:27]
ds_read_b64_tr_b16 a[184:185], v86 offset:8192
v_mul_f32 v180, v91, v180
M v[24:27], a[172:175], a[64:67], v[24:27]
buffer_load_dwordx4 v84, s[20:23], s46 offen lds
M v[28:31], a[160:163], a[8:11], v[28:31]
s_add_u32 m0, s39, 132096
ds_read_b64_tr_b16 a[186:187], v86 offset:10240
v_mul_f32 v181, v91, v181
M v[28:31], a[164:167], a[28:31], v[28:31]
ds_read_b64_tr_b16 a[188:189], v86 offset:12288
v_mul_f32 v182, v91, v182
M v[28:31], a[168:171], a[48:51], v[28:31]
ds_read_b64_tr_b16 a[190:191], v86 offset:14336
v_mul_f32 v183, v91, v183
M v[28:31], a[172:175], a[68:71], v[28:31]
s_add_u32 s51, s64, 303104
ds_write_b128 v80, v[96:99] offset:0
M v[32:35], a[160:163], a[12:15], v[32:35]
buffer_load_dwordx4 v84, s[20:23], s47 offen lds
M v[32:35], a[164:167], a[32:35], v[32:35]
s_add_u32 m0, s39, 133120
ds_read_b64_tr_b16 a[192:193], v87 offset:0
v_cvt_pk_bf16_f32 v180, v180, v181
M v[32:35], a[168:171], a[52:55], v[32:35]
ds_read_b64_tr_b16 a[194:195], v87 offset:2048
v_mul_f32 v200, v91, v200
M v[32:35], a[172:175], a[72:75], v[32:35]
ds_read_b64_tr_b16 a[196:197], v87 offset:4096
v_mul_f32 v201, v91, v201
M v[36:39], a[160:163], a[16:19], v[36:39]
ds_read_b64_tr_b16 a[198:199], v87 offset:6144
v_mul_f32 v202, v91, v202
M v[36:39], a[164:167], a[36:39], v[36:39]
ds_read_b64_tr_b16 a[200:201], v87 offset:8192
v_mul_f32 v203, v91, v203
M v[36:39], a[168:171], a[56:59], v[36:39]
ds_read_b64_tr_b16 a[202:203], v87 offset:10240
v_cvt_pk_bf16_f32 v181, v182, v183
M v[36:39], a[172:175], a[76:79], v[36:39]
s_waitcnt lgkmcnt(13)
ds_write_b128 v80, v[136:139] offset:4096
M v[40:43], a[176:179], a[80:83], 0
s_waitcnt lgkmcnt(12)
buffer_load_dwordx4 v84, s[20:23], s48 offen lds
M v[40:43], a[180:183], a[100:103], v[40:43]
s_waitcnt lgkmcnt(10)
ds_read_b64_tr_b16 a[204:205], v87 offset:12288
v_cvt_pk_bf16_f32 v182, v200, v201
M v[40:43], a[184:187], a[120:123], v[40:43]
s_waitcnt lgkmcnt(9)
ds_read_b64_tr_b16 a[206:207], v87 offset:14336
v_cvt_pk_bf16_f32 v183, v202, v203
M v[40:43], a[188:191], a[140:143], v[40:43]
s_add_u32 m0, s39, 134144
ds_read_b64_tr_b16 a[160:161], v88 offset:0
v_subrev_u32 v89, 65536, v89
M v[44:47], a[176:179], a[84:87], 0
s_add_u32 s44, s64, 311296
ds_read_b64_tr_b16 a[162:163], v88 offset:2048
v_mul_f32 v220, v91, v220
M v[44:47], a[180:183], a[104:107], v[44:47]
ds_read_b64_tr_b16 a[164:165], v88 offset:4096
v_mul_f32 v221, v91, v221
M v[44:47], a[184:187], a[124:127], v[44:47]
ds_read_b64_tr_b16 a[166:167], v88 offset:6144
v_mul_f32 v222, v91, v222
M v[44:47], a[188:191], a[144:147], v[44:47]
s_add_u32 s45, s64, 319488
ds_read_b64_tr_b16 a[168:169], v88 offset:8192
v_mul_f32 v223, v91, v223
M v[48:51], a[176:179], a[88:91], 0
buffer_load_dwordx4 v84, s[20:23], s49 offen lds
M v[48:51], a[180:183], a[108:111], v[48:51]
s_add_u32 m0, s39, 135168
ds_write_b128 v80, v[176:179] offset:8192
M v[48:51], a[184:187], a[128:131], v[48:51]
v_mul_f32 v240, v91, v240
v_cvt_pk_bf16_f32 v220, v220, v221
M v[48:51], a[188:191], a[148:151], v[48:51]
ds_read_b64_tr_b16 a[170:171], v88 offset:10240
v_mul_f32 v241, v91, v241
M v[52:55], a[176:179], a[92:95], 0
ds_read_b64_tr_b16 a[172:173], v88 offset:12288
v_mul_f32 v242, v91, v242
M v[52:55], a[180:183], a[112:115], v[52:55]
L_hop_c3:
s_cbranch_execz L_ret_c3
ds_read_b64_tr_b16 a[174:175], v88 offset:14336
v_mul_f32 v243, v91, v243
M v[52:55], a[184:187], a[132:135], v[52:55]
v_cvt_pk_bf16_f32 v221, v222, v223
v_mul_f32 v104, v92, v104
M v[52:55], a[188:191], a[152:155], v[52:55]
v_cvt_pk_bf16_f32 v222, v240, v241
v_cvt_pk_bf16_f32 v223, v242, v243
M v[56:59], a[176:179], a[96:99], 0
buffer_load_dwordx4 v84, s[20:23], s50 offen lds
M v[56:59], a[180:183], a[116:119], v[56:59]
s_add_u32 m0, s39, 136192
ds_write_b128 v80, v[216:219] offset:12288
M v[56:59], a[184:187], a[136:139], v[56:59]
v_mul_f32 v105, v92, v105
v_mul_f32 v106, v92, v106
M v[56:59], a[188:191], a[156:159], v[56:59]
s_waitcnt lgkmcnt(15)
ds_read_b64_tr_b16 a[176:177], v89 offset:0
v_mul_f32 v107, v92, v107
M v[60:63], a[192:195], a[80:83], 0
s_waitcnt lgkmcnt(15)
ds_read_b64_tr_b16 a[178:179], v89 offset:2048
v_cvt_pk_bf16_f32 v104, v104, v105
M v[60:63], a[196:199], a[100:103], v[60:63]
s_waitcnt lgkmcnt(15)
ds_read_b64_tr_b16 a[180:181], v89 offset:4096
v_mul_f32 v124, v92, v124
M v[60:63], a[200:203], a[120:123], v[60:63]
s_waitcnt lgkmcnt(13)
ds_read_b64_tr_b16 a[182:183], v89 offset:6144
v_mul_f32 v125, v92, v125
M v[60:63], a[204:207], a[140:143], v[60:63]
ds_read_b64_tr_b16 a[184:185], v89 offset:8192
v_mul_f32 v126, v92, v126
M v[64:67], a[192:195], a[84:87], 0
buffer_load_dwordx4 v84, s[20:23], s51 offen lds
M v[64:67], a[196:199], a[104:107], v[64:67]
s_add_u32 m0, s39, 137216
ds_write_b128 v80, v[100:103] offset:16384
M v[64:67], a[200:203], a[124:127], v[64:67]
v_mul_f32 v127, v92, v127
v_cvt_pk_bf16_f32 v105, v106, v107
M v[64:67], a[204:207], a[144:147], v[64:67]
ds_read_b64_tr_b16 a[186:187], v89 offset:10240
v_cvt_pk_bf16_f32 v106, v124, v125
M v[68:71], a[192:195], a[88:91], 0
ds_read_b64_tr_b16 a[188:189], v89 offset:12288
v_cvt_pk_bf16_f32 v107, v126, v127
M v[68:71], a[196:199], a[108:111], v[68:71]
ds_read_b64_tr_b16 a[190:191], v89 offset:14336
v_mul_f32 v144, v92, v144
M v[68:71], a[200:203], a[128:131], v[68:71]
v_mul_f32 v145, v92, v145
v_mul_f32 v146, v92, v146
M v[68:71], a[204:207], a[148:151], v[68:71]
s_add_u32 s46, s65, 262144
v_mul_f32 v147, v92, v147
v_cvt_pk_bf16_f32 v144, v144, v145
M v[72:75], a[192:195], a[92:95], 0
buffer_load_dwordx4 v84, s[20:23], s44 offen lds
M v[72:75], a[196:199], a[112:115], v[72:75]
s_add_u32 m0, s39, 138240
v_mul_f32 v164, v92, v164
v_mul_f32 v165, v92, v165
M v[72:75], a[200:203], a[132:135], v[72:75]
ds_write_b128 v80, v[140:143] offset:20480
M v[72:75], a[204:207], a[152:155], v[72:75]
v_mul_f32 v166, v92, v166
v_mul_f32 v167, v92, v167
M v[76:79], a[192:195], a[96:99], 0
v_cvt_pk_bf16_f32 v145, v146, v147
v_mul_f32 v184, v92, v184
M v[76:79], a[196:199], a[116:119], v[76:79]
v_cvt_pk_bf16_f32 v146, v164, v165
v_cvt_pk_bf16_f32 v147, v166, v167
M v[76:79], a[200:203], a[136:139], v[76:79]
v_mul_f32 v185, v92, v185
v_mul_f32 v186, v92, v186
M v[76:79], a[204:207], a[156:159], v[76:79]
s_waitcnt lgkmcnt(15)
v_mul_f32 v187, v92, v187
v_cvt_pk_bf16_f32 v184, v184, v185
M v[40:43], a[160:163], a[0:3], v[40:43]
s_waitcnt lgkmcnt(15)
buffer_load_dwordx4 v84, s[20:23], s45 offen lds
M v[40:43], a[164:167], a[20:23], v[40:43]
s_waitcnt lgkmcnt(13)
v_mul_f32 v204, v92, v204
v_mul_f32 v205, v92, v205
s_add_u32 m0, s39, 65536
M v[40:43], a[168:171], a[40:43], v[40:43]
s_waitcnt lgkmcnt(11)
v_mul_f32 v206, v92, v206
v_mul_f32 v207, v92, v207
M v[40:43], a[172:175], a[60:63], v[40:43]
ds_write_b128 v80, v[180:183] offset:24576
M v[44:47], a[160:163], a[4:7], v[44:47]
v_cvt_pk_bf16_f32 v185, v186, v187
v_mul_f32 v224, v92, v224
M v[44:47], a[164:167], a[24:27], v[44:47]
v_cvt_pk_bf16_f32 v186, v204, v205
v_cvt_pk_bf16_f32 v187, v206, v207
M v[44:47], a[168:171], a[44:47], v[44:47]
v_mul_f32 v225, v92, v225
v_mul_f32 v226, v92, v226
M v[44:47], a[172:175], a[64:67], v[44:47]
v_mul_f32 v227, v92, v227
v_cvt_pk_bf16_f32 v224, v224, v225
M v[48:51], a[160:163], a[8:11], v[48:51]
v_mul_f32 v244, v92, v244
v_mul_f32 v245, v92, v245
M v[48:51], a[164:167], a[28:31], v[48:51]
v_mul_f32 v246, v92, v246
v_mul_f32 v247, v92, v247
M v[48:51], a[168:171], a[48:51], v[48:51]
v_cvt_pk_bf16_f32 v225, v226, v227
v_mul_f32 v108, v93, v108
M v[48:51], a[172:175], a[68:71], v[48:51]
v_cvt_pk_bf16_f32 v226, v244, v245
v_cvt_pk_bf16_f32 v227, v246, v247
M v[52:55], a[160:163], a[12:15], v[52:55]
ds_write_b128 v80, v[220:223] offset:28672
M v[52:55], a[164:167], a[32:35], v[52:55]
v_mul_f32 v109, v93, v109
v_mul_f32 v110, v93, v110
M v[52:55], a[168:171], a[52:55], v[52:55]
v_mul_f32 v111, v93, v111
v_cvt_pk_bf16_f32 v108, v108, v109
M v[52:55], a[172:175], a[72:75], v[52:55]
v_mul_f32 v128, v93, v128
v_mul_f32 v129, v93, v129
M v[56:59], a[160:163], a[16:19], v[56:59]
v_mul_f32 v130, v93, v130
v_mul_f32 v131, v93, v131
M v[56:59], a[164:167], a[36:39], v[56:59]
v_cvt_pk_bf16_f32 v109, v110, v111
v_mul_f32 v148, v93, v148
M v[56:59], a[168:171], a[56:59], v[56:59]
v_cvt_pk_bf16_f32 v110, v128, v129
v_cvt_pk_bf16_f32 v111, v130, v131
M v[56:59], a[172:175], a[76:79], v[56:59]
s_waitcnt lgkmcnt(10)
v_mul_f32 v149, v93, v149
v_mul_f32 v150, v93, v150
M v[60:63], a[176:179], a[0:3], v[60:63]
s_waitcnt lgkmcnt(8)
ds_write_b128 v80, v[104:107] offset:32768
M v[60:63], a[180:183], a[20:23], v[60:63]
s_waitcnt lgkmcnt(6)
v_mul_f32 v151, v93, v151
v_cvt_pk_bf16_f32 v148, v148, v149
M v[60:63], a[184:187], a[40:43], v[60:63]
s_waitcnt lgkmcnt(4)
v_mul_f32 v168, v93, v168
v_mul_f32 v169, v93, v169
M v[60:63], a[188:191], a[60:63], v[60:63]
s_waitcnt vmcnt(8)
v_mul_f32 v170, v93, v170
v_mul_f32 v171, v93, v171
M v[64:67], a[176:179], a[4:7], v[64:67]
s_barrier
ds_read_b64_tr_b16 a[192:193], v86 offset:32768
v_cvt_pk_bf16_f32 v149, v150, v151
M v[64:67], a[180:183], a[24:27], v[64:67]
s_add_u32 s47, s65, 270336
ds_read_b64_tr_b16 a[194:195], v86 offset:34816
v_cvt_pk_bf16_f32 v150, v168, v169
M v[64:67], a[184:187], a[44:47], v[64:67]
s_add_u32 s48, s65, 278528
ds_read_b64_tr_b16 a[196:197], v86 offset:36864
v_cvt_pk_bf16_f32 v151, v170, v171
M v[64:67], a[188:191], a[64:67], v[64:67]
s_add_u32 s49, s65, 286720
ds_read_b64_tr_b16 a[198:199], v86 offset:38912
v_mul_f32 v188, v93, v188
M v[68:71], a[176:179], a[8:11], v[68:71]
s_add_u32 s50, s65, 294912
ds_read_b64_tr_b16 a[200:201], v86 offset:40960
v_mul_f32 v189, v93, v189
M v[68:71], a[180:183], a[28:31], v[68:71]
buffer_load_dwordx4 v84, s[20:23], s46 offen lds
M v[68:71], a[184:187], a[48:51], v[68:71]
s_add_u32 m0, s39, 66560
ds_read_b64_tr_b16 a[202:203], v86 offset:43008
v_mul_f32 v190, v93, v190
M v[68:71], a[188:191], a[68:71], v[68:71]
s_add_u32 s51, s65, 303104
ds_read_b64_tr_b16 a[204:205], v86 offset:45056
v_mul_f32 v191, v93, v191
M v[72:75], a[176:179], a[12:15], v[72:75]
ds_read_b64_tr_b16 a[206:207], v86 offset:47104
v_cvt_pk_bf16_f32 v188, v188, v189
M v[72:75], a[180:183], a[32:35], v[72:75]
ds_write_b128 v80, v[144:147] offset:36864
M v[72:75], a[184:187], a[52:55], v[72:75]
buffer_load_dwordx4 v84, s[20:23], s47 offen lds
M v[72:75], a[188:191], a[72:75], v[72:75]
s_add_u32 m0, s39, 67584
ds_read_b64_tr_b16 a[160:161], v87 offset:32768
v_mul_f32 v208, v93, v208
M v[76:79], a[176:179], a[16:19], v[76:79]
ds_read_b64_tr_b16 a[162:163], v87 offset:34816
v_mul_f32 v209, v93, v209
M v[76:79], a[180:183], a[36:39], v[76:79]
ds_read_b64_tr_b16 a[164:165], v87 offset:36864
v_mul_f32 v210, v93, v210
M v[76:79], a[184:187], a[56:59], v[76:79]
ds_write_b128 v80, v[184:187] offset:40960
M v[76:79], a[188:191], a[76:79], v[76:79]
s_waitcnt lgkmcnt(11)
v_mul_f32 v211, v93, v211
v_cvt_pk_bf16_f32 v189, v190, v191
M a[208:211], a[192:195], a[80:83], 0
s_waitcnt lgkmcnt(9)
buffer_load_dwordx4 v84, s[20:23], s48 offen lds
M a[208:211], a[196:199], a[100:103], a[208:211]
s_waitcnt lgkmcnt(7)
ds_read_b64_tr_b16 a[166:167], v87 offset:38912
v_cvt_pk_bf16_f32 v190, v208, v209
M a[208:211], a[200:203], a[120:123], a[208:211]
s_waitcnt lgkmcnt(6)
ds_read_b64_tr_b16 a[168:169], v87 offset:40960
v_cvt_pk_bf16_f32 v191, v210, v211
M a[208:211], a[204:207], a[140:143], a[208:211]
s_add_u32 m0, s39, 68608
ds_read_b64_tr_b16 a[170:171], v87 offset:43008
v_mul_f32 v228, v93, v228
M a[212:215], a[192:195], a[84:87], 0
s_add_u32 s44, s65, 311296
ds_read_b64_tr_b16 a[172:173], v87 offset:45056
v_mul_f32 v229, v93, v229
M a[212:215], a[196:199], a[104:107], a[212:215]
ds_read_b64_tr_b16 a[174:175], v87 offset:47104
v_mul_f32 v230, v93, v230
M a[212:215], a[200:203], a[124:127], a[212:215]
ds_read_b64_tr_b16 a[176:177], v88 offset:32768
v_mul_f32 v231, v93, v231
M a[212:215], a[204:207], a[144:147], a[212:215]
s_add_u32 s45, s65, 319488
ds_write_b128 v80, v[224:227] offset:45056
M a[216:219], a[192:195], a[88:91], 0
buffer_load_dwordx4 v84, s[20:23], s49 offen lds
M a[216:219], a[196:199], a[108:111], a[216:219]
s_add_u32 m0, s39, 69632
ds_read_b64_tr_b16 a[178:179], v88 offset:34816
v_cvt_pk_bf16_f32 v228, v228, v229
M a[216:219], a[200:203], a[128:131], a[216:219]
ds_read_b64_tr_b16 a[180:181], v88 offset:36864
v_mul_f32 v248, v93, v248
M a[216:219], a[204:207], a[148:151], a[216:219]
ds_read_b64_tr_b16 a[182:183], v88 offset:38912
v_mul_f32 v249, v93, v249
M a[220:223], a[192:195], a[92:95], 0
ds_read_b64_tr_b16 a[184:185], v88 offset:40960
v_mul_f32 v250, v93, v250
M a[220:223], a[196:199], a[112:115], a[220:223]
ds_read_b64_tr_b16 a[186:187], v88 offset:43008
v_mul_f32 v251, v93, v251
M a[220:223], a[200:203], a[132:135], a[220:223]
ds_read_b64_tr_b16 a[188:189], v88 offset:45056
v_cvt_pk_bf16_f32 v229, v230, v231
M a[220:223], a[204:207], a[152:155], a[220:223]
ds_write_b128 v80, v[108:111] offset:49152
M a[224:227], a[192:195], a[96:99], 0
buffer_load_dwordx4 v84, s[20:23], s50 offen lds
M a[224:227], a[196:199], a[116:119], a[224:227]
s_add_u32 m0, s39, 70656
ds_read_b64_tr_b16 a[190:191], v88 offset:47104
v_cvt_pk_bf16_f32 v230, v248, v249
M a[224:227], a[200:203], a[136:139], a[224:227]
ds_read_b64_tr_b16 a[192:193], v89 offset:32768
v_cvt_pk_bf16_f32 v231, v250, v251
M a[224:227], a[204:207], a[156:159], a[224:227]
s_waitcnt lgkmcnt(15)
ds_read_b64_tr_b16 a[194:195], v89 offset:34816
v_add_u32 v86, 65536, v86
M a[228:231], a[160:163], a[80:83], 0
s_waitcnt lgkmcnt(15)
ds_read_b64_tr_b16 a[196:197], v89 offset:36864
v_mul_f32 v112, v94, v112
M a[228:231], a[164:167], a[100:103], a[228:231]
s_waitcnt lgkmcnt(15)
ds_read_b64_tr_b16 a[198:199], v89 offset:38912
v_mul_f32 v113, v94, v113
M a[228:231], a[168:171], a[120:123], a[228:231]
s_waitcnt lgkmcnt(14)
ds_read_b64_tr_b16 a[200:201], v89 offset:40960
v_mul_f32 v114, v94, v114
M a[228:231], a[172:175], a[140:143], a[228:231]
ds_read_b64_tr_b16 a[202:203], v89 offset:43008
v_mul_f32 v115, v94, v115
M a[232:235], a[160:163], a[84:87], 0
ds_write_b128 v80, v[148:151] offset:53248
M a[232:235], a[164:167], a[104:107], a[232:235]
buffer_load_dwordx4 v84, s[20:23], s51 offen lds
M a[232:235], a[168:171], a[124:127], a[232:235]
s_add_u32 m0, s39, 71680
ds_read_b64_tr_b16 a[204:205], v89 offset:45056
v_cvt_pk_bf16_f32 v112, v112, v113
M a[232:235], a[172:175], a[144:147], a[232:235]
ds_read_b64_tr_b16 a[206:207], v89 offset:47104
v_mul_f32 v132, v94, v132
M a[236:239], a[160:163], a[88:91], 0
v_mul_f32 v133, v94, v133
v_mul_f32 v134, v94, v134
M a[236:239], a[164:167], a[108:111], a[236:239]
v_mul_f32 v135, v94, v135
v_cvt_pk_bf16_f32 v113, v114, v115
M a[236:239], a[168:171], a[128:131], a[236:239]
v_cvt_pk_bf16_f32 v114, v132, v133
v_cvt_pk_bf16_f32 v115, v134, v135
M a[236:239], a[172:175], a[148:151], a[236:239]
s_add_u32 s46, s66, 262144
v_mul_f32 v152, v94, v152
v_mul_f32 v153, v94, v153
M a[240:243], a[160:163], a[92:95], 0
buffer_load_dwordx4 v84, s[20:23], s44 offen lds
M a[240:243], a[164:167], a[112:115], a[240:243]
s_add_u32 m0, s39, 72704
ds_write_b128 v80, v[188:191] offset:57344
M a[240:243], a[168:171], a[132:135], a[240:243]
v_mul_f32 v154, v94, v154
v_mul_f32 v155, v94, v155
M a[240:243], a[172:175], a[152:155], a[240:243]
v_mul_f32 v172, v94, v172
v_cvt_pk_bf16_f32 v152, v152, v153
M a[244:247], a[160:163], a[96:99], 0
v_mul_f32 v173, v94, v173
v_mul_f32 v174, v94, v174
M a[244:247], a[164:167], a[116:119], a[244:247]
v_mul_f32 v175, v94, v175
v_cvt_pk_bf16_f32 v153, v154, v155
M a[244:247], a[168:171], a[136:139], a[244:247]
v_cvt_pk_bf16_f32 v154, v172, v173
v_cvt_pk_bf16_f32 v155, v174, v175
M a[244:247], a[172:175], a[156:159], a[244:247]
s_waitcnt lgkmcnt(15)
v_mul_f32 v192, v94, v192
v_mul_f32 v193, v94, v193
M a[208:211], a[176:179], a[0:3], a[208:211]
s_waitcnt lgkmcnt(15)
buffer_load_dwordx4 v84, s[20:23], s45 offen lds
M a[208:211], a[180:183], a[20:23], a[208:211]
s_waitcnt lgkmcnt(13)
v_mul_f32 v194, v94, v194
v_mul_f32 v195, v94, v195
s_add_u32 m0, s39, 98304
M a[208:211], a[184:187], a[40:43], a[208:211]
s_waitcnt lgkmcnt(10)
ds_write_b128 v80, v[228:231] offset:61440
M a[208:211], a[188:191], a[60:63], a[208:211]
s_add_u32 s47, s66, 270336
v_mul_f32 v212, v94, v212
v_cvt_pk_bf16_f32 v192, v192, v193
M a[212:215], a[176:179], a[4:7], a[212:215]
v_mul_f32 v213, v94, v213
v_mul_f32 v214, v94, v214
M a[212:215], a[180:183], a[24:27], a[212:215]
v_mul_f32 v215, v94, v215
v_cvt_pk_bf16_f32 v193, v194, v195
M a[212:215], a[184:187], a[44:47], a[212:215]
v_cvt_pk_bf16_f32 v194, v212, v213
v_add_u32 v87, 65536, v87
M a[212:215], a[188:191], a[64:67], a[212:215]
s_add_u32 s48, s66, 278528
v_cvt_pk_bf16_f32 v195, v214, v215
v_mul_f32 v232, v94, v232
M a[216:219], a[176:179], a[8:11], a[216:219]
v_mul_f32 v233, v94, v233
v_mul_f32 v234, v94, v234
M a[216:219], a[180:183], a[28:31], a[216:219]
v_mul_f32 v235, v94, v235
v_cvt_pk_bf16_f32 v232, v232, v233
M a[216:219], a[184:187], a[48:51], a[216:219]
v_mul_f32 v252, v94, v252
v_mul_f32 v253, v94, v253
M a[216:219], a[188:191], a[68:71], a[216:219]
v_mul_f32 v254, v94, v254
v_mul_f32 v255, v94, v255
M a[220:223], a[176:179], a[12:15], a[220:223]
s_waitcnt vmcnt(8) lgkmcnt(0)
v_cvt_pk_bf16_f32 v233, v234, v235
v_add_u32 v88, 65536, v88
M a[220:223], a[180:183], a[32:35], a[220:223]
s_barrier
ds_read_b64_tr_b16 a[160:161], v86 offset:0
v_cvt_pk_bf16_f32 v234, v252, v253
M a[220:223], a[184:187], a[52:55], a[220:223]
ds_read_b64_tr_b16 a[162:163], v86 offset:2048
v_cvt_pk_bf16_f32 v235, v254, v255
M a[220:223], a[188:191], a[72:75], a[220:223]
s_add_u32 s49, s66, 286720
ds_read_b64_tr_b16 a[164:165], v86 offset:4096
v_add_u32 v89, 65536, v89
M a[224:227], a[176:179], a[16:19], a[224:227]
ds_read_b64_tr_b16 a[166:167], v86 offset:6144
v_add_u32 v92, 4096, v85
M a[224:227], a[180:183], a[36:39], a[224:227]
ds_read_b128 v[116:119], v81 offset:0
M a[224:227], a[184:187], a[56:59], a[224:227]
ds_read_b128 v[156:159], v81 offset:4096
M a[224:227], a[188:191], a[76:79], a[224:227]
ds_read_b128 v[196:199], v81 offset:8192
M a[228:231], a[192:195], a[0:3], a[228:231]
ds_read_b128 v[236:239], v81 offset:12288
M a[228:231], a[196:199], a[20:23], a[228:231]
ds_read_b64_tr_b16 a[168:169], v86 offset:8192
M a[228:231], a[200:203], a[40:43], a[228:231]
ds_read_b64_tr_b16 a[170:171], v86 offset:10240
M a[228:231], a[204:207], a[60:63], a[228:231]
s_add_u32 s50, s66, 294912
ds_read_b64_tr_b16 a[172:173], v86 offset:12288
M a[232:235], a[192:195], a[4:7], a[232:235]
buffer_load_dwordx4 v84, s[20:23], s46 offen lds
M a[232:235], a[196:199], a[24:27], a[232:235]
s_add_u32 m0, s39, 99328
ds_read_b64_tr_b16 a[174:175], v86 offset:14336
v_subrev_u32 v86, 65536, v86
M a[232:235], a[200:203], a[44:47], a[232:235]
ds_read_b64_tr_b16 a[176:177], v87 offset:0
M a[232:235], a[204:207], a[64:67], a[232:235]
ds_read_b64_tr_b16 a[178:179], v87 offset:2048
M a[236:239], a[192:195], a[8:11], a[236:239]
s_waitcnt lgkmcnt(6)
ds_read_b64_tr_b16 a[180:181], v87 offset:4096
M a[236:239], a[196:199], a[28:31], a[236:239]
s_barrier
ds_read_b64_tr_b16 a[182:183], v87 offset:6144
M a[236:239], a[200:203], a[48:51], a[236:239]
ds_read_b64_tr_b16 a[184:185], v87 offset:8192
M a[236:239], a[204:207], a[68:71], a[236:239]
s_add_u32 s51, s66, 303104
ds_read_b64_tr_b16 a[186:187], v87 offset:10240
M a[240:243], a[192:195], a[12:15], a[240:243]
buffer_load_dwordx4 v84, s[20:23], s47 offen lds
M a[240:243], a[196:199], a[32:35], a[240:243]
s_add_u32 m0, s39, 100352
ds_read_b64_tr_b16 a[188:189], v87 offset:12288
M a[240:243], a[200:203], a[52:55], a[240:243]
ds_read_b64_tr_b16 a[190:191], v87 offset:14336
v_subrev_u32 v87, 65536, v87
M a[240:243], a[204:207], a[72:75], a[240:243]
ds_read_b128 v[120:123], v81 offset:16384
M a[244:247], a[192:195], a[16:19], a[244:247]
ds_read_b64_tr_b16 a[192:193], v88 offset:0
ds_read_b64_tr_b16 a[194:195], v88 offset:2048
M a[244:247], a[196:199], a[36:39], a[244:247]
ds_read_b64_tr_b16 a[196:197], v88 offset:4096
ds_read_b64_tr_b16 a[198:199], v88 offset:6144
M a[244:247], a[200:203], a[56:59], a[244:247]
ds_read_b64_tr_b16 a[200:201], v88 offset:8192
ds_read_b64_tr_b16 a[202:203], v88 offset:10240
M a[244:247], a[204:207], a[76:79], a[244:247]
s_add_u32 s44, s66, 311296
ds_read_b64_tr_b16 a[204:205], v88 offset:12288
ds_read_b64_tr_b16 a[206:207], v88 offset:14336
M v[0:3], a[160:163], v[96:99], v[0:3]
ds_write_b128 v80, v[112:115] offset:0
buffer_load_dwordx4 v84, s[20:23], s48 offen lds
s_add_u32 m0, s39, 101376
M v[0:3], a[164:167], v[136:139], v[0:3]
s_waitcnt lgkmcnt(15)
v_subrev_u32 v88, 65536, v88
M v[0:3], a[168:171], v[176:179], v[0:3]
s_waitcnt lgkmcnt(15)
ds_read_b128 v[160:163], v81 offset:20480
M v[0:3], a[172:175], v[216:219], v[0:3]
ds_read_b128 v[200:203], v81 offset:24576
M v[4:7], a[160:163], v[100:103], v[4:7]
ds_write_b128 v80, v[152:155] offset:4096
M v[4:7], a[164:167], v[140:143], v[4:7]
M v[4:7], a[168:171], v[180:183], v[4:7]
ds_read_b128 v[240:243], v81 offset:28672
M v[4:7], a[172:175], v[220:223], v[4:7]
s_add_u32 s45, s66, 319488
ds_read_b128 v[124:127], v81 offset:32768
M v[8:11], a[160:163], v[104:107], v[8:11]
ds_write_b128 v80, v[192:195] offset:8192
M v[8:11], a[164:167], v[144:147], v[8:11]
buffer_load_dwordx4 v84, s[20:23], s49 offen lds
M v[8:11], a[168:171], v[184:187], v[8:11]
s_add_u32 m0, s39, 102400
M v[8:11], a[172:175], v[224:227], v[8:11]
ds_read_b128 v[164:167], v81 offset:36864
M v[12:15], a[160:163], v[108:111], v[12:15]
ds_write_b128 v80, v[232:235] offset:12288
M v[12:15], a[164:167], v[148:151], v[12:15]
M v[12:15], a[168:171], v[188:191], v[12:15]
ds_read_b128 v[204:207], v81 offset:40960
M v[12:15], a[172:175], v[228:231], v[12:15]
ds_read_b128 v[244:247], v81 offset:45056
M v[16:19], a[160:163], v[112:115], v[16:19]
buffer_load_dwordx4 v84, s[20:23], s50 offen lds
M v[16:19], a[164:167], v[152:155], v[16:19]
s_add_u32 m0, s39, 103424
ds_read_b128 v[128:131], v81 offset:49152
M v[16:19], a[168:171], v[192:195], v[16:19]
ds_read_b128 v[168:171], v81 offset:53248
M v[16:19], a[172:175], v[232:235], v[16:19]
s_waitcnt lgkmcnt(15)
ds_read_b128 v[208:211], v81 offset:57344
M v[20:23], a[176:179], v[96:99], v[20:23]
s_waitcnt lgkmcnt(15)
ds_read_b128 v[248:251], v81 offset:61440
M v[20:23], a[180:183], v[136:139], v[20:23]
s_waitcnt lgkmcnt(15)
ds_read_b64_tr_b16 a[160:161], v89 offset:0
M v[20:23], a[184:187], v[176:179], v[20:23]
s_waitcnt lgkmcnt(15)
ds_read_b64_tr_b16 a[162:163], v89 offset:2048
M v[20:23], a[188:191], v[216:219], v[20:23]
ds_read_b64_tr_b16 a[164:165], v89 offset:4096
M v[24:27], a[176:179], v[100:103], v[24:27]
buffer_load_dwordx4 v84, s[20:23], s51 offen lds
M v[24:27], a[180:183], v[140:143], v[24:27]
s_add_u32 m0, s39, 104448
ds_read_b64_tr_b16 a[166:167], v89 offset:6144
M v[24:27], a[184:187], v[180:183], v[24:27]
ds_read_b64_tr_b16 a[168:169], v89 offset:8192
M v[24:27], a[188:191], v[220:223], v[24:27]
ds_read_b64_tr_b16 a[170:171], v89 offset:10240
M v[28:31], a[176:179], v[104:107], v[28:31]
ds_read_b64_tr_b16 a[172:173], v89 offset:12288
M v[28:31], a[180:183], v[144:147], v[28:31]
ds_read_b64_tr_b16 a[174:175], v89 offset:14336
v_subrev_u32 v89, 65536, v89
M v[28:31], a[184:187], v[184:187], v[28:31]
M v[28:31], a[188:191], v[224:227], v[28:31]
M v[32:35], a[176:179], v[108:111], v[32:35]
buffer_load_dwordx4 v84, s[20:23], s44 offen lds
M v[32:35], a[180:183], v[148:151], v[32:35]
M v[32:35], a[184:187], v[188:191], v[32:35]
M v[32:35], a[188:191], v[228:231], v[32:35]
M v[36:39], a[176:179], v[112:115], v[36:39]
s_waitcnt lgkmcnt(14)
M v[36:39], a[180:183], v[152:155], v[36:39]
s_barrier
ds_read_b128 v[132:135], v81 offset:0
M v[36:39], a[184:187], v[192:195], v[36:39]
s_add_u32 m0, s39, 105472
ds_read_b128 v[172:175], v81 offset:4096
M v[36:39], a[188:191], v[232:235], v[36:39]
s_add_u32 s46, s67, 0
ds_read_b128 v[212:215], v81 offset:8192
M v[0:3], a[192:195], v[116:119], v[0:3]
s_add_u32 s47, s67, 8192
ds_read_b128 v[252:255], v81 offset:12288
M v[0:3], a[196:199], v[156:159], v[0:3]
buffer_load_dwordx4 v84, s[20:23], s45 offen lds
M v[0:3], a[200:203], v[196:199], v[0:3]
s_add_u32 m0, s39, 131072
M v[0:3], a[204:207], v[236:239], v[0:3]
M v[4:7], a[192:195], v[120:123], v[4:7]
M v[4:7], a[196:199], v[160:163], v[4:7]
M v[4:7], a[200:203], v[200:203], v[4:7]
M v[4:7], a[204:207], v[240:243], v[4:7]
s_add_u32 s48, s67, 16384
M v[8:11], a[192:195], v[124:127], v[8:11]
M v[8:11], a[196:199], v[164:167], v[8:11]
s_waitcnt lgkmcnt(15)
v_cvt_pk_bf16_f32 v0, v0, v1
v_cvt_pk_bf16_f32 v1, v2, v3
M v[8:11], a[200:203], v[204:207], v[8:11]
s_waitcnt lgkmcnt(15)
v_cvt_pk_bf16_f32 v4, v4, v5
v_cvt_pk_bf16_f32 v5, v6, v7
M v[8:11], a[204:207], v[244:247], v[8:11]
s_waitcnt lgkmcnt(15)
M v[12:15], a[192:195], v[128:131], v[12:15]
s_waitcnt lgkmcnt(14)
M v[12:15], a[196:199], v[168:171], v[12:15]
s_waitcnt lgkmcnt(13)
M v[12:15], a[200:203], v[208:211], v[12:15]
s_waitcnt lgkmcnt(12)
M v[12:15], a[204:207], v[248:251], v[12:15]
s_waitcnt lgkmcnt(3)
v_cvt_pk_bf16_f32 v8, v8, v9
v_cvt_pk_bf16_f32 v9, v10, v11
M v[16:19], a[192:195], v[132:135], v[16:19]
s_waitcnt lgkmcnt(2)
M v[16:19], a[196:199], v[172:175], v[16:19]
s_waitcnt lgkmcnt(1)
M v[16:19], a[200:203], v[212:215], v[16:19]
s_waitcnt lgkmcnt(0)
v_cvt_pk_bf16_f32 v12, v12, v13
v_cvt_pk_bf16_f32 v13, v14, v15
M v[16:19], a[204:207], v[252:255], v[16:19]
L_hop_c4:
s_cbranch_execz L_ret_c4
M v[20:23], a[160:163], v[116:119], v[20:23]
M v[20:23], a[164:167], v[156:159], v[20:23]
s_waitcnt vmcnt(8)
M v[20:23], a[168:171], v[196:199], v[20:23]
s_barrier
ds_read_b64_tr_b16 a[176:177], v86 offset:0
M v[20:23], a[172:175], v[236:239], v[20:23]
s_add_u32 s49, s67, 24576
ds_read_b64_tr_b16 a[178:179], v86 offset:2048
v_cvt_pk_bf16_f32 v16, v16, v17
M v[24:27], a[160:163], v[120:123], v[24:27]
s_add_u32 s50, s67, 32768
ds_read_b64_tr_b16 a[180:181], v86 offset:4096
v_cvt_pk_bf16_f32 v17, v18, v19
M v[24:27], a[164:167], v[160:163], v[24:27]
ds_read_b64_tr_b16 a[182:183], v86 offset:6144
v_cvt_pk_bf16_f32 v2, v20, v21
M v[24:27], a[168:171], v[200:203], v[24:27]
ds_read_b64_tr_b16 a[184:185], v86 offset:8192
v_cvt_pk_bf16_f32 v3, v22, v23
M v[24:27], a[172:175], v[240:243], v[24:27]
buffer_load_dwordx4 v84, s[20:23], s46 offen lds
M v[28:31], a[160:163], v[124:127], v[28:31]
s_add_u32 m0, s39, 132096
ds_read_b64_tr_b16 a[186:187], v86 offset:10240
M v[28:31], a[164:167], v[164:167], v[28:31]
ds_read_b64_tr_b16 a[188:189], v86 offset:12288
M v[28:31], a[168:171], v[204:207], v[28:31]
ds_read_b64_tr_b16 a[190:191], v86 offset:14336
v_cvt_pk_bf16_f32 v6, v24, v25
M v[28:31], a[172:175], v[244:247], v[28:31]
s_add_u32 s51, s67, 40960
buffer_store_dwordx4 v[0:3], v85, s[24:27], s72 offen offset:0 sc1
M v[32:35], a[160:163], v[128:131], v[32:35]
ds_read_b64_tr_b16 a[192:193], v87 offset:0
v_cvt_pk_bf16_f32 v7, v26, v27
M v[32:35], a[164:167], v[168:171], v[32:35]
ds_read_b64_tr_b16 a[194:195], v87 offset:2048
M v[32:35], a[168:171], v[208:211], v[32:35]
buffer_load_dwordx4 v84, s[20:23], s47 offen lds
M v[32:35], a[172:175], v[248:251], v[32:35]
s_add_u32 m0, s39, 133120
ds_read_b64_tr_b16 a[196:197], v87 offset:4096
v_cvt_pk_bf16_f32 v10, v28, v29
M v[36:39], a[160:163], v[132:135], v[36:39]
ds_read_b64_tr_b16 a[198:199], v87 offset:6144
v_cvt_pk_bf16_f32 v11, v30, v31
M v[36:39], a[164:167], v[172:175], v[36:39]
ds_read_b64_tr_b16 a[200:201], v87 offset:8192
v_cvt_pk_bf16_f32 v14, v32, v33
M v[36:39], a[168:171], v[212:215], v[36:39]
ds_read_b64_tr_b16 a[202:203], v87 offset:10240
v_cvt_pk_bf16_f32 v15, v34, v35
M v[36:39], a[172:175], v[252:255], v[36:39]
s_waitcnt lgkmcnt(12)
ds_read_b64_tr_b16 a[204:205], v87 offset:12288
M v[40:43], a[176:179], v[96:99], v[40:43]
s_waitcnt lgkmcnt(11)
buffer_load_dwordx4 v84, s[20:23], s48 offen lds
M v[40:43], a[180:183], v[136:139], v[40:43]
s_waitcnt lgkmcnt(9)
ds_read_b64_tr_b16 a[206:207], v87 offset:14336
v_cvt_pk_bf16_f32 v18, v36, v37
M v[40:43], a[184:187], v[176:179], v[40:43]
s_waitcnt lgkmcnt(8)
ds_read_b64_tr_b16 a[160:161], v88 offset:0
v_cvt_pk_bf16_f32 v19, v38, v39
M v[40:43], a[188:191], v[216:219], v[40:43]
s_add_u32 m0, s39, 134144
buffer_store_dwordx4 v[4:7], v85, s[24:27], s72 offen offset:1024 sc1
M v[44:47], a[176:179], v[100:103], v[44:47]
s_lshl_b32 s42, s54, 8
ds_read_b64_tr_b16 a[162:163], v88 offset:2048
M v[44:47], a[180:183], v[140:143], v[44:47]
s_add_u32 s42, s42, 50331648
ds_read_b64_tr_b16 a[164:165], v88 offset:4096
M v[44:47], a[184:187], v[180:183], v[44:47]
s_lshl_b32 s43, s3, 2
ds_read_b64_tr_b16 a[166:167], v88 offset:6144
M v[44:47], a[188:191], v[220:223], v[44:47]
s_add_u32 s42, s42, s43
buffer_store_dwordx4 v[8:11], v85, s[24:27], s72 offen offset:2048 sc1
M v[48:51], a[176:179], v[104:107], v[48:51]
s_add_u32 s44, s67, 49152
ds_read_b64_tr_b16 a[168:169], v88 offset:8192
M v[48:51], a[180:183], v[144:147], v[48:51]
s_add_u32 s45, s67, 57344
ds_read_b64_tr_b16 a[170:171], v88 offset:10240
M v[48:51], a[184:187], v[184:187], v[48:51]
ds_read_b64_tr_b16 a[172:173], v88 offset:12288
M v[48:51], a[188:191], v[224:227], v[48:51]
buffer_load_dwordx4 v84, s[20:23], s49 offen lds
M v[52:55], a[176:179], v[108:111], v[52:55]
s_add_u32 m0, s39, 135168
ds_read_b64_tr_b16 a[174:175], v88 offset:14336
M v[52:55], a[180:183], v[148:151], v[52:55]
M v[52:55], a[184:187], v[188:191], v[52:55]
M v[52:55], a[188:191], v[228:231], v[52:55]
buffer_store_dwordx4 v[12:15], v85, s[24:27], s72 offen offset:3072 sc1
M v[56:59], a[176:179], v[112:115], v[56:59]
ds_read_b64_tr_b16 a[176:177], v89 offset:0
M v[56:59], a[180:183], v[152:155], v[56:59]
ds_read_b64_tr_b16 a[178:179], v89 offset:2048
M v[56:59], a[184:187], v[192:195], v[56:59]
ds_read_b64_tr_b16 a[180:181], v89 offset:4096
M v[56:59], a[188:191], v[232:235], v[56:59]
s_waitcnt lgkmcnt(15)
buffer_load_dwordx4 v84, s[20:23], s50 offen lds
M v[60:63], a[192:195], v[96:99], v[60:63]
s_waitcnt lgkmcnt(15)
ds_read_b64_tr_b16 a[182:183], v89 offset:6144
M v[60:63], a[196:199], v[136:139], v[60:63]
s_waitcnt lgkmcnt(14)
ds_read_b64_tr_b16 a[184:185], v89 offset:8192
M v[60:63], a[200:203], v[176:179], v[60:63]
s_waitcnt lgkmcnt(13)
ds_read_b64_tr_b16 a[186:187], v89 offset:10240
M v[60:63], a[204:207], v[216:219], v[60:63]
s_add_u32 m0, s39, 136192
buffer_store_dwordx4 v[16:19], v92, s[24:27], s72 offen offset:0 sc1
M v[64:67], a[192:195], v[100:103], v[64:67]
ds_read_b64_tr_b16 a[188:189], v89 offset:12288
M v[64:67], a[196:199], v[140:143], v[64:67]
ds_read_b64_tr_b16 a[190:191], v89 offset:14336
M v[64:67], a[200:203], v[180:183], v[64:67]
M v[64:67], a[204:207], v[220:223], v[64:67]
buffer_load_dwordx4 v84, s[20:23], s51 offen lds
M v[68:71], a[192:195], v[104:107], v[68:71]
s_add_u32 m0, s39, 137216
M v[68:71], a[196:199], v[144:147], v[68:71]
M v[68:71], a[200:203], v[184:187], v[68:71]
v_mov_b32 v80, s42
v_cmp_eq_u32 vcc, 0, v85
M v[68:71], a[204:207], v[224:227], v[68:71]
s_add_u32 s46, s67, 262144
v_cndmask_b32 v80, -16, v80, vcc
M v[72:75], a[192:195], v[108:111], v[72:75]
buffer_load_dwordx4 v84, s[20:23], s44 offen lds
M v[72:75], a[196:199], v[148:151], v[72:75]
s_add_u32 m0, s39, 138240
M v[72:75], a[200:203], v[188:191], v[72:75]
M v[72:75], a[204:207], v[228:231], v[72:75]
M v[76:79], a[192:195], v[112:115], v[76:79]
M v[76:79], a[196:199], v[152:155], v[76:79]
M v[76:79], a[200:203], v[192:195], v[76:79]
M v[76:79], a[204:207], v[232:235], v[76:79]
s_waitcnt lgkmcnt(14)
M v[40:43], a[160:163], v[116:119], v[40:43]
s_waitcnt lgkmcnt(12)
buffer_load_dwordx4 v84, s[20:23], s45 offen lds
M v[40:43], a[164:167], v[156:159], v[40:43]
s_waitcnt lgkmcnt(10)
M v[40:43], a[168:171], v[196:199], v[40:43]
s_waitcnt lgkmcnt(8)
M v[40:43], a[172:175], v[236:239], v[40:43]
M v[44:47], a[160:163], v[120:123], v[44:47]
M v[44:47], a[164:167], v[160:163], v[44:47]
M v[44:47], a[168:171], v[200:203], v[44:47]
M v[44:47], a[172:175], v[240:243], v[44:47]
M v[48:51], a[160:163], v[124:127], v[48:51]
M v[48:51], a[164:167], v[164:167], v[48:51]
M v[48:51], a[168:171], v[204:207], v[48:51]
M v[48:51], a[172:175], v[244:247], v[48:51]
v_cvt_pk_bf16_f32 v40, v40, v41
v_cvt_pk_bf16_f32 v41, v42, v43
M v[52:55], a[160:163], v[128:131], v[52:55]
M v[52:55], a[164:167], v[168:171], v[52:55]
v_cvt_pk_bf16_f32 v44, v44, v45
v_cvt_pk_bf16_f32 v45, v46, v47
M v[52:55], a[168:171], v[208:211], v[52:55]
M v[52:55], a[172:175], v[248:251], v[52:55]
v_cvt_pk_bf16_f32 v48, v48, v49
v_cvt_pk_bf16_f32 v49, v50, v51
M v[56:59], a[160:163], v[132:135], v[56:59]
M v[56:59], a[164:167], v[172:175], v[56:59]
M v[56:59], a[168:171], v[212:215], v[56:59]
M v[56:59], a[172:175], v[252:255], v[56:59]
s_waitcnt lgkmcnt(6)
M v[60:63], a[176:179], v[116:119], v[60:63]
s_waitcnt lgkmcnt(4)
v_cvt_pk_bf16_f32 v52, v52, v53
v_cvt_pk_bf16_f32 v53, v54, v55
M v[60:63], a[180:183], v[156:159], v[60:63]
s_waitcnt lgkmcnt(2)
M v[60:63], a[184:187], v[196:199], v[60:63]
s_waitcnt lgkmcnt(0)
v_cvt_pk_bf16_f32 v56, v56, v57
v_cvt_pk_bf16_f32 v57, v58, v59
M v[60:63], a[188:191], v[236:239], v[60:63]
s_waitcnt vmcnt(13)
M v[64:67], a[176:179], v[120:123], v[64:67]
s_barrier
ds_read_b64_tr_b16 a[192:193], v86 offset:32768
M v[64:67], a[180:183], v[160:163], v[64:67]
s_add_u32 m0, s39, 65536
ds_read_b64_tr_b16 a[194:195], v86 offset:34816
M v[64:67], a[184:187], v[200:203], v[64:67]
s_add_u32 s47, s67, 270336
ds_read_b64_tr_b16 a[196:197], v86 offset:36864
v_cvt_pk_bf16_f32 v42, v60, v61
M v[64:67], a[188:191], v[240:243], v[64:67]
s_add_u32 s48, s67, 278528
ds_read_b64_tr_b16 a[198:199], v86 offset:38912
v_cvt_pk_bf16_f32 v43, v62, v63
M v[68:71], a[176:179], v[124:127], v[68:71]
s_add_u32 s49, s67, 286720
ds_read_b64_tr_b16 a[200:201], v86 offset:40960
M v[68:71], a[180:183], v[164:167], v[68:71]
s_add_u32 s50, s67, 294912
buffer_load_dwordx4 v84, s[20:23], s46 offen lds
M v[68:71], a[184:187], v[204:207], v[68:71]
s_add_u32 m0, s39, 66560
ds_read_b64_tr_b16 a[202:203], v86 offset:43008
v_cvt_pk_bf16_f32 v46, v64, v65
M v[68:71], a[188:191], v[244:247], v[68:71]
s_add_u32 s51, s67, 303104
ds_read_b64_tr_b16 a[204:205], v86 offset:45056
v_cvt_pk_bf16_f32 v47, v66, v67
M v[72:75], a[176:179], v[128:131], v[72:75]
ds_read_b64_tr_b16 a[206:207], v86 offset:47104
v_add_u32 v86, 65536, v86
M v[72:75], a[180:183], v[168:171], v[72:75]
buffer_load_dwordx4 v84, s[20:23], s47 offen lds
M v[72:75], a[184:187], v[208:211], v[72:75]
s_add_u32 m0, s39, 67584
ds_read_b64_tr_b16 a[160:161], v87 offset:32768
v_cvt_pk_bf16_f32 v50, v68, v69
M v[72:75], a[188:191], v[248:251], v[72:75]
ds_read_b64_tr_b16 a[162:163], v87 offset:34816
v_cvt_pk_bf16_f32 v51, v70, v71
M v[76:79], a[176:179], v[132:135], v[76:79]
ds_read_b64_tr_b16 a[164:165], v87 offset:36864
M v[76:79], a[180:183], v[172:175], v[76:79]
buffer_store_dwordx4 v[40:43], v85, s[24:27], s73 offen offset:0 sc1
M v[76:79], a[184:187], v[212:215], v[76:79]
ds_read_b64_tr_b16 a[166:167], v87 offset:38912
v_cvt_pk_bf16_f32 v54, v72, v73
M v[76:79], a[188:191], v[252:255], v[76:79]
s_waitcnt lgkmcnt(10)
ds_read_b64_tr_b16 a[168:169], v87 offset:40960
v_cvt_pk_bf16_f32 v55, v74, v75
M a[208:211], a[192:195], v[96:99], a[208:211]
s_waitcnt lgkmcnt(9)
buffer_load_dwordx4 v84, s[20:23], s48 offen lds
M a[208:211], a[196:199], v[136:139], a[208:211]
s_waitcnt lgkmcnt(7)
ds_read_b64_tr_b16 a[170:171], v87 offset:43008
v_cvt_pk_bf16_f32 v58, v76, v77
M a[208:211], a[200:203], v[176:179], a[208:211]
s_waitcnt lgkmcnt(6)
ds_read_b64_tr_b16 a[172:173], v87 offset:45056
v_cvt_pk_bf16_f32 v59, v78, v79
M a[208:211], a[204:207], v[216:219], a[208:211]
s_add_u32 m0, s39, 68608
ds_read_b64_tr_b16 a[174:175], v87 offset:47104
v_add_u32 v87, 65536, v87
M a[212:215], a[192:195], v[100:103], a[212:215]
s_add_u32 s44, s67, 311296
buffer_store_dwordx4 v[44:47], v85, s[24:27], s73 offen offset:1024 sc1
M a[212:215], a[196:199], v[140:143], a[212:215]
ds_read_b64_tr_b16 a[176:177], v88 offset:32768
M a[212:215], a[200:203], v[180:183], a[212:215]
ds_read_b64_tr_b16 a[178:179], v88 offset:34816
M a[212:215], a[204:207], v[220:223], a[212:215]
s_add_u32 s45, s67, 319488
ds_read_b64_tr_b16 a[180:181], v88 offset:36864
M a[216:219], a[192:195], v[104:107], a[216:219]
buffer_load_dwordx4 v84, s[20:23], s49 offen lds
M a[216:219], a[196:199], v[144:147], a[216:219]
s_add_u32 m0, s39, 69632
ds_read_b64_tr_b16 a[182:183], v88 offset:38912
M a[216:219], a[200:203], v[184:187], a[216:219]
ds_read_b64_tr_b16 a[184:185], v88 offset:40960
M a[216:219], a[204:207], v[224:227], a[216:219]
ds_read_b64_tr_b16 a[186:187], v88 offset:43008
M a[220:223], a[192:195], v[108:111], a[220:223]
buffer_store_dwordx4 v[48:51], v85, s[24:27], s73 offen offset:2048 sc1
M a[220:223], a[196:199], v[148:151], a[220:223]
ds_read_b64_tr_b16 a[188:189], v88 offset:45056
M a[220:223], a[200:203], v[188:191], a[220:223]
ds_read_b64_tr_b16 a[190:191], v88 offset:47104
v_add_u32 v88, 65536, v88
M a[220:223], a[204:207], v[228:231], a[220:223]
M a[224:227], a[192:195], v[112:115], a[224:227]
buffer_load_dwordx4 v84, s[20:23], s50 offen lds
M a[224:227], a[196:199], v[152:155], a[224:227]
s_add_u32 m0, s39, 70656
ds_read_b64_tr_b16 a[192:193], v89 offset:32768
M a[224:227], a[200:203], v[192:195], a[224:227]
ds_read_b64_tr_b16 a[194:195], v89 offset:34816
M a[224:227], a[204:207], v[232:235], a[224:227]
s_waitcnt lgkmcnt(15)
ds_read_b64_tr_b16 a[196:197], v89 offset:36864
M a[228:231], a[160:163], v[96:99], a[228:231]
s_waitcnt lgkmcnt(15)
buffer_store_dwordx4 v[52:55], v85, s[24:27], s73 offen offset:3072 sc1
M a[228:231], a[164:167], v[136:139], a[228:231]
s_waitcnt lgkmcnt(13)
ds_read_b64_tr_b16 a[198:199], v89 offset:38912
M a[228:231], a[168:171], v[176:179], a[228:231]
s_waitcnt lgkmcnt(12)
ds_read_b64_tr_b16 a[200:201], v89 offset:40960
M a[228:231], a[172:175], v[216:219], a[228:231]
ds_read_b64_tr_b16 a[202:203], v89 offset:43008
M a[232:235], a[160:163], v[100:103], a[232:235]
buffer_load_dwordx4 v84, s[20:23], s51 offen lds
M a[232:235], a[164:167], v[140:143], a[232:235]
s_add_u32 m0, s39, 71680
ds_read_b64_tr_b16 a[204:205], v89 offset:45056
M a[232:235], a[168:171], v[180:183], a[232:235]
ds_read_b64_tr_b16 a[206:207], v89 offset:47104
v_add_u32 v89, 65536, v89
M a[232:235], a[172:175], v[220:223], a[232:235]
M a[236:239], a[160:163], v[104:107], a[236:239]
buffer_store_dwordx4 v[56:59], v92, s[24:27], s73 offen offset:0 sc1
M a[236:239], a[164:167], v[144:147], a[236:239]
s_sub_u32 s63, s64, s35
M a[236:239], a[168:171], v[184:187], a[236:239]
M a[236:239], a[172:175], v[224:227], a[236:239]
s_add_u32 s46, s68, 0
M a[240:243], a[160:163], v[108:111], a[240:243]
buffer_load_dwordx4 v84, s[20:23], s44 offen lds
M a[240:243], a[164:167], v[148:151], a[240:243]
s_add_u32 m0, s39, 72704
M a[240:243], a[168:171], v[188:191], a[240:243]
M a[240:243], a[172:175], v[228:231], a[240:243]
M a[244:247], a[160:163], v[112:115], a[244:247]
M a[244:247], a[164:167], v[152:155], a[244:247]
M a[244:247], a[168:171], v[192:195], a[244:247]
M a[244:247], a[172:175], v[232:235], a[244:247]
s_waitcnt lgkmcnt(14)
M a[208:211], a[176:179], v[116:119], a[208:211]
s_waitcnt lgkmcnt(12)
buffer_load_dwordx4 v84, s[20:23], s45 offen lds
M a[208:211], a[180:183], v[156:159], a[208:211]
s_waitcnt lgkmcnt(10)
M a[208:211], a[184:187], v[196:199], a[208:211]
s_waitcnt lgkmcnt(8)
M a[208:211], a[188:191], v[236:239], a[208:211]
M a[212:215], a[176:179], v[120:123], a[212:215]
M a[212:215], a[180:183], v[160:163], a[212:215]
M a[212:215], a[184:187], v[200:203], a[212:215]
M a[212:215], a[188:191], v[240:243], a[212:215]
M a[216:219], a[176:179], v[124:127], a[216:219]
M a[216:219], a[180:183], v[164:167], a[216:219]
M a[216:219], a[184:187], v[204:207], a[216:219]
M a[216:219], a[188:191], v[244:247], a[216:219]
v_accvgpr_read_b32 v40, a208
v_accvgpr_read_b32 v41, a209
M a[220:223], a[176:179], v[128:131], a[220:223]
v_accvgpr_read_b32 v42, a210
v_accvgpr_read_b32 v43, a211
M a[220:223], a[180:183], v[168:171], a[220:223]
v_cvt_pk_bf16_f32 v40, v40, v41
v_accvgpr_read_b32 v44, a212
M a[220:223], a[184:187], v[208:211], a[220:223]
v_cvt_pk_bf16_f32 v41, v42, v43
v_accvgpr_read_b32 v45, a213
M a[220:223], a[188:191], v[248:251], a[220:223]
v_accvgpr_read_b32 v46, a214
v_accvgpr_read_b32 v47, a215
M a[224:227], a[176:179], v[132:135], a[224:227]
v_cvt_pk_bf16_f32 v44, v44, v45
v_accvgpr_read_b32 v48, a216
M a[224:227], a[180:183], v[172:175], a[224:227]
v_cvt_pk_bf16_f32 v45, v46, v47
v_accvgpr_read_b32 v49, a217
M a[224:227], a[184:187], v[212:215], a[224:227]
v_accvgpr_read_b32 v50, a218
v_accvgpr_read_b32 v51, a219
M a[224:227], a[188:191], v[252:255], a[224:227]
s_waitcnt lgkmcnt(6)
v_cvt_pk_bf16_f32 v48, v48, v49
v_accvgpr_read_b32 v52, a220
M a[228:231], a[192:195], v[116:119], a[228:231]
s_waitcnt lgkmcnt(4)
v_cvt_pk_bf16_f32 v49, v50, v51
v_accvgpr_read_b32 v53, a221
M a[228:231], a[196:199], v[156:159], a[228:231]
s_waitcnt lgkmcnt(2)
v_accvgpr_read_b32 v54, a222
v_accvgpr_read_b32 v55, a223
M a[228:231], a[200:203], v[196:199], a[228:231]
s_waitcnt lgkmcnt(0)
v_cvt_pk_bf16_f32 v52, v52, v53
v_accvgpr_read_b32 v56, a224
M a[228:231], a[204:207], v[236:239], a[228:231]
s_waitcnt vmcnt(13)
v_cvt_pk_bf16_f32 v53, v54, v55
v_accvgpr_read_b32 v57, a225
M a[232:235], a[192:195], v[120:123], a[232:235]
s_barrier
ds_read_b64_tr_b16 a[160:161], v86 offset:0
v_accvgpr_read_b32 v58, a226
M a[232:235], a[196:199], v[160:163], a[232:235]
s_add_u32 m0, s39, 98304
ds_read_b64_tr_b16 a[162:163], v86 offset:2048
v_accvgpr_read_b32 v60, a228
M a[232:235], a[200:203], v[200:203], a[232:235]
s_add_u32 s47, s68, 8192
ds_read_b64_tr_b16 a[164:165], v86 offset:4096
v_accvgpr_read_b32 v61, a229
M a[232:235], a[204:207], v[240:243], a[232:235]
s_add_u32 s48, s68, 16384
buffer_store_dword v81, v80, s[24:27], s63 offen sc1
M a[236:239], a[192:195], v[124:127], a[236:239]
s_add_u32 s49, s68, 24576
ds_read_b64_tr_b16 a[166:167], v86 offset:6144
v_accvgpr_read_b32 v62, a230
M a[236:239], a[196:199], v[164:167], a[236:239]
s_add_u32 s50, s68, 32768
ds_read_b64_tr_b16 a[168:169], v86 offset:8192
v_accvgpr_read_b32 v63, a231
M a[236:239], a[200:203], v[204:207], a[236:239]
buffer_load_dwordx4 v84, s[20:23], s46 offen lds
M a[236:239], a[204:207], v[244:247], a[236:239]
s_add_u32 m0, s39, 99328
ds_read_b64_tr_b16 a[170:171], v86 offset:10240
v_cvt_pk_bf16_f32 v42, v60, v61
M a[240:243], a[192:195], v[128:131], a[240:243]
s_add_u32 s51, s68, 40960
ds_read_b64_tr_b16 a[172:173], v86 offset:12288
v_cvt_pk_bf16_f32 v43, v62, v63
M a[240:243], a[196:199], v[168:171], a[240:243]
ds_read_b64_tr_b16 a[174:175], v86 offset:14336
v_accvgpr_read_b32 v64, a232
M a[240:243], a[200:203], v[208:211], a[240:243]
buffer_load_dwordx4 v84, s[20:23], s47 offen lds
M a[240:243], a[204:207], v[248:251], a[240:243]
s_add_u32 m0, s39, 100352
ds_read_b64_tr_b16 a[176:177], v87 offset:0
v_accvgpr_read_b32 v65, a233
M a[244:247], a[192:195], v[132:135], a[244:247]
ds_read_b64_tr_b16 a[178:179], v87 offset:2048
v_accvgpr_read_b32 v66, a234
M a[244:247], a[196:199], v[172:175], a[244:247]
ds_read_b64_tr_b16 a[180:181], v87 offset:4096
v_accvgpr_read_b32 v67, a235
M a[244:247], a[200:203], v[212:215], a[244:247]
buffer_store_dwordx4 v[40:43], v85, s[24:27], s74 offen offset:0 sc1
M a[244:247], a[204:207], v[252:255], a[244:247]
s_waitcnt lgkmcnt(9)
ds_read_b64_tr_b16 a[182:183], v87 offset:6144
v_cvt_pk_bf16_f32 v46, v64, v65
M v[0:3], a[160:163], a[80:83], 0
s_waitcnt lgkmcnt(8)
ds_read_b64_tr_b16 a[184:185], v87 offset:8192
v_cvt_pk_bf16_f32 v47, v66, v67
M v[0:3], a[164:167], a[100:103], v[0:3]
s_waitcnt lgkmcnt(7)
ds_read_b64_tr_b16 a[186:187], v87 offset:10240
v_accvgpr_read_b32 v68, a236
M v[0:3], a[168:171], a[120:123], v[0:3]
s_waitcnt lgkmcnt(6)
buffer_load_dwordx4 v84, s[20:23], s48 offen lds
M v[0:3], a[172:175], a[140:143], v[0:3]
s_add_u32 m0, s39, 101376
ds_read_b64_tr_b16 a[188:189], v87 offset:12288
v_accvgpr_read_b32 v69, a237
M v[4:7], a[160:163], a[84:87], 0
s_add_u32 s44, s68, 49152
ds_read_b64_tr_b16 a[190:191], v87 offset:14336
v_accvgpr_read_b32 v70, a238
M v[4:7], a[164:167], a[104:107], v[4:7]
s_sub_u32 s42, s71, s35
v_accvgpr_read_b32 v71, a239
v_cvt_pk_bf16_f32 v50, v68, v69
M v[4:7], a[168:171], a[124:127], v[4:7]
s_mul_i32 s43, s42, 160
buffer_store_dwordx4 v[44:47], v85, s[24:27], s74 offen offset:1024 sc1
M v[4:7], a[172:175], a[144:147], v[4:7]
s_mul_i32 s52, s54, 327680
ds_read_b64_tr_b16 a[192:193], v88 offset:0
v_cvt_pk_bf16_f32 v51, v70, v71
M v[8:11], a[160:163], a[88:91], 0
s_add_u32 s43, s43, s52
v_accvgpr_read_b32 v72, a240
v_accvgpr_read_b32 v73, a241
M v[8:11], a[164:167], a[108:111], v[8:11]
s_add_u32 s52, s3, 4
v_accvgpr_read_b32 v74, a242
v_accvgpr_read_b32 v75, a243
M v[8:11], a[168:171], a[128:131], v[8:11]
s_and_b32 s52, s52, 7
buffer_load_dwordx4 v84, s[20:23], s49 offen lds
M v[8:11], a[172:175], a[148:151], v[8:11]
s_add_u32 m0, s39, 102400
ds_read_b64_tr_b16 a[194:195], v88 offset:2048
v_cvt_pk_bf16_f32 v54, v72, v73
M v[12:15], a[160:163], a[92:95], 0
s_lshl_b32 s58, 15, s52
ds_read_b64_tr_b16 a[196:197], v88 offset:4096
v_cvt_pk_bf16_f32 v55, v74, v75
M v[12:15], a[164:167], a[112:115], v[12:15]
s_lshr_b32 s52, s58, 8
ds_read_b64_tr_b16 a[198:199], v88 offset:6144
v_accvgpr_read_b32 v59, a227
M v[12:15], a[168:171], a[132:135], v[12:15]
s_or_b32 s58, s58, s52
buffer_store_dwordx4 v[48:51], v85, s[24:27], s74 offen offset:2048 sc1
M v[12:15], a[172:175], a[152:155], v[12:15]
s_lshl_b32 s59, 0x3f, s3
ds_read_b64_tr_b16 a[200:201], v88 offset:8192
v_cvt_pk_bf16_f32 v56, v56, v57
M v[16:19], a[160:163], a[96:99], 0
s_lshr_b32 s52, s59, 8
ds_read_b64_tr_b16 a[202:203], v88 offset:10240
v_accvgpr_read_b32 v76, a244
M v[16:19], a[164:167], a[116:119], v[16:19]
s_or_b32 s59, s59, s52
buffer_load_dwordx4 v84, s[20:23], s50 offen lds
M v[16:19], a[168:171], a[136:139], v[16:19]
s_add_u32 m0, s39, 103424
ds_read_b64_tr_b16 a[204:205], v88 offset:12288
v_accvgpr_read_b32 v77, a245
M v[16:19], a[172:175], a[156:159], v[16:19]
s_waitcnt lgkmcnt(13)
ds_read_b64_tr_b16 a[206:207], v88 offset:14336
v_accvgpr_read_b32 v78, a246
M v[20:23], a[176:179], a[80:83], 0
s_waitcnt lgkmcnt(12)
v_accvgpr_read_b32 v79, a247
v_cvt_pk_bf16_f32 v57, v58, v59
M v[20:23], a[180:183], a[100:103], v[20:23]
s_waitcnt lgkmcnt(10)
buffer_store_dwordx4 v[52:55], v85, s[24:27], s74 offen offset:3072 sc1
M v[20:23], a[184:187], a[120:123], v[20:23]
s_waitcnt lgkmcnt(8)
v_cvt_pk_bf16_f32 v58, v76, v77
v_cvt_pk_bf16_f32 v59, v78, v79
M v[20:23], a[188:191], a[140:143], v[20:23]
s_lshl_b32 s52, s54, 8
ds_read_b64_tr_b16 a[160:161], v89 offset:0
v_bfe_u32 v90, v81, 4, 6
M v[24:27], a[176:179], a[84:87], 0
s_add_u32 s52, s52, s42
ds_read_b64_tr_b16 a[162:163], v89 offset:2048
v_cmp_gt_u32 vcc, 8, v90
M v[24:27], a[180:183], a[104:107], v[24:27]
s_add_u32 s52, s52, 50331648
buffer_load_dwordx4 v84, s[20:23], s51 offen lds
L_hop_c5:
s_cbranch_execz L_ret_c5
M v[24:27], a[184:187], a[124:127], v[24:27]
s_add_u32 m0, s39, 104448
ds_read_b64_tr_b16 a[164:165], v89 offset:4096
v_lshl_add_u32 v90, v90, 2, s52
M v[24:27], a[188:191], a[144:147], v[24:27]
s_add_u32 s32, s3, 7
ds_read_b64_tr_b16 a[166:167], v89 offset:6144
v_cndmask_b32 v90, -16, v90, vcc
M v[28:31], a[176:179], a[88:91], 0
s_add_u32 s33, s3, 6
ds_read_b64_tr_b16 a[168:169], v89 offset:8192
v_subrev_u32 v86, 65536, v86
M v[28:31], a[180:183], a[108:111], v[28:31]
s_add_u32 s34, s3, 5
buffer_store_dwordx4 v[56:59], v92, s[24:27], s74 offen offset:0 sc1
M v[28:31], a[184:187], a[128:131], v[28:31]
s_add_u32 s36, s3, 4
ds_read_b64_tr_b16 a[170:171], v89 offset:10240
v_subrev_u32 v87, 65536, v87
M v[28:31], a[188:191], a[148:151], v[28:31]
s_add_u32 s37, s3, 3
ds_read_b64_tr_b16 a[172:173], v89 offset:12288
v_subrev_u32 v88, 65536, v88
M v[32:35], a[176:179], a[92:95], 0
s_add_u32 s38, s3, 2
ds_read_b64_tr_b16 a[174:175], v89 offset:14336
v_subrev_u32 v89, 65536, v89
M v[32:35], a[180:183], a[112:115], v[32:35]
s_add_u32 s41, s3, 1
buffer_load_dwordx4 v84, s[20:23], s44 offen lds
M v[32:35], a[184:187], a[132:135], v[32:35]
s_and_b32 s32, s32, 7
M v[32:35], a[188:191], a[152:155], v[32:35]
s_and_b32 s33, s33, 7
M v[36:39], a[176:179], a[96:99], 0
s_and_b32 s34, s34, 7
M v[36:39], a[180:183], a[116:119], v[36:39]
s_and_b32 s36, s36, 7
s_and_b32 s37, s37, 7
s_and_b32 s38, s38, 7
M v[36:39], a[184:187], a[136:139], v[36:39]
s_and_b32 s41, s41, 7
s_mul_i32 s32, s32, 163840
s_mul_i32 s33, s33, 163840
M v[36:39], a[188:191], a[156:159], v[36:39]
s_waitcnt lgkmcnt(14)
s_mul_i32 s34, s34, 163840
s_mul_i32 s36, s36, 163840
M v[0:3], a[192:195], a[0:3], v[0:3]
s_waitcnt lgkmcnt(12)
s_mul_i32 s37, s37, 163840
s_mul_i32 s38, s38, 163840
M v[0:3], a[196:199], a[20:23], v[0:3]
s_waitcnt lgkmcnt(10)
s_add_u32 s32, s32, s43
s_mul_i32 s41, s41, 163840
M v[0:3], a[200:203], a[40:43], v[0:3]
s_waitcnt lgkmcnt(8)
s_add_u32 s33, s33, s43
s_add_u32 s34, s34, s43
M v[0:3], a[204:207], a[60:63], v[0:3]
s_add_u32 s36, s36, s43
s_add_u32 s37, s37, s43
s_add_u32 s38, s38, s43
M v[4:7], a[192:195], a[4:7], v[4:7]
s_add_u32 s41, s41, s43
s_and_b32 s58, s58, 0xff
s_add_u32 m0, s39, 105472
M v[4:7], a[196:199], a[24:27], v[4:7]
s_add_u32 s45, s68, 57344
buffer_load_dwordx4 v84, s[20:23], s45 offen lds
M v[4:7], a[200:203], a[44:47], v[4:7]
M v[4:7], a[204:207], a[64:67], v[4:7]
M v[8:11], a[192:195], a[8:11], v[8:11]
M v[8:11], a[196:199], a[28:31], v[8:11]
M v[8:11], a[200:203], a[48:51], v[8:11]
M v[8:11], a[204:207], a[68:71], v[8:11]
M v[12:15], a[192:195], a[12:15], v[12:15]
M v[12:15], a[196:199], a[32:35], v[12:15]
M v[12:15], a[200:203], a[52:55], v[12:15]
M v[12:15], a[204:207], a[72:75], v[12:15]
M v[16:19], a[192:195], a[16:19], v[16:19]
M v[16:19], a[196:199], a[36:39], v[16:19]
M v[16:19], a[200:203], a[56:59], v[16:19]
M v[16:19], a[204:207], a[76:79], v[16:19]
s_waitcnt lgkmcnt(6)
M v[20:23], a[160:163], a[0:3], v[20:23]
s_waitcnt lgkmcnt(4)
M v[20:23], a[164:167], a[20:23], v[20:23]
s_waitcnt lgkmcnt(2)
M v[20:23], a[168:171], a[40:43], v[20:23]
s_waitcnt lgkmcnt(0)
M v[20:23], a[172:175], a[60:63], v[20:23]
s_waitcnt vmcnt(14)
M v[24:27], a[160:163], a[4:7], v[24:27]
s_barrier
ds_read_b64_tr_b16 a[176:177], v86 offset:0
M v[24:27], a[164:167], a[24:27], v[24:27]
s_sub_u32 s63, s65, s35
ds_read_b64_tr_b16 a[178:179], v86 offset:2048
M v[24:27], a[168:171], a[44:47], v[24:27]
s_add_u32 m0, s39, 131072
ds_read_b64_tr_b16 a[180:181], v86 offset:4096
M v[24:27], a[172:175], a[64:67], v[24:27]
s_add_u32 s46, s68, 262144
buffer_store_dword v81, v80, s[24:27], s63 offen sc1
M v[28:31], a[160:163], a[8:11], v[28:31]
s_add_u32 s47, s68, 270336
ds_read_b64_tr_b16 a[182:183], v86 offset:6144
M v[28:31], a[164:167], a[28:31], v[28:31]
s_add_u32 s48, s68, 278528
ds_read_b64_tr_b16 a[184:185], v86 offset:8192
M v[28:31], a[168:171], a[48:51], v[28:31]
s_add_u32 s49, s68, 286720
buffer_load_dwordx4 v84, s[20:23], s46 offen lds
M v[28:31], a[172:175], a[68:71], v[28:31]
s_add_u32 m0, s39, 132096
ds_read_b64_tr_b16 a[186:187], v86 offset:10240
M v[32:35], a[160:163], a[12:15], v[32:35]
s_add_u32 s50, s68, 294912
ds_read_b64_tr_b16 a[188:189], v86 offset:12288
M v[32:35], a[164:167], a[32:35], v[32:35]
s_add_u32 s51, s68, 303104
ds_read_b64_tr_b16 a[190:191], v86 offset:14336
M v[32:35], a[168:171], a[52:55], v[32:35]
buffer_load_dwordx4 v84, s[20:23], s47 offen lds
M v[32:35], a[172:175], a[72:75], v[32:35]
s_add_u32 m0, s39, 133120
ds_read_b64_tr_b16 a[192:193], v87 offset:0
M v[36:39], a[160:163], a[16:19], v[36:39]
ds_read_b64_tr_b16 a[194:195], v87 offset:2048
M v[36:39], a[164:167], a[36:39], v[36:39]
ds_read_b64_tr_b16 a[196:197], v87 offset:4096
M v[36:39], a[168:171], a[56:59], v[36:39]
ds_read_b64_tr_b16 a[198:199], v87 offset:6144
M v[36:39], a[172:175], a[76:79], v[36:39]
s_waitcnt lgkmcnt(10)
ds_read_b64_tr_b16 a[200:201], v87 offset:8192
M v[0:3], a[176:179], v[96:99], v[0:3]
s_waitcnt lgkmcnt(9)
buffer_load_dwordx4 v84, s[20:23], s48 offen lds
M v[0:3], a[180:183], v[136:139], v[0:3]
s_waitcnt lgkmcnt(7)
ds_read_b64_tr_b16 a[202:203], v87 offset:10240
M v[0:3], a[184:187], v[176:179], v[0:3]
s_waitcnt lgkmcnt(6)
ds_read_b64_tr_b16 a[204:205], v87 offset:12288
M v[0:3], a[188:191], v[216:219], v[0:3]
s_add_u32 m0, s39, 134144
ds_read_b64_tr_b16 a[206:207], v87 offset:14336
M v[4:7], a[176:179], v[100:103], v[4:7]
s_add_u32 s44, s68, 311296
ds_read_b64_tr_b16 a[160:161], v88 offset:0
M v[4:7], a[180:183], v[140:143], v[4:7]
ds_read_b64_tr_b16 a[162:163], v88 offset:2048
M v[4:7], a[184:187], v[180:183], v[4:7]
ds_read_b64_tr_b16 a[164:165], v88 offset:4096
M v[4:7], a[188:191], v[220:223], v[4:7]
s_add_u32 s45, s68, 319488
ds_read_b64_tr_b16 a[166:167], v88 offset:6144
M v[8:11], a[176:179], v[104:107], v[8:11]
buffer_load_dwordx4 v84, s[20:23], s49 offen lds
M v[8:11], a[180:183], v[144:147], v[8:11]
s_add_u32 m0, s39, 135168
ds_read_b64_tr_b16 a[168:169], v88 offset:8192
M v[8:11], a[184:187], v[184:187], v[8:11]
ds_read_b64_tr_b16 a[170:171], v88 offset:10240
M v[8:11], a[188:191], v[224:227], v[8:11]
ds_read_b64_tr_b16 a[172:173], v88 offset:12288
M v[12:15], a[176:179], v[108:111], v[12:15]
ds_read_b64_tr_b16 a[174:175], v88 offset:14336
M v[12:15], a[180:183], v[148:151], v[12:15]
M v[12:15], a[184:187], v[188:191], v[12:15]
M v[12:15], a[188:191], v[228:231], v[12:15]
M v[16:19], a[176:179], v[112:115], v[16:19]
buffer_load_dwordx4 v84, s[20:23], s50 offen lds
M v[16:19], a[180:183], v[152:155], v[16:19]
s_add_u32 m0, s39, 136192
ds_read_b64_tr_b16 a[176:177], v89 offset:0
M v[16:19], a[184:187], v[192:195], v[16:19]
ds_read_b64_tr_b16 a[178:179], v89 offset:2048
M v[16:19], a[188:191], v[232:235], v[16:19]
s_waitcnt lgkmcnt(15)
ds_read_b64_tr_b16 a[180:181], v89 offset:4096
M v[20:23], a[192:195], v[96:99], v[20:23]
s_waitcnt lgkmcnt(15)
ds_read_b64_tr_b16 a[182:183], v89 offset:6144
M v[20:23], a[196:199], v[136:139], v[20:23]
s_waitcnt lgkmcnt(14)
ds_read_b64_tr_b16 a[184:185], v89 offset:8192
M v[20:23], a[200:203], v[176:179], v[20:23]
s_waitcnt lgkmcnt(13)
ds_read_b64_tr_b16 a[186:187], v89 offset:10240
M v[20:23], a[204:207], v[216:219], v[20:23]
ds_read_b64_tr_b16 a[188:189], v89 offset:12288
M v[24:27], a[192:195], v[100:103], v[24:27]
buffer_load_dwordx4 v84, s[20:23], s51 offen lds
M v[24:27], a[196:199], v[140:143], v[24:27]
s_add_u32 m0, s39, 137216
ds_read_b64_tr_b16 a[190:191], v89 offset:14336
M v[24:27], a[200:203], v[180:183], v[24:27]
M v[24:27], a[204:207], v[220:223], v[24:27]
M v[28:31], a[192:195], v[104:107], v[28:31]
M v[28:31], a[196:199], v[144:147], v[28:31]
s_sub_u32 s63, s66, s35
M v[28:31], a[200:203], v[184:187], v[28:31]
M v[28:31], a[204:207], v[224:227], v[28:31]
s_add_u32 s46, s69, 0
M v[32:35], a[192:195], v[108:111], v[32:35]
buffer_load_dwordx4 v84, s[20:23], s44 offen lds
M v[32:35], a[196:199], v[148:151], v[32:35]
s_add_u32 m0, s39, 138240
M v[32:35], a[200:203], v[188:191], v[32:35]
M v[32:35], a[204:207], v[228:231], v[32:35]
M v[36:39], a[192:195], v[112:115], v[36:39]
M v[36:39], a[196:199], v[152:155], v[36:39]
M v[36:39], a[200:203], v[192:195], v[36:39]
M v[36:39], a[204:207], v[232:235], v[36:39]
s_waitcnt lgkmcnt(14)
M v[0:3], a[160:163], v[116:119], v[0:3]
s_waitcnt lgkmcnt(12)
buffer_load_dwordx4 v84, s[20:23], s45 offen lds
M v[0:3], a[164:167], v[156:159], v[0:3]
s_waitcnt lgkmcnt(10)
M v[0:3], a[168:171], v[196:199], v[0:3]
s_waitcnt lgkmcnt(8)
M v[0:3], a[172:175], v[236:239], v[0:3]
M v[4:7], a[160:163], v[120:123], v[4:7]
M v[4:7], a[164:167], v[160:163], v[4:7]
M v[4:7], a[168:171], v[200:203], v[4:7]
M v[4:7], a[172:175], v[240:243], v[4:7]
M v[8:11], a[160:163], v[124:127], v[8:11]
M v[8:11], a[164:167], v[164:167], v[8:11]
M v[8:11], a[168:171], v[204:207], v[8:11]
M v[8:11], a[172:175], v[244:247], v[8:11]
v_cvt_pk_bf16_f32 v0, v0, v1
v_cvt_pk_bf16_f32 v1, v2, v3
M v[12:15], a[160:163], v[128:131], v[12:15]
M v[12:15], a[164:167], v[168:171], v[12:15]
v_cvt_pk_bf16_f32 v4, v4, v5
v_cvt_pk_bf16_f32 v5, v6, v7
M v[12:15], a[168:171], v[208:211], v[12:15]
M v[12:15], a[172:175], v[248:251], v[12:15]
v_cvt_pk_bf16_f32 v8, v8, v9
v_cvt_pk_bf16_f32 v9, v10, v11
M v[16:19], a[160:163], v[132:135], v[16:19]
M v[16:19], a[164:167], v[172:175], v[16:19]
M v[16:19], a[168:171], v[212:215], v[16:19]
M v[16:19], a[172:175], v[252:255], v[16:19]
s_waitcnt lgkmcnt(6)
M v[20:23], a[176:179], v[116:119], v[20:23]
s_waitcnt lgkmcnt(4)
v_cvt_pk_bf16_f32 v12, v12, v13
v_cvt_pk_bf16_f32 v13, v14, v15
M v[20:23], a[180:183], v[156:159], v[20:23]
s_waitcnt lgkmcnt(2)
M v[20:23], a[184:187], v[196:199], v[20:23]
s_waitcnt lgkmcnt(0)
v_cvt_pk_bf16_f32 v16, v16, v17
v_cvt_pk_bf16_f32 v17, v18, v19
M v[20:23], a[188:191], v[236:239], v[20:23]
s_waitcnt vmcnt(9)
M v[24:27], a[176:179], v[120:123], v[24:27]
s_barrier
ds_read_b64_tr_b16 a[192:193], v86 offset:32768
M v[24:27], a[180:183], v[160:163], v[24:27]
s_add_u32 m0, s39, 65536
ds_read_b64_tr_b16 a[194:195], v86 offset:34816
M v[24:27], a[184:187], v[200:203], v[24:27]
s_add_u32 s47, s69, 8192
ds_read_b64_tr_b16 a[196:197], v86 offset:36864
v_cvt_pk_bf16_f32 v2, v20, v21
M v[24:27], a[188:191], v[240:243], v[24:27]
s_add_u32 s48, s69, 16384
buffer_store_dword v81, v80, s[24:27], s63 offen sc1
M v[28:31], a[176:179], v[124:127], v[28:31]
s_add_u32 s49, s69, 24576
ds_read_b64_tr_b16 a[198:199], v86 offset:38912
v_cvt_pk_bf16_f32 v3, v22, v23
M v[28:31], a[180:183], v[164:167], v[28:31]
s_add_u32 s50, s69, 32768
ds_read_b64_tr_b16 a[200:201], v86 offset:40960
v_cvt_pk_bf16_f32 v6, v24, v25
M v[28:31], a[184:187], v[204:207], v[28:31]
buffer_load_dwordx4 v84, s[20:23], s46 offen lds
M v[28:31], a[188:191], v[244:247], v[28:31]
s_add_u32 m0, s39, 66560
ds_read_b64_tr_b16 a[202:203], v86 offset:43008
v_cvt_pk_bf16_f32 v7, v26, v27
M v[32:35], a[176:179], v[128:131], v[32:35]
s_add_u32 s51, s69, 40960
ds_read_b64_tr_b16 a[204:205], v86 offset:45056
M v[32:35], a[180:183], v[168:171], v[32:35]
ds_read_b64_tr_b16 a[206:207], v86 offset:47104
v_cvt_pk_bf16_f32 v10, v28, v29
M v[32:35], a[184:187], v[208:211], v[32:35]
buffer_load_dwordx4 v84, s[20:23], s47 offen lds
M v[32:35], a[188:191], v[248:251], v[32:35]
s_add_u32 m0, s39, 67584
ds_read_b64_tr_b16 a[160:161], v87 offset:32768
v_cvt_pk_bf16_f32 v11, v30, v31
M v[36:39], a[176:179], v[132:135], v[36:39]
ds_read_b64_tr_b16 a[162:163], v87 offset:34816
v_add_u32 v86, 65536, v86
M v[36:39], a[180:183], v[172:175], v[36:39]
ds_read_b64_tr_b16 a[164:165], v87 offset:36864
v_cvt_pk_bf16_f32 v14, v32, v33
M v[36:39], a[184:187], v[212:215], v[36:39]
buffer_store_dwordx4 v[0:3], v85, s[24:27], s75 offen offset:0 sc1
M v[36:39], a[188:191], v[252:255], v[36:39]
s_waitcnt lgkmcnt(9)
ds_read_b64_tr_b16 a[166:167], v87 offset:38912
v_cvt_pk_bf16_f32 v15, v34, v35
M v[40:43], a[192:195], a[80:83], 0
s_waitcnt lgkmcnt(8)
ds_read_b64_tr_b16 a[168:169], v87 offset:40960
M v[40:43], a[196:199], a[100:103], v[40:43]
s_waitcnt lgkmcnt(7)
ds_read_b64_tr_b16 a[170:171], v87 offset:43008
v_cvt_pk_bf16_f32 v18, v36, v37
M v[40:43], a[200:203], a[120:123], v[40:43]
s_waitcnt lgkmcnt(6)
buffer_load_dwordx4 v84, s[20:23], s48 offen lds
M v[40:43], a[204:207], a[140:143], v[40:43]
s_add_u32 m0, s39, 68608
ds_read_b64_tr_b16 a[172:173], v87 offset:45056
v_cvt_pk_bf16_f32 v19, v38, v39
M v[44:47], a[192:195], a[84:87], 0
s_add_u32 s44, s69, 49152
ds_read_b64_tr_b16 a[174:175], v87 offset:47104
v_add_u32 v87, 65536, v87
M v[44:47], a[196:199], a[104:107], v[44:47]
ds_read_b64_tr_b16 a[176:177], v88 offset:32768
M v[44:47], a[200:203], a[124:127], v[44:47]
buffer_store_dwordx4 v[4:7], v85, s[24:27], s75 offen offset:1024 sc1
M v[44:47], a[204:207], a[144:147], v[44:47]
s_add_u32 s45, s69, 57344
ds_read_b64_tr_b16 a[178:179], v88 offset:34816
M v[48:51], a[192:195], a[88:91], 0
ds_read_b64_tr_b16 a[180:181], v88 offset:36864
M v[48:51], a[196:199], a[108:111], v[48:51]
ds_read_b64_tr_b16 a[182:183], v88 offset:38912
M v[48:51], a[200:203], a[128:131], v[48:51]
buffer_load_dwordx4 v84, s[20:23], s49 offen lds
M v[48:51], a[204:207], a[148:151], v[48:51]
s_add_u32 m0, s39, 69632
ds_read_b64_tr_b16 a[184:185], v88 offset:40960
M v[52:55], a[192:195], a[92:95], 0
ds_read_b64_tr_b16 a[186:187], v88 offset:43008
M v[52:55], a[196:199], a[112:115], v[52:55]
ds_read_b64_tr_b16 a[188:189], v88 offset:45056
M v[52:55], a[200:203], a[132:135], v[52:55]
buffer_store_dwordx4 v[8:11], v85, s[24:27], s75 offen offset:2048 sc1
M v[52:55], a[204:207], a[152:155], v[52:55]
ds_read_b64_tr_b16 a[190:191], v88 offset:47104
v_add_u32 v88, 65536, v88
M v[56:59], a[192:195], a[96:99], 0
ds_read_b64_tr_b16 a[192:193], v89 offset:32768
M v[56:59], a[196:199], a[116:119], v[56:59]
ds_read_b64_tr_b16 a[194:195], v89 offset:34816
M v[56:59], a[200:203], a[136:139], v[56:59]
buffer_load_dwordx4 v84, s[20:23], s50 offen lds
M v[56:59], a[204:207], a[156:159], v[56:59]
s_waitcnt lgkmcnt(15)
ds_read_b64_tr_b16 a[196:197], v89 offset:36864
M v[60:63], a[160:163], a[80:83], 0
s_waitcnt lgkmcnt(15)
ds_read_b64_tr_b16 a[198:199], v89 offset:38912
M v[60:63], a[164:167], a[100:103], v[60:63]
s_waitcnt lgkmcnt(14)
buffer_store_dwordx4 v[12:15], v85, s[24:27], s75 offen offset:3072 sc1
M v[60:63], a[168:171], a[120:123], v[60:63]
s_waitcnt lgkmcnt(12)
ds_read_b64_tr_b16 a[200:201], v89 offset:40960
M v[60:63], a[172:175], a[140:143], v[60:63]
s_add_u32 m0, s39, 70656
ds_read_b64_tr_b16 a[202:203], v89 offset:43008
M v[64:67], a[160:163], a[84:87], 0
ds_read_b64_tr_b16 a[204:205], v89 offset:45056
M v[64:67], a[164:167], a[104:107], v[64:67]
buffer_load_dwordx4 v84, s[20:23], s51 offen lds
M v[64:67], a[168:171], a[124:127], v[64:67]
s_add_u32 m0, s39, 71680
ds_read_b64_tr_b16 a[206:207], v89 offset:47104
v_add_u32 v89, 65536, v89
M v[64:67], a[172:175], a[144:147], v[64:67]
M v[68:71], a[160:163], a[88:91], 0
M v[68:71], a[164:167], a[108:111], v[68:71]
buffer_store_dwordx4 v[16:19], v92, s[24:27], s75 offen offset:0 sc1
M v[68:71], a[168:171], a[128:131], v[68:71]
M v[68:71], a[172:175], a[148:151], v[68:71]
s_add_u32 s46, s69, 262144
M v[72:75], a[160:163], a[92:95], 0
M v[72:75], a[164:167], a[112:115], v[72:75]
buffer_load_dwordx4 v84, s[20:23], s44 offen lds
M v[72:75], a[168:171], a[132:135], v[72:75]
s_add_u32 m0, s39, 72704
M v[72:75], a[172:175], a[152:155], v[72:75]
M v[76:79], a[160:163], a[96:99], 0
M v[76:79], a[164:167], a[116:119], v[76:79]
M v[76:79], a[168:171], a[136:139], v[76:79]
M v[76:79], a[172:175], a[156:159], v[76:79]
s_waitcnt lgkmcnt(14)
M v[40:43], a[176:179], a[0:3], v[40:43]
s_waitcnt lgkmcnt(12)
buffer_load_dwordx4 v84, s[20:23], s45 offen lds
M v[40:43], a[180:183], a[20:23], v[40:43]
s_waitcnt lgkmcnt(10)
M v[40:43], a[184:187], a[40:43], v[40:43]
s_waitcnt lgkmcnt(8)
M v[40:43], a[188:191], a[60:63], v[40:43]
M v[44:47], a[176:179], a[4:7], v[44:47]
M v[44:47], a[180:183], a[24:27], v[44:47]
M v[44:47], a[184:187], a[44:47], v[44:47]
M v[44:47], a[188:191], a[64:67], v[44:47]
M v[48:51], a[176:179], a[8:11], v[48:51]
M v[48:51], a[180:183], a[28:31], v[48:51]
M v[48:51], a[184:187], a[48:51], v[48:51]
M v[48:51], a[188:191], a[68:71], v[48:51]
M v[52:55], a[176:179], a[12:15], v[52:55]
M v[52:55], a[180:183], a[32:35], v[52:55]
M v[52:55], a[184:187], a[52:55], v[52:55]
M v[52:55], a[188:191], a[72:75], v[52:55]
M v[56:59], a[176:179], a[16:19], v[56:59]
M v[56:59], a[180:183], a[36:39], v[56:59]
M v[56:59], a[184:187], a[56:59], v[56:59]
M v[56:59], a[188:191], a[76:79], v[56:59]
s_waitcnt lgkmcnt(6)
M v[60:63], a[192:195], a[0:3], v[60:63]
s_waitcnt lgkmcnt(4)
M v[60:63], a[196:199], a[20:23], v[60:63]
s_waitcnt lgkmcnt(2)
M v[60:63], a[200:203], a[40:43], v[60:63]
s_waitcnt lgkmcnt(0)
M v[60:63], a[204:207], a[60:63], v[60:63]
s_waitcnt vmcnt(14)
M v[64:67], a[192:195], a[4:7], v[64:67]
s_barrier
ds_read_b64_tr_b16 a[160:161], v86 offset:0
M v[64:67], a[196:199], a[24:27], v[64:67]
s_add_u32 m0, s39, 98304
buffer_load_dword v91, v90, s[24:27], 0 offen sc1
M v[64:67], a[200:203], a[44:47], v[64:67]
s_add_u32 s47, s69, 270336
ds_read_b64_tr_b16 a[162:163], v86 offset:2048
M v[64:67], a[204:207], a[64:67], v[64:67]
s_add_u32 s48, s69, 278528
ds_read_b64_tr_b16 a[164:165], v86 offset:4096
M v[68:71], a[192:195], a[8:11], v[68:71]
s_add_u32 s49, s69, 286720
ds_read_b64_tr_b16 a[166:167], v86 offset:6144
M v[68:71], a[196:199], a[28:31], v[68:71]
s_add_u32 s50, s69, 294912
ds_read_b64_tr_b16 a[168:169], v86 offset:8192
M v[68:71], a[200:203], a[48:51], v[68:71]
buffer_load_dwordx4 v84, s[20:23], s46 offen lds
M v[68:71], a[204:207], a[68:71], v[68:71]
s_add_u32 m0, s39, 99328
ds_read_b64_tr_b16 a[170:171], v86 offset:10240
M v[72:75], a[192:195], a[12:15], v[72:75]
s_add_u32 s51, s69, 303104
ds_read_b64_tr_b16 a[172:173], v86 offset:12288
M v[72:75], a[196:199], a[32:35], v[72:75]
ds_read_b64_tr_b16 a[174:175], v86 offset:14336
v_subrev_u32 v86, 65536, v86
M v[72:75], a[200:203], a[52:55], v[72:75]
buffer_load_dwordx4 v84, s[20:23], s47 offen lds
M v[72:75], a[204:207], a[72:75], v[72:75]
s_add_u32 m0, s39, 100352
ds_read_b64_tr_b16 a[176:177], v87 offset:0
M v[76:79], a[192:195], a[16:19], v[76:79]
ds_read_b64_tr_b16 a[178:179], v87 offset:2048
M v[76:79], a[196:199], a[36:39], v[76:79]
ds_read_b64_tr_b16 a[180:181], v87 offset:4096
M v[76:79], a[200:203], a[56:59], v[76:79]
ds_read_b64_tr_b16 a[182:183], v87 offset:6144
M v[76:79], a[204:207], a[76:79], v[76:79]
s_waitcnt lgkmcnt(10)
ds_read_b64_tr_b16 a[184:185], v87 offset:8192
M v[40:43], a[160:163], v[96:99], v[40:43]
s_waitcnt lgkmcnt(9)
buffer_load_dwordx4 v84, s[20:23], s48 offen lds
M v[40:43], a[164:167], v[136:139], v[40:43]
s_waitcnt lgkmcnt(7)
ds_read_b64_tr_b16 a[186:187], v87 offset:10240
M v[40:43], a[168:171], v[176:179], v[40:43]
s_waitcnt lgkmcnt(6)
ds_read_b64_tr_b16 a[188:189], v87 offset:12288
M v[40:43], a[172:175], v[216:219], v[40:43]
s_add_u32 m0, s39, 101376
ds_read_b64_tr_b16 a[190:191], v87 offset:14336
v_subrev_u32 v87, 65536, v87
M v[44:47], a[160:163], v[100:103], v[44:47]
s_add_u32 s44, s69, 311296
ds_read_b64_tr_b16 a[192:193], v88 offset:0
M v[44:47], a[164:167], v[140:143], v[44:47]
ds_read_b64_tr_b16 a[194:195], v88 offset:2048
M v[44:47], a[168:171], v[180:183], v[44:47]
ds_read_b64_tr_b16 a[196:197], v88 offset:4096
M v[44:47], a[172:175], v[220:223], v[44:47]
s_add_u32 s45, s69, 319488
ds_read_b64_tr_b16 a[198:199], v88 offset:6144
M v[48:51], a[160:163], v[104:107], v[48:51]
buffer_load_dwordx4 v84, s[20:23], s49 offen lds
M v[48:51], a[164:167], v[144:147], v[48:51]
s_add_u32 m0, s39, 102400
ds_read_b64_tr_b16 a[200:201], v88 offset:8192
M v[48:51], a[168:171], v[184:187], v[48:51]
ds_read_b64_tr_b16 a[202:203], v88 offset:10240
M v[48:51], a[172:175], v[224:227], v[48:51]
ds_read_b64_tr_b16 a[204:205], v88 offset:12288
M v[52:55], a[160:163], v[108:111], v[52:55]
ds_read_b64_tr_b16 a[206:207], v88 offset:14336
v_subrev_u32 v88, 65536, v88
M v[52:55], a[164:167], v[148:151], v[52:55]
M v[52:55], a[168:171], v[188:191], v[52:55]
M v[52:55], a[172:175], v[228:231], v[52:55]
M v[56:59], a[160:163], v[112:115], v[56:59]
buffer_load_dwordx4 v84, s[20:23], s50 offen lds
M v[56:59], a[164:167], v[152:155], v[56:59]
s_add_u32 m0, s39, 103424
ds_read_b64_tr_b16 a[160:161], v89 offset:0
M v[56:59], a[168:171], v[192:195], v[56:59]
ds_read_b64_tr_b16 a[162:163], v89 offset:2048
M v[56:59], a[172:175], v[232:235], v[56:59]
s_waitcnt lgkmcnt(15)
ds_read_b64_tr_b16 a[164:165], v89 offset:4096
M v[60:63], a[176:179], v[96:99], v[60:63]
s_waitcnt lgkmcnt(15)
ds_read_b64_tr_b16 a[166:167], v89 offset:6144
M v[60:63], a[180:183], v[136:139], v[60:63]
s_waitcnt lgkmcnt(14)
ds_read_b64_tr_b16 a[168:169], v89 offset:8192
M v[60:63], a[184:187], v[176:179], v[60:63]
s_waitcnt lgkmcnt(13)
ds_read_b64_tr_b16 a[170:171], v89 offset:10240
M v[60:63], a[188:191], v[216:219], v[60:63]
ds_read_b64_tr_b16 a[172:173], v89 offset:12288
M v[64:67], a[176:179], v[100:103], v[64:67]
buffer_load_dwordx4 v84, s[20:23], s51 offen lds
M v[64:67], a[180:183], v[140:143], v[64:67]
s_add_u32 m0, s39, 104448
ds_read_b64_tr_b16 a[174:175], v89 offset:14336
v_subrev_u32 v89, 65536, v89
M v[64:67], a[184:187], v[180:183], v[64:67]
M v[64:67], a[188:191], v[220:223], v[64:67]
M v[68:71], a[176:179], v[104:107], v[68:71]
M v[68:71], a[180:183], v[144:147], v[68:71]
s_sub_u32 s63, s67, s35
M v[68:71], a[184:187], v[184:187], v[68:71]
M v[68:71], a[188:191], v[224:227], v[68:71]
s_add_u32 s46, s70, 0
M v[72:75], a[176:179], v[108:111], v[72:75]
L_hop_c6:
s_cbranch_execz L_ret_c6
buffer_load_dwordx4 v84, s[20:23], s44 offen lds
M v[72:75], a[180:183], v[148:151], v[72:75]
s_add_u32 m0, s39, 105472
M v[72:75], a[184:187], v[188:191], v[72:75]
M v[72:75], a[188:191], v[228:231], v[72:75]
M v[76:79], a[176:179], v[112:115], v[76:79]
M v[76:79], a[180:183], v[152:155], v[76:79]
M v[76:79], a[184:187], v[192:195], v[76:79]
M v[76:79], a[188:191], v[232:235], v[76:79]
s_waitcnt lgkmcnt(14)
M v[40:43], a[192:195], v[116:119], v[40:43]
s_waitcnt lgkmcnt(12)
buffer_load_dwordx4 v84, s[20:23], s45 offen lds
M v[40:43], a[196:199], v[156:159], v[40:43]
s_waitcnt lgkmcnt(10)
M v[40:43], a[200:203], v[196:199], v[40:43]
s_waitcnt lgkmcnt(8)
M v[40:43], a[204:207], v[236:239], v[40:43]
M v[44:47], a[192:195], v[120:123], v[44:47]
M v[44:47], a[196:199], v[160:163], v[44:47]
M v[44:47], a[200:203], v[200:203], v[44:47]
M v[44:47], a[204:207], v[240:243], v[44:47]
M v[48:51], a[192:195], v[124:127], v[48:51]
M v[48:51], a[196:199], v[164:167], v[48:51]
M v[48:51], a[200:203], v[204:207], v[48:51]
M v[48:51], a[204:207], v[244:247], v[48:51]
v_cvt_pk_bf16_f32 v40, v40, v41
v_cvt_pk_bf16_f32 v41, v42, v43
M v[52:55], a[192:195], v[128:131], v[52:55]
M v[52:55], a[196:199], v[168:171], v[52:55]
v_cvt_pk_bf16_f32 v44, v44, v45
v_cvt_pk_bf16_f32 v45, v46, v47
M v[52:55], a[200:203], v[208:211], v[52:55]
M v[52:55], a[204:207], v[248:251], v[52:55]
v_cvt_pk_bf16_f32 v48, v48, v49
v_cvt_pk_bf16_f32 v49, v50, v51
M v[56:59], a[192:195], v[132:135], v[56:59]
M v[56:59], a[196:199], v[172:175], v[56:59]
M v[56:59], a[200:203], v[212:215], v[56:59]
M v[56:59], a[204:207], v[252:255], v[56:59]
s_waitcnt lgkmcnt(6)
M v[60:63], a[160:163], v[116:119], v[60:63]
s_waitcnt lgkmcnt(4)
v_cvt_pk_bf16_f32 v52, v52, v53
v_cvt_pk_bf16_f32 v53, v54, v55
M v[60:63], a[164:167], v[156:159], v[60:63]
s_waitcnt lgkmcnt(2)
M v[60:63], a[168:171], v[196:199], v[60:63]
s_waitcnt lgkmcnt(0)
v_cvt_pk_bf16_f32 v56, v56, v57
v_cvt_pk_bf16_f32 v57, v58, v59
M v[60:63], a[172:175], v[236:239], v[60:63]
s_waitcnt vmcnt(9)
M v[64:67], a[160:163], v[120:123], v[64:67]
s_barrier
ds_read_b64_tr_b16 a[176:177], v86 offset:0
M v[64:67], a[164:167], v[160:163], v[64:67]
s_add_u32 m0, s39, 131072
ds_read_b64_tr_b16 a[178:179], v86 offset:2048
M v[64:67], a[168:171], v[200:203], v[64:67]
s_add_u32 s47, s70, 8192
ds_read_b64_tr_b16 a[180:181], v86 offset:4096
v_cvt_pk_bf16_f32 v42, v60, v61
M v[64:67], a[172:175], v[240:243], v[64:67]
s_add_u32 s48, s70, 16384
buffer_store_dword v81, v80, s[24:27], s63 offen sc1
M v[68:71], a[160:163], v[124:127], v[68:71]
s_add_u32 s49, s70, 24576
ds_read_b64_tr_b16 a[182:183], v86 offset:6144
v_cvt_pk_bf16_f32 v43, v62, v63
M v[68:71], a[164:167], v[164:167], v[68:71]
s_add_u32 s50, s70, 32768
ds_read_b64_tr_b16 a[184:185], v86 offset:8192
v_cvt_pk_bf16_f32 v46, v64, v65
M v[68:71], a[168:171], v[204:207], v[68:71]
buffer_load_dwordx4 v84, s[20:23], s46 offen lds
M v[68:71], a[172:175], v[244:247], v[68:71]
s_add_u32 m0, s39, 132096
ds_read_b64_tr_b16 a[186:187], v86 offset:10240
v_cvt_pk_bf16_f32 v47, v66, v67
M v[72:75], a[160:163], v[128:131], v[72:75]
s_add_u32 s51, s70, 40960
ds_read_b64_tr_b16 a[188:189], v86 offset:12288
M v[72:75], a[164:167], v[168:171], v[72:75]
ds_read_b64_tr_b16 a[190:191], v86 offset:14336
v_cvt_pk_bf16_f32 v50, v68, v69
M v[72:75], a[168:171], v[208:211], v[72:75]
buffer_load_dwordx4 v84, s[20:23], s47 offen lds
M v[72:75], a[172:175], v[248:251], v[72:75]
s_add_u32 m0, s39, 133120
ds_read_b64_tr_b16 a[192:193], v87 offset:0
v_cvt_pk_bf16_f32 v51, v70, v71
M v[76:79], a[160:163], v[132:135], v[76:79]
ds_read_b64_tr_b16 a[194:195], v87 offset:2048
M v[76:79], a[164:167], v[172:175], v[76:79]
ds_read_b64_tr_b16 a[196:197], v87 offset:4096
M v[76:79], a[168:171], v[212:215], v[76:79]
buffer_store_dwordx4 v[40:43], v85, s[24:27], s76 offen offset:0 sc1
M v[76:79], a[172:175], v[252:255], v[76:79]
s_waitcnt lgkmcnt(9)
ds_read_b64_tr_b16 a[198:199], v87 offset:6144
v_cvt_pk_bf16_f32 v54, v72, v73
M v[0:3], a[176:179], a[80:83], 0
s_waitcnt lgkmcnt(8)
ds_read_b64_tr_b16 a[200:201], v87 offset:8192
v_cvt_pk_bf16_f32 v55, v74, v75
M v[0:3], a[180:183], a[100:103], v[0:3]
s_waitcnt lgkmcnt(7)
ds_read_b64_tr_b16 a[202:203], v87 offset:10240
v_cvt_pk_bf16_f32 v58, v76, v77
M v[0:3], a[184:187], a[120:123], v[0:3]
s_waitcnt lgkmcnt(6)
buffer_load_dwordx4 v84, s[20:23], s48 offen lds
M v[0:3], a[188:191], a[140:143], v[0:3]
s_add_u32 m0, s39, 134144
ds_read_b64_tr_b16 a[204:205], v87 offset:12288
v_cvt_pk_bf16_f32 v59, v78, v79
M v[4:7], a[176:179], a[84:87], 0
s_add_u32 s44, s70, 49152
ds_read_b64_tr_b16 a[206:207], v87 offset:14336
M v[4:7], a[180:183], a[104:107], v[4:7]
ds_read_b64_tr_b16 a[160:161], v88 offset:0
M v[4:7], a[184:187], a[124:127], v[4:7]
buffer_store_dwordx4 v[44:47], v85, s[24:27], s76 offen offset:1024 sc1
M v[4:7], a[188:191], a[144:147], v[4:7]
s_add_u32 s45, s70, 57344
ds_read_b64_tr_b16 a[162:163], v88 offset:2048
M v[8:11], a[176:179], a[88:91], 0
ds_read_b64_tr_b16 a[164:165], v88 offset:4096
M v[8:11], a[180:183], a[108:111], v[8:11]
ds_read_b64_tr_b16 a[166:167], v88 offset:6144
M v[8:11], a[184:187], a[128:131], v[8:11]
buffer_load_dwordx4 v84, s[20:23], s49 offen lds
M v[8:11], a[188:191], a[148:151], v[8:11]
s_add_u32 m0, s39, 135168
ds_read_b64_tr_b16 a[168:169], v88 offset:8192
M v[12:15], a[176:179], a[92:95], 0
ds_read_b64_tr_b16 a[170:171], v88 offset:10240
M v[12:15], a[180:183], a[112:115], v[12:15]
ds_read_b64_tr_b16 a[172:173], v88 offset:12288
M v[12:15], a[184:187], a[132:135], v[12:15]
buffer_store_dwordx4 v[48:51], v85, s[24:27], s76 offen offset:2048 sc1
M v[12:15], a[188:191], a[152:155], v[12:15]
ds_read_b64_tr_b16 a[174:175], v88 offset:14336
M v[16:19], a[176:179], a[96:99], 0
ds_read_b64_tr_b16 a[176:177], v89 offset:0
M v[16:19], a[180:183], a[116:119], v[16:19]
ds_read_b64_tr_b16 a[178:179], v89 offset:2048
M v[16:19], a[184:187], a[136:139], v[16:19]
buffer_load_dwordx4 v84, s[20:23], s50 offen lds
M v[16:19], a[188:191], a[156:159], v[16:19]
s_waitcnt lgkmcnt(15)
ds_read_b64_tr_b16 a[180:181], v89 offset:4096
M v[20:23], a[192:195], a[80:83], 0
s_waitcnt lgkmcnt(15)
ds_read_b64_tr_b16 a[182:183], v89 offset:6144
M v[20:23], a[196:199], a[100:103], v[20:23]
s_waitcnt lgkmcnt(14)
buffer_store_dwordx4 v[52:55], v85, s[24:27], s76 offen offset:3072 sc1
M v[20:23], a[200:203], a[120:123], v[20:23]
s_waitcnt lgkmcnt(12)
ds_read_b64_tr_b16 a[184:185], v89 offset:8192
M v[20:23], a[204:207], a[140:143], v[20:23]
s_add_u32 m0, s39, 136192
ds_read_b64_tr_b16 a[186:187], v89 offset:10240
M v[24:27], a[192:195], a[84:87], 0
ds_read_b64_tr_b16 a[188:189], v89 offset:12288
M v[24:27], a[196:199], a[104:107], v[24:27]
buffer_load_dwordx4 v84, s[20:23], s51 offen lds
M v[24:27], a[200:203], a[124:127], v[24:27]
s_add_u32 m0, s39, 137216
ds_read_b64_tr_b16 a[190:191], v89 offset:14336
M v[24:27], a[204:207], a[144:147], v[24:27]
M v[28:31], a[192:195], a[88:91], 0
M v[28:31], a[196:199], a[108:111], v[28:31]
buffer_store_dwordx4 v[56:59], v92, s[24:27], s76 offen offset:0 sc1
M v[28:31], a[200:203], a[128:131], v[28:31]
M v[28:31], a[204:207], a[148:151], v[28:31]
s_add_u32 s46, s70, 262144
M v[32:35], a[192:195], a[92:95], 0
M v[32:35], a[196:199], a[112:115], v[32:35]
buffer_load_dwordx4 v84, s[20:23], s44 offen lds
M v[32:35], a[200:203], a[132:135], v[32:35]
s_add_u32 m0, s39, 138240
M v[32:35], a[204:207], a[152:155], v[32:35]
M v[36:39], a[192:195], a[96:99], 0
M v[36:39], a[196:199], a[116:119], v[36:39]
M v[36:39], a[200:203], a[136:139], v[36:39]
M v[36:39], a[204:207], a[156:159], v[36:39]
s_waitcnt lgkmcnt(14)
M v[0:3], a[160:163], a[0:3], v[0:3]
s_waitcnt lgkmcnt(12)
buffer_load_dwordx4 v84, s[20:23], s45 offen lds
M v[0:3], a[164:167], a[20:23], v[0:3]
s_waitcnt lgkmcnt(10)
M v[0:3], a[168:171], a[40:43], v[0:3]
s_waitcnt lgkmcnt(8)
M v[0:3], a[172:175], a[60:63], v[0:3]
M v[4:7], a[160:163], a[4:7], v[4:7]
M v[4:7], a[164:167], a[24:27], v[4:7]
M v[4:7], a[168:171], a[44:47], v[4:7]
M v[4:7], a[172:175], a[64:67], v[4:7]
M v[8:11], a[160:163], a[8:11], v[8:11]
M v[8:11], a[164:167], a[28:31], v[8:11]
M v[8:11], a[168:171], a[48:51], v[8:11]
M v[8:11], a[172:175], a[68:71], v[8:11]
M v[12:15], a[160:163], a[12:15], v[12:15]
M v[12:15], a[164:167], a[32:35], v[12:15]
M v[12:15], a[168:171], a[52:55], v[12:15]
M v[12:15], a[172:175], a[72:75], v[12:15]
M v[16:19], a[160:163], a[16:19], v[16:19]
M v[16:19], a[164:167], a[36:39], v[16:19]
M v[16:19], a[168:171], a[56:59], v[16:19]
M v[16:19], a[172:175], a[76:79], v[16:19]
s_waitcnt lgkmcnt(6)
M v[20:23], a[176:179], a[0:3], v[20:23]
s_waitcnt lgkmcnt(4)
M v[20:23], a[180:183], a[20:23], v[20:23]
s_waitcnt lgkmcnt(2)
M v[20:23], a[184:187], a[40:43], v[20:23]
s_waitcnt lgkmcnt(0)
M v[20:23], a[188:191], a[60:63], v[20:23]
s_waitcnt vmcnt(14)
M v[24:27], a[176:179], a[4:7], v[24:27]
s_barrier
ds_read_b64_tr_b16 a[192:193], v86 offset:32768
M v[24:27], a[180:183], a[24:27], v[24:27]
s_add_u32 m0, s39, 65536
ds_read_b64_tr_b16 a[194:195], v86 offset:34816
M v[24:27], a[184:187], a[44:47], v[24:27]
s_add_u32 s47, s70, 270336
ds_read_b64_tr_b16 a[196:197], v86 offset:36864
M v[24:27], a[188:191], a[64:67], v[24:27]
s_add_u32 s48, s70, 278528
ds_read_b64_tr_b16 a[198:199], v86 offset:38912
M v[28:31], a[176:179], a[8:11], v[28:31]
s_add_u32 s49, s70, 286720
ds_read_b64_tr_b16 a[200:201], v86 offset:40960
v_cmp_ne_u32 s[56:57], 0, v91
M v[28:31], a[180:183], a[28:31], v[28:31]
s_add_u32 s50, s70, 294912
buffer_load_dwordx4 v84, s[20:23], s46 offen lds
M v[28:31], a[184:187], a[48:51], v[28:31]
s_or_b32 s60, s56, s59
ds_read_b64_tr_b16 a[202:203], v86 offset:43008
M v[28:31], a[188:191], a[68:71], v[28:31]
s_add_u32 m0, s39, 66560
ds_read_b64_tr_b16 a[204:205], v86 offset:45056
M v[32:35], a[176:179], a[12:15], v[32:35]
s_add_u32 s51, s70, 303104
ds_read_b64_tr_b16 a[206:207], v86 offset:47104
v_add_u32 v86, 65536, v86
M v[32:35], a[180:183], a[32:35], v[32:35]
buffer_load_dwordx4 a[208:211], v85, s[24:27], s32 offen offset:0 sc1
M v[32:35], a[184:187], a[52:55], v[32:35]
ds_read_b64_tr_b16 a[160:161], v87 offset:32768
M v[32:35], a[188:191], a[72:75], v[32:35]
ds_read_b64_tr_b16 a[162:163], v87 offset:34816
M v[36:39], a[176:179], a[16:19], v[36:39]
ds_read_b64_tr_b16 a[164:165], v87 offset:36864
M v[36:39], a[180:183], a[36:39], v[36:39]
buffer_load_dwordx4 v84, s[20:23], s47 offen lds
M v[36:39], a[184:187], a[56:59], v[36:39]
s_add_u32 m0, s39, 67584
ds_read_b64_tr_b16 a[166:167], v87 offset:38912
M v[36:39], a[188:191], a[76:79], v[36:39]
s_waitcnt lgkmcnt(10)
ds_read_b64_tr_b16 a[168:169], v87 offset:40960
M v[0:3], a[192:195], v[96:99], v[0:3]
s_waitcnt lgkmcnt(9)
buffer_load_dwordx4 v84, s[20:23], s48 offen lds
M v[0:3], a[196:199], v[136:139], v[0:3]
s_waitcnt lgkmcnt(7)
ds_read_b64_tr_b16 a[170:171], v87 offset:43008
M v[0:3], a[200:203], v[176:179], v[0:3]
s_waitcnt lgkmcnt(6)
ds_read_b64_tr_b16 a[172:173], v87 offset:45056
M v[0:3], a[204:207], v[216:219], v[0:3]
s_add_u32 m0, s39, 68608
ds_read_b64_tr_b16 a[174:175], v87 offset:47104
v_add_u32 v87, 65536, v87
M v[4:7], a[192:195], v[100:103], v[4:7]
s_add_u32 s44, s70, 311296
ds_read_b64_tr_b16 a[176:177], v88 offset:32768
M v[4:7], a[196:199], v[140:143], v[4:7]
ds_read_b64_tr_b16 a[178:179], v88 offset:34816
M v[4:7], a[200:203], v[180:183], v[4:7]
ds_read_b64_tr_b16 a[180:181], v88 offset:36864
M v[4:7], a[204:207], v[220:223], v[4:7]
s_add_u32 s45, s70, 319488
ds_read_b64_tr_b16 a[182:183], v88 offset:38912
M v[8:11], a[192:195], v[104:107], v[8:11]
buffer_load_dwordx4 v84, s[20:23], s49 offen lds
M v[8:11], a[196:199], v[144:147], v[8:11]
s_add_u32 m0, s39, 69632
ds_read_b64_tr_b16 a[184:185], v88 offset:40960
M v[8:11], a[200:203], v[184:187], v[8:11]
ds_read_b64_tr_b16 a[186:187], v88 offset:43008
M v[8:11], a[204:207], v[224:227], v[8:11]
ds_read_b64_tr_b16 a[188:189], v88 offset:45056
M v[12:15], a[192:195], v[108:111], v[12:15]
ds_read_b64_tr_b16 a[190:191], v88 offset:47104
v_add_u32 v88, 65536, v88
M v[12:15], a[196:199], v[148:151], v[12:15]
buffer_load_dwordx4 a[212:215], v85, s[24:27], s32 offen offset:1024 sc1
M v[12:15], a[200:203], v[188:191], v[12:15]
M v[12:15], a[204:207], v[228:231], v[12:15]
M v[16:19], a[192:195], v[112:115], v[16:19]
ds_read_b64_tr_b16 a[192:193], v89 offset:32768
M v[16:19], a[196:199], v[152:155], v[16:19]
buffer_load_dwordx4 v84, s[20:23], s50 offen lds
M v[16:19], a[200:203], v[192:195], v[16:19]
s_add_u32 m0, s39, 70656
ds_read_b64_tr_b16 a[194:195], v89 offset:34816
M v[16:19], a[204:207], v[232:235], v[16:19]
s_waitcnt lgkmcnt(15)
ds_read_b64_tr_b16 a[196:197], v89 offset:36864
M v[20:23], a[160:163], v[96:99], v[20:23]
s_waitcnt lgkmcnt(15)
ds_read_b64_tr_b16 a[198:199], v89 offset:38912
M v[20:23], a[164:167], v[136:139], v[20:23]
s_waitcnt lgkmcnt(14)
ds_read_b64_tr_b16 a[200:201], v89 offset:40960
M v[20:23], a[168:171], v[176:179], v[20:23]
s_waitcnt lgkmcnt(13)
ds_read_b64_tr_b16 a[202:203], v89 offset:43008
M v[20:23], a[172:175], v[216:219], v[20:23]
ds_read_b64_tr_b16 a[204:205], v89 offset:45056
M v[24:27], a[160:163], v[100:103], v[24:27]
buffer_load_dwordx4 v84, s[20:23], s51 offen lds
M v[24:27], a[164:167], v[140:143], v[24:27]
s_add_u32 m0, s39, 71680
ds_read_b64_tr_b16 a[206:207], v89 offset:47104
v_add_u32 v89, 65536, v89
M v[24:27], a[168:171], v[180:183], v[24:27]
M v[24:27], a[172:175], v[220:223], v[24:27]
M v[28:31], a[160:163], v[104:107], v[28:31]
M v[28:31], a[164:167], v[144:147], v[28:31]
s_sub_u32 s63, s68, s35
M v[28:31], a[168:171], v[184:187], v[28:31]
M v[28:31], a[172:175], v[224:227], v[28:31]
s_add_u32 s46, s71, 0
M v[32:35], a[160:163], v[108:111], v[32:35]
buffer_load_dwordx4 v84, s[20:23], s44 offen lds
M v[32:35], a[164:167], v[148:151], v[32:35]
s_add_u32 m0, s39, 72704
M v[32:35], a[168:171], v[188:191], v[32:35]
M v[32:35], a[172:175], v[228:231], v[32:35]
M v[36:39], a[160:163], v[112:115], v[36:39]
buffer_load_dwordx4 a[216:219], v85, s[24:27], s32 offen offset:2048 sc1
M v[36:39], a[164:167], v[152:155], v[36:39]
M v[36:39], a[168:171], v[192:195], v[36:39]
M v[36:39], a[172:175], v[232:235], v[36:39]
s_waitcnt lgkmcnt(14)
M v[0:3], a[176:179], v[116:119], v[0:3]
s_waitcnt lgkmcnt(12)
buffer_load_dwordx4 v84, s[20:23], s45 offen lds
M v[0:3], a[180:183], v[156:159], v[0:3]
s_waitcnt lgkmcnt(10)
M v[0:3], a[184:187], v[196:199], v[0:3]
s_waitcnt lgkmcnt(8)
M v[0:3], a[188:191], v[236:239], v[0:3]
M v[4:7], a[176:179], v[120:123], v[4:7]
M v[4:7], a[180:183], v[160:163], v[4:7]
M v[4:7], a[184:187], v[200:203], v[4:7]
M v[4:7], a[188:191], v[240:243], v[4:7]
M v[8:11], a[176:179], v[124:127], v[8:11]
M v[8:11], a[180:183], v[164:167], v[8:11]
M v[8:11], a[184:187], v[204:207], v[8:11]
M v[8:11], a[188:191], v[244:247], v[8:11]
v_cvt_pk_bf16_f32 v0, v0, v1
v_cvt_pk_bf16_f32 v1, v2, v3
M v[12:15], a[176:179], v[128:131], v[12:15]
M v[12:15], a[180:183], v[168:171], v[12:15]
v_cvt_pk_bf16_f32 v4, v4, v5
v_cvt_pk_bf16_f32 v5, v6, v7
M v[12:15], a[184:187], v[208:211], v[12:15]
M v[12:15], a[188:191], v[248:251], v[12:15]
v_cvt_pk_bf16_f32 v8, v8, v9
v_cvt_pk_bf16_f32 v9, v10, v11
M v[16:19], a[176:179], v[132:135], v[16:19]
M v[16:19], a[180:183], v[172:175], v[16:19]
buffer_load_dwordx4 a[220:223], v85, s[24:27], s32 offen offset:3072 sc1
M v[16:19], a[184:187], v[212:215], v[16:19]
M v[16:19], a[188:191], v[252:255], v[16:19]
s_waitcnt lgkmcnt(6)
v_cvt_pk_bf16_f32 v12, v12, v13
v_cvt_pk_bf16_f32 v13, v14, v15
M v[20:23], a[192:195], v[116:119], v[20:23]
s_waitcnt lgkmcnt(4)
M v[20:23], a[196:199], v[156:159], v[20:23]
s_waitcnt lgkmcnt(2)
M v[20:23], a[200:203], v[196:199], v[20:23]
s_waitcnt lgkmcnt(0)
v_cvt_pk_bf16_f32 v16, v16, v17
v_cvt_pk_bf16_f32 v17, v18, v19
M v[20:23], a[204:207], v[236:239], v[20:23]
s_waitcnt vmcnt(12)
M v[24:27], a[192:195], v[120:123], v[24:27]
s_barrier
ds_read_b64_tr_b16 a[160:161], v86 offset:0
M v[24:27], a[196:199], v[160:163], v[24:27]
s_add_u32 m0, s39, 98304
buffer_load_dword v91, v90, s[24:27], 0 offen sc1
M v[24:27], a[200:203], v[200:203], v[24:27]
s_add_u32 s47, s71, 8192
ds_read_b64_tr_b16 a[162:163], v86 offset:2048
v_cvt_pk_bf16_f32 v2, v20, v21
M v[24:27], a[204:207], v[240:243], v[24:27]
s_add_u32 s48, s71, 16384
ds_read_b64_tr_b16 a[164:165], v86 offset:4096
v_cvt_pk_bf16_f32 v3, v22, v23
M v[28:31], a[192:195], v[124:127], v[28:31]
s_add_u32 s49, s71, 24576
buffer_store_dword v81, v80, s[24:27], s63 offen sc1
M v[28:31], a[196:199], v[164:167], v[28:31]
s_add_u32 s50, s71, 32768
ds_read_b64_tr_b16 a[166:167], v86 offset:6144
v_cvt_pk_bf16_f32 v6, v24, v25
M v[28:31], a[200:203], v[204:207], v[28:31]
ds_read_b64_tr_b16 a[168:169], v86 offset:8192
v_cvt_pk_bf16_f32 v7, v26, v27
M v[28:31], a[204:207], v[244:247], v[28:31]
s_add_u32 s51, s71, 40960
buffer_load_dwordx4 v84, s[20:23], s46 offen lds
M v[32:35], a[192:195], v[128:131], v[32:35]
s_add_u32 m0, s39, 99328
ds_read_b64_tr_b16 a[170:171], v86 offset:10240
ds_read_b64_tr_b16 a[172:173], v86 offset:12288
M v[32:35], a[196:199], v[168:171], v[32:35]
ds_read_b64_tr_b16 a[174:175], v86 offset:14336
v_cvt_pk_bf16_f32 v10, v28, v29
M v[32:35], a[200:203], v[208:211], v[32:35]
ds_read_b64_tr_b16 a[176:177], v87 offset:0
v_cvt_pk_bf16_f32 v11, v30, v31
M v[32:35], a[204:207], v[248:251], v[32:35]
ds_read_b64_tr_b16 a[178:179], v87 offset:2048
v_subrev_u32 v86, 65536, v86
M v[36:39], a[192:195], v[132:135], v[36:39]
buffer_load_dwordx4 v84, s[20:23], s47 offen lds
M v[36:39], a[196:199], v[172:175], v[36:39]
s_add_u32 m0, s39, 100352
ds_read_b64_tr_b16 a[180:181], v87 offset:4096
M v[36:39], a[200:203], v[212:215], v[36:39]
ds_read_b64_tr_b16 a[182:183], v87 offset:6144
v_cvt_pk_bf16_f32 v14, v32, v33
M v[36:39], a[204:207], v[252:255], v[36:39]
s_waitcnt lgkmcnt(10)
ds_read_b64_tr_b16 a[184:185], v87 offset:8192
v_cvt_pk_bf16_f32 v15, v34, v35
M v[40:43], a[160:163], a[80:83], 0
s_waitcnt lgkmcnt(9)
buffer_load_dwordx4 a[224:227], v92, s[24:27], s32 offen offset:0 sc1
M v[40:43], a[164:167], a[100:103], v[40:43]
s_waitcnt lgkmcnt(7)
ds_read_b64_tr_b16 a[186:187], v87 offset:10240
v_cvt_pk_bf16_f32 v18, v36, v37
M v[40:43], a[168:171], a[120:123], v[40:43]
s_waitcnt lgkmcnt(6)
ds_read_b64_tr_b16 a[188:189], v87 offset:12288
v_cvt_pk_bf16_f32 v19, v38, v39
M v[40:43], a[172:175], a[140:143], v[40:43]
s_add_u32 s44, s71, 49152
ds_read_b64_tr_b16 a[190:191], v87 offset:14336
v_subrev_u32 v87, 65536, v87
M v[44:47], a[160:163], a[84:87], 0
buffer_store_dwordx4 v[0:3], v85, s[24:27], s77 offen offset:0 sc1
M v[44:47], a[164:167], a[104:107], v[44:47]
ds_read_b64_tr_b16 a[192:193], v88 offset:0
M v[44:47], a[168:171], a[124:127], v[44:47]
ds_read_b64_tr_b16 a[194:195], v88 offset:2048
M v[44:47], a[172:175], a[144:147], v[44:47]
s_add_u32 s45, s71, 57344
buffer_load_dwordx4 v84, s[20:23], s48 offen lds
M v[48:51], a[160:163], a[88:91], 0
s_add_u32 m0, s39, 101376
ds_read_b64_tr_b16 a[196:197], v88 offset:4096
M v[48:51], a[164:167], a[108:111], v[48:51]
ds_read_b64_tr_b16 a[198:199], v88 offset:6144
M v[48:51], a[168:171], a[128:131], v[48:51]
ds_read_b64_tr_b16 a[200:201], v88 offset:8192
M v[48:51], a[172:175], a[148:151], v[48:51]
ds_read_b64_tr_b16 a[202:203], v88 offset:10240
M v[52:55], a[160:163], a[92:95], 0
buffer_store_dwordx4 v[4:7], v85, s[24:27], s77 offen offset:1024 sc1
M v[52:55], a[164:167], a[112:115], v[52:55]
ds_read_b64_tr_b16 a[204:205], v88 offset:12288
M v[52:55], a[168:171], a[132:135], v[52:55]
ds_read_b64_tr_b16 a[206:207], v88 offset:14336
v_subrev_u32 v88, 65536, v88
M v[52:55], a[172:175], a[152:155], v[52:55]
buffer_load_dwordx4 v84, s[20:23], s49 offen lds
M v[56:59], a[160:163], a[96:99], 0
s_add_u32 m0, s39, 102400
ds_read_b64_tr_b16 a[160:161], v89 offset:0
M v[56:59], a[164:167], a[116:119], v[56:59]
ds_read_b64_tr_b16 a[162:163], v89 offset:2048
M v[56:59], a[168:171], a[136:139], v[56:59]
ds_read_b64_tr_b16 a[164:165], v89 offset:4096
M v[56:59], a[172:175], a[156:159], v[56:59]
s_waitcnt lgkmcnt(15)
buffer_store_dwordx4 v[8:11], v85, s[24:27], s77 offen offset:2048 sc1
M v[60:63], a[176:179], a[80:83], 0
s_waitcnt lgkmcnt(15)
ds_read_b64_tr_b16 a[166:167], v89 offset:6144
M v[60:63], a[180:183], a[100:103], v[60:63]
s_waitcnt lgkmcnt(14)
ds_read_b64_tr_b16 a[168:169], v89 offset:8192
M v[60:63], a[184:187], a[120:123], v[60:63]
s_waitcnt lgkmcnt(13)
ds_read_b64_tr_b16 a[170:171], v89 offset:10240
M v[60:63], a[188:191], a[140:143], v[60:63]
buffer_load_dwordx4 v84, s[20:23], s50 offen lds
M v[64:67], a[176:179], a[84:87], 0
s_add_u32 m0, s39, 103424
buffer_load_dwordx4 a[228:231], v85, s[24:27], s33 offen offset:0 sc1
M v[64:67], a[180:183], a[104:107], v[64:67]
ds_read_b64_tr_b16 a[172:173], v89 offset:12288
M v[64:67], a[184:187], a[124:127], v[64:67]
ds_read_b64_tr_b16 a[174:175], v89 offset:14336
v_subrev_u32 v89, 65536, v89
M v[64:67], a[188:191], a[144:147], v[64:67]
M v[68:71], a[176:179], a[88:91], 0
M v[68:71], a[180:183], a[108:111], v[68:71]
buffer_store_dwordx4 v[12:15], v85, s[24:27], s77 offen offset:3072 sc1
M v[68:71], a[184:187], a[128:131], v[68:71]
M v[68:71], a[188:191], a[148:151], v[68:71]
s_add_u32 s46, s71, 262144
buffer_load_dwordx4 v84, s[20:23], s51 offen lds
M v[72:75], a[176:179], a[92:95], 0
s_add_u32 m0, s39, 104448
M v[72:75], a[180:183], a[112:115], v[72:75]
M v[72:75], a[184:187], a[132:135], v[72:75]
M v[72:75], a[188:191], a[152:155], v[72:75]
M v[76:79], a[176:179], a[96:99], 0
M v[76:79], a[180:183], a[116:119], v[76:79]
buffer_store_dwordx4 v[16:19], v92, s[24:27], s77 offen offset:0 sc1
M v[76:79], a[184:187], a[136:139], v[76:79]
M v[76:79], a[188:191], a[156:159], v[76:79]
L_hop_c7:
s_cbranch_execz L_ret_c7
s_waitcnt lgkmcnt(14)
buffer_load_dwordx4 v84, s[20:23], s44 offen lds
M v[40:43], a[192:195], a[0:3], v[40:43]
s_waitcnt lgkmcnt(12)
M v[40:43], a[196:199], a[20:23], v[40:43]
s_waitcnt lgkmcnt(10)
M v[40:43], a[200:203], a[40:43], v[40:43]
s_waitcnt lgkmcnt(8)
M v[40:43], a[204:207], a[60:63], v[40:43]
s_add_u32 m0, s39, 105472
M v[44:47], a[192:195], a[4:7], v[44:47]
M v[44:47], a[196:199], a[24:27], v[44:47]
M v[44:47], a[200:203], a[44:47], v[44:47]
buffer_load_dwordx4 a[232:235], v85, s[24:27], s33 offen offset:1024 sc1
M v[44:47], a[204:207], a[64:67], v[44:47]
buffer_load_dwordx4 v84, s[20:23], s45 offen lds
M v[48:51], a[192:195], a[8:11], v[48:51]
M v[48:51], a[196:199], a[28:31], v[48:51]
M v[48:51], a[200:203], a[48:51], v[48:51]
M v[48:51], a[204:207], a[68:71], v[48:51]
M v[52:55], a[192:195], a[12:15], v[52:55]
M v[52:55], a[196:199], a[32:35], v[52:55]
M v[52:55], a[200:203], a[52:55], v[52:55]
M v[52:55], a[204:207], a[72:75], v[52:55]
M v[56:59], a[192:195], a[16:19], v[56:59]
M v[56:59], a[196:199], a[36:39], v[56:59]
M v[56:59], a[200:203], a[56:59], v[56:59]
M v[56:59], a[204:207], a[76:79], v[56:59]
s_waitcnt lgkmcnt(6)
M v[60:63], a[160:163], a[0:3], v[60:63]
s_waitcnt lgkmcnt(4)
M v[60:63], a[164:167], a[20:23], v[60:63]
s_waitcnt lgkmcnt(2)
M v[60:63], a[168:171], a[40:43], v[60:63]
s_waitcnt lgkmcnt(0)
M v[60:63], a[172:175], a[60:63], v[60:63]
s_waitcnt vmcnt(19)
M v[64:67], a[160:163], a[4:7], v[64:67]
s_barrier
ds_read_b64_tr_b16 a[176:177], v86 offset:0
M v[64:67], a[164:167], a[24:27], v[64:67]
s_add_u32 m0, s39, 131072
ds_read_b64_tr_b16 a[178:179], v86 offset:2048
M v[64:67], a[168:171], a[44:47], v[64:67]
s_add_u32 s47, s71, 270336
ds_read_b64_tr_b16 a[180:181], v86 offset:4096
M v[64:67], a[172:175], a[64:67], v[64:67]
s_add_u32 s48, s71, 278528
buffer_load_dwordx4 a[236:239], v85, s[24:27], s33 offen offset:2048 sc1
M v[68:71], a[160:163], a[8:11], v[68:71]
s_add_u32 s49, s71, 286720
ds_read_b64_tr_b16 a[182:183], v86 offset:6144
M v[68:71], a[164:167], a[28:31], v[68:71]
s_add_u32 s50, s71, 294912
ds_read_b64_tr_b16 a[184:185], v86 offset:8192
M v[68:71], a[168:171], a[48:51], v[68:71]
ds_read_b64_tr_b16 a[186:187], v86 offset:10240
M v[68:71], a[172:175], a[68:71], v[68:71]
s_add_u32 s51, s71, 303104
buffer_load_dwordx4 v84, s[20:23], s46 offen lds
M v[72:75], a[160:163], a[12:15], v[72:75]
s_add_u32 m0, s39, 132096
ds_read_b64_tr_b16 a[188:189], v86 offset:12288
M v[72:75], a[164:167], a[32:35], v[72:75]
ds_read_b64_tr_b16 a[190:191], v86 offset:14336
M v[72:75], a[168:171], a[52:55], v[72:75]
ds_read_b64_tr_b16 a[192:193], v87 offset:0
M v[72:75], a[172:175], a[72:75], v[72:75]
buffer_load_dwordx4 v84, s[20:23], s47 offen lds
M v[76:79], a[160:163], a[16:19], v[76:79]
s_add_u32 m0, s39, 133120
ds_read_b64_tr_b16 a[194:195], v87 offset:2048
M v[76:79], a[164:167], a[36:39], v[76:79]
ds_read_b64_tr_b16 a[196:197], v87 offset:4096
M v[76:79], a[168:171], a[56:59], v[76:79]
ds_read_b64_tr_b16 a[198:199], v87 offset:6144
M v[76:79], a[172:175], a[76:79], v[76:79]
s_waitcnt lgkmcnt(10)
ds_read_b64_tr_b16 a[200:201], v87 offset:8192
M v[40:43], a[176:179], v[96:99], v[40:43]
s_waitcnt lgkmcnt(9)
buffer_load_dwordx4 v84, s[20:23], s48 offen lds
M v[40:43], a[180:183], v[136:139], v[40:43]
s_waitcnt lgkmcnt(7)
ds_read_b64_tr_b16 a[202:203], v87 offset:10240
M v[40:43], a[184:187], v[176:179], v[40:43]
s_waitcnt lgkmcnt(6)
ds_read_b64_tr_b16 a[204:205], v87 offset:12288
M v[40:43], a[188:191], v[216:219], v[40:43]
s_add_u32 m0, s39, 134144
ds_read_b64_tr_b16 a[206:207], v87 offset:14336
M v[44:47], a[176:179], v[100:103], v[44:47]
s_add_u32 s44, s71, 311296
ds_read_b64_tr_b16 a[160:161], v88 offset:0
M v[44:47], a[180:183], v[140:143], v[44:47]
ds_read_b64_tr_b16 a[162:163], v88 offset:2048
M v[44:47], a[184:187], v[180:183], v[44:47]
ds_read_b64_tr_b16 a[164:165], v88 offset:4096
M v[44:47], a[188:191], v[220:223], v[44:47]
s_add_u32 s45, s71, 319488
buffer_load_dwordx4 a[240:243], v85, s[24:27], s33 offen offset:3072 sc1
M v[48:51], a[176:179], v[104:107], v[48:51]
ds_read_b64_tr_b16 a[166:167], v88 offset:6144
M v[48:51], a[180:183], v[144:147], v[48:51]
ds_read_b64_tr_b16 a[168:169], v88 offset:8192
M v[48:51], a[184:187], v[184:187], v[48:51]
ds_read_b64_tr_b16 a[170:171], v88 offset:10240
M v[48:51], a[188:191], v[224:227], v[48:51]
buffer_load_dwordx4 v84, s[20:23], s49 offen lds
M v[52:55], a[176:179], v[108:111], v[52:55]
s_add_u32 m0, s39, 135168
ds_read_b64_tr_b16 a[172:173], v88 offset:12288
M v[52:55], a[180:183], v[148:151], v[52:55]
ds_read_b64_tr_b16 a[174:175], v88 offset:14336
M v[52:55], a[184:187], v[188:191], v[52:55]
M v[52:55], a[188:191], v[228:231], v[52:55]
M v[56:59], a[176:179], v[112:115], v[56:59]
buffer_load_dwordx4 v84, s[20:23], s50 offen lds
M v[56:59], a[180:183], v[152:155], v[56:59]
s_add_u32 m0, s39, 136192
ds_read_b64_tr_b16 a[176:177], v89 offset:0
M v[56:59], a[184:187], v[192:195], v[56:59]
ds_read_b64_tr_b16 a[178:179], v89 offset:2048
M v[56:59], a[188:191], v[232:235], v[56:59]
s_waitcnt lgkmcnt(15)
ds_read_b64_tr_b16 a[180:181], v89 offset:4096
M v[60:63], a[192:195], v[96:99], v[60:63]
s_waitcnt lgkmcnt(15)
ds_read_b64_tr_b16 a[182:183], v89 offset:6144
M v[60:63], a[196:199], v[136:139], v[60:63]
s_waitcnt lgkmcnt(14)
ds_read_b64_tr_b16 a[184:185], v89 offset:8192
M v[60:63], a[200:203], v[176:179], v[60:63]
s_waitcnt lgkmcnt(13)
ds_read_b64_tr_b16 a[186:187], v89 offset:10240
M v[60:63], a[204:207], v[216:219], v[60:63]
ds_read_b64_tr_b16 a[188:189], v89 offset:12288
M v[64:67], a[192:195], v[100:103], v[64:67]
buffer_load_dwordx4 v84, s[20:23], s51 offen lds
M v[64:67], a[196:199], v[140:143], v[64:67]
s_add_u32 m0, s39, 137216
ds_read_b64_tr_b16 a[190:191], v89 offset:14336
M v[64:67], a[200:203], v[180:183], v[64:67]
M v[64:67], a[204:207], v[220:223], v[64:67]
M v[68:71], a[192:195], v[104:107], v[68:71]
M v[68:71], a[196:199], v[144:147], v[68:71]
s_sub_u32 s63, s69, s35
buffer_load_dwordx4 a[244:247], v92, s[24:27], s33 offen offset:0 sc1
M v[68:71], a[200:203], v[184:187], v[68:71]
M v[68:71], a[204:207], v[224:227], v[68:71]
M v[72:75], a[192:195], v[108:111], v[72:75]
M v[72:75], a[196:199], v[148:151], v[72:75]
buffer_load_dwordx4 v84, s[20:23], s44 offen lds
M v[72:75], a[200:203], v[188:191], v[72:75]
s_add_u32 m0, s39, 138240
M v[72:75], a[204:207], v[228:231], v[72:75]
M v[76:79], a[192:195], v[112:115], v[76:79]
M v[76:79], a[196:199], v[152:155], v[76:79]
M v[76:79], a[200:203], v[192:195], v[76:79]
M v[76:79], a[204:207], v[232:235], v[76:79]
s_waitcnt lgkmcnt(14)
M v[40:43], a[160:163], v[116:119], v[40:43]
s_waitcnt lgkmcnt(12)
buffer_load_dwordx4 v84, s[20:23], s45 offen lds
M v[40:43], a[164:167], v[156:159], v[40:43]
s_waitcnt lgkmcnt(10)
M v[40:43], a[168:171], v[196:199], v[40:43]
s_waitcnt lgkmcnt(8)
M v[40:43], a[172:175], v[236:239], v[40:43]
M v[44:47], a[160:163], v[120:123], v[44:47]
M v[44:47], a[164:167], v[160:163], v[44:47]
M v[44:47], a[168:171], v[200:203], v[44:47]
M v[44:47], a[172:175], v[240:243], v[44:47]
M v[48:51], a[160:163], v[124:127], v[48:51]
M v[48:51], a[164:167], v[164:167], v[48:51]
M v[48:51], a[168:171], v[204:207], v[48:51]
M v[48:51], a[172:175], v[244:247], v[48:51]
v_cvt_pk_bf16_f32 v40, v40, v41
v_cvt_pk_bf16_f32 v41, v42, v43
M v[52:55], a[160:163], v[128:131], v[52:55]
M v[52:55], a[164:167], v[168:171], v[52:55]
v_cvt_pk_bf16_f32 v44, v44, v45
v_cvt_pk_bf16_f32 v45, v46, v47
M v[52:55], a[168:171], v[208:211], v[52:55]
M v[52:55], a[172:175], v[248:251], v[52:55]
v_cvt_pk_bf16_f32 v48, v48, v49
v_cvt_pk_bf16_f32 v49, v50, v51
M v[56:59], a[160:163], v[132:135], v[56:59]
M v[56:59], a[164:167], v[172:175], v[56:59]
M v[56:59], a[168:171], v[212:215], v[56:59]
M v[56:59], a[172:175], v[252:255], v[56:59]
s_waitcnt lgkmcnt(6)
M v[60:63], a[176:179], v[116:119], v[60:63]
s_waitcnt lgkmcnt(4)
v_cvt_pk_bf16_f32 v52, v52, v53
v_cvt_pk_bf16_f32 v53, v54, v55
M v[60:63], a[180:183], v[156:159], v[60:63]
s_waitcnt lgkmcnt(2)
M v[60:63], a[184:187], v[196:199], v[60:63]
s_waitcnt lgkmcnt(0)
v_cvt_pk_bf16_f32 v56, v56, v57
v_cvt_pk_bf16_f32 v57, v58, v59
M v[60:63], a[188:191], v[236:239], v[60:63]
s_waitcnt vmcnt(11)
M v[64:67], a[176:179], v[120:123], v[64:67]
s_barrier
ds_read_b64_tr_b16 a[192:193], v86 offset:32768
M v[64:67], a[180:183], v[160:163], v[64:67]
ds_read_b64_tr_b16 a[194:195], v86 offset:34816
M v[64:67], a[184:187], v[200:203], v[64:67]
ds_read_b64_tr_b16 a[196:197], v86 offset:36864
v_cvt_pk_bf16_f32 v42, v60, v61
M v[64:67], a[188:191], v[240:243], v[64:67]
buffer_store_dword v81, v80, s[24:27], s63 offen sc1
M v[68:71], a[176:179], v[124:127], v[68:71]
ds_read_b64_tr_b16 a[198:199], v86 offset:38912
v_cvt_pk_bf16_f32 v43, v62, v63
M v[68:71], a[180:183], v[164:167], v[68:71]
ds_read_b64_tr_b16 a[200:201], v86 offset:40960
M v[68:71], a[184:187], v[204:207], v[68:71]
ds_read_b64_tr_b16 a[202:203], v86 offset:43008
v_cvt_pk_bf16_f32 v46, v64, v65
M v[68:71], a[188:191], v[244:247], v[68:71]
ds_read_b64_tr_b16 a[204:205], v86 offset:45056
v_cvt_pk_bf16_f32 v47, v66, v67
M v[72:75], a[176:179], v[128:131], v[72:75]
ds_read_b64_tr_b16 a[206:207], v86 offset:47104
v_add_u32 v86, 65536, v86
M v[72:75], a[180:183], v[168:171], v[72:75]
buffer_store_dwordx4 v[40:43], v85, s[24:27], s78 offen offset:0 sc1
M v[72:75], a[184:187], v[208:211], v[72:75]
ds_read_b64_tr_b16 a[160:161], v87 offset:32768
v_cvt_pk_bf16_f32 v50, v68, v69
M v[72:75], a[188:191], v[248:251], v[72:75]
ds_read_b64_tr_b16 a[162:163], v87 offset:34816
v_cvt_pk_bf16_f32 v51, v70, v71
M v[76:79], a[176:179], v[132:135], v[76:79]
ds_read_b64_tr_b16 a[164:165], v87 offset:36864
M v[76:79], a[180:183], v[172:175], v[76:79]
buffer_store_dwordx4 v[44:47], v85, s[24:27], s78 offen offset:1024 sc1
M v[76:79], a[184:187], v[212:215], v[76:79]
ds_read_b64_tr_b16 a[166:167], v87 offset:38912
v_cvt_pk_bf16_f32 v54, v72, v73
M v[76:79], a[188:191], v[252:255], v[76:79]
s_waitcnt lgkmcnt(10)
ds_read_b64_tr_b16 a[168:169], v87 offset:40960
v_cvt_pk_bf16_f32 v55, v74, v75
M v[0:3], a[192:195], a[80:83], 0
s_waitcnt lgkmcnt(9)
ds_read_b64_tr_b16 a[170:171], v87 offset:43008
M v[0:3], a[196:199], a[100:103], v[0:3]
s_waitcnt lgkmcnt(8)
ds_read_b64_tr_b16 a[172:173], v87 offset:45056
v_cvt_pk_bf16_f32 v58, v76, v77
M v[0:3], a[200:203], a[120:123], v[0:3]
s_waitcnt lgkmcnt(7)
buffer_store_dwordx4 v[48:51], v85, s[24:27], s78 offen offset:2048 sc1
M v[0:3], a[204:207], a[140:143], v[0:3]
ds_read_b64_tr_b16 a[174:175], v87 offset:47104
v_cvt_pk_bf16_f32 v59, v78, v79
M v[4:7], a[192:195], a[84:87], 0
ds_read_b64_tr_b16 a[176:177], v88 offset:32768
v_add_u32 v87, 65536, v87
M v[4:7], a[196:199], a[104:107], v[4:7]
buffer_store_dwordx4 v[52:55], v85, s[24:27], s78 offen offset:3072 sc1
M v[4:7], a[200:203], a[124:127], v[4:7]
ds_read_b64_tr_b16 a[178:179], v88 offset:34816
M v[4:7], a[204:207], a[144:147], v[4:7]
ds_read_b64_tr_b16 a[180:181], v88 offset:36864
M v[8:11], a[192:195], a[88:91], 0
ds_read_b64_tr_b16 a[182:183], v88 offset:38912
M v[8:11], a[196:199], a[108:111], v[8:11]
buffer_store_dwordx4 v[56:59], v92, s[24:27], s78 offen offset:0 sc1
M v[8:11], a[200:203], a[128:131], v[8:11]
ds_read_b64_tr_b16 a[184:185], v88 offset:40960
M v[8:11], a[204:207], a[148:151], v[8:11]
ds_read_b64_tr_b16 a[186:187], v88 offset:43008
M v[12:15], a[192:195], a[92:95], 0
ds_read_b64_tr_b16 a[188:189], v88 offset:45056
M v[12:15], a[196:199], a[112:115], v[12:15]
ds_read_b64_tr_b16 a[190:191], v88 offset:47104
v_add_u32 v88, 65536, v88
M v[12:15], a[200:203], a[132:135], v[12:15]
M v[12:15], a[204:207], a[152:155], v[12:15]
M v[16:19], a[192:195], a[96:99], 0
ds_read_b64_tr_b16 a[192:193], v89 offset:32768
M v[16:19], a[196:199], a[116:119], v[16:19]
ds_read_b64_tr_b16 a[194:195], v89 offset:34816
M v[16:19], a[200:203], a[136:139], v[16:19]
ds_read_b64_tr_b16 a[196:197], v89 offset:36864
M v[16:19], a[204:207], a[156:159], v[16:19]
s_waitcnt lgkmcnt(15)
ds_read_b64_tr_b16 a[198:199], v89 offset:38912
M v[20:23], a[160:163], a[80:83], 0
s_waitcnt lgkmcnt(15)
ds_read_b64_tr_b16 a[200:201], v89 offset:40960
M v[20:23], a[164:167], a[100:103], v[20:23]
s_waitcnt lgkmcnt(15)
ds_read_b64_tr_b16 a[202:203], v89 offset:43008
M v[20:23], a[168:171], a[120:123], v[20:23]
s_waitcnt lgkmcnt(14)
ds_read_b64_tr_b16 a[204:205], v89 offset:45056
M v[20:23], a[172:175], a[140:143], v[20:23]
ds_read_b64_tr_b16 a[206:207], v89 offset:47104
v_add_u32 v89, 65536, v89
M v[24:27], a[160:163], a[84:87], 0
M v[24:27], a[164:167], a[104:107], v[24:27]
M v[24:27], a[168:171], a[124:127], v[24:27]
M v[24:27], a[172:175], a[144:147], v[24:27]
M v[28:31], a[160:163], a[88:91], 0
M v[28:31], a[164:167], a[108:111], v[28:31]
M v[28:31], a[168:171], a[128:131], v[28:31]
M v[28:31], a[172:175], a[148:151], v[28:31]
M v[32:35], a[160:163], a[92:95], 0
M v[32:35], a[164:167], a[112:115], v[32:35]
M v[32:35], a[168:171], a[132:135], v[32:35]
M v[32:35], a[172:175], a[152:155], v[32:35]
M v[36:39], a[160:163], a[96:99], 0
M v[36:39], a[164:167], a[116:119], v[36:39]
M v[36:39], a[168:171], a[136:139], v[36:39]
M v[36:39], a[172:175], a[156:159], v[36:39]
s_waitcnt lgkmcnt(14)
M v[0:3], a[176:179], a[0:3], v[0:3]
s_waitcnt lgkmcnt(12)
v_cmp_ne_u32 s[56:57], 0, v91
M v[0:3], a[180:183], a[20:23], v[0:3]
s_waitcnt lgkmcnt(10)
M v[0:3], a[184:187], a[40:43], v[0:3]
s_waitcnt lgkmcnt(8)
M v[0:3], a[188:191], a[60:63], v[0:3]
buffer_load_dwordx4 a[80:83], v85, s[24:27], s34 offen offset:0 sc1
M v[4:7], a[176:179], a[4:7], v[4:7]
M v[4:7], a[180:183], a[24:27], v[4:7]
M v[4:7], a[184:187], a[44:47], v[4:7]
M v[4:7], a[188:191], a[64:67], v[4:7]
M v[8:11], a[176:179], a[8:11], v[8:11]
M v[8:11], a[180:183], a[28:31], v[8:11]
M v[8:11], a[184:187], a[48:51], v[8:11]
M v[8:11], a[188:191], a[68:71], v[8:11]
M v[12:15], a[176:179], a[12:15], v[12:15]
M v[12:15], a[180:183], a[32:35], v[12:15]
M v[12:15], a[184:187], a[52:55], v[12:15]
buffer_load_dwordx4 a[84:87], v85, s[24:27], s34 offen offset:1024 sc1
M v[12:15], a[188:191], a[72:75], v[12:15]
M v[16:19], a[176:179], a[16:19], v[16:19]
M v[16:19], a[180:183], a[36:39], v[16:19]
M v[16:19], a[184:187], a[56:59], v[16:19]
M v[16:19], a[188:191], a[76:79], v[16:19]
s_waitcnt lgkmcnt(6)
M v[20:23], a[192:195], a[0:3], v[20:23]
s_waitcnt lgkmcnt(4)
M v[20:23], a[196:199], a[20:23], v[20:23]
s_waitcnt lgkmcnt(2)
M v[20:23], a[200:203], a[40:43], v[20:23]
s_waitcnt lgkmcnt(0)
M v[20:23], a[204:207], a[60:63], v[20:23]
s_waitcnt vmcnt(8)
M v[24:27], a[192:195], a[4:7], v[24:27]
s_barrier
ds_read_b64_tr_b16 a[160:161], v86 offset:0
M v[24:27], a[196:199], a[24:27], v[24:27]
ds_read_b64_tr_b16 a[162:163], v86 offset:2048
M v[24:27], a[200:203], a[44:47], v[24:27]
ds_read_b64_tr_b16 a[164:165], v86 offset:4096
M v[24:27], a[204:207], a[64:67], v[24:27]
buffer_load_dwordx4 a[88:91], v85, s[24:27], s34 offen offset:2048 sc1
M v[28:31], a[192:195], a[8:11], v[28:31]
ds_read_b64_tr_b16 a[166:167], v86 offset:6144
M v[28:31], a[196:199], a[28:31], v[28:31]
ds_read_b64_tr_b16 a[168:169], v86 offset:8192
M v[28:31], a[200:203], a[48:51], v[28:31]
ds_read_b64_tr_b16 a[170:171], v86 offset:10240
M v[28:31], a[204:207], a[68:71], v[28:31]
ds_read_b64_tr_b16 a[172:173], v86 offset:12288
M v[32:35], a[192:195], a[12:15], v[32:35]
ds_read_b64_tr_b16 a[174:175], v86 offset:14336
M v[32:35], a[196:199], a[32:35], v[32:35]
ds_read_b64_tr_b16 a[176:177], v87 offset:0
M v[32:35], a[200:203], a[52:55], v[32:35]
ds_read_b64_tr_b16 a[178:179], v87 offset:2048
M v[32:35], a[204:207], a[72:75], v[32:35]
ds_read_b64_tr_b16 a[180:181], v87 offset:4096
M v[36:39], a[192:195], a[16:19], v[36:39]
buffer_load_dwordx4 a[92:95], v85, s[24:27], s34 offen offset:3072 sc1
M v[36:39], a[196:199], a[36:39], v[36:39]
ds_read_b64_tr_b16 a[182:183], v87 offset:6144
M v[36:39], a[200:203], a[56:59], v[36:39]
ds_read_b64_tr_b16 a[184:185], v87 offset:8192
M v[36:39], a[204:207], a[76:79], v[36:39]
s_waitcnt lgkmcnt(11)
ds_read_b64_tr_b16 a[186:187], v87 offset:10240
M v[0:3], a[160:163], v[96:99], v[0:3]
s_waitcnt lgkmcnt(10)
ds_read_b64_tr_b16 a[188:189], v87 offset:12288
M v[0:3], a[164:167], v[136:139], v[0:3]
s_waitcnt lgkmcnt(9)
ds_read_b64_tr_b16 a[190:191], v87 offset:14336
M v[0:3], a[168:171], v[176:179], v[0:3]
s_waitcnt lgkmcnt(8)
ds_read_b64_tr_b16 a[192:193], v88 offset:0
M v[0:3], a[172:175], v[216:219], v[0:3]
ds_read_b64_tr_b16 a[194:195], v88 offset:2048
M v[4:7], a[160:163], v[100:103], v[4:7]
ds_read_b64_tr_b16 a[196:197], v88 offset:4096
M v[4:7], a[164:167], v[140:143], v[4:7]
ds_read_b64_tr_b16 a[198:199], v88 offset:6144
M v[4:7], a[168:171], v[180:183], v[4:7]
ds_read_b64_tr_b16 a[200:201], v88 offset:8192
M v[4:7], a[172:175], v[220:223], v[4:7]
buffer_load_dwordx4 a[96:99], v92, s[24:27], s34 offen offset:0 sc1
M v[8:11], a[160:163], v[104:107], v[8:11]
ds_read_b64_tr_b16 a[202:203], v88 offset:10240
M v[8:11], a[164:167], v[144:147], v[8:11]
ds_read_b64_tr_b16 a[204:205], v88 offset:12288
M v[8:11], a[168:171], v[184:187], v[8:11]
ds_read_b64_tr_b16 a[206:207], v88 offset:14336
M v[8:11], a[172:175], v[224:227], v[8:11]
M v[12:15], a[160:163], v[108:111], v[12:15]
M v[12:15], a[164:167], v[148:151], v[12:15]
M v[12:15], a[168:171], v[188:191], v[12:15]
M v[12:15], a[172:175], v[228:231], v[12:15]
s_waitcnt vmcnt(5)
M v[16:19], a[160:163], v[112:115], v[16:19]
s_barrier
ds_read_b64_tr_b16 a[160:161], v89 offset:0
M v[16:19], a[164:167], v[152:155], v[16:19]
s_sub_u32 s63, s70, s35
buffer_store_dword v81, v80, s[24:27], s63 offen sc1
M v[16:19], a[168:171], v[192:195], v[16:19]
ds_read_b64_tr_b16 a[162:163], v89 offset:2048
M v[16:19], a[172:175], v[232:235], v[16:19]
s_waitcnt lgkmcnt(15)
ds_read_b64_tr_b16 a[164:165], v89 offset:4096
M v[20:23], a[176:179], v[96:99], v[20:23]
s_waitcnt lgkmcnt(15)
buffer_load_dwordx4 a[100:103], v85, s[24:27], s36 offen offset:0 sc1
M v[20:23], a[180:183], v[136:139], v[20:23]
s_waitcnt lgkmcnt(13)
ds_read_b64_tr_b16 a[166:167], v89 offset:6144
M v[20:23], a[184:187], v[176:179], v[20:23]
s_waitcnt lgkmcnt(12)
ds_read_b64_tr_b16 a[168:169], v89 offset:8192
M v[20:23], a[188:191], v[216:219], v[20:23]
ds_read_b64_tr_b16 a[170:171], v89 offset:10240
M v[24:27], a[176:179], v[100:103], v[24:27]
ds_read_b64_tr_b16 a[172:173], v89 offset:12288
M v[24:27], a[180:183], v[140:143], v[24:27]
ds_read_b64_tr_b16 a[174:175], v89 offset:14336
M v[24:27], a[184:187], v[180:183], v[24:27]
M v[24:27], a[188:191], v[220:223], v[24:27]
M v[28:31], a[176:179], v[104:107], v[28:31]
M v[28:31], a[180:183], v[144:147], v[28:31]
buffer_load_dwordx4 a[104:107], v85, s[24:27], s36 offen offset:1024 sc1
M v[28:31], a[184:187], v[184:187], v[28:31]
M v[28:31], a[188:191], v[224:227], v[28:31]
M v[32:35], a[176:179], v[108:111], v[32:35]
M v[32:35], a[180:183], v[148:151], v[32:35]
M v[32:35], a[184:187], v[188:191], v[32:35]
M v[32:35], a[188:191], v[228:231], v[32:35]
M v[36:39], a[176:179], v[112:115], v[36:39]
M v[36:39], a[180:183], v[152:155], v[36:39]
M v[36:39], a[184:187], v[192:195], v[36:39]
M v[36:39], a[188:191], v[232:235], v[36:39]
s_waitcnt lgkmcnt(14)
M v[0:3], a[192:195], v[116:119], v[0:3]
s_waitcnt lgkmcnt(12)
buffer_load_dwordx4 a[108:111], v85, s[24:27], s36 offen offset:2048 sc1
M v[0:3], a[196:199], v[156:159], v[0:3]
s_waitcnt lgkmcnt(10)
M v[0:3], a[200:203], v[196:199], v[0:3]
s_waitcnt lgkmcnt(8)
M v[0:3], a[204:207], v[236:239], v[0:3]
M v[4:7], a[192:195], v[120:123], v[4:7]
M v[4:7], a[196:199], v[160:163], v[4:7]
M v[4:7], a[200:203], v[200:203], v[4:7]
M v[4:7], a[204:207], v[240:243], v[4:7]
M v[8:11], a[192:195], v[124:127], v[8:11]
M v[8:11], a[196:199], v[164:167], v[8:11]
M v[8:11], a[200:203], v[204:207], v[8:11]
M v[8:11], a[204:207], v[244:247], v[8:11]
buffer_load_dwordx4 a[112:115], v85, s[24:27], s36 offen offset:3072 sc1
M v[12:15], a[192:195], v[128:131], v[12:15]
M v[12:15], a[196:199], v[168:171], v[12:15]
M v[12:15], a[200:203], v[208:211], v[12:15]
M v[12:15], a[204:207], v[248:251], v[12:15]
M v[16:19], a[192:195], v[132:135], v[16:19]
M v[16:19], a[196:199], v[172:175], v[16:19]
M v[16:19], a[200:203], v[212:215], v[16:19]
M v[16:19], a[204:207], v[252:255], v[16:19]
s_waitcnt lgkmcnt(6)
M v[20:23], a[160:163], v[116:119], v[20:23]
s_waitcnt lgkmcnt(4)
M v[20:23], a[164:167], v[156:159], v[20:23]
s_waitcnt lgkmcnt(2)
M v[20:23], a[168:171], v[196:199], v[20:23]
s_waitcnt lgkmcnt(0)
buffer_load_dwordx4 a[116:119], v92, s[24:27], s36 offen offset:0 sc1
M v[20:23], a[172:175], v[236:239], v[20:23]
M v[24:27], a[160:163], v[120:123], v[24:27]
M v[24:27], a[164:167], v[160:163], v[24:27]
M v[24:27], a[168:171], v[200:203], v[24:27]
M v[24:27], a[172:175], v[240:243], v[24:27]
M v[28:31], a[160:163], v[124:127], v[28:31]
M v[28:31], a[164:167], v[164:167], v[28:31]
M v[28:31], a[168:171], v[204:207], v[28:31]
M v[28:31], a[172:175], v[244:247], v[28:31]
M v[32:35], a[160:163], v[128:131], v[32:35]
M v[32:35], a[164:167], v[168:171], v[32:35]
M v[32:35], a[168:171], v[208:211], v[32:35]
M v[32:35], a[172:175], v[248:251], v[32:35]
M v[36:39], a[160:163], v[132:135], v[36:39]
M v[36:39], a[164:167], v[172:175], v[36:39]
M v[36:39], a[168:171], v[212:215], v[36:39]
M v[36:39], a[172:175], v[252:255], v[36:39]
s_and_b32 s48, s56, s60
s_and_b32 s48, s48, s58
s_cmp_lg_u32 s48, s58
s_cbranch_scc1 L_redo
s_mov_b32 s50, 0x3f80
s_mov_b32 s51, 0x3f800000
buffer_load_dword v91, v90, s[24:27], 0 offen sc1
s_waitcnt vmcnt(1)
v_accvgpr_read_b32 v216, a208
v_accvgpr_read_b32 v217, a209
v_accvgpr_read_b32 v218, a210
v_accvgpr_read_b32 v219, a211
v_accvgpr_read_b32 v220, a212
v_accvgpr_read_b32 v221, a213
v_accvgpr_read_b32 v222, a214
v_accvgpr_read_b32 v223, a215
v_accvgpr_read_b32 v224, a216
v_accvgpr_read_b32 v225, a217
v_accvgpr_read_b32 v226, a218
v_accvgpr_read_b32 v227, a219
v_accvgpr_read_b32 v228, a220
v_accvgpr_read_b32 v229, a221
v_accvgpr_read_b32 v230, a222
v_accvgpr_read_b32 v231, a223
v_accvgpr_read_b32 v232, a224
v_accvgpr_read_b32 v233, a225
v_accvgpr_read_b32 v234, a226
v_accvgpr_read_b32 v235, a227
v_dot2c_f32_bf16 v0, s50, v216
v_dot2c_f32_bf16 v1, s51, v216
v_dot2c_f32_bf16 v2, s50, v217
v_dot2c_f32_bf16 v3, s51, v217
v_dot2c_f32_bf16 v20, s50, v218
v_dot2c_f32_bf16 v21, s51, v218
v_dot2c_f32_bf16 v22, s50, v219
v_dot2c_f32_bf16 v23, s51, v219
v_dot2c_f32_bf16 v4, s50, v220
v_dot2c_f32_bf16 v5, s51, v220
v_dot2c_f32_bf16 v6, s50, v221
L_hop_c8:
s_cbranch_execz L_ret_c8
v_dot2c_f32_bf16 v7, s51, v221
v_dot2c_f32_bf16 v24, s50, v222
v_dot2c_f32_bf16 v25, s51, v222
v_dot2c_f32_bf16 v26, s50, v223
v_dot2c_f32_bf16 v27, s51, v223
v_dot2c_f32_bf16 v8, s50, v224
v_dot2c_f32_bf16 v9, s51, v224
v_dot2c_f32_bf16 v10, s50, v225
v_dot2c_f32_bf16 v11, s51, v225
v_dot2c_f32_bf16 v28, s50, v226
v_dot2c_f32_bf16 v29, s51, v226
v_dot2c_f32_bf16 v30, s50, v227
v_dot2c_f32_bf16 v31, s51, v227
v_dot2c_f32_bf16 v12, s50, v228
v_dot2c_f32_bf16 v13, s51, v228
v_dot2c_f32_bf16 v14, s50, v229
v_dot2c_f32_bf16 v15, s51, v229
v_dot2c_f32_bf16 v32, s50, v230
v_dot2c_f32_bf16 v33, s51, v230
v_dot2c_f32_bf16 v34, s50, v231
v_dot2c_f32_bf16 v35, s51, v231
v_dot2c_f32_bf16 v16, s50, v232
v_dot2c_f32_bf16 v17, s51, v232
v_dot2c_f32_bf16 v18, s50, v233
v_dot2c_f32_bf16 v19, s51, v233
v_dot2c_f32_bf16 v36, s50, v234
v_dot2c_f32_bf16 v37, s51, v234
v_dot2c_f32_bf16 v38, s50, v235
v_dot2c_f32_bf16 v39, s51, v235
s_waitcnt vmcnt(0)
v_cmp_ne_u32 vcc, 0, v91
s_nop 1
s_bcnt1_i32_b64 s48, vcc
s_cmp_ge_u32 s48, 7
s_cbranch_scc1 L_all
s_mov_b32 s61, 0
L_poll:
buffer_load_dword v91, v90, s[24:27], 0 offen sc1
s_add_u32 s61, s61, 1
s_waitcnt vmcnt(0)
v_cmp_ne_u32 vcc, 0, v91
s_lshr_b32 s49, s61, 18
s_bcnt1_i32_b64 s48, vcc
s_add_u32 s48, s48, s49
s_cmp_lt_u32 s48, 7
s_cbranch_scc1 L_poll
L_all:
buffer_load_dwordx4 v[96:99], v85, s[24:27], s37 offen offset:0 sc1
buffer_load_dwordx4 v[100:103], v85, s[24:27], s37 offen offset:1024 sc1
buffer_load_dwordx4 v[104:107], v85, s[24:27], s37 offen offset:2048 sc1
buffer_load_dwordx4 v[108:111], v85, s[24:27], s37 offen offset:3072 sc1
buffer_load_dwordx4 v[112:115], v92, s[24:27], s37 offen offset:0 sc1
buffer_load_dwordx4 v[116:119], v85, s[24:27], s38 offen offset:0 sc1
buffer_load_dwordx4 v[120:123], v85, s[24:27], s38 offen offset:1024 sc1
buffer_load_dwordx4 v[124:127], v85, s[24:27], s38 offen offset:2048 sc1
buffer_load_dwordx4 v[128:131], v85, s[24:27], s38 offen offset:3072 sc1
buffer_load_dwordx4 v[132:135], v92, s[24:27], s38 offen offset:0 sc1
buffer_load_dwordx4 v[136:139], v85, s[24:27], s41 offen offset:0 sc1
buffer_load_dwordx4 v[140:143], v85, s[24:27], s41 offen offset:1024 sc1
buffer_load_dwordx4 v[144:147], v85, s[24:27], s41 offen offset:2048 sc1
buffer_load_dwordx4 v[148:151], v85, s[24:27], s41 offen offset:3072 sc1
buffer_load_dwordx4 v[152:155], v92, s[24:27], s41 offen offset:0 sc1
v_xor_b32 v47, 0x800, v81
v_lshrrev_b32 v44, 10, v47
v_and_b32 v45, 1, v44
v_mul_u32_u24 v45, 80, v45
v_bfe_u32 v46, v47, 4, 4
v_add_u32 v45, v45, v46
v_lshlrev_b32 v41, 11, v45
v_lshrrev_b32 v44, 1, v44
v_lshl_add_u32 v41, v44, 6, v41
v_bfe_u32 v44, v47, 8, 2
v_lshl_add_u32 v41, v44, 4, v41
s_lshr_b32 s46, s54, 2
s_and_b32 s47, s46, 15
s_mul_i32 s47, s47, 327680
s_lshr_b32 s46, s46, 4
s_lshl_b32 s46, s46, 10
s_add_u32 s47, s47, s46
s_add_u32 s47, s47, s42
s_mov_b32 s4, s96
s_mov_b32 s5, s97
s_mov_b32 s6, 5242880
s_mov_b32 s7, 0x20000
v_accvgpr_read_b32 v216, a228
v_accvgpr_read_b32 v217, a229
v_accvgpr_read_b32 v218, a230
v_accvgpr_read_b32 v219, a231
v_accvgpr_read_b32 v220, a232
v_accvgpr_read_b32 v221, a233
v_accvgpr_read_b32 v222, a234
v_accvgpr_read_b32 v223, a235
v_accvgpr_read_b32 v224, a236
v_accvgpr_read_b32 v225, a237
v_accvgpr_read_b32 v226, a238
v_accvgpr_read_b32 v227, a239
v_accvgpr_read_b32 v228, a240
v_accvgpr_read_b32 v229, a241
v_accvgpr_read_b32 v230, a242
v_accvgpr_read_b32 v231, a243
v_accvgpr_read_b32 v232, a244
v_accvgpr_read_b32 v233, a245
v_accvgpr_read_b32 v234, a246
v_accvgpr_read_b32 v235, a247
v_dot2c_f32_bf16 v0, s50, v216
v_dot2c_f32_bf16 v1, s51, v216
v_dot2c_f32_bf16 v2, s50, v217
v_dot2c_f32_bf16 v3, s51, v217
v_dot2c_f32_bf16 v20, s50, v218
v_dot2c_f32_bf16 v21, s51, v218
v_dot2c_f32_bf16 v22, s50, v219
v_dot2c_f32_bf16 v23, s51, v219
v_dot2c_f32_bf16 v4, s50, v220
v_dot2c_f32_bf16 v5, s51, v220
v_dot2c_f32_bf16 v6, s50, v221
v_dot2c_f32_bf16 v7, s51, v221
v_dot2c_f32_bf16 v24, s50, v222
v_dot2c_f32_bf16 v25, s51, v222
v_dot2c_f32_bf16 v26, s50, v223
v_dot2c_f32_bf16 v27, s51, v223
v_dot2c_f32_bf16 v8, s50, v224
v_dot2c_f32_bf16 v9, s51, v224
v_dot2c_f32_bf16 v10, s50, v225
v_dot2c_f32_bf16 v11, s51, v225
v_dot2c_f32_bf16 v28, s50, v226
v_dot2c_f32_bf16 v29, s51, v226
v_dot2c_f32_bf16 v30, s50, v227
v_dot2c_f32_bf16 v31, s51, v227
v_dot2c_f32_bf16 v12, s50, v228
v_dot2c_f32_bf16 v13, s51, v228
v_dot2c_f32_bf16 v14, s50, v229
v_dot2c_f32_bf16 v15, s51, v229
v_dot2c_f32_bf16 v32, s50, v230
v_dot2c_f32_bf16 v33, s51, v230
v_dot2c_f32_bf16 v34, s50, v231
v_dot2c_f32_bf16 v35, s51, v231
v_dot2c_f32_bf16 v16, s50, v232
v_dot2c_f32_bf16 v17, s51, v232
v_dot2c_f32_bf16 v18, s50, v233
v_dot2c_f32_bf16 v19, s51, v233
v_dot2c_f32_bf16 v36, s50, v234
v_dot2c_f32_bf16 v37, s51, v234
v_dot2c_f32_bf16 v38, s50, v235
v_dot2c_f32_bf16 v39, s51, v235
v_accvgpr_read_b32 v216, a80
v_accvgpr_read_b32 v217, a81
v_accvgpr_read_b32 v218, a82
v_accvgpr_read_b32 v219, a83
v_accvgpr_read_b32 v220, a84
v_accvgpr_read_b32 v221, a85
v_accvgpr_read_b32 v222, a86
v_accvgpr_read_b32 v223, a87
v_accvgpr_read_b32 v224, a88
v_accvgpr_read_b32 v225, a89
v_accvgpr_read_b32 v226, a90
v_accvgpr_read_b32 v227, a91
v_accvgpr_read_b32 v228, a92
v_accvgpr_read_b32 v229, a93
v_accvgpr_read_b32 v230, a94
v_accvgpr_read_b32 v231, a95
v_accvgpr_read_b32 v232, a96
v_accvgpr_read_b32 v233, a97
v_accvgpr_read_b32 v234, a98
v_accvgpr_read_b32 v235, a99
v_dot2c_f32_bf16 v0, s50, v216
v_dot2c_f32_bf16 v1, s51, v216
v_dot2c_f32_bf16 v2, s50, v217
v_dot2c_f32_bf16 v3, s51, v217
v_dot2c_f32_bf16 v20, s50, v218
v_dot2c_f32_bf16 v21, s51, v218
v_dot2c_f32_bf16 v22, s50, v219
v_dot2c_f32_bf16 v23, s51, v219
v_dot2c_f32_bf16 v4, s50, v220
v_dot2c_f32_bf16 v5, s51, v220
v_dot2c_f32_bf16 v6, s50, v221
v_dot2c_f32_bf16 v7, s51, v221
v_dot2c_f32_bf16 v24, s50, v222
v_dot2c_f32_bf16 v25, s51, v222
v_dot2c_f32_bf16 v26, s50, v223
v_dot2c_f32_bf16 v27, s51, v223
v_dot2c_f32_bf16 v8, s50, v224
v_dot2c_f32_bf16 v9, s51, v224
v_dot2c_f32_bf16 v10, s50, v225
v_dot2c_f32_bf16 v11, s51, v225
v_dot2c_f32_bf16 v28, s50, v226
v_dot2c_f32_bf16 v29, s51, v226
v_dot2c_f32_bf16 v30, s50, v227
v_dot2c_f32_bf16 v31, s51, v227
v_dot2c_f32_bf16 v12, s50, v228
v_dot2c_f32_bf16 v13, s51, v228
v_dot2c_f32_bf16 v14, s50, v229
v_dot2c_f32_bf16 v15, s51, v229
v_dot2c_f32_bf16 v32, s50, v230
v_dot2c_f32_bf16 v33, s51, v230
v_dot2c_f32_bf16 v34, s50, v231
v_dot2c_f32_bf16 v35, s51, v231
v_dot2c_f32_bf16 v16, s50, v232
v_dot2c_f32_bf16 v17, s51, v232
v_dot2c_f32_bf16 v18, s50, v233
v_dot2c_f32_bf16 v19, s51, v233
v_dot2c_f32_bf16 v36, s50, v234
v_dot2c_f32_bf16 v37, s51, v234
v_dot2c_f32_bf16 v38, s50, v235
v_dot2c_f32_bf16 v39, s51, v235
v_accvgpr_read_b32 v216, a100
v_accvgpr_read_b32 v217, a101
v_accvgpr_read_b32 v218, a102
v_accvgpr_read_b32 v219, a103
v_accvgpr_read_b32 v220, a104
v_accvgpr_read_b32 v221, a105
v_accvgpr_read_b32 v222, a106
v_accvgpr_read_b32 v223, a107
v_accvgpr_read_b32 v224, a108
v_accvgpr_read_b32 v225, a109
v_accvgpr_read_b32 v226, a110
v_accvgpr_read_b32 v227, a111
v_accvgpr_read_b32 v228, a112
v_accvgpr_read_b32 v229, a113
v_accvgpr_read_b32 v230, a114
v_accvgpr_read_b32 v231, a115
v_accvgpr_read_b32 v232, a116
v_accvgpr_read_b32 v233, a117
v_accvgpr_read_b32 v234, a118
v_accvgpr_read_b32 v235, a119
v_dot2c_f32_bf16 v0, s50, v216
v_dot2c_f32_bf16 v1, s51, v216
v_dot2c_f32_bf16 v2, s50, v217
v_dot2c_f32_bf16 v3, s51, v217
v_dot2c_f32_bf16 v20, s50, v218
v_dot2c_f32_bf16 v21, s51, v218
v_dot2c_f32_bf16 v22, s50, v219
v_dot2c_f32_bf16 v23, s51, v219
v_dot2c_f32_bf16 v4, s50, v220
v_dot2c_f32_bf16 v5, s51, v220
v_dot2c_f32_bf16 v6, s50, v221
v_dot2c_f32_bf16 v7, s51, v221
v_dot2c_f32_bf16 v24, s50, v222
v_dot2c_f32_bf16 v25, s51, v222
v_dot2c_f32_bf16 v26, s50, v223
v_dot2c_f32_bf16 v27, s51, v223
v_dot2c_f32_bf16 v8, s50, v224
v_dot2c_f32_bf16 v9, s51, v224
v_dot2c_f32_bf16 v10, s50, v225
v_dot2c_f32_bf16 v11, s51, v225
v_dot2c_f32_bf16 v28, s50, v226
v_dot2c_f32_bf16 v29, s51, v226
v_dot2c_f32_bf16 v30, s50, v227
v_dot2c_f32_bf16 v31, s51, v227
v_dot2c_f32_bf16 v12, s50, v228
v_dot2c_f32_bf16 v13, s51, v228
v_dot2c_f32_bf16 v14, s50, v229
v_dot2c_f32_bf16 v15, s51, v229
v_dot2c_f32_bf16 v32, s50, v230
v_dot2c_f32_bf16 v33, s51, v230
v_dot2c_f32_bf16 v34, s50, v231
v_dot2c_f32_bf16 v35, s51, v231
v_dot2c_f32_bf16 v16, s50, v232
v_dot2c_f32_bf16 v17, s51, v232
v_dot2c_f32_bf16 v18, s50, v233
v_dot2c_f32_bf16 v19, s51, v233
v_dot2c_f32_bf16 v36, s50, v234
v_dot2c_f32_bf16 v37, s51, v234
v_dot2c_f32_bf16 v38, s50, v235
v_dot2c_f32_bf16 v39, s51, v235
s_waitcnt vmcnt(10)
v_dot2c_f32_bf16 v0, s50, v96
v_dot2c_f32_bf16 v1, s51, v96
v_dot2c_f32_bf16 v2, s50, v97
v_dot2c_f32_bf16 v3, s51, v97
v_dot2c_f32_bf16 v20, s50, v98
v_dot2c_f32_bf16 v21, s51, v98
v_dot2c_f32_bf16 v22, s50, v99
v_dot2c_f32_bf16 v23, s51, v99
v_dot2c_f32_bf16 v4, s50, v100
v_dot2c_f32_bf16 v5, s51, v100
v_dot2c_f32_bf16 v6, s50, v101
v_dot2c_f32_bf16 v7, s51, v101
v_dot2c_f32_bf16 v24, s50, v102
v_dot2c_f32_bf16 v25, s51, v102
v_dot2c_f32_bf16 v26, s50, v103
v_dot2c_f32_bf16 v27, s51, v103
v_dot2c_f32_bf16 v8, s50, v104
v_dot2c_f32_bf16 v9, s51, v104
v_dot2c_f32_bf16 v10, s50, v105
v_dot2c_f32_bf16 v11, s51, v105
v_dot2c_f32_bf16 v28, s50, v106
v_dot2c_f32_bf16 v29, s51, v106
v_dot2c_f32_bf16 v30, s50, v107
v_dot2c_f32_bf16 v31, s51, v107
v_dot2c_f32_bf16 v12, s50, v108
v_dot2c_f32_bf16 v13, s51, v108
v_dot2c_f32_bf16 v14, s50, v109
v_dot2c_f32_bf16 v15, s51, v109
v_dot2c_f32_bf16 v32, s50, v110
v_dot2c_f32_bf16 v33, s51, v110
v_dot2c_f32_bf16 v34, s50, v111
v_dot2c_f32_bf16 v35, s51, v111
v_dot2c_f32_bf16 v16, s50, v112
v_dot2c_f32_bf16 v17, s51, v112
v_dot2c_f32_bf16 v18, s50, v113
v_dot2c_f32_bf16 v19, s51, v113
v_dot2c_f32_bf16 v36, s50, v114
v_dot2c_f32_bf16 v37, s51, v114
v_dot2c_f32_bf16 v38, s50, v115
v_dot2c_f32_bf16 v39, s51, v115
s_waitcnt vmcnt(5)
v_dot2c_f32_bf16 v0, s50, v116
v_dot2c_f32_bf16 v1, s51, v116
v_dot2c_f32_bf16 v2, s50, v117
v_dot2c_f32_bf16 v3, s51, v117
v_dot2c_f32_bf16 v20, s50, v118
v_dot2c_f32_bf16 v21, s51, v118
v_dot2c_f32_bf16 v22, s50, v119
v_dot2c_f32_bf16 v23, s51, v119
v_dot2c_f32_bf16 v4, s50, v120
v_dot2c_f32_bf16 v5, s51, v120
v_dot2c_f32_bf16 v6, s50, v121
v_dot2c_f32_bf16 v7, s51, v121
v_dot2c_f32_bf16 v24, s50, v122
v_dot2c_f32_bf16 v25, s51, v122
v_dot2c_f32_bf16 v26, s50, v123
v_dot2c_f32_bf16 v27, s51, v123
v_dot2c_f32_bf16 v8, s50, v124
v_dot2c_f32_bf16 v9, s51, v124
v_dot2c_f32_bf16 v10, s50, v125
v_dot2c_f32_bf16 v11, s51, v125
v_dot2c_f32_bf16 v28, s50, v126
v_dot2c_f32_bf16 v29, s51, v126
v_dot2c_f32_bf16 v30, s50, v127
v_dot2c_f32_bf16 v31, s51, v127
v_dot2c_f32_bf16 v12, s50, v128
v_dot2c_f32_bf16 v13, s51, v128
v_dot2c_f32_bf16 v14, s50, v129
v_dot2c_f32_bf16 v15, s51, v129
v_dot2c_f32_bf16 v32, s50, v130
v_dot2c_f32_bf16 v33, s51, v130
v_dot2c_f32_bf16 v34, s50, v131
v_dot2c_f32_bf16 v35, s51, v131
v_dot2c_f32_bf16 v16, s50, v132
v_dot2c_f32_bf16 v17, s51, v132
v_dot2c_f32_bf16 v18, s50, v133
v_dot2c_f32_bf16 v19, s51, v133
v_dot2c_f32_bf16 v36, s50, v134
v_dot2c_f32_bf16 v37, s51, v134
v_dot2c_f32_bf16 v38, s50, v135
v_dot2c_f32_bf16 v39, s51, v135
s_waitcnt vmcnt(0)
v_dot2c_f32_bf16 v0, s50, v136
v_dot2c_f32_bf16 v1, s51, v136
v_dot2c_f32_bf16 v2, s50, v137
v_dot2c_f32_bf16 v3, s51, v137
v_dot2c_f32_bf16 v20, s50, v138
v_dot2c_f32_bf16 v21, s51, v138
v_dot2c_f32_bf16 v22, s50, v139
v_dot2c_f32_bf16 v23, s51, v139
v_dot2c_f32_bf16 v4, s50, v140
v_dot2c_f32_bf16 v5, s51, v140
v_dot2c_f32_bf16 v6, s50, v141
v_dot2c_f32_bf16 v7, s51, v141
v_dot2c_f32_bf16 v24, s50, v142
v_dot2c_f32_bf16 v25, s51, v142
v_dot2c_f32_bf16 v26, s50, v143
v_dot2c_f32_bf16 v27, s51, v143
v_dot2c_f32_bf16 v8, s50, v144
v_dot2c_f32_bf16 v9, s51, v144
v_dot2c_f32_bf16 v10, s50, v145
v_dot2c_f32_bf16 v11, s51, v145
v_dot2c_f32_bf16 v28, s50, v146
v_dot2c_f32_bf16 v29, s51, v146
v_dot2c_f32_bf16 v30, s50, v147
v_dot2c_f32_bf16 v31, s51, v147
v_dot2c_f32_bf16 v12, s50, v148
v_dot2c_f32_bf16 v13, s51, v148
v_dot2c_f32_bf16 v14, s50, v149
v_dot2c_f32_bf16 v15, s51, v149
v_dot2c_f32_bf16 v32, s50, v150
v_dot2c_f32_bf16 v33, s51, v150
v_dot2c_f32_bf16 v34, s50, v151
v_dot2c_f32_bf16 v35, s51, v151
v_dot2c_f32_bf16 v16, s50, v152
v_dot2c_f32_bf16 v17, s51, v152
v_dot2c_f32_bf16 v18, s50, v153
v_dot2c_f32_bf16 v19, s51, v153
v_dot2c_f32_bf16 v36, s50, v154
v_dot2c_f32_bf16 v37, s51, v154
v_dot2c_f32_bf16 v38, s50, v155
v_dot2c_f32_bf16 v39, s51, v155
s_nop 2
v_cvt_pk_bf16_f32 v0, v0, v1
v_cvt_pk_bf16_f32 v1, v2, v3
v_cvt_pk_bf16_f32 v2, v20, v21
v_cvt_pk_bf16_f32 v3, v22, v23
v_cvt_pk_bf16_f32 v4, v4, v5
v_cvt_pk_bf16_f32 v5, v6, v7
v_cvt_pk_bf16_f32 v6, v24, v25
v_cvt_pk_bf16_f32 v7, v26, v27
v_cvt_pk_bf16_f32 v8, v8, v9
v_cvt_pk_bf16_f32 v9, v10, v11
v_cvt_pk_bf16_f32 v10, v28, v29
v_cvt_pk_bf16_f32 v11, v30, v31
v_cvt_pk_bf16_f32 v12, v12, v13
v_cvt_pk_bf16_f32 v13, v14, v15
v_cvt_pk_bf16_f32 v14, v32, v33
v_cvt_pk_bf16_f32 v15, v34, v35
v_cvt_pk_bf16_f32 v16, v16, v17
v_cvt_pk_bf16_f32 v17, v18, v19
v_cvt_pk_bf16_f32 v18, v36, v37
v_cvt_pk_bf16_f32 v19, v38, v39
s_nop 1
v_permlane32_swap_b32 v0, v2
v_permlane32_swap_b32 v1, v3
v_permlane32_swap_b32 v4, v6
v_permlane32_swap_b32 v5, v7
v_permlane32_swap_b32 v8, v10
v_permlane32_swap_b32 v9, v11
v_permlane32_swap_b32 v12, v14
v_permlane32_swap_b32 v13, v15
v_permlane32_swap_b32 v16, v18
v_permlane32_swap_b32 v17, v19
s_nop 1
v_permlane16_swap_b32 v0, v2
v_permlane16_swap_b32 v1, v3
v_permlane16_swap_b32 v4, v6
v_permlane16_swap_b32 v5, v7
v_permlane16_swap_b32 v8, v10
v_permlane16_swap_b32 v9, v11
v_permlane16_swap_b32 v12, v14
v_permlane16_swap_b32 v13, v15
v_permlane16_swap_b32 v16, v18
v_permlane16_swap_b32 v17, v19
buffer_store_dwordx4 v[0:3], v41, s[4:7], s47 offen sc1
s_add_u32 s47, s47, 32768
buffer_store_dwordx4 v[4:7], v41, s[4:7], s47 offen sc1
s_add_u32 s47, s47, 32768
buffer_store_dwordx4 v[8:11], v41, s[4:7], s47 offen sc1
s_add_u32 s47, s47, 32768
buffer_store_dwordx4 v[12:15], v41, s[4:7], s47 offen sc1
s_add_u32 s47, s47, 32768
buffer_store_dwordx4 v[16:19], v41, s[4:7], s47 offen sc1
s_add_u32 s47, s47, 32768
L_end:
s_endpgm
L_slow0:
s_waitcnt vmcnt(0) lgkmcnt(0)
s_barrier
v_mov_b32 v0, 0xff800000
v_mov_b32 v1, 0xff800000
v_mov_b32 v2, 0xff800000
v_mov_b32 v3, 0xff800000
v_mov_b32 v4, 0xff800000
s_mov_b32 s61, 0
L_slow0_max:
s_add_u32 m0, s36, 0
s_lshl_b32 s44, s61, 12
s_and_b32 s45, s44, 61440
s_add_u32 s44, s44, s45
s_add_u32 s44, s44, s32
s_add_u32 s44, s44, 0
buffer_load_dwordx4 v69, s[12:15], s44 offen offset:0 lds
buffer_load_dwordx4 v70, s[12:15], s44 offen offset:1024 lds
buffer_load_dwordx4 v69, s[12:15], s44 offen offset:2048 lds
buffer_load_dwordx4 v70, s[12:15], s44 offen offset:3072 lds
s_waitcnt vmcnt(0)
s_barrier
ds_read_b128 a[160:163], v57 offset:0
ds_read_b128 a[164:167], v58 offset:0
ds_read_b128 a[168:171], v59 offset:0
ds_read_b128 a[172:175], v60 offset:0
ds_read_b128 a[176:179], v57 offset:4096
ds_read_b128 a[180:183], v58 offset:4096
ds_read_b128 a[184:187], v59 offset:4096
ds_read_b128 a[188:191], v60 offset:4096
s_waitcnt lgkmcnt(0)
M v[16:19], a[160:163], a[0:3], 0
M v[16:19], a[164:167], a[20:23], v[16:19]
M v[16:19], a[168:171], a[40:43], v[16:19]
M v[16:19], a[172:175], a[60:63], v[16:19]
M v[24:27], a[160:163], a[4:7], 0
M v[24:27], a[164:167], a[24:27], v[24:27]
M v[24:27], a[168:171], a[44:47], v[24:27]
M v[24:27], a[172:175], a[64:67], v[24:27]
M v[32:35], a[160:163], a[8:11], 0
M v[32:35], a[164:167], a[28:31], v[32:35]
M v[32:35], a[168:171], a[48:51], v[32:35]
M v[32:35], a[172:175], a[68:71], v[32:35]
M v[40:43], a[160:163], a[12:15], 0
M v[40:43], a[164:167], a[32:35], v[40:43]
M v[40:43], a[168:171], a[52:55], v[40:43]
M v[40:43], a[172:175], a[72:75], v[40:43]
M v[48:51], a[160:163], a[16:19], 0
M v[48:51], a[164:167], a[36:39], v[48:51]
M v[48:51], a[168:171], a[56:59], v[48:51]
M v[48:51], a[172:175], a[76:79], v[48:51]
M v[20:23], a[176:179], a[0:3], 0
M v[20:23], a[180:183], a[20:23], v[20:23]
M v[20:23], a[184:187], a[40:43], v[20:23]
M v[20:23], a[188:191], a[60:63], v[20:23]
M v[28:31], a[176:179], a[4:7], 0
M v[28:31], a[180:183], a[24:27], v[28:31]
M v[28:31], a[184:187], a[44:47], v[28:31]
M v[28:31], a[188:191], a[64:67], v[28:31]
M v[36:39], a[176:179], a[8:11], 0
M v[36:39], a[180:183], a[28:31], v[36:39]
M v[36:39], a[184:187], a[48:51], v[36:39]
M v[36:39], a[188:191], a[68:71], v[36:39]
M v[44:47], a[176:179], a[12:15], 0
M v[44:47], a[180:183], a[32:35], v[44:47]
M v[44:47], a[184:187], a[52:55], v[44:47]
M v[44:47], a[188:191], a[72:75], v[44:47]
M v[52:55], a[176:179], a[16:19], 0
M v[52:55], a[180:183], a[36:39], v[52:55]
M v[52:55], a[184:187], a[56:59], v[52:55]
M v[52:55], a[188:191], a[76:79], v[52:55]
s_nop 7
v_max3_f32 v0, v0, v16, v17
v_max3_f32 v0, v0, v18, v19
v_max3_f32 v0, v0, v20, v21
v_max3_f32 v0, v0, v22, v23
v_max3_f32 v1, v1, v24, v25
v_max3_f32 v1, v1, v26, v27
v_max3_f32 v1, v1, v28, v29
v_max3_f32 v1, v1, v30, v31
v_max3_f32 v2, v2, v32, v33
v_max3_f32 v2, v2, v34, v35
v_max3_f32 v2, v2, v36, v37
v_max3_f32 v2, v2, v38, v39
v_max3_f32 v3, v3, v40, v41
v_max3_f32 v3, v3, v42, v43
v_max3_f32 v3, v3, v44, v45
v_max3_f32 v3, v3, v46, v47
v_max3_f32 v4, v4, v48, v49
v_max3_f32 v4, v4, v50, v51
v_max3_f32 v4, v4, v52, v53
v_max3_f32 v4, v4, v54, v55
s_barrier
s_add_u32 s61, s61, 1
s_cmp_lt_u32 s61, 16
s_cbranch_scc1 L_slow0_max
v_mov_b32 v8, v0
s_nop 1
v_permlane32_swap_b32 v8, v0
s_nop 1
v_max_f32 v0, v8, v0
v_mov_b32 v8, v0
s_nop 1
v_permlane16_swap_b32 v8, v0
s_nop 1
v_max_f32 v0, v8, v0
v_mov_b32 v90, 0
v_mov_b32 v8, v1
s_nop 1
v_permlane32_swap_b32 v8, v1
s_nop 1
v_max_f32 v1, v8, v1
v_mov_b32 v8, v1
s_nop 1
v_permlane16_swap_b32 v8, v1
s_nop 1
v_max_f32 v1, v8, v1
v_mov_b32 v91, 0
v_mov_b32 v8, v2
s_nop 1
v_permlane32_swap_b32 v8, v2
s_nop 1
v_max_f32 v2, v8, v2
v_mov_b32 v8, v2
s_nop 1
v_permlane16_swap_b32 v8, v2
s_nop 1
v_max_f32 v2, v8, v2
v_mov_b32 v92, 0
v_mov_b32 v8, v3
s_nop 1
v_permlane32_swap_b32 v8, v3
s_nop 1
v_max_f32 v3, v8, v3
v_mov_b32 v8, v3
s_nop 1
v_permlane16_swap_b32 v8, v3
s_nop 1
v_max_f32 v3, v8, v3
v_mov_b32 v93, 0
v_mov_b32 v8, v4
s_nop 1
v_permlane32_swap_b32 v8, v4
s_nop 1
v_max_f32 v4, v8, v4
v_mov_b32 v8, v4
s_nop 1
v_permlane16_swap_b32 v8, v4
s_nop 1
v_max_f32 v4, v8, v4
v_mov_b32 v94, 0
v_mov_b32 v96, 0
v_mov_b32 v97, 0
v_mov_b32 v98, 0
v_mov_b32 v99, 0
v_mov_b32 v100, 0
v_mov_b32 v101, 0
v_mov_b32 v102, 0
v_mov_b32 v103, 0
v_mov_b32 v104, 0
v_mov_b32 v105, 0
v_mov_b32 v106, 0
v_mov_b32 v107, 0
v_mov_b32 v108, 0
v_mov_b32 v109, 0
v_mov_b32 v110, 0
v_mov_b32 v111, 0
v_mov_b32 v112, 0
v_mov_b32 v113, 0
v_mov_b32 v114, 0
v_mov_b32 v115, 0
v_mov_b32 v116, 0
v_mov_b32 v117, 0
v_mov_b32 v118, 0
v_mov_b32 v119, 0
v_mov_b32 v120, 0
v_mov_b32 v121, 0
v_mov_b32 v122, 0
v_mov_b32 v123, 0
v_mov_b32 v124, 0
v_mov_b32 v125, 0
v_mov_b32 v126, 0
v_mov_b32 v127, 0
v_mov_b32 v128, 0
v_mov_b32 v129, 0
v_mov_b32 v130, 0
v_mov_b32 v131, 0
v_mov_b32 v132, 0
v_mov_b32 v133, 0
v_mov_b32 v134, 0
v_mov_b32 v135, 0
v_mov_b32 v136, 0
v_mov_b32 v137, 0
v_mov_b32 v138, 0
v_mov_b32 v139, 0
v_mov_b32 v140, 0
v_mov_b32 v141, 0
v_mov_b32 v142, 0
v_mov_b32 v143, 0
v_mov_b32 v144, 0
v_mov_b32 v145, 0
v_mov_b32 v146, 0
v_mov_b32 v147, 0
v_mov_b32 v148, 0
v_mov_b32 v149, 0
v_mov_b32 v150, 0
v_mov_b32 v151, 0
v_mov_b32 v152, 0
v_mov_b32 v153, 0
v_mov_b32 v154, 0
v_mov_b32 v155, 0
v_mov_b32 v156, 0
v_mov_b32 v157, 0
v_mov_b32 v158, 0
v_mov_b32 v159, 0
v_mov_b32 v160, 0
v_mov_b32 v161, 0
v_mov_b32 v162, 0
v_mov_b32 v163, 0
v_mov_b32 v164, 0
v_mov_b32 v165, 0
v_mov_b32 v166, 0
v_mov_b32 v167, 0
v_mov_b32 v168, 0
v_mov_b32 v169, 0
v_mov_b32 v170, 0
v_mov_b32 v171, 0
v_mov_b32 v172, 0
v_mov_b32 v173, 0
v_mov_b32 v174, 0
v_mov_b32 v175, 0
v_mov_b32 v176, 0
v_mov_b32 v177, 0
v_mov_b32 v178, 0
v_mov_b32 v179, 0
v_mov_b32 v180, 0
v_mov_b32 v181, 0
v_mov_b32 v182, 0
v_mov_b32 v183, 0
v_mov_b32 v184, 0
v_mov_b32 v185, 0
v_mov_b32 v186, 0
v_mov_b32 v187, 0
v_mov_b32 v188, 0
v_mov_b32 v189, 0
v_mov_b32 v190, 0
v_mov_b32 v191, 0
v_mov_b32 v192, 0
v_mov_b32 v193, 0
v_mov_b32 v194, 0
v_mov_b32 v195, 0
v_mov_b32 v196, 0
v_mov_b32 v197, 0
v_mov_b32 v198, 0
v_mov_b32 v199, 0
v_mov_b32 v200, 0
v_mov_b32 v201, 0
v_mov_b32 v202, 0
v_mov_b32 v203, 0
v_mov_b32 v204, 0
v_mov_b32 v205, 0
v_mov_b32 v206, 0
v_mov_b32 v207, 0
v_mov_b32 v208, 0
v_mov_b32 v209, 0
v_mov_b32 v210, 0
v_mov_b32 v211, 0
v_mov_b32 v212, 0
v_mov_b32 v213, 0
v_mov_b32 v214, 0
v_mov_b32 v215, 0
v_mov_b32 v216, 0
v_mov_b32 v217, 0
v_mov_b32 v218, 0
v_mov_b32 v219, 0
v_mov_b32 v220, 0
v_mov_b32 v221, 0
v_mov_b32 v222, 0
v_mov_b32 v223, 0
v_mov_b32 v224, 0
v_mov_b32 v225, 0
v_mov_b32 v226, 0
v_mov_b32 v227, 0
v_mov_b32 v228, 0
v_mov_b32 v229, 0
v_mov_b32 v230, 0
v_mov_b32 v231, 0
v_mov_b32 v232, 0
v_mov_b32 v233, 0
v_mov_b32 v234, 0
v_mov_b32 v235, 0
v_mov_b32 v236, 0
v_mov_b32 v237, 0
v_mov_b32 v238, 0
v_mov_b32 v239, 0
v_mov_b32 v240, 0
v_mov_b32 v241, 0
v_mov_b32 v242, 0
v_mov_b32 v243, 0
v_mov_b32 v244, 0
v_mov_b32 v245, 0
v_mov_b32 v246, 0
v_mov_b32 v247, 0
v_mov_b32 v248, 0
v_mov_b32 v249, 0
v_mov_b32 v250, 0
v_mov_b32 v251, 0
v_mov_b32 v252, 0
v_mov_b32 v253, 0
v_mov_b32 v254, 0
v_mov_b32 v255, 0
s_mov_b32 s61, 0
L_slow0_att:
s_add_u32 m0, s36, 0
s_lshl_b32 s44, s61, 12
s_and_b32 s45, s44, 61440
s_add_u32 s44, s44, s45
s_add_u32 s44, s44, s32
s_add_u32 s44, s44, 0
buffer_load_dwordx4 v69, s[12:15], s44 offen offset:0 lds
buffer_load_dwordx4 v70, s[12:15], s44 offen offset:1024 lds
buffer_load_dwordx4 v69, s[12:15], s44 offen offset:2048 lds
buffer_load_dwordx4 v70, s[12:15], s44 offen offset:3072 lds
s_add_u32 m0, s36, 65536
s_lshl_b32 s44, s61, 12
s_and_b32 s45, s44, 61440
s_add_u32 s44, s44, s45
s_add_u32 s44, s44, s32
s_add_u32 s44, s44, 0
buffer_load_dwordx4 v69, s[16:19], s44 offen offset:0 lds
buffer_load_dwordx4 v70, s[16:19], s44 offen offset:1024 lds
buffer_load_dwordx4 v69, s[16:19], s44 offen offset:2048 lds
buffer_load_dwordx4 v70, s[16:19], s44 offen offset:3072 lds
s_waitcnt vmcnt(0)
s_barrier
ds_read_b128 a[160:163], v57 offset:0
ds_read_b128 a[164:167], v58 offset:0
ds_read_b128 a[168:171], v59 offset:0
ds_read_b128 a[172:175], v60 offset:0
ds_read_b128 a[176:179], v57 offset:4096
ds_read_b128 a[180:183], v58 offset:4096
ds_read_b128 a[184:187], v59 offset:4096
ds_read_b128 a[188:191], v60 offset:4096
s_waitcnt lgkmcnt(0)
M v[16:19], a[160:163], a[0:3], 0
M v[16:19], a[164:167], a[20:23], v[16:19]
M v[16:19], a[168:171], a[40:43], v[16:19]
M v[16:19], a[172:175], a[60:63], v[16:19]
M v[24:27], a[160:163], a[4:7], 0
M v[24:27], a[164:167], a[24:27], v[24:27]
M v[24:27], a[168:171], a[44:47], v[24:27]
M v[24:27], a[172:175], a[64:67], v[24:27]
M v[32:35], a[160:163], a[8:11], 0
M v[32:35], a[164:167], a[28:31], v[32:35]
M v[32:35], a[168:171], a[48:51], v[32:35]
M v[32:35], a[172:175], a[68:71], v[32:35]
M v[40:43], a[160:163], a[12:15], 0
M v[40:43], a[164:167], a[32:35], v[40:43]
M v[40:43], a[168:171], a[52:55], v[40:43]
M v[40:43], a[172:175], a[72:75], v[40:43]
M v[48:51], a[160:163], a[16:19], 0
M v[48:51], a[164:167], a[36:39], v[48:51]
M v[48:51], a[168:171], a[56:59], v[48:51]
M v[48:51], a[172:175], a[76:79], v[48:51]
M v[20:23], a[176:179], a[0:3], 0
M v[20:23], a[180:183], a[20:23], v[20:23]
M v[20:23], a[184:187], a[40:43], v[20:23]
M v[20:23], a[188:191], a[60:63], v[20:23]
M v[28:31], a[176:179], a[4:7], 0
M v[28:31], a[180:183], a[24:27], v[28:31]
M v[28:31], a[184:187], a[44:47], v[28:31]
M v[28:31], a[188:191], a[64:67], v[28:31]
M v[36:39], a[176:179], a[8:11], 0
M v[36:39], a[180:183], a[28:31], v[36:39]
M v[36:39], a[184:187], a[48:51], v[36:39]
M v[36:39], a[188:191], a[68:71], v[36:39]
M v[44:47], a[176:179], a[12:15], 0
M v[44:47], a[180:183], a[32:35], v[44:47]
M v[44:47], a[184:187], a[52:55], v[44:47]
M v[44:47], a[188:191], a[72:75], v[44:47]
M v[52:55], a[176:179], a[16:19], 0
M v[52:55], a[180:183], a[36:39], v[52:55]
M v[52:55], a[184:187], a[56:59], v[52:55]
M v[52:55], a[188:191], a[76:79], v[52:55]
s_nop 7
v_sub_f32 v16, v16, v0
v_sub_f32 v17, v17, v0
v_sub_f32 v18, v18, v0
v_sub_f32 v19, v19, v0
v_sub_f32 v20, v20, v0
v_sub_f32 v21, v21, v0
v_sub_f32 v22, v22, v0
v_sub_f32 v23, v23, v0
v_exp_f32 v16, v16
v_exp_f32 v17, v17
v_exp_f32 v18, v18
v_exp_f32 v19, v19
v_exp_f32 v20, v20
v_exp_f32 v21, v21
v_exp_f32 v22, v22
v_exp_f32 v23, v23
s_nop 0
v_add_f32 v90, v90, v16
v_add_f32 v90, v90, v17
v_add_f32 v90, v90, v18
v_add_f32 v90, v90, v19
v_add_f32 v90, v90, v20
v_add_f32 v90, v90, v21
v_add_f32 v90, v90, v22
v_add_f32 v90, v90, v23
v_cvt_pk_bf16_f32 v16, v16, v17
v_cvt_pk_bf16_f32 v17, v18, v19
v_cvt_pk_bf16_f32 v18, v20, v21
v_cvt_pk_bf16_f32 v19, v22, v23
v_sub_f32 v24, v24, v1
v_sub_f32 v25, v25, v1
v_sub_f32 v26, v26, v1
v_sub_f32 v27, v27, v1
v_sub_f32 v28, v28, v1
v_sub_f32 v29, v29, v1
v_sub_f32 v30, v30, v1
v_sub_f32 v31, v31, v1
v_exp_f32 v24, v24
v_exp_f32 v25, v25
v_exp_f32 v26, v26
v_exp_f32 v27, v27
v_exp_f32 v28, v28
v_exp_f32 v29, v29
v_exp_f32 v30, v30
v_exp_f32 v31, v31
s_nop 0
v_add_f32 v91, v91, v24
v_add_f32 v91, v91, v25
v_add_f32 v91, v91, v26
v_add_f32 v91, v91, v27
v_add_f32 v91, v91, v28
v_add_f32 v91, v91, v29
v_add_f32 v91, v91, v30
v_add_f32 v91, v91, v31
v_cvt_pk_bf16_f32 v24, v24, v25
v_cvt_pk_bf16_f32 v25, v26, v27
v_cvt_pk_bf16_f32 v26, v28, v29
v_cvt_pk_bf16_f32 v27, v30, v31
v_sub_f32 v32, v32, v2
v_sub_f32 v33, v33, v2
v_sub_f32 v34, v34, v2
v_sub_f32 v35, v35, v2
v_sub_f32 v36, v36, v2
v_sub_f32 v37, v37, v2
v_sub_f32 v38, v38, v2
v_sub_f32 v39, v39, v2
v_exp_f32 v32, v32
v_exp_f32 v33, v33
v_exp_f32 v34, v34
v_exp_f32 v35, v35
v_exp_f32 v36, v36
v_exp_f32 v37, v37
v_exp_f32 v38, v38
v_exp_f32 v39, v39
s_nop 0
v_add_f32 v92, v92, v32
v_add_f32 v92, v92, v33
v_add_f32 v92, v92, v34
v_add_f32 v92, v92, v35
v_add_f32 v92, v92, v36
v_add_f32 v92, v92, v37
v_add_f32 v92, v92, v38
v_add_f32 v92, v92, v39
v_cvt_pk_bf16_f32 v32, v32, v33
v_cvt_pk_bf16_f32 v33, v34, v35
v_cvt_pk_bf16_f32 v34, v36, v37
v_cvt_pk_bf16_f32 v35, v38, v39
v_sub_f32 v40, v40, v3
v_sub_f32 v41, v41, v3
v_sub_f32 v42, v42, v3
v_sub_f32 v43, v43, v3
v_sub_f32 v44, v44, v3
v_sub_f32 v45, v45, v3
v_sub_f32 v46, v46, v3
v_sub_f32 v47, v47, v3
v_exp_f32 v40, v40
v_exp_f32 v41, v41
v_exp_f32 v42, v42
v_exp_f32 v43, v43
v_exp_f32 v44, v44
v_exp_f32 v45, v45
v_exp_f32 v46, v46
v_exp_f32 v47, v47
s_nop 0
v_add_f32 v93, v93, v40
v_add_f32 v93, v93, v41
v_add_f32 v93, v93, v42
v_add_f32 v93, v93, v43
v_add_f32 v93, v93, v44
v_add_f32 v93, v93, v45
v_add_f32 v93, v93, v46
v_add_f32 v93, v93, v47
v_cvt_pk_bf16_f32 v40, v40, v41
v_cvt_pk_bf16_f32 v41, v42, v43
v_cvt_pk_bf16_f32 v42, v44, v45
v_cvt_pk_bf16_f32 v43, v46, v47
v_sub_f32 v48, v48, v4
v_sub_f32 v49, v49, v4
v_sub_f32 v50, v50, v4
v_sub_f32 v51, v51, v4
v_sub_f32 v52, v52, v4
v_sub_f32 v53, v53, v4
v_sub_f32 v54, v54, v4
v_sub_f32 v55, v55, v4
v_exp_f32 v48, v48
v_exp_f32 v49, v49
v_exp_f32 v50, v50
v_exp_f32 v51, v51
v_exp_f32 v52, v52
v_exp_f32 v53, v53
v_exp_f32 v54, v54
v_exp_f32 v55, v55
s_nop 0
v_add_f32 v94, v94, v48
v_add_f32 v94, v94, v49
v_add_f32 v94, v94, v50
v_add_f32 v94, v94, v51
v_add_f32 v94, v94, v52
v_add_f32 v94, v94, v53
v_add_f32 v94, v94, v54
v_add_f32 v94, v94, v55
v_cvt_pk_bf16_f32 v48, v48, v49
v_cvt_pk_bf16_f32 v49, v50, v51
v_cvt_pk_bf16_f32 v50, v52, v53
v_cvt_pk_bf16_f32 v51, v54, v55
ds_read_b64_tr_b16 a[192:193], v61 offset:0
ds_read_b64_tr_b16 a[194:195], v61 offset:4096
s_waitcnt lgkmcnt(0)
M v[96:99], a[192:195], v[16:19], v[96:99]
M v[100:103], a[192:195], v[24:27], v[100:103]
M v[104:107], a[192:195], v[32:35], v[104:107]
M v[108:111], a[192:195], v[40:43], v[108:111]
M v[112:115], a[192:195], v[48:51], v[112:115]
ds_read_b64_tr_b16 a[192:193], v62 offset:0
ds_read_b64_tr_b16 a[194:195], v62 offset:4096
s_waitcnt lgkmcnt(0)
M v[116:119], a[192:195], v[16:19], v[116:119]
M v[120:123], a[192:195], v[24:27], v[120:123]
M v[124:127], a[192:195], v[32:35], v[124:127]
M v[128:131], a[192:195], v[40:43], v[128:131]
M v[132:135], a[192:195], v[48:51], v[132:135]
ds_read_b64_tr_b16 a[192:193], v63 offset:0
ds_read_b64_tr_b16 a[194:195], v63 offset:4096
s_waitcnt lgkmcnt(0)
M v[136:139], a[192:195], v[16:19], v[136:139]
M v[140:143], a[192:195], v[24:27], v[140:143]
M v[144:147], a[192:195], v[32:35], v[144:147]
M v[148:151], a[192:195], v[40:43], v[148:151]
M v[152:155], a[192:195], v[48:51], v[152:155]
ds_read_b64_tr_b16 a[192:193], v64 offset:0
ds_read_b64_tr_b16 a[194:195], v64 offset:4096
s_waitcnt lgkmcnt(0)
M v[156:159], a[192:195], v[16:19], v[156:159]
M v[160:163], a[192:195], v[24:27], v[160:163]
M v[164:167], a[192:195], v[32:35], v[164:167]
M v[168:171], a[192:195], v[40:43], v[168:171]
M v[172:175], a[192:195], v[48:51], v[172:175]
ds_read_b64_tr_b16 a[192:193], v65 offset:0
ds_read_b64_tr_b16 a[194:195], v65 offset:4096
s_waitcnt lgkmcnt(0)
M v[176:179], a[192:195], v[16:19], v[176:179]
M v[180:183], a[192:195], v[24:27], v[180:183]
M v[184:187], a[192:195], v[32:35], v[184:187]
M v[188:191], a[192:195], v[40:43], v[188:191]
M v[192:195], a[192:195], v[48:51], v[192:195]
ds_read_b64_tr_b16 a[192:193], v66 offset:0
ds_read_b64_tr_b16 a[194:195], v66 offset:4096
s_waitcnt lgkmcnt(0)
M v[196:199], a[192:195], v[16:19], v[196:199]
M v[200:203], a[192:195], v[24:27], v[200:203]
M v[204:207], a[192:195], v[32:35], v[204:207]
M v[208:211], a[192:195], v[40:43], v[208:211]
M v[212:215], a[192:195], v[48:51], v[212:215]
ds_read_b64_tr_b16 a[192:193], v67 offset:0
ds_read_b64_tr_b16 a[194:195], v67 offset:4096
s_waitcnt lgkmcnt(0)
M v[216:219], a[192:195], v[16:19], v[216:219]
M v[220:223], a[192:195], v[24:27], v[220:223]
M v[224:227], a[192:195], v[32:35], v[224:227]
M v[228:231], a[192:195], v[40:43], v[228:231]
M v[232:235], a[192:195], v[48:51], v[232:235]
ds_read_b64_tr_b16 a[192:193], v68 offset:0
ds_read_b64_tr_b16 a[194:195], v68 offset:4096
s_waitcnt lgkmcnt(0)
M v[236:239], a[192:195], v[16:19], v[236:239]
M v[240:243], a[192:195], v[24:27], v[240:243]
M v[244:247], a[192:195], v[32:35], v[244:247]
M v[248:251], a[192:195], v[40:43], v[248:251]
M v[252:255], a[192:195], v[48:51], v[252:255]
s_barrier
s_add_u32 s61, s61, 1
s_cmp_lt_u32 s61, 16
s_cbranch_scc1 L_slow0_att
v_mov_b32 v0, v90
s_nop 1
v_permlane32_swap_b32 v0, v90
s_nop 1
v_add_f32 v90, v0, v90
v_mov_b32 v0, v90
s_nop 1
v_permlane16_swap_b32 v0, v90
s_nop 1
v_add_f32 v90, v0, v90
v_mov_b32 v1, v91
s_nop 1
v_permlane32_swap_b32 v1, v91
s_nop 1
v_add_f32 v91, v1, v91
v_mov_b32 v1, v91
s_nop 1
v_permlane16_swap_b32 v1, v91
s_nop 1
v_add_f32 v91, v1, v91
v_mov_b32 v2, v92
s_nop 1
v_permlane32_swap_b32 v2, v92
s_nop 1
v_add_f32 v92, v2, v92
v_mov_b32 v2, v92
s_nop 1
v_permlane16_swap_b32 v2, v92
s_nop 1
v_add_f32 v92, v2, v92
v_mov_b32 v3, v93
s_nop 1
v_permlane32_swap_b32 v3, v93
s_nop 1
v_add_f32 v93, v3, v93
v_mov_b32 v3, v93
s_nop 1
v_permlane16_swap_b32 v3, v93
s_nop 1
v_add_f32 v93, v3, v93
v_mov_b32 v4, v94
s_nop 1
v_permlane32_swap_b32 v4, v94
s_nop 1
v_add_f32 v94, v4, v94
v_mov_b32 v4, v94
s_nop 1
v_permlane16_swap_b32 v4, v94
s_nop 1
v_add_f32 v94, v4, v94
v_rcp_f32 v90, v90
v_rcp_f32 v91, v91
v_rcp_f32 v92, v92
v_rcp_f32 v93, v93
v_rcp_f32 v94, v94
s_add_u32 s44, s64, 512
s_add_u32 m0, s36, 131072
s_nop 0
buffer_load_dwordx4 v73, s[8:11], s44 offen lds
s_add_u32 s45, s64, 66048
s_add_u32 m0, s36, 132096
s_nop 0
buffer_load_dwordx4 v73, s[8:11], s45 offen lds
s_add_u32 s46, s64, 131584
s_add_u32 m0, s36, 133120
s_nop 0
buffer_load_dwordx4 v73, s[8:11], s46 offen lds
s_add_u32 s47, s64, 197120
s_add_u32 m0, s36, 134144
s_nop 0
buffer_load_dwordx4 v73, s[8:11], s47 offen lds
s_add_u32 s48, s65, 512
s_add_u32 m0, s36, 147456
s_nop 0
buffer_load_dwordx4 v73, s[8:11], s48 offen lds
s_add_u32 s49, s65, 66048
s_add_u32 m0, s36, 148480
s_nop 0
buffer_load_dwordx4 v73, s[8:11], s49 offen lds
s_add_u32 s50, s65, 131584
s_add_u32 m0, s36, 149504
s_nop 0
buffer_load_dwordx4 v73, s[8:11], s50 offen lds
s_add_u32 s51, s65, 197120
s_add_u32 m0, s36, 150528
s_nop 0
buffer_load_dwordx4 v73, s[8:11], s51 offen lds
s_add_u32 s44, s72, 0
s_add_u32 m0, s37, 0
s_nop 0
buffer_load_dwordx4 v71, s[4:7], s44 offen lds
s_add_u32 s45, s72, 8192
s_add_u32 m0, s37, 1024
s_nop 0
buffer_load_dwordx4 v72, s[4:7], s45 offen lds
s_add_u32 s46, s72, 16384
s_add_u32 m0, s37, 2048
s_nop 0
buffer_load_dwordx4 v71, s[4:7], s46 offen lds
s_add_u32 s47, s72, 24576
s_add_u32 m0, s37, 3072
s_nop 0
buffer_load_dwordx4 v72, s[4:7], s47 offen lds
s_add_u32 s48, s72, 32768
s_add_u32 m0, s37, 4096
s_nop 0
buffer_load_dwordx4 v71, s[4:7], s48 offen lds
s_add_u32 s49, s73, 0
s_add_u32 m0, s38, 0
s_nop 0
buffer_load_dwordx4 v71, s[4:7], s49 offen lds
s_add_u32 s50, s73, 8192
s_add_u32 m0, s38, 1024
s_nop 0
buffer_load_dwordx4 v72, s[4:7], s50 offen lds
s_add_u32 s51, s73, 16384
s_add_u32 m0, s38, 2048
s_nop 0
buffer_load_dwordx4 v71, s[4:7], s51 offen lds
s_add_u32 s44, s73, 24576
s_add_u32 m0, s38, 3072
s_nop 0
buffer_load_dwordx4 v72, s[4:7], s44 offen lds
s_add_u32 s45, s73, 32768
s_add_u32 m0, s38, 4096
s_nop 0
buffer_load_dwordx4 v71, s[4:7], s45 offen lds
s_add_u32 s49, s43, 0
s_and_b32 s49, s49, 131071
s_add_u32 s49, s49, s100
s_add_u32 m0, s36, 0
s_nop 0
buffer_load_dwordx4 v69, s[12:15], s49 offen nt lds
buffer_load_dwordx4 v70, s[12:15], s49 offen offset:1024 nt lds
buffer_load_dwordx4 v69, s[12:15], s49 offen offset:2048 nt lds
buffer_load_dwordx4 v70, s[12:15], s49 offen offset:3072 nt lds
s_add_u32 s50, s43, 8192
s_and_b32 s50, s50, 131071
s_add_u32 s50, s50, s100
s_add_u32 m0, s36, 16384
s_nop 0
buffer_load_dwordx4 v69, s[12:15], s50 offen nt lds
buffer_load_dwordx4 v70, s[12:15], s50 offen offset:1024 nt lds
buffer_load_dwordx4 v69, s[12:15], s50 offen offset:2048 nt lds
buffer_load_dwordx4 v70, s[12:15], s50 offen offset:3072 nt lds
s_add_u32 s51, s43, 0
s_and_b32 s51, s51, 131071
s_add_u32 s51, s51, s100
s_add_u32 m0, s36, 65536
s_nop 0
buffer_load_dwordx4 v69, s[16:19], s51 offen nt lds
buffer_load_dwordx4 v70, s[16:19], s51 offen offset:1024 nt lds
buffer_load_dwordx4 v69, s[16:19], s51 offen offset:2048 nt lds
buffer_load_dwordx4 v70, s[16:19], s51 offen offset:3072 nt lds
s_waitcnt vmcnt(0) lgkmcnt(0)
s_barrier
s_nop 7
s_branch L_back0
L_slow1:
s_waitcnt vmcnt(0) lgkmcnt(0)
s_barrier
v_mov_b32 v0, 0xff800000
v_mov_b32 v1, 0xff800000
v_mov_b32 v2, 0xff800000
v_mov_b32 v3, 0xff800000
v_mov_b32 v4, 0xff800000
s_mov_b32 s61, 0
L_slow1_max:
s_add_u32 m0, s36, 0
s_lshl_b32 s44, s61, 12
s_and_b32 s45, s44, 61440
s_add_u32 s44, s44, s45
s_add_u32 s44, s44, s32
s_add_u32 s44, s44, 262144
buffer_load_dwordx4 v69, s[12:15], s44 offen offset:0 lds
buffer_load_dwordx4 v70, s[12:15], s44 offen offset:1024 lds
buffer_load_dwordx4 v69, s[12:15], s44 offen offset:2048 lds
buffer_load_dwordx4 v70, s[12:15], s44 offen offset:3072 lds
s_waitcnt vmcnt(0)
s_barrier
ds_read_b128 a[160:163], v57 offset:0
ds_read_b128 a[164:167], v58 offset:0
ds_read_b128 a[168:171], v59 offset:0
ds_read_b128 a[172:175], v60 offset:0
ds_read_b128 a[176:179], v57 offset:4096
ds_read_b128 a[180:183], v58 offset:4096
ds_read_b128 a[184:187], v59 offset:4096
ds_read_b128 a[188:191], v60 offset:4096
s_waitcnt lgkmcnt(0)
M v[16:19], a[160:163], a[0:3], 0
M v[16:19], a[164:167], a[20:23], v[16:19]
M v[16:19], a[168:171], a[40:43], v[16:19]
M v[16:19], a[172:175], a[60:63], v[16:19]
M v[24:27], a[160:163], a[4:7], 0
M v[24:27], a[164:167], a[24:27], v[24:27]
M v[24:27], a[168:171], a[44:47], v[24:27]
M v[24:27], a[172:175], a[64:67], v[24:27]
M v[32:35], a[160:163], a[8:11], 0
M v[32:35], a[164:167], a[28:31], v[32:35]
M v[32:35], a[168:171], a[48:51], v[32:35]
M v[32:35], a[172:175], a[68:71], v[32:35]
M v[40:43], a[160:163], a[12:15], 0
M v[40:43], a[164:167], a[32:35], v[40:43]
M v[40:43], a[168:171], a[52:55], v[40:43]
M v[40:43], a[172:175], a[72:75], v[40:43]
M v[48:51], a[160:163], a[16:19], 0
M v[48:51], a[164:167], a[36:39], v[48:51]
M v[48:51], a[168:171], a[56:59], v[48:51]
M v[48:51], a[172:175], a[76:79], v[48:51]
M v[20:23], a[176:179], a[0:3], 0
M v[20:23], a[180:183], a[20:23], v[20:23]
M v[20:23], a[184:187], a[40:43], v[20:23]
M v[20:23], a[188:191], a[60:63], v[20:23]
M v[28:31], a[176:179], a[4:7], 0
M v[28:31], a[180:183], a[24:27], v[28:31]
M v[28:31], a[184:187], a[44:47], v[28:31]
M v[28:31], a[188:191], a[64:67], v[28:31]
M v[36:39], a[176:179], a[8:11], 0
M v[36:39], a[180:183], a[28:31], v[36:39]
M v[36:39], a[184:187], a[48:51], v[36:39]
M v[36:39], a[188:191], a[68:71], v[36:39]
M v[44:47], a[176:179], a[12:15], 0
M v[44:47], a[180:183], a[32:35], v[44:47]
M v[44:47], a[184:187], a[52:55], v[44:47]
M v[44:47], a[188:191], a[72:75], v[44:47]
M v[52:55], a[176:179], a[16:19], 0
M v[52:55], a[180:183], a[36:39], v[52:55]
M v[52:55], a[184:187], a[56:59], v[52:55]
M v[52:55], a[188:191], a[76:79], v[52:55]
s_nop 7
v_max3_f32 v0, v0, v16, v17
v_max3_f32 v0, v0, v18, v19
v_max3_f32 v0, v0, v20, v21
v_max3_f32 v0, v0, v22, v23
v_max3_f32 v1, v1, v24, v25
v_max3_f32 v1, v1, v26, v27
v_max3_f32 v1, v1, v28, v29
v_max3_f32 v1, v1, v30, v31
v_max3_f32 v2, v2, v32, v33
v_max3_f32 v2, v2, v34, v35
v_max3_f32 v2, v2, v36, v37
v_max3_f32 v2, v2, v38, v39
v_max3_f32 v3, v3, v40, v41
v_max3_f32 v3, v3, v42, v43
v_max3_f32 v3, v3, v44, v45
v_max3_f32 v3, v3, v46, v47
v_max3_f32 v4, v4, v48, v49
v_max3_f32 v4, v4, v50, v51
v_max3_f32 v4, v4, v52, v53
v_max3_f32 v4, v4, v54, v55
s_barrier
s_add_u32 s61, s61, 1
s_cmp_lt_u32 s61, 16
s_cbranch_scc1 L_slow1_max
v_mov_b32 v8, v0
s_nop 1
v_permlane32_swap_b32 v8, v0
s_nop 1
v_max_f32 v0, v8, v0
v_mov_b32 v8, v0
s_nop 1
v_permlane16_swap_b32 v8, v0
s_nop 1
v_max_f32 v0, v8, v0
v_mov_b32 v90, 0
v_mov_b32 v8, v1
s_nop 1
v_permlane32_swap_b32 v8, v1
s_nop 1
v_max_f32 v1, v8, v1
v_mov_b32 v8, v1
s_nop 1
v_permlane16_swap_b32 v8, v1
s_nop 1
v_max_f32 v1, v8, v1
v_mov_b32 v91, 0
v_mov_b32 v8, v2
s_nop 1
v_permlane32_swap_b32 v8, v2
s_nop 1
v_max_f32 v2, v8, v2
v_mov_b32 v8, v2
s_nop 1
v_permlane16_swap_b32 v8, v2
s_nop 1
v_max_f32 v2, v8, v2
v_mov_b32 v92, 0
v_mov_b32 v8, v3
s_nop 1
v_permlane32_swap_b32 v8, v3
s_nop 1
v_max_f32 v3, v8, v3
v_mov_b32 v8, v3
s_nop 1
v_permlane16_swap_b32 v8, v3
s_nop 1
v_max_f32 v3, v8, v3
v_mov_b32 v93, 0
v_mov_b32 v8, v4
s_nop 1
v_permlane32_swap_b32 v8, v4
s_nop 1
v_max_f32 v4, v8, v4
v_mov_b32 v8, v4
s_nop 1
v_permlane16_swap_b32 v8, v4
s_nop 1
v_max_f32 v4, v8, v4
v_mov_b32 v94, 0
v_mov_b32 v96, 0
v_mov_b32 v97, 0
v_mov_b32 v98, 0
v_mov_b32 v99, 0
v_mov_b32 v100, 0
v_mov_b32 v101, 0
v_mov_b32 v102, 0
v_mov_b32 v103, 0
v_mov_b32 v104, 0
v_mov_b32 v105, 0
v_mov_b32 v106, 0
v_mov_b32 v107, 0
v_mov_b32 v108, 0
v_mov_b32 v109, 0
v_mov_b32 v110, 0
v_mov_b32 v111, 0
v_mov_b32 v112, 0
v_mov_b32 v113, 0
v_mov_b32 v114, 0
v_mov_b32 v115, 0
v_mov_b32 v116, 0
v_mov_b32 v117, 0
v_mov_b32 v118, 0
v_mov_b32 v119, 0
v_mov_b32 v120, 0
v_mov_b32 v121, 0
v_mov_b32 v122, 0
v_mov_b32 v123, 0
v_mov_b32 v124, 0
v_mov_b32 v125, 0
v_mov_b32 v126, 0
v_mov_b32 v127, 0
v_mov_b32 v128, 0
v_mov_b32 v129, 0
v_mov_b32 v130, 0
v_mov_b32 v131, 0
v_mov_b32 v132, 0
v_mov_b32 v133, 0
v_mov_b32 v134, 0
v_mov_b32 v135, 0
v_mov_b32 v136, 0
v_mov_b32 v137, 0
v_mov_b32 v138, 0
v_mov_b32 v139, 0
v_mov_b32 v140, 0
v_mov_b32 v141, 0
v_mov_b32 v142, 0
v_mov_b32 v143, 0
v_mov_b32 v144, 0
v_mov_b32 v145, 0
v_mov_b32 v146, 0
v_mov_b32 v147, 0
v_mov_b32 v148, 0
v_mov_b32 v149, 0
v_mov_b32 v150, 0
v_mov_b32 v151, 0
v_mov_b32 v152, 0
v_mov_b32 v153, 0
v_mov_b32 v154, 0
v_mov_b32 v155, 0
v_mov_b32 v156, 0
v_mov_b32 v157, 0
v_mov_b32 v158, 0
v_mov_b32 v159, 0
v_mov_b32 v160, 0
v_mov_b32 v161, 0
v_mov_b32 v162, 0
v_mov_b32 v163, 0
v_mov_b32 v164, 0
v_mov_b32 v165, 0
v_mov_b32 v166, 0
v_mov_b32 v167, 0
v_mov_b32 v168, 0
v_mov_b32 v169, 0
v_mov_b32 v170, 0
v_mov_b32 v171, 0
v_mov_b32 v172, 0
v_mov_b32 v173, 0
v_mov_b32 v174, 0
v_mov_b32 v175, 0
v_mov_b32 v176, 0
v_mov_b32 v177, 0
v_mov_b32 v178, 0
v_mov_b32 v179, 0
v_mov_b32 v180, 0
v_mov_b32 v181, 0
v_mov_b32 v182, 0
v_mov_b32 v183, 0
v_mov_b32 v184, 0
v_mov_b32 v185, 0
v_mov_b32 v186, 0
v_mov_b32 v187, 0
v_mov_b32 v188, 0
v_mov_b32 v189, 0
v_mov_b32 v190, 0
v_mov_b32 v191, 0
v_mov_b32 v192, 0
v_mov_b32 v193, 0
v_mov_b32 v194, 0
v_mov_b32 v195, 0
v_mov_b32 v196, 0
v_mov_b32 v197, 0
v_mov_b32 v198, 0
v_mov_b32 v199, 0
v_mov_b32 v200, 0
v_mov_b32 v201, 0
v_mov_b32 v202, 0
v_mov_b32 v203, 0
v_mov_b32 v204, 0
v_mov_b32 v205, 0
v_mov_b32 v206, 0
v_mov_b32 v207, 0
v_mov_b32 v208, 0
v_mov_b32 v209, 0
v_mov_b32 v210, 0
v_mov_b32 v211, 0
v_mov_b32 v212, 0
v_mov_b32 v213, 0
v_mov_b32 v214, 0
v_mov_b32 v215, 0
v_mov_b32 v216, 0
v_mov_b32 v217, 0
v_mov_b32 v218, 0
v_mov_b32 v219, 0
v_mov_b32 v220, 0
v_mov_b32 v221, 0
v_mov_b32 v222, 0
v_mov_b32 v223, 0
v_mov_b32 v224, 0
v_mov_b32 v225, 0
v_mov_b32 v226, 0
v_mov_b32 v227, 0
v_mov_b32 v228, 0
v_mov_b32 v229, 0
v_mov_b32 v230, 0
v_mov_b32 v231, 0
v_mov_b32 v232, 0
v_mov_b32 v233, 0
v_mov_b32 v234, 0
v_mov_b32 v235, 0
v_mov_b32 v236, 0
v_mov_b32 v237, 0
v_mov_b32 v238, 0
v_mov_b32 v239, 0
v_mov_b32 v240, 0
v_mov_b32 v241, 0
v_mov_b32 v242, 0
v_mov_b32 v243, 0
v_mov_b32 v244, 0
v_mov_b32 v245, 0
v_mov_b32 v246, 0
v_mov_b32 v247, 0
v_mov_b32 v248, 0
v_mov_b32 v249, 0
v_mov_b32 v250, 0
v_mov_b32 v251, 0
v_mov_b32 v252, 0
v_mov_b32 v253, 0
v_mov_b32 v254, 0
v_mov_b32 v255, 0
s_mov_b32 s61, 0
L_slow1_att:
s_add_u32 m0, s36, 0
s_lshl_b32 s44, s61, 12
s_and_b32 s45, s44, 61440
s_add_u32 s44, s44, s45
s_add_u32 s44, s44, s32
s_add_u32 s44, s44, 262144
buffer_load_dwordx4 v69, s[12:15], s44 offen offset:0 lds
buffer_load_dwordx4 v70, s[12:15], s44 offen offset:1024 lds
buffer_load_dwordx4 v69, s[12:15], s44 offen offset:2048 lds
buffer_load_dwordx4 v70, s[12:15], s44 offen offset:3072 lds
s_add_u32 m0, s36, 65536
s_lshl_b32 s44, s61, 12
s_and_b32 s45, s44, 61440
s_add_u32 s44, s44, s45
s_add_u32 s44, s44, s32
s_add_u32 s44, s44, 262144
buffer_load_dwordx4 v69, s[16:19], s44 offen offset:0 lds
buffer_load_dwordx4 v70, s[16:19], s44 offen offset:1024 lds
buffer_load_dwordx4 v69, s[16:19], s44 offen offset:2048 lds
buffer_load_dwordx4 v70, s[16:19], s44 offen offset:3072 lds
s_waitcnt vmcnt(0)
s_barrier
ds_read_b128 a[160:163], v57 offset:0
ds_read_b128 a[164:167], v58 offset:0
ds_read_b128 a[168:171], v59 offset:0
ds_read_b128 a[172:175], v60 offset:0
ds_read_b128 a[176:179], v57 offset:4096
ds_read_b128 a[180:183], v58 offset:4096
ds_read_b128 a[184:187], v59 offset:4096
ds_read_b128 a[188:191], v60 offset:4096
s_waitcnt lgkmcnt(0)
M v[16:19], a[160:163], a[0:3], 0
M v[16:19], a[164:167], a[20:23], v[16:19]
M v[16:19], a[168:171], a[40:43], v[16:19]
M v[16:19], a[172:175], a[60:63], v[16:19]
M v[24:27], a[160:163], a[4:7], 0
M v[24:27], a[164:167], a[24:27], v[24:27]
M v[24:27], a[168:171], a[44:47], v[24:27]
M v[24:27], a[172:175], a[64:67], v[24:27]
M v[32:35], a[160:163], a[8:11], 0
M v[32:35], a[164:167], a[28:31], v[32:35]
M v[32:35], a[168:171], a[48:51], v[32:35]
M v[32:35], a[172:175], a[68:71], v[32:35]
M v[40:43], a[160:163], a[12:15], 0
M v[40:43], a[164:167], a[32:35], v[40:43]
M v[40:43], a[168:171], a[52:55], v[40:43]
M v[40:43], a[172:175], a[72:75], v[40:43]
M v[48:51], a[160:163], a[16:19], 0
M v[48:51], a[164:167], a[36:39], v[48:51]
M v[48:51], a[168:171], a[56:59], v[48:51]
M v[48:51], a[172:175], a[76:79], v[48:51]
M v[20:23], a[176:179], a[0:3], 0
M v[20:23], a[180:183], a[20:23], v[20:23]
M v[20:23], a[184:187], a[40:43], v[20:23]
M v[20:23], a[188:191], a[60:63], v[20:23]
M v[28:31], a[176:179], a[4:7], 0
M v[28:31], a[180:183], a[24:27], v[28:31]
M v[28:31], a[184:187], a[44:47], v[28:31]
M v[28:31], a[188:191], a[64:67], v[28:31]
M v[36:39], a[176:179], a[8:11], 0
M v[36:39], a[180:183], a[28:31], v[36:39]
M v[36:39], a[184:187], a[48:51], v[36:39]
M v[36:39], a[188:191], a[68:71], v[36:39]
M v[44:47], a[176:179], a[12:15], 0
M v[44:47], a[180:183], a[32:35], v[44:47]
M v[44:47], a[184:187], a[52:55], v[44:47]
M v[44:47], a[188:191], a[72:75], v[44:47]
M v[52:55], a[176:179], a[16:19], 0
M v[52:55], a[180:183], a[36:39], v[52:55]
M v[52:55], a[184:187], a[56:59], v[52:55]
M v[52:55], a[188:191], a[76:79], v[52:55]
s_nop 7
v_sub_f32 v16, v16, v0
v_sub_f32 v17, v17, v0
v_sub_f32 v18, v18, v0
v_sub_f32 v19, v19, v0
v_sub_f32 v20, v20, v0
v_sub_f32 v21, v21, v0
v_sub_f32 v22, v22, v0
v_sub_f32 v23, v23, v0
v_exp_f32 v16, v16
v_exp_f32 v17, v17
v_exp_f32 v18, v18
v_exp_f32 v19, v19
v_exp_f32 v20, v20
v_exp_f32 v21, v21
v_exp_f32 v22, v22
v_exp_f32 v23, v23
s_nop 0
v_add_f32 v90, v90, v16
v_add_f32 v90, v90, v17
v_add_f32 v90, v90, v18
v_add_f32 v90, v90, v19
v_add_f32 v90, v90, v20
v_add_f32 v90, v90, v21
v_add_f32 v90, v90, v22
v_add_f32 v90, v90, v23
v_cvt_pk_bf16_f32 v16, v16, v17
v_cvt_pk_bf16_f32 v17, v18, v19
v_cvt_pk_bf16_f32 v18, v20, v21
v_cvt_pk_bf16_f32 v19, v22, v23
v_sub_f32 v24, v24, v1
v_sub_f32 v25, v25, v1
v_sub_f32 v26, v26, v1
v_sub_f32 v27, v27, v1
v_sub_f32 v28, v28, v1
v_sub_f32 v29, v29, v1
v_sub_f32 v30, v30, v1
v_sub_f32 v31, v31, v1
v_exp_f32 v24, v24
v_exp_f32 v25, v25
v_exp_f32 v26, v26
v_exp_f32 v27, v27
v_exp_f32 v28, v28
v_exp_f32 v29, v29
v_exp_f32 v30, v30
v_exp_f32 v31, v31
s_nop 0
v_add_f32 v91, v91, v24
v_add_f32 v91, v91, v25
v_add_f32 v91, v91, v26
v_add_f32 v91, v91, v27
v_add_f32 v91, v91, v28
v_add_f32 v91, v91, v29
v_add_f32 v91, v91, v30
v_add_f32 v91, v91, v31
v_cvt_pk_bf16_f32 v24, v24, v25
v_cvt_pk_bf16_f32 v25, v26, v27
v_cvt_pk_bf16_f32 v26, v28, v29
v_cvt_pk_bf16_f32 v27, v30, v31
v_sub_f32 v32, v32, v2
v_sub_f32 v33, v33, v2
v_sub_f32 v34, v34, v2
v_sub_f32 v35, v35, v2
v_sub_f32 v36, v36, v2
v_sub_f32 v37, v37, v2
v_sub_f32 v38, v38, v2
v_sub_f32 v39, v39, v2
v_exp_f32 v32, v32
v_exp_f32 v33, v33
v_exp_f32 v34, v34
v_exp_f32 v35, v35
v_exp_f32 v36, v36
v_exp_f32 v37, v37
v_exp_f32 v38, v38
v_exp_f32 v39, v39
s_nop 0
v_add_f32 v92, v92, v32
v_add_f32 v92, v92, v33
v_add_f32 v92, v92, v34
v_add_f32 v92, v92, v35
v_add_f32 v92, v92, v36
v_add_f32 v92, v92, v37
v_add_f32 v92, v92, v38
v_add_f32 v92, v92, v39
v_cvt_pk_bf16_f32 v32, v32, v33
v_cvt_pk_bf16_f32 v33, v34, v35
v_cvt_pk_bf16_f32 v34, v36, v37
v_cvt_pk_bf16_f32 v35, v38, v39
v_sub_f32 v40, v40, v3
v_sub_f32 v41, v41, v3
v_sub_f32 v42, v42, v3
v_sub_f32 v43, v43, v3
v_sub_f32 v44, v44, v3
v_sub_f32 v45, v45, v3
v_sub_f32 v46, v46, v3
v_sub_f32 v47, v47, v3
v_exp_f32 v40, v40
v_exp_f32 v41, v41
v_exp_f32 v42, v42
v_exp_f32 v43, v43
v_exp_f32 v44, v44
v_exp_f32 v45, v45
v_exp_f32 v46, v46
v_exp_f32 v47, v47
s_nop 0
v_add_f32 v93, v93, v40
v_add_f32 v93, v93, v41
v_add_f32 v93, v93, v42
v_add_f32 v93, v93, v43
v_add_f32 v93, v93, v44
v_add_f32 v93, v93, v45
v_add_f32 v93, v93, v46
v_add_f32 v93, v93, v47
v_cvt_pk_bf16_f32 v40, v40, v41
v_cvt_pk_bf16_f32 v41, v42, v43
v_cvt_pk_bf16_f32 v42, v44, v45
v_cvt_pk_bf16_f32 v43, v46, v47
v_sub_f32 v48, v48, v4
v_sub_f32 v49, v49, v4
v_sub_f32 v50, v50, v4
v_sub_f32 v51, v51, v4
v_sub_f32 v52, v52, v4
v_sub_f32 v53, v53, v4
v_sub_f32 v54, v54, v4
v_sub_f32 v55, v55, v4
v_exp_f32 v48, v48
v_exp_f32 v49, v49
v_exp_f32 v50, v50
v_exp_f32 v51, v51
v_exp_f32 v52, v52
v_exp_f32 v53, v53
v_exp_f32 v54, v54
v_exp_f32 v55, v55
s_nop 0
v_add_f32 v94, v94, v48
v_add_f32 v94, v94, v49
v_add_f32 v94, v94, v50
v_add_f32 v94, v94, v51
v_add_f32 v94, v94, v52
v_add_f32 v94, v94, v53
v_add_f32 v94, v94, v54
v_add_f32 v94, v94, v55
v_cvt_pk_bf16_f32 v48, v48, v49
v_cvt_pk_bf16_f32 v49, v50, v51
v_cvt_pk_bf16_f32 v50, v52, v53
v_cvt_pk_bf16_f32 v51, v54, v55
ds_read_b64_tr_b16 a[192:193], v61 offset:0
ds_read_b64_tr_b16 a[194:195], v61 offset:4096
s_waitcnt lgkmcnt(0)
M v[96:99], a[192:195], v[16:19], v[96:99]
M v[100:103], a[192:195], v[24:27], v[100:103]
M v[104:107], a[192:195], v[32:35], v[104:107]
M v[108:111], a[192:195], v[40:43], v[108:111]
M v[112:115], a[192:195], v[48:51], v[112:115]
ds_read_b64_tr_b16 a[192:193], v62 offset:0
ds_read_b64_tr_b16 a[194:195], v62 offset:4096
s_waitcnt lgkmcnt(0)
M v[116:119], a[192:195], v[16:19], v[116:119]
M v[120:123], a[192:195], v[24:27], v[120:123]
M v[124:127], a[192:195], v[32:35], v[124:127]
M v[128:131], a[192:195], v[40:43], v[128:131]
M v[132:135], a[192:195], v[48:51], v[132:135]
ds_read_b64_tr_b16 a[192:193], v63 offset:0
ds_read_b64_tr_b16 a[194:195], v63 offset:4096
s_waitcnt lgkmcnt(0)
M v[136:139], a[192:195], v[16:19], v[136:139]
M v[140:143], a[192:195], v[24:27], v[140:143]
M v[144:147], a[192:195], v[32:35], v[144:147]
M v[148:151], a[192:195], v[40:43], v[148:151]
M v[152:155], a[192:195], v[48:51], v[152:155]
ds_read_b64_tr_b16 a[192:193], v64 offset:0
ds_read_b64_tr_b16 a[194:195], v64 offset:4096
s_waitcnt lgkmcnt(0)
M v[156:159], a[192:195], v[16:19], v[156:159]
M v[160:163], a[192:195], v[24:27], v[160:163]
M v[164:167], a[192:195], v[32:35], v[164:167]
M v[168:171], a[192:195], v[40:43], v[168:171]
M v[172:175], a[192:195], v[48:51], v[172:175]
ds_read_b64_tr_b16 a[192:193], v65 offset:0
ds_read_b64_tr_b16 a[194:195], v65 offset:4096
s_waitcnt lgkmcnt(0)
M v[176:179], a[192:195], v[16:19], v[176:179]
M v[180:183], a[192:195], v[24:27], v[180:183]
M v[184:187], a[192:195], v[32:35], v[184:187]
M v[188:191], a[192:195], v[40:43], v[188:191]
M v[192:195], a[192:195], v[48:51], v[192:195]
ds_read_b64_tr_b16 a[192:193], v66 offset:0
ds_read_b64_tr_b16 a[194:195], v66 offset:4096
s_waitcnt lgkmcnt(0)
M v[196:199], a[192:195], v[16:19], v[196:199]
M v[200:203], a[192:195], v[24:27], v[200:203]
M v[204:207], a[192:195], v[32:35], v[204:207]
M v[208:211], a[192:195], v[40:43], v[208:211]
M v[212:215], a[192:195], v[48:51], v[212:215]
ds_read_b64_tr_b16 a[192:193], v67 offset:0
ds_read_b64_tr_b16 a[194:195], v67 offset:4096
s_waitcnt lgkmcnt(0)
M v[216:219], a[192:195], v[16:19], v[216:219]
M v[220:223], a[192:195], v[24:27], v[220:223]
M v[224:227], a[192:195], v[32:35], v[224:227]
M v[228:231], a[192:195], v[40:43], v[228:231]
M v[232:235], a[192:195], v[48:51], v[232:235]
ds_read_b64_tr_b16 a[192:193], v68 offset:0
ds_read_b64_tr_b16 a[194:195], v68 offset:4096
s_waitcnt lgkmcnt(0)
M v[236:239], a[192:195], v[16:19], v[236:239]
M v[240:243], a[192:195], v[24:27], v[240:243]
M v[244:247], a[192:195], v[32:35], v[244:247]
M v[248:251], a[192:195], v[40:43], v[248:251]
M v[252:255], a[192:195], v[48:51], v[252:255]
s_barrier
s_add_u32 s61, s61, 1
s_cmp_lt_u32 s61, 16
s_cbranch_scc1 L_slow1_att
v_mov_b32 v0, v90
s_nop 1
v_permlane32_swap_b32 v0, v90
s_nop 1
v_add_f32 v90, v0, v90
v_mov_b32 v0, v90
s_nop 1
v_permlane16_swap_b32 v0, v90
s_nop 1
v_add_f32 v90, v0, v90
v_mov_b32 v1, v91
s_nop 1
v_permlane32_swap_b32 v1, v91
s_nop 1
v_add_f32 v91, v1, v91
v_mov_b32 v1, v91
s_nop 1
v_permlane16_swap_b32 v1, v91
s_nop 1
v_add_f32 v91, v1, v91
v_mov_b32 v2, v92
s_nop 1
v_permlane32_swap_b32 v2, v92
s_nop 1
v_add_f32 v92, v2, v92
v_mov_b32 v2, v92
s_nop 1
v_permlane16_swap_b32 v2, v92
s_nop 1
v_add_f32 v92, v2, v92
v_mov_b32 v3, v93
s_nop 1
v_permlane32_swap_b32 v3, v93
s_nop 1
v_add_f32 v93, v3, v93
v_mov_b32 v3, v93
s_nop 1
v_permlane16_swap_b32 v3, v93
s_nop 1
v_add_f32 v93, v3, v93
v_mov_b32 v4, v94
s_nop 1
v_permlane32_swap_b32 v4, v94
s_nop 1
v_add_f32 v94, v4, v94
v_mov_b32 v4, v94
s_nop 1
v_permlane16_swap_b32 v4, v94
s_nop 1
v_add_f32 v94, v4, v94
v_rcp_f32 v90, v90
v_rcp_f32 v91, v91
v_rcp_f32 v92, v92
v_rcp_f32 v93, v93
v_rcp_f32 v94, v94
s_add_u32 s46, s64, 0
s_add_u32 m0, s39, 131072
s_nop 0
buffer_load_dwordx4 v84, s[20:23], s46 offen lds
s_add_u32 s47, s64, 8192
s_add_u32 m0, s39, 132096
s_nop 0
buffer_load_dwordx4 v84, s[20:23], s47 offen lds
s_add_u32 s48, s64, 16384
s_add_u32 m0, s39, 133120
s_nop 0
buffer_load_dwordx4 v84, s[20:23], s48 offen lds
s_add_u32 s49, s64, 24576
s_add_u32 m0, s39, 134144
s_nop 0
buffer_load_dwordx4 v84, s[20:23], s49 offen lds
s_add_u32 s50, s64, 32768
s_add_u32 m0, s39, 135168
s_nop 0
buffer_load_dwordx4 v84, s[20:23], s50 offen lds
s_add_u32 s51, s64, 40960
s_add_u32 m0, s39, 136192
s_nop 0
buffer_load_dwordx4 v84, s[20:23], s51 offen lds
s_add_u32 s44, s64, 49152
s_add_u32 m0, s39, 137216
s_nop 0
buffer_load_dwordx4 v84, s[20:23], s44 offen lds
s_add_u32 s45, s64, 57344
s_add_u32 m0, s39, 138240
s_nop 0
buffer_load_dwordx4 v84, s[20:23], s45 offen lds
s_add_u32 s46, s65, 0
s_add_u32 m0, s39, 65536
s_nop 0
buffer_load_dwordx4 v84, s[20:23], s46 offen lds
s_add_u32 s47, s65, 8192
s_add_u32 m0, s39, 66560
s_nop 0
buffer_load_dwordx4 v84, s[20:23], s47 offen lds
s_add_u32 s48, s65, 16384
s_add_u32 m0, s39, 67584
s_nop 0
buffer_load_dwordx4 v84, s[20:23], s48 offen lds
s_add_u32 s49, s65, 24576
s_add_u32 m0, s39, 68608
s_nop 0
buffer_load_dwordx4 v84, s[20:23], s49 offen lds
s_add_u32 s50, s65, 32768
s_add_u32 m0, s39, 69632
s_nop 0
buffer_load_dwordx4 v84, s[20:23], s50 offen lds
s_add_u32 s51, s65, 40960
s_add_u32 m0, s39, 70656
s_nop 0
buffer_load_dwordx4 v84, s[20:23], s51 offen lds
s_add_u32 s44, s65, 49152
s_add_u32 m0, s39, 71680
s_nop 0
buffer_load_dwordx4 v84, s[20:23], s44 offen lds
s_add_u32 s45, s65, 57344
s_add_u32 m0, s39, 72704
s_nop 0
buffer_load_dwordx4 v84, s[20:23], s45 offen lds
ds_write_b128 v80, a[80:83] offset:0
ds_write_b128 v80, a[100:103] offset:4096
ds_write_b128 v80, a[120:123] offset:8192
ds_write_b128 v80, a[140:143] offset:12288
ds_write_b128 v80, a[84:87] offset:16384
ds_write_b128 v80, a[104:107] offset:20480
ds_write_b128 v80, a[124:127] offset:24576
ds_write_b128 v80, a[144:147] offset:28672
ds_write_b128 v80, a[88:91] offset:32768
ds_write_b128 v80, a[108:111] offset:36864
ds_write_b128 v80, a[128:131] offset:40960
ds_write_b128 v80, a[148:151] offset:45056
ds_write_b128 v80, a[92:95] offset:49152
ds_write_b128 v80, a[112:115] offset:53248
ds_write_b128 v80, a[132:135] offset:57344
s_waitcnt vmcnt(0) lgkmcnt(0)
s_barrier
s_nop 7
s_branch L_back1
L_spin:
s_mov_b32 s61, 0
L_spin1:
v_mov_b32 v56, s54
buffer_load_dword v56, v56, s[28:31], 0 offen sc1
s_add_u32 s61, s61, 1
s_waitcnt vmcnt(0)
v_readfirstlane_b32 s101, v56
s_lshr_b32 s44, s61, 11
s_nop 0
s_add_u32 s44, s44, s101
s_cmp_lt_u32 s44, 1024
s_cbranch_scc1 L_spin1
s_branch L_ready
L_redo:
s_mov_b32 s61, 0
L_poll2:
buffer_load_dword v91, v90, s[24:27], 0 offen sc1
s_add_u32 s61, s61, 1
s_waitcnt vmcnt(0)
v_cmp_ne_u32 vcc, 0, v91
s_lshr_b32 s49, s61, 18
s_bcnt1_i32_b64 s48, vcc
s_add_u32 s48, s48, s49
s_cmp_lt_u32 s48, 7
s_cbranch_scc1 L_poll2
buffer_load_dwordx4 a[208:211], v85, s[24:27], s32 offen offset:0 sc1
buffer_load_dwordx4 a[212:215], v85, s[24:27], s32 offen offset:1024 sc1
buffer_load_dwordx4 a[216:219], v85, s[24:27], s32 offen offset:2048 sc1
buffer_load_dwordx4 a[220:223], v85, s[24:27], s32 offen offset:3072 sc1
buffer_load_dwordx4 a[224:227], v92, s[24:27], s32 offen offset:0 sc1
buffer_load_dwordx4 a[228:231], v85, s[24:27], s33 offen offset:0 sc1
buffer_load_dwordx4 a[232:235], v85, s[24:27], s33 offen offset:1024 sc1
buffer_load_dwordx4 a[236:239], v85, s[24:27], s33 offen offset:2048 sc1
buffer_load_dwordx4 a[240:243], v85, s[24:27], s33 offen offset:3072 sc1
buffer_load_dwordx4 a[244:247], v92, s[24:27], s33 offen offset:0 sc1
buffer_load_dwordx4 a[80:83], v85, s[24:27], s34 offen offset:0 sc1
buffer_load_dwordx4 a[84:87], v85, s[24:27], s34 offen offset:1024 sc1
buffer_load_dwordx4 a[88:91], v85, s[24:27], s34 offen offset:2048 sc1
buffer_load_dwordx4 a[92:95], v85, s[24:27], s34 offen offset:3072 sc1
buffer_load_dwordx4 a[96:99], v92, s[24:27], s34 offen offset:0 sc1
buffer_load_dwordx4 a[100:103], v85, s[24:27], s36 offen offset:0 sc1
buffer_load_dwordx4 a[104:107], v85, s[24:27], s36 offen offset:1024 sc1
buffer_load_dwordx4 a[108:111], v85, s[24:27], s36 offen offset:2048 sc1
buffer_load_dwordx4 a[112:115], v85, s[24:27], s36 offen offset:3072 sc1
buffer_load_dwordx4 a[116:119], v92, s[24:27], s36 offen offset:0 sc1
s_mov_b32 s50, 0x3f80
s_mov_b32 s51, 0x3f800000
s_waitcnt vmcnt(0)
v_accvgpr_read_b32 v216, a208
v_accvgpr_read_b32 v217, a209
v_accvgpr_read_b32 v218, a210
v_accvgpr_read_b32 v219, a211
v_accvgpr_read_b32 v220, a212
v_accvgpr_read_b32 v221, a213
v_accvgpr_read_b32 v222, a214
v_accvgpr_read_b32 v223, a215
v_accvgpr_read_b32 v224, a216
v_accvgpr_read_b32 v225, a217
v_accvgpr_read_b32 v226, a218
v_accvgpr_read_b32 v227, a219
v_accvgpr_read_b32 v228, a220
v_accvgpr_read_b32 v229, a221
v_accvgpr_read_b32 v230, a222
v_accvgpr_read_b32 v231, a223
v_accvgpr_read_b32 v232, a224
v_accvgpr_read_b32 v233, a225
v_accvgpr_read_b32 v234, a226
v_accvgpr_read_b32 v235, a227
v_dot2c_f32_bf16 v0, s50, v216
v_dot2c_f32_bf16 v1, s51, v216
v_dot2c_f32_bf16 v2, s50, v217
v_dot2c_f32_bf16 v3, s51, v217
v_dot2c_f32_bf16 v20, s50, v218
v_dot2c_f32_bf16 v21, s51, v218
v_dot2c_f32_bf16 v22, s50, v219
v_dot2c_f32_bf16 v23, s51, v219
v_dot2c_f32_bf16 v4, s50, v220
v_dot2c_f32_bf16 v5, s51, v220
v_dot2c_f32_bf16 v6, s50, v221
v_dot2c_f32_bf16 v7, s51, v221
v_dot2c_f32_bf16 v24, s50, v222
v_dot2c_f32_bf16 v25, s51, v222
v_dot2c_f32_bf16 v26, s50, v223
v_dot2c_f32_bf16 v27, s51, v223
v_dot2c_f32_bf16 v8, s50, v224
v_dot2c_f32_bf16 v9, s51, v224
v_dot2c_f32_bf16 v10, s50, v225
v_dot2c_f32_bf16 v11, s51, v225
v_dot2c_f32_bf16 v28, s50, v226
v_dot2c_f32_bf16 v29, s51, v226
v_dot2c_f32_bf16 v30, s50, v227
v_dot2c_f32_bf16 v31, s51, v227
v_dot2c_f32_bf16 v12, s50, v228
v_dot2c_f32_bf16 v13, s51, v228
v_dot2c_f32_bf16 v14, s50, v229
v_dot2c_f32_bf16 v15, s51, v229
v_dot2c_f32_bf16 v32, s50, v230
v_dot2c_f32_bf16 v33, s51, v230
v_dot2c_f32_bf16 v34, s50, v231
v_dot2c_f32_bf16 v35, s51, v231
v_dot2c_f32_bf16 v16, s50, v232
v_dot2c_f32_bf16 v17, s51, v232
v_dot2c_f32_bf16 v18, s50, v233
v_dot2c_f32_bf16 v19, s51, v233
v_dot2c_f32_bf16 v36, s50, v234
v_dot2c_f32_bf16 v37, s51, v234
v_dot2c_f32_bf16 v38, s50, v235
v_dot2c_f32_bf16 v39, s51, v235
s_branch L_all
L_codeend:
.p2align 12
.section .rodata,"a"
.p2align 6
.amdhsa_kernel concat_heads__mha_block_cached__gqa_block_cached__near_ridge_kernel
  .amdhsa_next_free_vgpr 512
  .amdhsa_next_free_sgpr 102
  .amdhsa_accum_offset 256
  .amdhsa_group_segment_fixed_size 0
  .amdhsa_kernarg_size 104
  .amdhsa_user_sgpr_count 2
  .amdhsa_user_sgpr_kernarg_segment_ptr 1
  .amdhsa_system_sgpr_workgroup_id_x 1
.end_amdhsa_kernel
```
